```python
import torch

def _softmax(x, axis=-1):
    return torch.softmax(x, dim=axis)

def _gelu(x):
    return torch.nn.functional.gelu(x, approximate='tanh')

def _silu(x):
    return torch.nn.functional.silu(x)

def _sigmoid(x):
    return torch.sigmoid(x)

def _layernorm(x, axis=-1, eps=1e-05):
    m = x.mean(dim=axis, keepdim=True)
    v = x.var(dim=axis, keepdim=True, unbiased=False)
    return (x - m) / torch.sqrt(v + eps)

def _scatter_add(tgt, idx, src, axis=0):
    return tgt.clone().index_add_(axis, idx, src)

def _segment_sum(src, seg, n):
    out = torch.zeros((n,) + src.shape[1:], dtype=src.dtype)
    return out.index_add_(0, seg, src)

def _pad(x, pw):
    flat = tuple((v for pair in reversed(pw) for v in pair))
    return torch.nn.functional.pad(x, flat)
kernel_name = 'gated_mix__softmax_full_mha__memory_aug_recurrent_mem_tr__prompt'

def setup_inputs():

    _w = lambda a: (lambda t: t.to(torch.bfloat16) if t.is_floating_point() else t)(torch.as_tensor(a))

    def _A_setup():
        B, S, D = (1, 2048, 448)
        return {'x': _w((lambda *s: torch.randn(*s, dtype=torch.bfloat16) * 0.05)(B, S, D)), 'wqkv': _w((lambda *s: torch.randn(*s, dtype=torch.bfloat16) * 1.6)(D, 3 * D)), 'wo': _w((lambda *s: torch.randn(*s, dtype=torch.bfloat16) * 0.05)(D, D))}
    _A_in = _A_setup()

    def _B_setup():
        B, S, Dm = (1, 2048, 448)
        H, Dh = (16, 256)
        M, seg = (8, 32)
        seg = min(seg, S)
        S = S // seg * seg
        return {'x': _w((lambda *s: torch.randn(*s, dtype=torch.bfloat16) * 0.05)(B, S, Dm)), 'mem0': _w((lambda *s: torch.randn(*s, dtype=torch.bfloat16) * 1.6)(B, M, Dm)), 'Wq': _w((lambda *s: torch.randn(*s, dtype=torch.bfloat16) * 0.8)(Dm, H, Dh) * Dm ** (-0.5)), 'Wk': _w((lambda *s: torch.randn(*s, dtype=torch.bfloat16) * 0.8)(Dm, H, Dh) * Dm ** (-0.5)), 'Wv': _w((lambda *s: torch.randn(*s, dtype=torch.bfloat16) * 1.6)(Dm, H, Dh) * Dm ** (-0.5)), 'Wo': _w((lambda *s: torch.randn(*s, dtype=torch.bfloat16) * 1.6)(H, Dh, Dm) * (H * Dh) ** (-0.5)), 'seg_len': seg}
    _B_in = _B_setup()
    return {'A_x': _A_in['x'], 'A_wqkv': _A_in['wqkv'], 'A_wo': _A_in['wo'], 'B_x': _B_in['x'], 'B_mem0': _B_in['mem0'], 'B_Wq': _B_in['Wq'], 'B_Wk': _B_in['Wk'], 'B_Wv': _B_in['Wv'], 'B_Wo': _B_in['Wo'], 'B_seg_len': _B_in['seg_len'], 'gate_w': _w((lambda *s: torch.randn(*s, dtype=torch.bfloat16) * 0.05)(448) * 16.0)}

def reference(A_x, A_wqkv, A_wo, B_x, B_mem0, B_Wq, B_Wk, B_Wv, B_Wo, B_seg_len, gate_w):

    def _A_ref(x, wqkv, wo):
        B, S, D = x.shape
        H = 16
        Dh = D // H
        qkv = (lambda x, *d: x.permute(*d))((x @ wqkv).reshape(B, S, 3, H, Dh), 2, 0, 3, 1, 4)
        q, k, v = (qkv[0], qkv[1], qkv[2])
        scale = Dh ** (-0.5)
        scores = torch.einsum('bhqd,bhkd->bhqk', q, k) * scale
        p = _softmax(scores, axis=-1)
        o = torch.einsum('bhqk,bhkd->bhqd', p, v)
        return (lambda x, *d: x.permute(*d))(o, 0, 2, 1, 3).reshape(B, S, D) @ wo

    def _B_ref(x, mem0, Wq, Wk, Wv, Wo, seg_len):
        B, S, Dm = x.shape
        H, Dh = (Wq.shape[1], Wq.shape[2])
        M = mem0.shape[1]
        scale = Dh ** (-0.5)
        n_seg = S // seg_len
        L = M + seg_len
        idx = torch.arange(L)
        mask = (idx[:, None] < M) | (idx[:, None] >= idx[None, :])
        mem = mem0
        outs = []
        for s in range(n_seg):
            xs = x[:, s * seg_len:(s + 1) * seg_len, :].clone()
            h = torch.concatenate([mem, xs], axis=1)
            q = torch.einsum('btd,dhe->bhte', h, Wq)
            k = torch.einsum('btd,dhe->bhte', h, Wk)
            v = torch.einsum('btd,dhe->bhte', h, Wv)
            scores = torch.einsum('bhqe,bhke->bhqk', q, k) * scale
            scores = torch.where(mask[None, None], scores, -1000000000.0)
            p = _softmax(scores, axis=-1)
            o = torch.einsum('bhqk,bhke->bhqe', p, v)
            o = torch.einsum('bhte,hed->btd', o, Wo)
            mem = o[:, :M, :].clone()
            outs.append(o[:, M:, :])
        return torch.concatenate(outs, axis=1)
    x = A_x
    g = _sigmoid((x * gate_w).sum(-1, keepdims=True))
    a = _A_ref(x, A_wqkv, A_wo)
    b = _B_ref(x, B_mem0, B_Wq, B_Wk, B_Wv, B_Wo, B_seg_len)
    return g * a + (1 - g) * b
```

```asm
; @launch grid=(256,1,1) block=(256,1,1) lds=163840
.amdgcn_target "amdgcn-amd-amdhsa--gfx950"
.text
.globl gated_mix__softmax_full_mha__memory_aug_recurrent_mem_tr__prompt_kernel
.p2align 8
.type gated_mix__softmax_full_mha__memory_aug_recurrent_mem_tr__prompt_kernel,@function
gated_mix__softmax_full_mha__memory_aug_recurrent_mem_tr__prompt_kernel:
  s_cmp_ge_u32 s2, 256
  s_cbranch_scc1 L_exit
  s_load_dwordx4 s[56:59], s[0:1], 96
  s_load_dwordx16 s[64:79], s[0:1], 0
  s_load_dwordx8 s[80:87], s[0:1], 64
  s_getreg_b32 s3, hwreg(HW_REG_XCC_ID)
  s_and_b32 s3, s3, 15
  v_lshrrev_b32 v1, 6, v0
  v_and_b32 v0, 63, v0
  s_nop 0
  v_readfirstlane_b32 s17, v1
  s_waitcnt lgkmcnt(0)
  s_mov_b32 s8, s86
  s_mov_b32 s9, s87
  s_mov_b32 s10, 1835008
  s_mov_b32 s11, 0x20000
  s_mov_b32 s12, s58
  s_mov_b32 s13, s59
  s_mov_b32 s14, 268435456
  s_mov_b32 s15, 0x20000
  s_add_u32 s4, s58, 46137344
  s_addc_u32 s5, s59, 0
  s_mov_b32 s6, 679936
  s_mov_b32 s7, 0x20000
  s_xor_b32 s40, s3, 3
  s_and_b32 s40, s40, 7
  s_mov_b32 s41, 1
  s_cmp_lg_u32 s17, 0
  s_cbranch_scc1 L_t0
  s_lshl_b32 s39, s40, 5
  s_cmp_ge_u32 s3, 8
  s_cselect_b32 s39, 8, s39
  s_atomic_add s41, s[56:57], s39 glc
L_t0:
  v_lshlrev_b32 v249, 7, v0
  s_lshl_b32 s38, s2, 2
  s_add_u32 s38, s38, s17
  s_cmp_lg_u32 s17, 3
  s_cbranch_scc1 tc_1
  s_getpc_b64 s[34:35]
  s_and_b32 s34, s34, 0xffffff00
  s_bfe_u32 s36, s2, 0x40003
  s_lshl_b32 s36, s36, 13
  v_add_u32 v6, s36, v249
  v_min_u32 v6, L_exit-gated_mix__softmax_full_mha__memory_aug_recurrent_mem_tr__prompt_kernel-512, v6
  global_load_dword v250, v6, s[34:35]
tc_1:
  v_lshlrev_b32 v3, 4, v0
  v_bfe_u32 v1, v0, 5, 1
  v_lshlrev_b32 v2, 0, v1
  v_xor_b32 v2, v2, v0
  v_and_b32 v2, 31, v2
  v_bfe_u32 v1, v0, 5, 1
  v_lshlrev_b32 v4, 13, v1
  v_lshl_add_u32 v4, v2, 4, v4
  v_bfe_u32 v1, v0, 4, 2
  v_lshlrev_b32 v2, 0, v1
  v_xor_b32 v2, v2, v0
  v_and_b32 v2, 15, v2
  v_bfe_u32 v1, v0, 0, 4
  v_lshlrev_b32 v5, 9, v1
  v_lshl_add_u32 v5, v2, 4, v5
  s_and_b32 s34, s17, 1
  s_lshl_b32 s34, s34, 14
  v_xor_b32 v6, 0, v5
  v_add_u32 v6, s34, v6
  v_xor_b32 v7, 64, v5
  v_add_u32 v7, s34, v7
  v_xor_b32 v8, 128, v5
  v_add_u32 v8, s34, v8
  v_xor_b32 v9, 192, v5
  v_add_u32 v9, s34, v9
  v_add_u32 v2, 0, v0
  v_mul_u32_u24 v1, 2341, v2
  v_lshrrev_b32 v1, 16, v1
  v_mul_u32_u24 v14, 28, v1
  v_sub_u32 v2, v2, v14
  v_lshrrev_b32 v14, 2, v1
  v_and_b32 v14, 2, v14
  v_xor_b32 v2, v2, v14
  v_mul_u32_u24 v1, 896, v1
  v_lshl_add_u32 v14, v2, 4, v1
  v_add_u32 v2, 64, v0
  v_mul_u32_u24 v1, 2341, v2
  v_lshrrev_b32 v1, 16, v1
  v_mul_u32_u24 v15, 28, v1
  v_sub_u32 v2, v2, v15
  v_lshrrev_b32 v15, 2, v1
  v_and_b32 v15, 2, v15
  v_xor_b32 v2, v2, v15
  v_mul_u32_u24 v1, 896, v1
  v_lshl_add_u32 v15, v2, 4, v1
  v_add_u32 v2, 128, v0
  v_mul_u32_u24 v1, 2341, v2
  v_lshrrev_b32 v1, 16, v1
  v_mul_u32_u24 v16, 28, v1
  v_sub_u32 v2, v2, v16
  v_lshrrev_b32 v16, 2, v1
  v_and_b32 v16, 2, v16
  v_xor_b32 v2, v2, v16
  v_mul_u32_u24 v1, 896, v1
  v_lshl_add_u32 v16, v2, 4, v1
  v_add_u32 v2, 192, v0
  v_mul_u32_u24 v1, 2341, v2
  v_lshrrev_b32 v1, 16, v1
  v_mul_u32_u24 v17, 28, v1
  v_sub_u32 v2, v2, v17
  v_lshrrev_b32 v17, 2, v1
  v_and_b32 v17, 2, v17
  v_xor_b32 v2, v2, v17
  v_mul_u32_u24 v1, 896, v1
  v_lshl_add_u32 v17, v2, 4, v1
  v_add_u32 v2, 256, v0
  v_mul_u32_u24 v1, 2341, v2
  v_lshrrev_b32 v1, 16, v1
  v_mul_u32_u24 v18, 28, v1
  v_sub_u32 v2, v2, v18
  v_lshrrev_b32 v18, 2, v1
  v_and_b32 v18, 2, v18
  v_xor_b32 v2, v2, v18
  v_mul_u32_u24 v1, 896, v1
  v_lshl_add_u32 v18, v2, 4, v1
  v_add_u32 v2, 320, v0
  v_mul_u32_u24 v1, 2341, v2
  v_lshrrev_b32 v1, 16, v1
  v_mul_u32_u24 v19, 28, v1
  v_sub_u32 v2, v2, v19
  v_lshrrev_b32 v19, 2, v1
  v_and_b32 v19, 2, v19
  v_xor_b32 v2, v2, v19
  v_mul_u32_u24 v1, 896, v1
  v_lshl_add_u32 v19, v2, 4, v1
  v_add_u32 v2, 384, v0
  v_mul_u32_u24 v1, 2341, v2
  v_lshrrev_b32 v1, 16, v1
  v_mul_u32_u24 v20, 28, v1
  v_sub_u32 v2, v2, v20
  v_lshrrev_b32 v20, 2, v1
  v_and_b32 v20, 2, v20
  v_xor_b32 v2, v2, v20
  v_mul_u32_u24 v1, 896, v1
  v_lshl_add_u32 v20, v2, 4, v1
  s_lshr_b32 s34, s17, 1
  v_bfe_u32 v1, v0, 4, 2
  v_lshlrev_b32 v2, 3, v1
  v_bfe_u32 v1, v0, 2, 2
  v_lshl_add_u32 v2, v1, 0, v2
  v_mul_u32_u24 v2, 448, v2
  s_mul_i32 s35, s34, 224
  v_bfe_u32 v1, v0, 0, 2
  v_lshlrev_b32 v10, 3, v1
  v_add_u32 v10, s35, v10
  v_add_u32 v10, 32768, v10
  v_add_u32 v10, v10, v2
  s_cmp_eq_u32 s34, 0
  s_cselect_b32 s35, 32, -32
  v_bfe_u32 v1, v0, 4, 1
  v_mul_i32_i24 v1, s35, v1
  v_sub_u32 v11, v10, v1
  v_add_u32 v10, v10, v1
  v_add_u32 v12, 57344, v10
  v_add_u32 v13, 57344, v11
  s_mul_i32 s35, s34, 57344
  s_add_u32 s35, s35, 32768
  v_xor_b32 v200, 0, v5
  v_add_u32 v200, s35, v200
  v_xor_b32 v201, 64, v5
  v_add_u32 v201, s35, v201
  v_xor_b32 v202, 128, v5
  v_add_u32 v202, s35, v202
  v_xor_b32 v203, 192, v5
  v_add_u32 v203, s35, v203
  s_and_b32 s35, s17, 1
  s_lshl_b32 s35, s35, 7
  v_xor_b32 v2, s35, v4
  v_xor_b32 v204, 0, v2
  v_xor_b32 v205, 32, v2
  v_xor_b32 v206, 64, v2
  v_xor_b32 v207, 96, v2
  s_cmp_lg_u32 s17, 0
  s_cbranch_scc1 L_notick
  s_waitcnt lgkmcnt(0)
  s_lshl_b32 s35, s40, 5
  s_add_u32 s35, s35, s41
  s_cmp_eq_u32 s39, 8
  s_cselect_b32 s41, 32, s41
  s_cmp_lt_u32 s41, 32
  s_cbranch_scc1 L_gottick
  s_mov_b32 s41, 1
  s_atomic_add s41, s[56:57], 4 glc
  s_waitcnt lgkmcnt(0)
  s_mov_b32 s23, 300000
  v_mbcnt_lo_u32_b32 v40, -1, 0
  v_cmp_gt_u32 vcc, 8, v40
  v_lshlrev_b32 v40, 5, v40
  s_nop 0
  v_cndmask_b32 v40, 4, v40, vcc
cs_2:
  global_load_dword v41, v40, s[56:57] sc1
  s_waitcnt vmcnt(0)
  v_min_u32 v42, 32, v41
  v_readlane_b32 s35, v41, 8
  v_readlane_b32 s34, v42, 0
  s_add_u32 s35, s35, s34
  v_readlane_b32 s34, v42, 1
  s_add_u32 s35, s35, s34
  v_readlane_b32 s34, v42, 2
  s_add_u32 s35, s35, s34
  v_readlane_b32 s34, v42, 3
  s_add_u32 s35, s35, s34
  v_readlane_b32 s34, v42, 4
  s_add_u32 s35, s35, s34
  v_readlane_b32 s34, v42, 5
  s_add_u32 s35, s35, s34
  v_readlane_b32 s34, v42, 6
  s_add_u32 s35, s35, s34
  v_readlane_b32 s34, v42, 7
  s_add_u32 s35, s35, s34
  s_cmp_ge_u32 s35, 256
  s_cbranch_scc1 L_all
  s_sub_u32 s23, s23, 1
  s_cbranch_scc0 cs_2
  s_branch L_exit
L_all:
  s_mov_b32 s35, 0
  v_readlane_b32 s34, v42, 0
  s_sub_u32 s36, 32, s34
  s_cmp_lt_u32 s41, s36
  s_cbranch_scc0 sl_3
  s_add_u32 s35, s34, s41
  s_add_u32 s35, s35, 0
sl_3:
  s_sub_u32 s41, s41, s36
  v_readlane_b32 s34, v42, 1
  s_sub_u32 s36, 32, s34
  s_cmp_lt_u32 s41, s36
  s_cbranch_scc0 sl_4
  s_add_u32 s35, s34, s41
  s_add_u32 s35, s35, 32
sl_4:
  s_sub_u32 s41, s41, s36
  v_readlane_b32 s34, v42, 2
  s_sub_u32 s36, 32, s34
  s_cmp_lt_u32 s41, s36
  s_cbranch_scc0 sl_5
  s_add_u32 s35, s34, s41
  s_add_u32 s35, s35, 64
sl_5:
  s_sub_u32 s41, s41, s36
  v_readlane_b32 s34, v42, 3
  s_sub_u32 s36, 32, s34
  s_cmp_lt_u32 s41, s36
  s_cbranch_scc0 sl_6
  s_add_u32 s35, s34, s41
  s_add_u32 s35, s35, 96
sl_6:
  s_sub_u32 s41, s41, s36
  v_readlane_b32 s34, v42, 4
  s_sub_u32 s36, 32, s34
  s_cmp_lt_u32 s41, s36
  s_cbranch_scc0 sl_7
  s_add_u32 s35, s34, s41
  s_add_u32 s35, s35, 128
sl_7:
  s_sub_u32 s41, s41, s36
  v_readlane_b32 s34, v42, 5
  s_sub_u32 s36, 32, s34
  s_cmp_lt_u32 s41, s36
  s_cbranch_scc0 sl_8
  s_add_u32 s35, s34, s41
  s_add_u32 s35, s35, 160
sl_8:
  s_sub_u32 s41, s41, s36
  v_readlane_b32 s34, v42, 6
  s_sub_u32 s36, 32, s34
  s_cmp_lt_u32 s41, s36
  s_cbranch_scc0 sl_9
  s_add_u32 s35, s34, s41
  s_add_u32 s35, s35, 192
sl_9:
  s_sub_u32 s41, s41, s36
  v_readlane_b32 s34, v42, 7
  s_sub_u32 s36, 32, s34
  s_cmp_lt_u32 s41, s36
  s_cbranch_scc0 sl_10
  s_add_u32 s35, s34, s41
  s_add_u32 s35, s35, 224
sl_10:
  s_sub_u32 s41, s41, s36
L_gottick:
  v_mov_b32 v2, s35
  v_mov_b32 v1, 147456
  ds_write_b32 v1, v2
  s_waitcnt lgkmcnt(0)
L_notick:
  s_barrier
  v_mov_b32 v1, 147456
  ds_read_b32 v2, v1
  s_waitcnt lgkmcnt(0)
  v_readfirstlane_b32 s46, v2
  s_and_b32 s46, s46, 255
  s_cmp_ge_u32 s46, 32
  s_cbranch_scc1 L_worker
  v_lshlrev_b32 v3, 4, v0
  s_and_b32 s18, s46, 15
  s_lshl_b32 s18, s18, 2
  s_add_u32 s18, s18, s17
  s_cmp_ge_u32 s46, 16
  s_cbranch_scc1 ini_11
  s_barrier
  s_mov_b32 s20, s74
  s_mov_b32 s21, s75
  s_mov_b32 s22, 3670016
  s_mov_b32 s23, 0x20000
  s_mov_b32 s24, s76
  s_mov_b32 s25, s77
  s_mov_b32 s26, 3670016
  s_mov_b32 s27, 0x20000
  v_xor_b32 v18, 0, v4
  v_xor_b32 v19, 32, v4
  v_xor_b32 v20, 64, v4
  v_xor_b32 v21, 96, v4
  v_xor_b32 v22, 128, v4
  v_xor_b32 v23, 160, v4
  v_xor_b32 v24, 192, v4
  v_xor_b32 v25, 224, v4
  s_and_b32 s19, s46, 15
  s_lshl_b32 s41, s19, 9
  s_mul_i32 s42, s17, 917504
  s_add_u32 s42, s42, s41
  s_lshl_b32 s47, s17, 14
  s_add_u32 s47, s47, 98304
  s_add_u32 m0, s47, 0
  s_add_u32 s44, s42, 0
  buffer_load_dwordx4 v18, s[24:27], s44 offen lds
  s_add_u32 m0, s47, 1024
  s_add_u32 s44, s42, 32768
  buffer_load_dwordx4 v19, s[24:27], s44 offen lds
  s_add_u32 m0, s47, 2048
  s_add_u32 s44, s42, 65536
  buffer_load_dwordx4 v20, s[24:27], s44 offen lds
  s_add_u32 m0, s47, 3072
  s_add_u32 s44, s42, 98304
  buffer_load_dwordx4 v21, s[24:27], s44 offen lds
  s_add_u32 m0, s47, 4096
  s_add_u32 s44, s42, 131072
  buffer_load_dwordx4 v22, s[24:27], s44 offen lds
  s_add_u32 m0, s47, 5120
  s_add_u32 s44, s42, 163840
  buffer_load_dwordx4 v23, s[24:27], s44 offen lds
  s_add_u32 m0, s47, 6144
  s_add_u32 s44, s42, 196608
  buffer_load_dwordx4 v24, s[24:27], s44 offen lds
  s_add_u32 m0, s47, 7168
  s_add_u32 s44, s42, 229376
  buffer_load_dwordx4 v25, s[24:27], s44 offen lds
  s_add_u32 m0, s47, 8192
  s_add_u32 s44, s42, 16384
  buffer_load_dwordx4 v18, s[24:27], s44 offen lds
  s_add_u32 m0, s47, 9216
  s_add_u32 s44, s42, 49152
  buffer_load_dwordx4 v19, s[24:27], s44 offen lds
  s_add_u32 m0, s47, 10240
  s_add_u32 s44, s42, 81920
  buffer_load_dwordx4 v20, s[24:27], s44 offen lds
  s_add_u32 m0, s47, 11264
  s_add_u32 s44, s42, 114688
  buffer_load_dwordx4 v21, s[24:27], s44 offen lds
  s_add_u32 m0, s47, 12288
  s_add_u32 s44, s42, 147456
  buffer_load_dwordx4 v22, s[24:27], s44 offen lds
  s_add_u32 m0, s47, 13312
  s_add_u32 s44, s42, 180224
  buffer_load_dwordx4 v23, s[24:27], s44 offen lds
  s_add_u32 m0, s47, 14336
  s_add_u32 s44, s42, 212992
  buffer_load_dwordx4 v24, s[24:27], s44 offen lds
  s_add_u32 m0, s47, 15360
  s_add_u32 s44, s42, 245760
  buffer_load_dwordx4 v25, s[24:27], s44 offen lds
  s_mul_i32 s34, s19, 52
  s_lshr_b32 s34, s34, 8
  s_mul_i32 s34, s34, 5
  s_sub_u32 s34, s19, s34
  s_lshl_b32 s33, s34, 6
  s_lshr_b32 s35, s17, 1
  s_lshl_b32 s35, s35, 5
  s_add_u32 s33, s33, s35
  s_and_b32 s35, s17, 1
  s_lshl_b32 s35, s35, 1
  s_add_u32 s33, s33, s35
  s_lshl_b32 s33, s33, 13
  s_add_u32 s33, s33, s41
  s_lshl_b32 s36, s17, 13
  s_add_u32 m0, s36, 0
  s_add_u32 s44, s33, 0
  buffer_load_dwordx4 v18, s[20:23], s44 offen lds
  s_add_u32 m0, s36, 1024
  s_add_u32 s44, s33, 65536
  buffer_load_dwordx4 v19, s[20:23], s44 offen lds
  s_add_u32 m0, s36, 2048
  s_add_u32 s44, s33, 32768
  buffer_load_dwordx4 v20, s[20:23], s44 offen lds
  s_add_u32 m0, s36, 3072
  s_add_u32 s44, s33, 98304
  buffer_load_dwordx4 v21, s[20:23], s44 offen lds
  s_add_u32 m0, s36, 4096
  s_add_u32 s44, s33, 131072
  buffer_load_dwordx4 v22, s[20:23], s44 offen lds
  s_add_u32 m0, s36, 5120
  s_add_u32 s44, s33, 196608
  buffer_load_dwordx4 v23, s[20:23], s44 offen lds
  s_add_u32 m0, s36, 6144
  s_add_u32 s44, s33, 163840
  buffer_load_dwordx4 v24, s[20:23], s44 offen lds
  s_add_u32 m0, s36, 7168
  s_add_u32 s44, s33, 229376
  buffer_load_dwordx4 v25, s[20:23], s44 offen lds
  s_mov_b32 s45, 0x3db8aa3b
  v_xor_b32 v6, 0, v5
  v_add_u32 v10, 49152, v6
  v_add_u32 v14, s47, v6
  v_xor_b32 v7, 64, v5
  v_add_u32 v11, 49152, v7
  v_add_u32 v15, s47, v7
  v_xor_b32 v8, 128, v5
  v_add_u32 v12, 49152, v8
  v_add_u32 v16, s47, v8
  v_xor_b32 v9, 192, v5
  v_add_u32 v13, 49152, v9
  v_add_u32 v17, s47, v9
  v_lshrrev_b32 v26, 5, v0
  v_mul_u32_u24 v2, 16, v26
  v_sub_u32 v2, 32, v2
  v_mul_u32_u24 v26, 132, v26
  s_add_u32 m0, s36, 32768
  s_add_u32 s44, s33, 524288
  buffer_load_dwordx4 v18, s[20:23], s44 offen lds
  s_add_u32 m0, s36, 33792
  s_add_u32 s44, s33, 589824
  buffer_load_dwordx4 v19, s[20:23], s44 offen lds
  s_add_u32 m0, s36, 34816
  s_add_u32 s44, s33, 557056
  buffer_load_dwordx4 v20, s[20:23], s44 offen lds
  s_add_u32 m0, s36, 35840
  s_add_u32 s44, s33, 622592
  buffer_load_dwordx4 v21, s[20:23], s44 offen lds
  s_add_u32 m0, s36, 36864
  s_add_u32 s44, s33, 655360
  buffer_load_dwordx4 v22, s[20:23], s44 offen lds
  s_add_u32 m0, s36, 37888
  s_add_u32 s44, s33, 720896
  buffer_load_dwordx4 v23, s[20:23], s44 offen lds
  s_add_u32 m0, s36, 38912
  s_add_u32 s44, s33, 688128
  buffer_load_dwordx4 v24, s[20:23], s44 offen lds
  s_add_u32 m0, s36, 39936
  s_add_u32 s44, s33, 753664
  buffer_load_dwordx4 v25, s[20:23], s44 offen lds
  s_waitcnt vmcnt(24)
  ds_read_b128 v[28:31], v14 offset:0
  ds_read_b128 v[32:35], v15 offset:0
  ds_read_b128 v[36:39], v16 offset:0
  ds_read_b128 v[40:43], v17 offset:0
  ds_read_b128 v[44:47], v14 offset:256
  ds_read_b128 v[48:51], v15 offset:256
  ds_read_b128 v[52:55], v16 offset:256
  ds_read_b128 v[56:59], v17 offset:256
  s_waitcnt lgkmcnt(0)
  s_waitcnt vmcnt(16)
  ds_read_b128 v[60:63], v14 offset:8192
  ds_read_b128 v[64:67], v15 offset:8192
  ds_read_b128 v[68:71], v16 offset:8192
  ds_read_b128 v[72:75], v17 offset:8192
  ds_read_b128 v[76:79], v14 offset:8448
  ds_read_b128 v[80:83], v15 offset:8448
  ds_read_b128 v[84:87], v16 offset:8448
  ds_read_b128 v[88:91], v17 offset:8448
  s_waitcnt lgkmcnt(0)
  s_waitcnt vmcnt(8)
  s_barrier
  ds_read_b128 v[92:95], v6 offset:0
  ds_read_b128 v[96:99], v6 offset:8192
  ds_read_b128 v[100:103], v7 offset:0
  ds_read_b128 v[104:107], v7 offset:8192
  s_waitcnt lgkmcnt(3)
  v_mfma_f32_16x16x32_bf16 v[144:147], v[92:95], v[28:31], 0
  ds_read_b128 v[108:111], v8 offset:0
  v_mfma_f32_16x16x32_bf16 v[152:155], v[92:95], v[60:63], 0
  s_waitcnt lgkmcnt(3)
  v_mfma_f32_16x16x32_bf16 v[148:151], v[96:99], v[28:31], 0
  ds_read_b128 v[112:115], v8 offset:8192
  v_mfma_f32_16x16x32_bf16 v[156:159], v[96:99], v[60:63], 0
  s_waitcnt lgkmcnt(3)
  v_mfma_f32_16x16x32_bf16 v[144:147], v[100:103], v[32:35], v[144:147]
  ds_read_b128 v[92:95], v9 offset:0
  v_mfma_f32_16x16x32_bf16 v[152:155], v[100:103], v[64:67], v[152:155]
  s_add_u32 m0, s36, 65536
  s_add_u32 s44, s33, 1048576
  buffer_load_dwordx4 v18, s[20:23], s44 offen lds
  s_waitcnt lgkmcnt(3)
  v_mfma_f32_16x16x32_bf16 v[148:151], v[104:107], v[32:35], v[148:151]
  ds_read_b128 v[96:99], v9 offset:8192
  v_mfma_f32_16x16x32_bf16 v[156:159], v[104:107], v[64:67], v[156:159]
  s_waitcnt lgkmcnt(3)
  v_mfma_f32_16x16x32_bf16 v[144:147], v[108:111], v[36:39], v[144:147]
  ds_read_b128 v[100:103], v6 offset:256
  v_mfma_f32_16x16x32_bf16 v[152:155], v[108:111], v[68:71], v[152:155]
  s_waitcnt lgkmcnt(3)
  v_mfma_f32_16x16x32_bf16 v[148:151], v[112:115], v[36:39], v[148:151]
  ds_read_b128 v[104:107], v6 offset:8448
  v_mfma_f32_16x16x32_bf16 v[156:159], v[112:115], v[68:71], v[156:159]
  s_add_u32 m0, s36, 66560
  s_add_u32 s44, s33, 1114112
  buffer_load_dwordx4 v19, s[20:23], s44 offen lds
  s_waitcnt lgkmcnt(3)
  v_mfma_f32_16x16x32_bf16 v[144:147], v[92:95], v[40:43], v[144:147]
  ds_read_b128 v[108:111], v7 offset:256
  v_mfma_f32_16x16x32_bf16 v[152:155], v[92:95], v[72:75], v[152:155]
  s_waitcnt lgkmcnt(3)
  v_mfma_f32_16x16x32_bf16 v[148:151], v[96:99], v[40:43], v[148:151]
  ds_read_b128 v[112:115], v7 offset:8448
  v_mfma_f32_16x16x32_bf16 v[156:159], v[96:99], v[72:75], v[156:159]
  s_waitcnt lgkmcnt(3)
  v_mfma_f32_16x16x32_bf16 v[144:147], v[100:103], v[44:47], v[144:147]
  ds_read_b128 v[92:95], v8 offset:256
  v_mfma_f32_16x16x32_bf16 v[152:155], v[100:103], v[76:79], v[152:155]
  s_add_u32 m0, s36, 67584
  s_add_u32 s44, s33, 1081344
  buffer_load_dwordx4 v20, s[20:23], s44 offen lds
  s_waitcnt lgkmcnt(3)
  v_mfma_f32_16x16x32_bf16 v[148:151], v[104:107], v[44:47], v[148:151]
  ds_read_b128 v[96:99], v8 offset:8448
  v_mfma_f32_16x16x32_bf16 v[156:159], v[104:107], v[76:79], v[156:159]
  s_waitcnt lgkmcnt(3)
  v_mfma_f32_16x16x32_bf16 v[144:147], v[108:111], v[48:51], v[144:147]
  ds_read_b128 v[100:103], v9 offset:256
  v_mfma_f32_16x16x32_bf16 v[152:155], v[108:111], v[80:83], v[152:155]
  s_waitcnt lgkmcnt(3)
  v_mfma_f32_16x16x32_bf16 v[148:151], v[112:115], v[48:51], v[148:151]
  ds_read_b128 v[104:107], v9 offset:8448
  v_mfma_f32_16x16x32_bf16 v[156:159], v[112:115], v[80:83], v[156:159]
  s_add_u32 m0, s36, 68608
  s_add_u32 s44, s33, 1146880
  buffer_load_dwordx4 v21, s[20:23], s44 offen lds
  s_waitcnt lgkmcnt(3)
  v_mfma_f32_16x16x32_bf16 v[144:147], v[92:95], v[52:55], v[144:147]
  ds_read_b128 v[108:111], v6 offset:16384
  v_mfma_f32_16x16x32_bf16 v[152:155], v[92:95], v[84:87], v[152:155]
  s_waitcnt lgkmcnt(3)
  v_mfma_f32_16x16x32_bf16 v[148:151], v[96:99], v[52:55], v[148:151]
  ds_read_b128 v[112:115], v6 offset:24576
  v_mfma_f32_16x16x32_bf16 v[156:159], v[96:99], v[84:87], v[156:159]
  s_waitcnt lgkmcnt(3)
  v_mfma_f32_16x16x32_bf16 v[144:147], v[100:103], v[56:59], v[144:147]
  ds_read_b128 v[92:95], v7 offset:16384
  v_mfma_f32_16x16x32_bf16 v[152:155], v[100:103], v[88:91], v[152:155]
  s_add_u32 m0, s36, 69632
  s_add_u32 s44, s33, 1179648
  buffer_load_dwordx4 v22, s[20:23], s44 offen lds
  s_waitcnt lgkmcnt(3)
  v_mfma_f32_16x16x32_bf16 v[148:151], v[104:107], v[56:59], v[148:151]
  ds_read_b128 v[96:99], v7 offset:24576
  v_mfma_f32_16x16x32_bf16 v[156:159], v[104:107], v[88:91], v[156:159]
  s_waitcnt lgkmcnt(3)
  v_mfma_f32_16x16x32_bf16 v[160:163], v[108:111], v[28:31], 0
  ds_read_b128 v[100:103], v8 offset:16384
  v_mfma_f32_16x16x32_bf16 v[168:171], v[108:111], v[60:63], 0
  s_waitcnt lgkmcnt(3)
  v_mfma_f32_16x16x32_bf16 v[164:167], v[112:115], v[28:31], 0
  ds_read_b128 v[104:107], v8 offset:24576
  v_mfma_f32_16x16x32_bf16 v[172:175], v[112:115], v[60:63], 0
  v_mul_f32 v144, s45, v144
  v_mul_f32 v145, s45, v145
  s_waitcnt lgkmcnt(3)
  v_mfma_f32_16x16x32_bf16 v[160:163], v[92:95], v[32:35], v[160:163]
  ds_read_b128 v[108:111], v9 offset:16384
  v_mul_f32 v146, s45, v146
  v_mul_f32 v147, s45, v147
  v_mfma_f32_16x16x32_bf16 v[168:171], v[92:95], v[64:67], v[168:171]
  s_add_u32 m0, s36, 70656
  s_add_u32 s44, s33, 1245184
  buffer_load_dwordx4 v23, s[20:23], s44 offen lds
  v_mul_f32 v148, s45, v148
  v_mul_f32 v149, s45, v149
  s_waitcnt lgkmcnt(3)
  v_mfma_f32_16x16x32_bf16 v[164:167], v[96:99], v[32:35], v[164:167]
  ds_read_b128 v[112:115], v9 offset:24576
  v_mul_f32 v150, s45, v150
  v_mfma_f32_16x16x32_bf16 v[172:175], v[96:99], v[64:67], v[172:175]
  v_mul_f32 v151, s45, v151
  s_waitcnt lgkmcnt(3)
  v_mfma_f32_16x16x32_bf16 v[160:163], v[100:103], v[36:39], v[160:163]
  ds_read_b128 v[92:95], v6 offset:16640
  v_cvt_pk_bf16_f32 v208, v144, v145
  v_mfma_f32_16x16x32_bf16 v[168:171], v[100:103], v[68:71], v[168:171]
  v_cvt_pk_bf16_f32 v209, v146, v147
  s_waitcnt lgkmcnt(3)
  v_mfma_f32_16x16x32_bf16 v[164:167], v[104:107], v[36:39], v[164:167]
  ds_read_b128 v[96:99], v6 offset:24832
  v_cvt_pk_bf16_f32 v210, v148, v149
  v_mfma_f32_16x16x32_bf16 v[172:175], v[104:107], v[68:71], v[172:175]
  s_add_u32 m0, s36, 71680
  s_add_u32 s44, s33, 1212416
  buffer_load_dwordx4 v24, s[20:23], s44 offen lds
  v_cvt_pk_bf16_f32 v211, v150, v151
  s_waitcnt lgkmcnt(3)
  v_mfma_f32_16x16x32_bf16 v[160:163], v[108:111], v[40:43], v[160:163]
  ds_read_b128 v[100:103], v7 offset:16640
  v_accvgpr_write_b32 a32, v208
  v_mfma_f32_16x16x32_bf16 v[168:171], v[108:111], v[72:75], v[168:171]
  v_accvgpr_write_b32 a33, v209
  s_waitcnt lgkmcnt(3)
  v_mfma_f32_16x16x32_bf16 v[164:167], v[112:115], v[40:43], v[164:167]
  ds_read_b128 v[104:107], v7 offset:24832
  v_accvgpr_write_b32 a34, v210
  v_mfma_f32_16x16x32_bf16 v[172:175], v[112:115], v[72:75], v[172:175]
  v_accvgpr_write_b32 a35, v211
  s_waitcnt lgkmcnt(3)
  v_mfma_f32_16x16x32_bf16 v[160:163], v[92:95], v[44:47], v[160:163]
  ds_read_b128 v[108:111], v8 offset:16640
  v_mul_f32 v152, s45, v152
  v_mfma_f32_16x16x32_bf16 v[168:171], v[92:95], v[76:79], v[168:171]
  s_add_u32 m0, s36, 72704
  s_add_u32 s44, s33, 1277952
  buffer_load_dwordx4 v25, s[20:23], s44 offen lds
  v_mul_f32 v153, s45, v153
  s_waitcnt lgkmcnt(3)
  v_mfma_f32_16x16x32_bf16 v[164:167], v[96:99], v[44:47], v[164:167]
  ds_read_b128 v[112:115], v8 offset:24832
  v_mul_f32 v154, s45, v154
  v_mfma_f32_16x16x32_bf16 v[172:175], v[96:99], v[76:79], v[172:175]
  v_mul_f32 v155, s45, v155
  s_waitcnt lgkmcnt(3)
  v_mfma_f32_16x16x32_bf16 v[160:163], v[100:103], v[48:51], v[160:163]
  ds_read_b128 v[92:95], v9 offset:16640
  v_mul_f32 v156, s45, v156
  v_mfma_f32_16x16x32_bf16 v[168:171], v[100:103], v[80:83], v[168:171]
  v_mul_f32 v157, s45, v157
  s_waitcnt lgkmcnt(3)
  v_mfma_f32_16x16x32_bf16 v[164:167], v[104:107], v[48:51], v[164:167]
  ds_read_b128 v[96:99], v9 offset:24832
  v_mul_f32 v158, s45, v158
  v_mfma_f32_16x16x32_bf16 v[172:175], v[104:107], v[80:83], v[172:175]
  s_add_u32 m0, s47, 0
  s_add_u32 s44, s42, 262144
  buffer_load_dwordx4 v18, s[24:27], s44 offen lds
  v_mul_f32 v159, s45, v159
  s_waitcnt lgkmcnt(3)
  v_mfma_f32_16x16x32_bf16 v[160:163], v[108:111], v[52:55], v[160:163]
  v_cvt_pk_bf16_f32 v212, v152, v153
  v_mfma_f32_16x16x32_bf16 v[168:171], v[108:111], v[84:87], v[168:171]
  v_cvt_pk_bf16_f32 v213, v154, v155
  s_waitcnt lgkmcnt(2)
  v_mfma_f32_16x16x32_bf16 v[164:167], v[112:115], v[52:55], v[164:167]
  v_cvt_pk_bf16_f32 v214, v156, v157
  v_mfma_f32_16x16x32_bf16 v[172:175], v[112:115], v[84:87], v[172:175]
  v_cvt_pk_bf16_f32 v215, v158, v159
  s_waitcnt lgkmcnt(1)
  v_mfma_f32_16x16x32_bf16 v[160:163], v[92:95], v[56:59], v[160:163]
  v_accvgpr_write_b32 a88, v212
  v_mfma_f32_16x16x32_bf16 v[168:171], v[92:95], v[88:91], v[168:171]
  s_add_u32 m0, s47, 1024
  s_add_u32 s44, s42, 294912
  buffer_load_dwordx4 v19, s[24:27], s44 offen lds
  v_accvgpr_write_b32 a89, v213
  s_waitcnt lgkmcnt(0)
  v_mfma_f32_16x16x32_bf16 v[164:167], v[96:99], v[56:59], v[164:167]
  v_accvgpr_write_b32 a90, v214
  v_mfma_f32_16x16x32_bf16 v[172:175], v[96:99], v[88:91], v[172:175]
  v_accvgpr_write_b32 a91, v215
  s_waitcnt vmcnt(10)
  s_barrier
  ds_read_b128 v[100:103], v6 offset:32768
  ds_read_b128 v[104:107], v6 offset:40960
  ds_read_b128 v[108:111], v7 offset:32768
  ds_read_b128 v[112:115], v7 offset:40960
  s_waitcnt lgkmcnt(3)
  v_mfma_f32_16x16x32_bf16 v[144:147], v[100:103], v[28:31], 0
  ds_read_b128 v[92:95], v8 offset:32768
  v_mfma_f32_16x16x32_bf16 v[152:155], v[100:103], v[60:63], 0
  s_waitcnt lgkmcnt(3)
  v_mfma_f32_16x16x32_bf16 v[148:151], v[104:107], v[28:31], 0
  ds_read_b128 v[96:99], v8 offset:40960
  v_mfma_f32_16x16x32_bf16 v[156:159], v[104:107], v[60:63], 0
  v_mul_f32 v160, s45, v160
  v_mul_f32 v161, s45, v161
  s_waitcnt lgkmcnt(3)
  v_mfma_f32_16x16x32_bf16 v[144:147], v[108:111], v[32:35], v[144:147]
  ds_read_b128 v[100:103], v9 offset:32768
  v_mul_f32 v162, s45, v162
  v_mul_f32 v163, s45, v163
  v_mfma_f32_16x16x32_bf16 v[152:155], v[108:111], v[64:67], v[152:155]
  s_add_u32 m0, s47, 2048
  s_add_u32 s44, s42, 327680
  buffer_load_dwordx4 v20, s[24:27], s44 offen lds
  v_mul_f32 v164, s45, v164
  v_mul_f32 v165, s45, v165
  s_waitcnt lgkmcnt(3)
  v_mfma_f32_16x16x32_bf16 v[148:151], v[112:115], v[32:35], v[148:151]
  ds_read_b128 v[104:107], v9 offset:40960
  v_mul_f32 v166, s45, v166
  v_mfma_f32_16x16x32_bf16 v[156:159], v[112:115], v[64:67], v[156:159]
  v_mul_f32 v167, s45, v167
  s_waitcnt lgkmcnt(3)
  v_mfma_f32_16x16x32_bf16 v[144:147], v[92:95], v[36:39], v[144:147]
  ds_read_b128 v[108:111], v6 offset:33024
  v_cvt_pk_bf16_f32 v216, v160, v161
  v_mfma_f32_16x16x32_bf16 v[152:155], v[92:95], v[68:71], v[152:155]
  v_cvt_pk_bf16_f32 v217, v162, v163
  s_waitcnt lgkmcnt(3)
  v_mfma_f32_16x16x32_bf16 v[148:151], v[96:99], v[36:39], v[148:151]
  ds_read_b128 v[112:115], v6 offset:41216
  v_cvt_pk_bf16_f32 v218, v164, v165
  v_mfma_f32_16x16x32_bf16 v[156:159], v[96:99], v[68:71], v[156:159]
  s_add_u32 m0, s47, 3072
  s_add_u32 s44, s42, 360448
  buffer_load_dwordx4 v21, s[24:27], s44 offen lds
  v_cvt_pk_bf16_f32 v219, v166, v167
  s_waitcnt lgkmcnt(3)
  v_mfma_f32_16x16x32_bf16 v[144:147], v[100:103], v[40:43], v[144:147]
  ds_read_b128 v[92:95], v7 offset:33024
  v_accvgpr_write_b32 a36, v216
  v_mfma_f32_16x16x32_bf16 v[152:155], v[100:103], v[72:75], v[152:155]
  v_accvgpr_write_b32 a37, v217
  s_waitcnt lgkmcnt(3)
  v_mfma_f32_16x16x32_bf16 v[148:151], v[104:107], v[40:43], v[148:151]
  ds_read_b128 v[96:99], v7 offset:41216
  v_accvgpr_write_b32 a38, v218
  v_mfma_f32_16x16x32_bf16 v[156:159], v[104:107], v[72:75], v[156:159]
  v_accvgpr_write_b32 a39, v219
  s_waitcnt lgkmcnt(3)
  v_mfma_f32_16x16x32_bf16 v[144:147], v[108:111], v[44:47], v[144:147]
  ds_read_b128 v[100:103], v8 offset:33024
  v_mul_f32 v168, s45, v168
  v_mfma_f32_16x16x32_bf16 v[152:155], v[108:111], v[76:79], v[152:155]
  s_add_u32 m0, s47, 4096
  s_add_u32 s44, s42, 393216
  buffer_load_dwordx4 v22, s[24:27], s44 offen lds
  v_mul_f32 v169, s45, v169
  s_waitcnt lgkmcnt(3)
  v_mfma_f32_16x16x32_bf16 v[148:151], v[112:115], v[44:47], v[148:151]
  ds_read_b128 v[104:107], v8 offset:41216
  v_mul_f32 v170, s45, v170
  v_mfma_f32_16x16x32_bf16 v[156:159], v[112:115], v[76:79], v[156:159]
  v_mul_f32 v171, s45, v171
  s_waitcnt lgkmcnt(3)
  v_mfma_f32_16x16x32_bf16 v[144:147], v[92:95], v[48:51], v[144:147]
  ds_read_b128 v[108:111], v9 offset:33024
  v_mul_f32 v172, s45, v172
  v_mfma_f32_16x16x32_bf16 v[152:155], v[92:95], v[80:83], v[152:155]
  v_mul_f32 v173, s45, v173
  s_waitcnt lgkmcnt(3)
  v_mfma_f32_16x16x32_bf16 v[148:151], v[96:99], v[48:51], v[148:151]
  ds_read_b128 v[112:115], v9 offset:41216
  v_mul_f32 v174, s45, v174
  v_mfma_f32_16x16x32_bf16 v[156:159], v[96:99], v[80:83], v[156:159]
  s_add_u32 m0, s47, 5120
  s_add_u32 s44, s42, 425984
  buffer_load_dwordx4 v23, s[24:27], s44 offen lds
  v_mul_f32 v175, s45, v175
  s_waitcnt lgkmcnt(3)
  v_mfma_f32_16x16x32_bf16 v[144:147], v[100:103], v[52:55], v[144:147]
  ds_read_b128 v[92:95], v10 offset:0
  v_cvt_pk_bf16_f32 v220, v168, v169
  v_mfma_f32_16x16x32_bf16 v[152:155], v[100:103], v[84:87], v[152:155]
  v_cvt_pk_bf16_f32 v221, v170, v171
  s_waitcnt lgkmcnt(3)
  v_mfma_f32_16x16x32_bf16 v[148:151], v[104:107], v[52:55], v[148:151]
  ds_read_b128 v[96:99], v10 offset:8192
  v_cvt_pk_bf16_f32 v222, v172, v173
  v_mfma_f32_16x16x32_bf16 v[156:159], v[104:107], v[84:87], v[156:159]
  v_cvt_pk_bf16_f32 v223, v174, v175
  s_waitcnt lgkmcnt(3)
  v_mfma_f32_16x16x32_bf16 v[144:147], v[108:111], v[56:59], v[144:147]
  ds_read_b128 v[100:103], v11 offset:0
  v_accvgpr_write_b32 a92, v220
  v_mfma_f32_16x16x32_bf16 v[152:155], v[108:111], v[88:91], v[152:155]
  s_add_u32 m0, s47, 6144
  s_add_u32 s44, s42, 458752
  buffer_load_dwordx4 v24, s[24:27], s44 offen lds
  v_accvgpr_write_b32 a93, v221
  s_waitcnt lgkmcnt(3)
  v_mfma_f32_16x16x32_bf16 v[148:151], v[112:115], v[56:59], v[148:151]
  ds_read_b128 v[104:107], v11 offset:8192
  v_accvgpr_write_b32 a94, v222
  v_mfma_f32_16x16x32_bf16 v[156:159], v[112:115], v[88:91], v[156:159]
  v_accvgpr_write_b32 a95, v223
  s_waitcnt lgkmcnt(3)
  v_mfma_f32_16x16x32_bf16 v[160:163], v[92:95], v[28:31], 0
  ds_read_b128 v[108:111], v12 offset:0
  v_mfma_f32_16x16x32_bf16 v[168:171], v[92:95], v[60:63], 0
  s_waitcnt lgkmcnt(3)
  v_mfma_f32_16x16x32_bf16 v[164:167], v[96:99], v[28:31], 0
  ds_read_b128 v[112:115], v12 offset:8192
  v_mfma_f32_16x16x32_bf16 v[172:175], v[96:99], v[60:63], 0
  v_mul_f32 v144, s45, v144
  v_mul_f32 v145, s45, v145
  s_waitcnt lgkmcnt(3)
  v_mfma_f32_16x16x32_bf16 v[160:163], v[100:103], v[32:35], v[160:163]
  ds_read_b128 v[92:95], v13 offset:0
  v_mul_f32 v146, s45, v146
  v_mul_f32 v147, s45, v147
  v_mfma_f32_16x16x32_bf16 v[168:171], v[100:103], v[64:67], v[168:171]
  s_add_u32 m0, s47, 7168
  s_add_u32 s44, s42, 491520
  buffer_load_dwordx4 v25, s[24:27], s44 offen lds
  v_mul_f32 v148, s45, v148
  v_mul_f32 v149, s45, v149
  s_waitcnt lgkmcnt(3)
  v_mfma_f32_16x16x32_bf16 v[164:167], v[104:107], v[32:35], v[164:167]
  ds_read_b128 v[96:99], v13 offset:8192
  v_mul_f32 v150, s45, v150
  v_mfma_f32_16x16x32_bf16 v[172:175], v[104:107], v[64:67], v[172:175]
  v_mul_f32 v151, s45, v151
  s_waitcnt lgkmcnt(3)
  v_mfma_f32_16x16x32_bf16 v[160:163], v[108:111], v[36:39], v[160:163]
  ds_read_b128 v[100:103], v10 offset:256
  v_cvt_pk_bf16_f32 v224, v144, v145
  v_mfma_f32_16x16x32_bf16 v[168:171], v[108:111], v[68:71], v[168:171]
  v_cvt_pk_bf16_f32 v225, v146, v147
  s_waitcnt lgkmcnt(3)
  v_mfma_f32_16x16x32_bf16 v[164:167], v[112:115], v[36:39], v[164:167]
  ds_read_b128 v[104:107], v10 offset:8448
  v_cvt_pk_bf16_f32 v226, v148, v149
  v_mfma_f32_16x16x32_bf16 v[172:175], v[112:115], v[68:71], v[172:175]
  s_add_u32 m0, s47, 8192
  s_add_u32 s44, s42, 278528
  buffer_load_dwordx4 v18, s[24:27], s44 offen lds
  v_cvt_pk_bf16_f32 v227, v150, v151
  s_waitcnt lgkmcnt(3)
  v_mfma_f32_16x16x32_bf16 v[160:163], v[92:95], v[40:43], v[160:163]
  ds_read_b128 v[108:111], v11 offset:256
  v_accvgpr_write_b32 a40, v224
  v_mfma_f32_16x16x32_bf16 v[168:171], v[92:95], v[72:75], v[168:171]
  v_accvgpr_write_b32 a41, v225
  s_waitcnt lgkmcnt(3)
  v_mfma_f32_16x16x32_bf16 v[164:167], v[96:99], v[40:43], v[164:167]
  ds_read_b128 v[112:115], v11 offset:8448
  v_accvgpr_write_b32 a42, v226
  v_mfma_f32_16x16x32_bf16 v[172:175], v[96:99], v[72:75], v[172:175]
  v_accvgpr_write_b32 a43, v227
  s_waitcnt lgkmcnt(3)
  v_mfma_f32_16x16x32_bf16 v[160:163], v[100:103], v[44:47], v[160:163]
  ds_read_b128 v[92:95], v12 offset:256
  v_mul_f32 v152, s45, v152
  v_mfma_f32_16x16x32_bf16 v[168:171], v[100:103], v[76:79], v[168:171]
  s_add_u32 m0, s47, 9216
  s_add_u32 s44, s42, 311296
  buffer_load_dwordx4 v19, s[24:27], s44 offen lds
  v_mul_f32 v153, s45, v153
  s_waitcnt lgkmcnt(3)
  v_mfma_f32_16x16x32_bf16 v[164:167], v[104:107], v[44:47], v[164:167]
  ds_read_b128 v[96:99], v12 offset:8448
  v_mul_f32 v154, s45, v154
  v_mfma_f32_16x16x32_bf16 v[172:175], v[104:107], v[76:79], v[172:175]
  v_mul_f32 v155, s45, v155
  s_waitcnt lgkmcnt(3)
  v_mfma_f32_16x16x32_bf16 v[160:163], v[108:111], v[48:51], v[160:163]
  ds_read_b128 v[100:103], v13 offset:256
  v_mul_f32 v156, s45, v156
  v_mfma_f32_16x16x32_bf16 v[168:171], v[108:111], v[80:83], v[168:171]
  v_mul_f32 v157, s45, v157
  s_waitcnt lgkmcnt(3)
  v_mfma_f32_16x16x32_bf16 v[164:167], v[112:115], v[48:51], v[164:167]
  ds_read_b128 v[104:107], v13 offset:8448
  v_mul_f32 v158, s45, v158
  v_mfma_f32_16x16x32_bf16 v[172:175], v[112:115], v[80:83], v[172:175]
  s_add_u32 m0, s47, 10240
  s_add_u32 s44, s42, 344064
  buffer_load_dwordx4 v20, s[24:27], s44 offen lds
  v_mul_f32 v159, s45, v159
  s_waitcnt lgkmcnt(3)
  v_mfma_f32_16x16x32_bf16 v[160:163], v[92:95], v[52:55], v[160:163]
  v_cvt_pk_bf16_f32 v228, v152, v153
  v_mfma_f32_16x16x32_bf16 v[168:171], v[92:95], v[84:87], v[168:171]
  v_cvt_pk_bf16_f32 v229, v154, v155
  s_waitcnt lgkmcnt(2)
  v_mfma_f32_16x16x32_bf16 v[164:167], v[96:99], v[52:55], v[164:167]
  v_cvt_pk_bf16_f32 v230, v156, v157
  v_mfma_f32_16x16x32_bf16 v[172:175], v[96:99], v[84:87], v[172:175]
  v_cvt_pk_bf16_f32 v231, v158, v159
  s_waitcnt lgkmcnt(1)
  v_mfma_f32_16x16x32_bf16 v[160:163], v[100:103], v[56:59], v[160:163]
  v_accvgpr_write_b32 a96, v228
  v_mfma_f32_16x16x32_bf16 v[168:171], v[100:103], v[88:91], v[168:171]
  s_add_u32 m0, s47, 11264
  s_add_u32 s44, s42, 376832
  buffer_load_dwordx4 v21, s[24:27], s44 offen lds
  v_accvgpr_write_b32 a97, v229
  s_waitcnt lgkmcnt(0)
  v_mfma_f32_16x16x32_bf16 v[164:167], v[104:107], v[56:59], v[164:167]
  v_accvgpr_write_b32 a98, v230
  v_mfma_f32_16x16x32_bf16 v[172:175], v[104:107], v[88:91], v[172:175]
  v_accvgpr_write_b32 a99, v231
  s_waitcnt vmcnt(12)
  s_barrier
  ds_read_b128 v[108:111], v10 offset:16384
  ds_read_b128 v[112:115], v10 offset:24576
  ds_read_b128 v[92:95], v11 offset:16384
  ds_read_b128 v[96:99], v11 offset:24576
  s_waitcnt lgkmcnt(3)
  v_mfma_f32_16x16x32_bf16 v[144:147], v[108:111], v[28:31], 0
  ds_read_b128 v[100:103], v12 offset:16384
  v_mfma_f32_16x16x32_bf16 v[152:155], v[108:111], v[60:63], 0
  s_waitcnt lgkmcnt(3)
  v_mfma_f32_16x16x32_bf16 v[148:151], v[112:115], v[28:31], 0
  ds_read_b128 v[104:107], v12 offset:24576
  v_mfma_f32_16x16x32_bf16 v[156:159], v[112:115], v[60:63], 0
  v_mul_f32 v160, s45, v160
  v_mul_f32 v161, s45, v161
  s_waitcnt lgkmcnt(3)
  v_mfma_f32_16x16x32_bf16 v[144:147], v[92:95], v[32:35], v[144:147]
  ds_read_b128 v[108:111], v13 offset:16384
  v_mul_f32 v162, s45, v162
  v_mul_f32 v163, s45, v163
  v_mfma_f32_16x16x32_bf16 v[152:155], v[92:95], v[64:67], v[152:155]
  s_add_u32 m0, s47, 12288
  s_add_u32 s44, s42, 409600
  buffer_load_dwordx4 v22, s[24:27], s44 offen lds
  v_mul_f32 v164, s45, v164
  v_mul_f32 v165, s45, v165
  s_waitcnt lgkmcnt(3)
  v_mfma_f32_16x16x32_bf16 v[148:151], v[96:99], v[32:35], v[148:151]
  ds_read_b128 v[112:115], v13 offset:24576
  v_mul_f32 v166, s45, v166
  v_mfma_f32_16x16x32_bf16 v[156:159], v[96:99], v[64:67], v[156:159]
  v_mul_f32 v167, s45, v167
  s_waitcnt lgkmcnt(3)
  v_mfma_f32_16x16x32_bf16 v[144:147], v[100:103], v[36:39], v[144:147]
  ds_read_b128 v[92:95], v10 offset:16640
  v_cvt_pk_bf16_f32 v200, v160, v161
  v_mfma_f32_16x16x32_bf16 v[152:155], v[100:103], v[68:71], v[152:155]
  v_cvt_pk_bf16_f32 v201, v162, v163
  s_waitcnt lgkmcnt(3)
  v_mfma_f32_16x16x32_bf16 v[148:151], v[104:107], v[36:39], v[148:151]
  ds_read_b128 v[96:99], v10 offset:24832
  v_cvt_pk_bf16_f32 v202, v164, v165
  v_mfma_f32_16x16x32_bf16 v[156:159], v[104:107], v[68:71], v[156:159]
  s_add_u32 m0, s47, 13312
  s_add_u32 s44, s42, 442368
  buffer_load_dwordx4 v23, s[24:27], s44 offen lds
  v_cvt_pk_bf16_f32 v203, v166, v167
  s_waitcnt lgkmcnt(3)
  v_mfma_f32_16x16x32_bf16 v[144:147], v[108:111], v[40:43], v[144:147]
  ds_read_b128 v[100:103], v11 offset:16640
  v_accvgpr_write_b32 a44, v200
  v_mfma_f32_16x16x32_bf16 v[152:155], v[108:111], v[72:75], v[152:155]
  v_accvgpr_write_b32 a45, v201
  s_waitcnt lgkmcnt(3)
  v_mfma_f32_16x16x32_bf16 v[148:151], v[112:115], v[40:43], v[148:151]
  ds_read_b128 v[104:107], v11 offset:24832
  v_accvgpr_write_b32 a46, v202
  v_mfma_f32_16x16x32_bf16 v[156:159], v[112:115], v[72:75], v[156:159]
  v_accvgpr_write_b32 a47, v203
  s_waitcnt lgkmcnt(3)
  v_mfma_f32_16x16x32_bf16 v[144:147], v[92:95], v[44:47], v[144:147]
  ds_read_b128 v[108:111], v12 offset:16640
  v_mul_f32 v168, s45, v168
  v_mfma_f32_16x16x32_bf16 v[152:155], v[92:95], v[76:79], v[152:155]
  s_add_u32 m0, s47, 14336
  s_add_u32 s44, s42, 475136
  buffer_load_dwordx4 v24, s[24:27], s44 offen lds
  v_mul_f32 v169, s45, v169
  s_waitcnt lgkmcnt(3)
  v_mfma_f32_16x16x32_bf16 v[148:151], v[96:99], v[44:47], v[148:151]
  ds_read_b128 v[112:115], v12 offset:24832
  v_mul_f32 v170, s45, v170
  v_mfma_f32_16x16x32_bf16 v[156:159], v[96:99], v[76:79], v[156:159]
  v_mul_f32 v171, s45, v171
  s_waitcnt lgkmcnt(3)
  v_mfma_f32_16x16x32_bf16 v[144:147], v[100:103], v[48:51], v[144:147]
  ds_read_b128 v[92:95], v13 offset:16640
  v_mul_f32 v172, s45, v172
  v_mfma_f32_16x16x32_bf16 v[152:155], v[100:103], v[80:83], v[152:155]
  v_mul_f32 v173, s45, v173
  s_waitcnt lgkmcnt(3)
  v_mfma_f32_16x16x32_bf16 v[148:151], v[104:107], v[48:51], v[148:151]
  ds_read_b128 v[96:99], v13 offset:24832
  v_mul_f32 v174, s45, v174
  v_mfma_f32_16x16x32_bf16 v[156:159], v[104:107], v[80:83], v[156:159]
  s_add_u32 m0, s47, 15360
  s_add_u32 s44, s42, 507904
  buffer_load_dwordx4 v25, s[24:27], s44 offen lds
  v_mul_f32 v175, s45, v175
  s_waitcnt lgkmcnt(3)
  v_mfma_f32_16x16x32_bf16 v[144:147], v[108:111], v[52:55], v[144:147]
  ds_read_b128 v[100:103], v10 offset:32768
  v_cvt_pk_bf16_f32 v204, v168, v169
  v_mfma_f32_16x16x32_bf16 v[152:155], v[108:111], v[84:87], v[152:155]
  v_cvt_pk_bf16_f32 v205, v170, v171
  s_waitcnt lgkmcnt(3)
  v_mfma_f32_16x16x32_bf16 v[148:151], v[112:115], v[52:55], v[148:151]
  ds_read_b128 v[104:107], v10 offset:40960
  v_cvt_pk_bf16_f32 v206, v172, v173
  v_mfma_f32_16x16x32_bf16 v[156:159], v[112:115], v[84:87], v[156:159]
  v_cvt_pk_bf16_f32 v207, v174, v175
  s_waitcnt lgkmcnt(3)
  v_mfma_f32_16x16x32_bf16 v[144:147], v[92:95], v[56:59], v[144:147]
  ds_read_b128 v[108:111], v11 offset:32768
  v_accvgpr_write_b32 a100, v204
  v_mfma_f32_16x16x32_bf16 v[152:155], v[92:95], v[88:91], v[152:155]
  v_accvgpr_write_b32 a101, v205
  s_waitcnt lgkmcnt(3)
  v_mfma_f32_16x16x32_bf16 v[148:151], v[96:99], v[56:59], v[148:151]
  ds_read_b128 v[112:115], v11 offset:40960
  v_accvgpr_write_b32 a102, v206
  v_mfma_f32_16x16x32_bf16 v[156:159], v[96:99], v[88:91], v[156:159]
  v_accvgpr_write_b32 a103, v207
  s_waitcnt lgkmcnt(3)
  v_mfma_f32_16x16x32_bf16 v[160:163], v[100:103], v[28:31], 0
  ds_read_b128 v[92:95], v12 offset:32768
  v_mfma_f32_16x16x32_bf16 v[168:171], v[100:103], v[60:63], 0
  s_waitcnt lgkmcnt(3)
  v_mfma_f32_16x16x32_bf16 v[164:167], v[104:107], v[28:31], 0
  ds_read_b128 v[96:99], v12 offset:40960
  v_mfma_f32_16x16x32_bf16 v[172:175], v[104:107], v[60:63], 0
  v_mul_f32 v144, s45, v144
  v_mul_f32 v145, s45, v145
  s_waitcnt lgkmcnt(3)
  v_mfma_f32_16x16x32_bf16 v[160:163], v[108:111], v[32:35], v[160:163]
  ds_read_b128 v[100:103], v13 offset:32768
  v_mul_f32 v146, s45, v146
  v_mul_f32 v147, s45, v147
  v_mfma_f32_16x16x32_bf16 v[168:171], v[108:111], v[64:67], v[168:171]
  v_mul_f32 v148, s45, v148
  v_mul_f32 v149, s45, v149
  s_waitcnt lgkmcnt(3)
  v_mfma_f32_16x16x32_bf16 v[164:167], v[112:115], v[32:35], v[164:167]
  ds_read_b128 v[104:107], v13 offset:40960
  v_mul_f32 v150, s45, v150
  v_mfma_f32_16x16x32_bf16 v[172:175], v[112:115], v[64:67], v[172:175]
  v_mul_f32 v151, s45, v151
  s_waitcnt lgkmcnt(3)
  v_mfma_f32_16x16x32_bf16 v[160:163], v[92:95], v[36:39], v[160:163]
  ds_read_b128 v[108:111], v10 offset:33024
  v_cvt_pk_bf16_f32 v208, v144, v145
  v_mfma_f32_16x16x32_bf16 v[168:171], v[92:95], v[68:71], v[168:171]
  v_cvt_pk_bf16_f32 v209, v146, v147
  s_waitcnt lgkmcnt(3)
  v_mfma_f32_16x16x32_bf16 v[164:167], v[96:99], v[36:39], v[164:167]
  ds_read_b128 v[112:115], v10 offset:41216
  v_cvt_pk_bf16_f32 v210, v148, v149
  v_mfma_f32_16x16x32_bf16 v[172:175], v[96:99], v[68:71], v[172:175]
  s_waitcnt vmcnt(8)
  ds_read_b128 a[0:3], v14 offset:0
  v_cvt_pk_bf16_f32 v211, v150, v151
  s_waitcnt lgkmcnt(4)
  v_mfma_f32_16x16x32_bf16 v[160:163], v[100:103], v[40:43], v[160:163]
  ds_read_b128 v[92:95], v11 offset:33024
  v_accvgpr_write_b32 a48, v208
  v_mfma_f32_16x16x32_bf16 v[168:171], v[100:103], v[72:75], v[168:171]
  v_accvgpr_write_b32 a49, v209
  s_waitcnt lgkmcnt(4)
  v_mfma_f32_16x16x32_bf16 v[164:167], v[104:107], v[40:43], v[164:167]
  ds_read_b128 v[96:99], v11 offset:41216
  v_accvgpr_write_b32 a50, v210
  v_mfma_f32_16x16x32_bf16 v[172:175], v[104:107], v[72:75], v[172:175]
  v_accvgpr_write_b32 a51, v211
  s_waitcnt lgkmcnt(4)
  v_mfma_f32_16x16x32_bf16 v[160:163], v[108:111], v[44:47], v[160:163]
  ds_read_b128 v[100:103], v12 offset:33024
  v_mul_f32 v152, s45, v152
  v_mfma_f32_16x16x32_bf16 v[168:171], v[108:111], v[76:79], v[168:171]
  ds_read_b128 a[4:7], v15 offset:0
  v_mul_f32 v153, s45, v153
  s_waitcnt lgkmcnt(5)
  v_mfma_f32_16x16x32_bf16 v[164:167], v[112:115], v[44:47], v[164:167]
  ds_read_b128 v[104:107], v12 offset:41216
  v_mul_f32 v154, s45, v154
  v_mfma_f32_16x16x32_bf16 v[172:175], v[112:115], v[76:79], v[172:175]
  v_mul_f32 v155, s45, v155
  s_waitcnt lgkmcnt(4)
  v_mfma_f32_16x16x32_bf16 v[160:163], v[92:95], v[48:51], v[160:163]
  ds_read_b128 v[108:111], v13 offset:33024
  v_mul_f32 v156, s45, v156
  v_mfma_f32_16x16x32_bf16 v[168:171], v[92:95], v[80:83], v[168:171]
  v_mul_f32 v157, s45, v157
  s_waitcnt lgkmcnt(4)
  v_mfma_f32_16x16x32_bf16 v[164:167], v[96:99], v[48:51], v[164:167]
  ds_read_b128 v[112:115], v13 offset:41216
  v_mul_f32 v158, s45, v158
  v_mfma_f32_16x16x32_bf16 v[172:175], v[96:99], v[80:83], v[172:175]
  ds_read_b128 a[8:11], v16 offset:0
  v_mul_f32 v159, s45, v159
  s_waitcnt lgkmcnt(5)
  v_mfma_f32_16x16x32_bf16 v[160:163], v[100:103], v[52:55], v[160:163]
  v_cvt_pk_bf16_f32 v212, v152, v153
  v_mfma_f32_16x16x32_bf16 v[168:171], v[100:103], v[84:87], v[168:171]
  v_cvt_pk_bf16_f32 v213, v154, v155
  s_waitcnt lgkmcnt(3)
  v_mfma_f32_16x16x32_bf16 v[164:167], v[104:107], v[52:55], v[164:167]
  v_cvt_pk_bf16_f32 v214, v156, v157
  v_mfma_f32_16x16x32_bf16 v[172:175], v[104:107], v[84:87], v[172:175]
  v_cvt_pk_bf16_f32 v215, v158, v159
  s_waitcnt lgkmcnt(2)
  v_mfma_f32_16x16x32_bf16 v[160:163], v[108:111], v[56:59], v[160:163]
  v_accvgpr_write_b32 a104, v212
  v_mfma_f32_16x16x32_bf16 v[168:171], v[108:111], v[88:91], v[168:171]
  ds_read_b128 a[12:15], v17 offset:0
  v_accvgpr_write_b32 a105, v213
  s_waitcnt lgkmcnt(2)
  v_mfma_f32_16x16x32_bf16 v[164:167], v[112:115], v[56:59], v[164:167]
  v_accvgpr_write_b32 a106, v214
  v_mfma_f32_16x16x32_bf16 v[172:175], v[112:115], v[88:91], v[172:175]
  v_accvgpr_write_b32 a107, v215
  ds_read_b128 a[16:19], v14 offset:256
  ds_read_b128 a[20:23], v15 offset:256
  ds_read_b128 a[24:27], v16 offset:256
  ds_read_b128 a[28:31], v17 offset:256
  s_waitcnt lgkmcnt(0)
  s_add_u32 m0, s47, 0
  s_add_u32 s44, s42, 524288
  buffer_load_dwordx4 v18, s[24:27], s44 offen lds
  s_add_u32 m0, s47, 1024
  s_add_u32 s44, s42, 557056
  buffer_load_dwordx4 v19, s[24:27], s44 offen lds
  s_add_u32 m0, s47, 2048
  s_add_u32 s44, s42, 589824
  buffer_load_dwordx4 v20, s[24:27], s44 offen lds
  s_add_u32 m0, s47, 3072
  s_add_u32 s44, s42, 622592
  buffer_load_dwordx4 v21, s[24:27], s44 offen lds
  s_add_u32 m0, s47, 4096
  s_add_u32 s44, s42, 655360
  buffer_load_dwordx4 v22, s[24:27], s44 offen lds
  s_add_u32 m0, s47, 5120
  s_add_u32 s44, s42, 688128
  buffer_load_dwordx4 v23, s[24:27], s44 offen lds
  s_add_u32 m0, s47, 6144
  s_add_u32 s44, s42, 720896
  buffer_load_dwordx4 v24, s[24:27], s44 offen lds
  s_add_u32 m0, s47, 7168
  s_add_u32 s44, s42, 753664
  buffer_load_dwordx4 v25, s[24:27], s44 offen lds
  s_waitcnt vmcnt(8)
  ds_read_b128 a[56:59], v14 offset:8192
  ds_read_b128 a[60:63], v15 offset:8192
  ds_read_b128 a[64:67], v16 offset:8192
  ds_read_b128 a[68:71], v17 offset:8192
  ds_read_b128 a[72:75], v14 offset:8448
  ds_read_b128 a[76:79], v15 offset:8448
  ds_read_b128 a[80:83], v16 offset:8448
  ds_read_b128 a[84:87], v17 offset:8448
  ds_read_b128 v[92:95], v6 offset:0
  ds_read_b128 v[96:99], v6 offset:8192
  ds_read_b128 v[100:103], v7 offset:0
  ds_read_b128 v[104:107], v7 offset:8192
  s_waitcnt lgkmcnt(3)
  v_mfma_f32_16x16x32_bf16 v[144:147], v[92:95], a[0:3], 0
  ds_read_b128 v[108:111], v8 offset:0
  v_mfma_f32_16x16x32_bf16 v[152:155], v[92:95], a[56:59], 0
  s_waitcnt lgkmcnt(3)
  v_mfma_f32_16x16x32_bf16 v[148:151], v[96:99], a[0:3], 0
  ds_read_b128 v[112:115], v8 offset:8192
  v_mfma_f32_16x16x32_bf16 v[156:159], v[96:99], a[56:59], 0
  v_mul_f32 v160, s45, v160
  v_mul_f32 v161, s45, v161
  s_waitcnt lgkmcnt(3)
  v_mfma_f32_16x16x32_bf16 v[144:147], v[100:103], a[4:7], v[144:147]
  ds_read_b128 v[92:95], v9 offset:0
  v_mul_f32 v162, s45, v162
  v_mul_f32 v163, s45, v163
  v_mfma_f32_16x16x32_bf16 v[152:155], v[100:103], a[60:63], v[152:155]
  s_add_u32 m0, s47, 8192
  s_add_u32 s44, s42, 540672
  buffer_load_dwordx4 v18, s[24:27], s44 offen lds
  v_mul_f32 v164, s45, v164
  v_mul_f32 v165, s45, v165
  s_waitcnt lgkmcnt(3)
  v_mfma_f32_16x16x32_bf16 v[148:151], v[104:107], a[4:7], v[148:151]
  ds_read_b128 v[96:99], v9 offset:8192
  v_mul_f32 v166, s45, v166
  v_mfma_f32_16x16x32_bf16 v[156:159], v[104:107], a[60:63], v[156:159]
  v_mul_f32 v167, s45, v167
  s_waitcnt lgkmcnt(3)
  v_mfma_f32_16x16x32_bf16 v[144:147], v[108:111], a[8:11], v[144:147]
  ds_read_b128 v[100:103], v6 offset:256
  v_cvt_pk_bf16_f32 v216, v160, v161
  v_mfma_f32_16x16x32_bf16 v[152:155], v[108:111], a[64:67], v[152:155]
  v_cvt_pk_bf16_f32 v217, v162, v163
  s_waitcnt lgkmcnt(3)
  v_mfma_f32_16x16x32_bf16 v[148:151], v[112:115], a[8:11], v[148:151]
  ds_read_b128 v[104:107], v6 offset:8448
  v_cvt_pk_bf16_f32 v218, v164, v165
  v_mfma_f32_16x16x32_bf16 v[156:159], v[112:115], a[64:67], v[156:159]
  s_add_u32 m0, s47, 9216
  s_add_u32 s44, s42, 573440
  buffer_load_dwordx4 v19, s[24:27], s44 offen lds
  v_cvt_pk_bf16_f32 v219, v166, v167
  s_waitcnt lgkmcnt(3)
  v_mfma_f32_16x16x32_bf16 v[144:147], v[92:95], a[12:15], v[144:147]
  ds_read_b128 v[108:111], v7 offset:256
  v_accvgpr_write_b32 a52, v216
  v_mfma_f32_16x16x32_bf16 v[152:155], v[92:95], a[68:71], v[152:155]
  v_accvgpr_write_b32 a53, v217
  s_waitcnt lgkmcnt(3)
  v_mfma_f32_16x16x32_bf16 v[148:151], v[96:99], a[12:15], v[148:151]
  ds_read_b128 v[112:115], v7 offset:8448
  v_accvgpr_write_b32 a54, v218
  v_mfma_f32_16x16x32_bf16 v[156:159], v[96:99], a[68:71], v[156:159]
  v_accvgpr_write_b32 a55, v219
  s_waitcnt lgkmcnt(3)
  v_mfma_f32_16x16x32_bf16 v[144:147], v[100:103], a[16:19], v[144:147]
  ds_read_b128 v[92:95], v8 offset:256
  v_mul_f32 v168, s45, v168
  v_mfma_f32_16x16x32_bf16 v[152:155], v[100:103], a[72:75], v[152:155]
  s_add_u32 m0, s47, 10240
  s_add_u32 s44, s42, 606208
  buffer_load_dwordx4 v20, s[24:27], s44 offen lds
  v_mul_f32 v169, s45, v169
  s_waitcnt lgkmcnt(3)
  v_mfma_f32_16x16x32_bf16 v[148:151], v[104:107], a[16:19], v[148:151]
  ds_read_b128 v[96:99], v8 offset:8448
  v_mul_f32 v170, s45, v170
  v_mfma_f32_16x16x32_bf16 v[156:159], v[104:107], a[72:75], v[156:159]
  v_mul_f32 v171, s45, v171
  s_waitcnt lgkmcnt(3)
  v_mfma_f32_16x16x32_bf16 v[144:147], v[108:111], a[20:23], v[144:147]
  ds_read_b128 v[100:103], v9 offset:256
  v_mul_f32 v172, s45, v172
  v_mfma_f32_16x16x32_bf16 v[152:155], v[108:111], a[76:79], v[152:155]
  v_mul_f32 v173, s45, v173
  s_waitcnt lgkmcnt(3)
  v_mfma_f32_16x16x32_bf16 v[148:151], v[112:115], a[20:23], v[148:151]
  ds_read_b128 v[104:107], v9 offset:8448
  v_mul_f32 v174, s45, v174
  v_mfma_f32_16x16x32_bf16 v[156:159], v[112:115], a[76:79], v[156:159]
  s_add_u32 m0, s47, 11264
  s_add_u32 s44, s42, 638976
  buffer_load_dwordx4 v21, s[24:27], s44 offen lds
  v_mul_f32 v175, s45, v175
  s_waitcnt lgkmcnt(3)
  v_mfma_f32_16x16x32_bf16 v[144:147], v[92:95], a[24:27], v[144:147]
  ds_read_b128 v[108:111], v6 offset:16384
  v_cvt_pk_bf16_f32 v220, v168, v169
  v_mfma_f32_16x16x32_bf16 v[152:155], v[92:95], a[80:83], v[152:155]
  v_cvt_pk_bf16_f32 v221, v170, v171
  s_waitcnt lgkmcnt(3)
  v_mfma_f32_16x16x32_bf16 v[148:151], v[96:99], a[24:27], v[148:151]
  ds_read_b128 v[112:115], v6 offset:24576
  v_cvt_pk_bf16_f32 v222, v172, v173
  v_mfma_f32_16x16x32_bf16 v[156:159], v[96:99], a[80:83], v[156:159]
  v_cvt_pk_bf16_f32 v223, v174, v175
  s_waitcnt lgkmcnt(3)
  v_mfma_f32_16x16x32_bf16 v[144:147], v[100:103], a[28:31], v[144:147]
  ds_read_b128 v[92:95], v7 offset:16384
  v_accvgpr_write_b32 a108, v220
  v_mfma_f32_16x16x32_bf16 v[152:155], v[100:103], a[84:87], v[152:155]
  s_add_u32 m0, s47, 12288
  s_add_u32 s44, s42, 671744
  buffer_load_dwordx4 v22, s[24:27], s44 offen lds
  v_accvgpr_write_b32 a109, v221
  s_waitcnt lgkmcnt(3)
  v_mfma_f32_16x16x32_bf16 v[148:151], v[104:107], a[28:31], v[148:151]
  ds_read_b128 v[96:99], v7 offset:24576
  v_accvgpr_write_b32 a110, v222
  v_mfma_f32_16x16x32_bf16 v[156:159], v[104:107], a[84:87], v[156:159]
  v_accvgpr_write_b32 a111, v223
  s_waitcnt lgkmcnt(3)
  v_mfma_f32_16x16x32_bf16 v[160:163], v[108:111], a[0:3], 0
  ds_read_b128 v[100:103], v8 offset:16384
  v_mfma_f32_16x16x32_bf16 v[168:171], v[108:111], a[56:59], 0
  s_waitcnt lgkmcnt(3)
  v_mfma_f32_16x16x32_bf16 v[164:167], v[112:115], a[0:3], 0
  ds_read_b128 v[104:107], v8 offset:24576
  v_mfma_f32_16x16x32_bf16 v[172:175], v[112:115], a[56:59], 0
  v_mul_f32 v144, s45, v144
  v_mul_f32 v145, s45, v145
  s_waitcnt lgkmcnt(3)
  v_mfma_f32_16x16x32_bf16 v[160:163], v[92:95], a[4:7], v[160:163]
  ds_read_b128 v[108:111], v9 offset:16384
  v_mul_f32 v146, s45, v146
  v_mul_f32 v147, s45, v147
  v_mfma_f32_16x16x32_bf16 v[168:171], v[92:95], a[60:63], v[168:171]
  s_add_u32 m0, s47, 13312
  s_add_u32 s44, s42, 704512
  buffer_load_dwordx4 v23, s[24:27], s44 offen lds
  v_mul_f32 v148, s45, v148
  v_mul_f32 v149, s45, v149
  s_waitcnt lgkmcnt(3)
  v_mfma_f32_16x16x32_bf16 v[164:167], v[96:99], a[4:7], v[164:167]
  ds_read_b128 v[112:115], v9 offset:24576
  v_mul_f32 v150, s45, v150
  v_mfma_f32_16x16x32_bf16 v[172:175], v[96:99], a[60:63], v[172:175]
  v_mul_f32 v151, s45, v151
  s_waitcnt lgkmcnt(3)
  v_mfma_f32_16x16x32_bf16 v[160:163], v[100:103], a[8:11], v[160:163]
  ds_read_b128 v[92:95], v6 offset:16640
  v_cvt_pk_bf16_f32 v224, v144, v145
  v_mfma_f32_16x16x32_bf16 v[168:171], v[100:103], a[64:67], v[168:171]
  v_cvt_pk_bf16_f32 v225, v146, v147
  s_waitcnt lgkmcnt(3)
  v_mfma_f32_16x16x32_bf16 v[164:167], v[104:107], a[8:11], v[164:167]
  ds_read_b128 v[96:99], v6 offset:24832
  v_cvt_pk_bf16_f32 v226, v148, v149
  v_mfma_f32_16x16x32_bf16 v[172:175], v[104:107], a[64:67], v[172:175]
  s_add_u32 m0, s47, 14336
  s_add_u32 s44, s42, 737280
  buffer_load_dwordx4 v24, s[24:27], s44 offen lds
  v_cvt_pk_bf16_f32 v227, v150, v151
  s_waitcnt lgkmcnt(3)
  v_mfma_f32_16x16x32_bf16 v[160:163], v[108:111], a[12:15], v[160:163]
  ds_read_b128 v[100:103], v7 offset:16640
  v_accvgpr_write_b32 a144, v224
  v_mfma_f32_16x16x32_bf16 v[168:171], v[108:111], a[68:71], v[168:171]
  v_accvgpr_write_b32 a145, v225
  s_waitcnt lgkmcnt(3)
  v_mfma_f32_16x16x32_bf16 v[164:167], v[112:115], a[12:15], v[164:167]
  ds_read_b128 v[104:107], v7 offset:24832
  v_accvgpr_write_b32 a146, v226
  v_mfma_f32_16x16x32_bf16 v[172:175], v[112:115], a[68:71], v[172:175]
  v_accvgpr_write_b32 a147, v227
  s_waitcnt lgkmcnt(3)
  v_mfma_f32_16x16x32_bf16 v[160:163], v[92:95], a[16:19], v[160:163]
  ds_read_b128 v[108:111], v8 offset:16640
  v_mul_f32 v152, s45, v152
  v_mfma_f32_16x16x32_bf16 v[168:171], v[92:95], a[72:75], v[168:171]
  s_add_u32 m0, s47, 15360
  s_add_u32 s44, s42, 770048
  buffer_load_dwordx4 v25, s[24:27], s44 offen lds
  v_mul_f32 v153, s45, v153
  s_waitcnt lgkmcnt(3)
  v_mfma_f32_16x16x32_bf16 v[164:167], v[96:99], a[16:19], v[164:167]
  ds_read_b128 v[112:115], v8 offset:24832
  v_mul_f32 v154, s45, v154
  v_mfma_f32_16x16x32_bf16 v[172:175], v[96:99], a[72:75], v[172:175]
  v_mul_f32 v155, s45, v155
  s_waitcnt lgkmcnt(3)
  v_mfma_f32_16x16x32_bf16 v[160:163], v[100:103], a[20:23], v[160:163]
  ds_read_b128 v[92:95], v9 offset:16640
  v_mul_f32 v156, s45, v156
  v_mfma_f32_16x16x32_bf16 v[168:171], v[100:103], a[76:79], v[168:171]
  v_mul_f32 v157, s45, v157
  s_waitcnt lgkmcnt(3)
  v_mfma_f32_16x16x32_bf16 v[164:167], v[104:107], a[20:23], v[164:167]
  ds_read_b128 v[96:99], v9 offset:24832
  v_mul_f32 v158, s45, v158
  v_mfma_f32_16x16x32_bf16 v[172:175], v[104:107], a[76:79], v[172:175]
  s_waitcnt vmcnt(8)
  ds_read_b128 a[112:115], v14 offset:0
  v_mul_f32 v159, s45, v159
  s_waitcnt lgkmcnt(4)
  v_mfma_f32_16x16x32_bf16 v[160:163], v[108:111], a[24:27], v[160:163]
  ds_read_b128 v[100:103], v6 offset:32768
  v_cvt_pk_bf16_f32 v228, v152, v153
  v_mfma_f32_16x16x32_bf16 v[168:171], v[108:111], a[80:83], v[168:171]
  v_cvt_pk_bf16_f32 v229, v154, v155
  s_waitcnt lgkmcnt(4)
  v_mfma_f32_16x16x32_bf16 v[164:167], v[112:115], a[24:27], v[164:167]
  ds_read_b128 v[104:107], v6 offset:40960
  v_cvt_pk_bf16_f32 v230, v156, v157
  v_mfma_f32_16x16x32_bf16 v[172:175], v[112:115], a[80:83], v[172:175]
  v_cvt_pk_bf16_f32 v231, v158, v159
  s_waitcnt lgkmcnt(4)
  v_mfma_f32_16x16x32_bf16 v[160:163], v[92:95], a[28:31], v[160:163]
  ds_read_b128 v[108:111], v7 offset:32768
  v_accvgpr_write_b32 a200, v228
  v_mfma_f32_16x16x32_bf16 v[168:171], v[92:95], a[84:87], v[168:171]
  ds_read_b128 a[116:119], v15 offset:0
  v_accvgpr_write_b32 a201, v229
  s_waitcnt lgkmcnt(5)
  v_mfma_f32_16x16x32_bf16 v[164:167], v[96:99], a[28:31], v[164:167]
  ds_read_b128 v[112:115], v7 offset:40960
  v_accvgpr_write_b32 a202, v230
  v_mfma_f32_16x16x32_bf16 v[172:175], v[96:99], a[84:87], v[172:175]
  v_accvgpr_write_b32 a203, v231
  s_waitcnt lgkmcnt(4)
  v_mfma_f32_16x16x32_bf16 v[144:147], v[100:103], a[0:3], 0
  ds_read_b128 v[92:95], v8 offset:32768
  v_mfma_f32_16x16x32_bf16 v[152:155], v[100:103], a[56:59], 0
  s_waitcnt lgkmcnt(4)
  v_mfma_f32_16x16x32_bf16 v[148:151], v[104:107], a[0:3], 0
  ds_read_b128 v[96:99], v8 offset:40960
  v_mfma_f32_16x16x32_bf16 v[156:159], v[104:107], a[56:59], 0
  v_mul_f32 v160, s45, v160
  v_mul_f32 v161, s45, v161
  s_waitcnt lgkmcnt(4)
  v_mfma_f32_16x16x32_bf16 v[144:147], v[108:111], a[4:7], v[144:147]
  ds_read_b128 v[100:103], v9 offset:32768
  v_mul_f32 v162, s45, v162
  v_mul_f32 v163, s45, v163
  v_mfma_f32_16x16x32_bf16 v[152:155], v[108:111], a[60:63], v[152:155]
  ds_read_b128 a[120:123], v16 offset:0
  v_mul_f32 v164, s45, v164
  v_mul_f32 v165, s45, v165
  s_waitcnt lgkmcnt(4)
  v_mfma_f32_16x16x32_bf16 v[148:151], v[112:115], a[4:7], v[148:151]
  ds_read_b128 v[104:107], v9 offset:40960
  v_mul_f32 v166, s45, v166
  v_mfma_f32_16x16x32_bf16 v[156:159], v[112:115], a[60:63], v[156:159]
  v_mul_f32 v167, s45, v167
  s_waitcnt lgkmcnt(4)
  v_mfma_f32_16x16x32_bf16 v[144:147], v[92:95], a[8:11], v[144:147]
  ds_read_b128 v[108:111], v6 offset:33024
  v_cvt_pk_bf16_f32 v200, v160, v161
  v_mfma_f32_16x16x32_bf16 v[152:155], v[92:95], a[64:67], v[152:155]
  v_cvt_pk_bf16_f32 v201, v162, v163
  s_waitcnt lgkmcnt(4)
  v_mfma_f32_16x16x32_bf16 v[148:151], v[96:99], a[8:11], v[148:151]
  ds_read_b128 v[112:115], v6 offset:41216
  v_cvt_pk_bf16_f32 v202, v164, v165
  v_mfma_f32_16x16x32_bf16 v[156:159], v[96:99], a[64:67], v[156:159]
  ds_read_b128 a[124:127], v17 offset:0
  v_cvt_pk_bf16_f32 v203, v166, v167
  s_waitcnt lgkmcnt(5)
  v_mfma_f32_16x16x32_bf16 v[144:147], v[100:103], a[12:15], v[144:147]
  ds_read_b128 v[92:95], v7 offset:33024
  v_accvgpr_write_b32 a148, v200
  v_mfma_f32_16x16x32_bf16 v[152:155], v[100:103], a[68:71], v[152:155]
  v_accvgpr_write_b32 a149, v201
  s_waitcnt lgkmcnt(4)
  v_mfma_f32_16x16x32_bf16 v[148:151], v[104:107], a[12:15], v[148:151]
  ds_read_b128 v[96:99], v7 offset:41216
  v_accvgpr_write_b32 a150, v202
  v_mfma_f32_16x16x32_bf16 v[156:159], v[104:107], a[68:71], v[156:159]
  v_accvgpr_write_b32 a151, v203
  s_waitcnt lgkmcnt(4)
  v_mfma_f32_16x16x32_bf16 v[144:147], v[108:111], a[16:19], v[144:147]
  ds_read_b128 v[100:103], v8 offset:33024
  v_mul_f32 v168, s45, v168
  v_mfma_f32_16x16x32_bf16 v[152:155], v[108:111], a[72:75], v[152:155]
  ds_read_b128 a[128:131], v14 offset:256
  v_mul_f32 v169, s45, v169
  s_waitcnt lgkmcnt(5)
  v_mfma_f32_16x16x32_bf16 v[148:151], v[112:115], a[16:19], v[148:151]
  ds_read_b128 v[104:107], v8 offset:41216
  v_mul_f32 v170, s45, v170
  v_mfma_f32_16x16x32_bf16 v[156:159], v[112:115], a[72:75], v[156:159]
  v_mul_f32 v171, s45, v171
  s_waitcnt lgkmcnt(4)
  v_mfma_f32_16x16x32_bf16 v[144:147], v[92:95], a[20:23], v[144:147]
  ds_read_b128 v[108:111], v9 offset:33024
  v_mul_f32 v172, s45, v172
  v_mfma_f32_16x16x32_bf16 v[152:155], v[92:95], a[76:79], v[152:155]
  v_mul_f32 v173, s45, v173
  s_waitcnt lgkmcnt(4)
  v_mfma_f32_16x16x32_bf16 v[148:151], v[96:99], a[20:23], v[148:151]
  ds_read_b128 v[112:115], v9 offset:41216
  v_mul_f32 v174, s45, v174
  v_mfma_f32_16x16x32_bf16 v[156:159], v[96:99], a[76:79], v[156:159]
  ds_read_b128 a[132:135], v15 offset:256
  v_mul_f32 v175, s45, v175
  s_waitcnt lgkmcnt(5)
  v_mfma_f32_16x16x32_bf16 v[144:147], v[100:103], a[24:27], v[144:147]
  ds_read_b128 v[92:95], v10 offset:0
  v_cvt_pk_bf16_f32 v204, v168, v169
  v_mfma_f32_16x16x32_bf16 v[152:155], v[100:103], a[80:83], v[152:155]
  v_cvt_pk_bf16_f32 v205, v170, v171
  s_waitcnt lgkmcnt(4)
  v_mfma_f32_16x16x32_bf16 v[148:151], v[104:107], a[24:27], v[148:151]
  ds_read_b128 v[96:99], v10 offset:8192
  v_cvt_pk_bf16_f32 v206, v172, v173
  v_mfma_f32_16x16x32_bf16 v[156:159], v[104:107], a[80:83], v[156:159]
  v_cvt_pk_bf16_f32 v207, v174, v175
  s_waitcnt lgkmcnt(4)
  v_mfma_f32_16x16x32_bf16 v[144:147], v[108:111], a[28:31], v[144:147]
  ds_read_b128 v[100:103], v11 offset:0
  v_accvgpr_write_b32 a204, v204
  v_mfma_f32_16x16x32_bf16 v[152:155], v[108:111], a[84:87], v[152:155]
  ds_read_b128 a[136:139], v16 offset:256
  v_accvgpr_write_b32 a205, v205
  s_waitcnt lgkmcnt(5)
  v_mfma_f32_16x16x32_bf16 v[148:151], v[112:115], a[28:31], v[148:151]
  ds_read_b128 v[104:107], v11 offset:8192
  v_accvgpr_write_b32 a206, v206
  v_mfma_f32_16x16x32_bf16 v[156:159], v[112:115], a[84:87], v[156:159]
  v_accvgpr_write_b32 a207, v207
  s_waitcnt lgkmcnt(4)
  v_mfma_f32_16x16x32_bf16 v[160:163], v[92:95], a[0:3], 0
  ds_read_b128 v[108:111], v12 offset:0
  v_mfma_f32_16x16x32_bf16 v[168:171], v[92:95], a[56:59], 0
  s_waitcnt lgkmcnt(4)
  v_mfma_f32_16x16x32_bf16 v[164:167], v[96:99], a[0:3], 0
  ds_read_b128 v[112:115], v12 offset:8192
  v_mfma_f32_16x16x32_bf16 v[172:175], v[96:99], a[56:59], 0
  v_mul_f32 v144, s45, v144
  v_mul_f32 v145, s45, v145
  s_waitcnt lgkmcnt(4)
  v_mfma_f32_16x16x32_bf16 v[160:163], v[100:103], a[4:7], v[160:163]
  ds_read_b128 v[92:95], v13 offset:0
  v_mul_f32 v146, s45, v146
  v_mul_f32 v147, s45, v147
  v_mfma_f32_16x16x32_bf16 v[168:171], v[100:103], a[60:63], v[168:171]
  ds_read_b128 a[140:143], v17 offset:256
  v_mul_f32 v148, s45, v148
  v_mul_f32 v149, s45, v149
  s_waitcnt lgkmcnt(4)
  v_mfma_f32_16x16x32_bf16 v[164:167], v[104:107], a[4:7], v[164:167]
  ds_read_b128 v[96:99], v13 offset:8192
  v_mul_f32 v150, s45, v150
  v_mfma_f32_16x16x32_bf16 v[172:175], v[104:107], a[60:63], v[172:175]
  v_mul_f32 v151, s45, v151
  s_waitcnt lgkmcnt(4)
  v_mfma_f32_16x16x32_bf16 v[160:163], v[108:111], a[8:11], v[160:163]
  ds_read_b128 v[100:103], v10 offset:256
  v_cvt_pk_bf16_f32 v208, v144, v145
  v_mfma_f32_16x16x32_bf16 v[168:171], v[108:111], a[64:67], v[168:171]
  v_cvt_pk_bf16_f32 v209, v146, v147
  s_waitcnt lgkmcnt(4)
  v_mfma_f32_16x16x32_bf16 v[164:167], v[112:115], a[8:11], v[164:167]
  ds_read_b128 v[104:107], v10 offset:8448
  v_cvt_pk_bf16_f32 v210, v148, v149
  v_mfma_f32_16x16x32_bf16 v[172:175], v[112:115], a[64:67], v[172:175]
  s_waitcnt lgkmcnt(3)
  s_add_u32 m0, s47, 0
  s_add_u32 s44, s42, 786432
  buffer_load_dwordx4 v18, s[24:27], s44 offen lds
  v_cvt_pk_bf16_f32 v211, v150, v151
  v_mfma_f32_16x16x32_bf16 v[160:163], v[92:95], a[12:15], v[160:163]
  ds_read_b128 v[108:111], v11 offset:256
  v_accvgpr_write_b32 a152, v208
  v_mfma_f32_16x16x32_bf16 v[168:171], v[92:95], a[68:71], v[168:171]
  v_accvgpr_write_b32 a153, v209
  s_waitcnt lgkmcnt(3)
  v_mfma_f32_16x16x32_bf16 v[164:167], v[96:99], a[12:15], v[164:167]
  ds_read_b128 v[112:115], v11 offset:8448
  v_accvgpr_write_b32 a154, v210
  v_mfma_f32_16x16x32_bf16 v[172:175], v[96:99], a[68:71], v[172:175]
  v_accvgpr_write_b32 a155, v211
  s_waitcnt lgkmcnt(3)
  v_mfma_f32_16x16x32_bf16 v[160:163], v[100:103], a[16:19], v[160:163]
  ds_read_b128 v[92:95], v12 offset:256
  v_mul_f32 v152, s45, v152
  v_mfma_f32_16x16x32_bf16 v[168:171], v[100:103], a[72:75], v[168:171]
  s_add_u32 m0, s47, 1024
  s_add_u32 s44, s42, 802816
  buffer_load_dwordx4 v19, s[24:27], s44 offen lds
  v_mul_f32 v153, s45, v153
  s_waitcnt lgkmcnt(3)
  v_mfma_f32_16x16x32_bf16 v[164:167], v[104:107], a[16:19], v[164:167]
  ds_read_b128 v[96:99], v12 offset:8448
  v_mul_f32 v154, s45, v154
  v_mfma_f32_16x16x32_bf16 v[172:175], v[104:107], a[72:75], v[172:175]
  v_mul_f32 v155, s45, v155
  s_waitcnt lgkmcnt(3)
  v_mfma_f32_16x16x32_bf16 v[160:163], v[108:111], a[20:23], v[160:163]
  ds_read_b128 v[100:103], v13 offset:256
  v_mul_f32 v156, s45, v156
  v_mfma_f32_16x16x32_bf16 v[168:171], v[108:111], a[76:79], v[168:171]
  v_mul_f32 v157, s45, v157
  s_waitcnt lgkmcnt(3)
  v_mfma_f32_16x16x32_bf16 v[164:167], v[112:115], a[20:23], v[164:167]
  ds_read_b128 v[104:107], v13 offset:8448
  v_mul_f32 v158, s45, v158
  v_mfma_f32_16x16x32_bf16 v[172:175], v[112:115], a[76:79], v[172:175]
  s_add_u32 m0, s47, 2048
  s_add_u32 s44, s42, 819200
  buffer_load_dwordx4 v20, s[24:27], s44 offen lds
  v_mul_f32 v159, s45, v159
  s_waitcnt lgkmcnt(3)
  v_mfma_f32_16x16x32_bf16 v[160:163], v[92:95], a[24:27], v[160:163]
  ds_read_b128 v[108:111], v10 offset:16384
  v_cvt_pk_bf16_f32 v212, v152, v153
  v_mfma_f32_16x16x32_bf16 v[168:171], v[92:95], a[80:83], v[168:171]
  v_cvt_pk_bf16_f32 v213, v154, v155
  s_waitcnt lgkmcnt(3)
  v_mfma_f32_16x16x32_bf16 v[164:167], v[96:99], a[24:27], v[164:167]
  ds_read_b128 v[112:115], v10 offset:24576
  v_cvt_pk_bf16_f32 v214, v156, v157
  v_mfma_f32_16x16x32_bf16 v[172:175], v[96:99], a[80:83], v[172:175]
  v_cvt_pk_bf16_f32 v215, v158, v159
  s_waitcnt lgkmcnt(3)
  v_mfma_f32_16x16x32_bf16 v[160:163], v[100:103], a[28:31], v[160:163]
  ds_read_b128 v[92:95], v11 offset:16384
  v_accvgpr_write_b32 a208, v212
  v_mfma_f32_16x16x32_bf16 v[168:171], v[100:103], a[84:87], v[168:171]
  s_add_u32 m0, s47, 3072
  s_add_u32 s44, s42, 835584
  buffer_load_dwordx4 v21, s[24:27], s44 offen lds
  v_accvgpr_write_b32 a209, v213
  s_waitcnt lgkmcnt(3)
  v_mfma_f32_16x16x32_bf16 v[164:167], v[104:107], a[28:31], v[164:167]
  ds_read_b128 v[96:99], v11 offset:24576
  v_accvgpr_write_b32 a210, v214
  v_mfma_f32_16x16x32_bf16 v[172:175], v[104:107], a[84:87], v[172:175]
  v_accvgpr_write_b32 a211, v215
  s_waitcnt lgkmcnt(3)
  v_mfma_f32_16x16x32_bf16 v[144:147], v[108:111], a[0:3], 0
  ds_read_b128 v[100:103], v12 offset:16384
  v_mfma_f32_16x16x32_bf16 v[152:155], v[108:111], a[56:59], 0
  s_waitcnt lgkmcnt(3)
  v_mfma_f32_16x16x32_bf16 v[148:151], v[112:115], a[0:3], 0
  ds_read_b128 v[104:107], v12 offset:24576
  v_mfma_f32_16x16x32_bf16 v[156:159], v[112:115], a[56:59], 0
  v_mul_f32 v160, s45, v160
  v_mul_f32 v161, s45, v161
  s_waitcnt lgkmcnt(3)
  v_mfma_f32_16x16x32_bf16 v[144:147], v[92:95], a[4:7], v[144:147]
  ds_read_b128 v[108:111], v13 offset:16384
  v_mul_f32 v162, s45, v162
  v_mul_f32 v163, s45, v163
  v_mfma_f32_16x16x32_bf16 v[152:155], v[92:95], a[60:63], v[152:155]
  s_add_u32 m0, s47, 4096
  s_add_u32 s44, s42, 851968
  buffer_load_dwordx4 v22, s[24:27], s44 offen lds
  v_mul_f32 v164, s45, v164
  v_mul_f32 v165, s45, v165
  s_waitcnt lgkmcnt(3)
  v_mfma_f32_16x16x32_bf16 v[148:151], v[96:99], a[4:7], v[148:151]
  ds_read_b128 v[112:115], v13 offset:24576
  v_mul_f32 v166, s45, v166
  v_mfma_f32_16x16x32_bf16 v[156:159], v[96:99], a[60:63], v[156:159]
  v_mul_f32 v167, s45, v167
  s_waitcnt lgkmcnt(3)
  v_mfma_f32_16x16x32_bf16 v[144:147], v[100:103], a[8:11], v[144:147]
  ds_read_b128 v[92:95], v10 offset:16640
  v_cvt_pk_bf16_f32 v216, v160, v161
  v_mfma_f32_16x16x32_bf16 v[152:155], v[100:103], a[64:67], v[152:155]
  v_cvt_pk_bf16_f32 v217, v162, v163
  s_waitcnt lgkmcnt(3)
  v_mfma_f32_16x16x32_bf16 v[148:151], v[104:107], a[8:11], v[148:151]
  ds_read_b128 v[96:99], v10 offset:24832
  v_cvt_pk_bf16_f32 v218, v164, v165
  v_mfma_f32_16x16x32_bf16 v[156:159], v[104:107], a[64:67], v[156:159]
  s_add_u32 m0, s47, 5120
  s_add_u32 s44, s42, 868352
  buffer_load_dwordx4 v23, s[24:27], s44 offen lds
  v_cvt_pk_bf16_f32 v219, v166, v167
  s_waitcnt lgkmcnt(3)
  v_mfma_f32_16x16x32_bf16 v[144:147], v[108:111], a[12:15], v[144:147]
  ds_read_b128 v[100:103], v11 offset:16640
  v_accvgpr_write_b32 a156, v216
  v_mfma_f32_16x16x32_bf16 v[152:155], v[108:111], a[68:71], v[152:155]
  v_accvgpr_write_b32 a157, v217
  s_waitcnt lgkmcnt(3)
  v_mfma_f32_16x16x32_bf16 v[148:151], v[112:115], a[12:15], v[148:151]
  ds_read_b128 v[104:107], v11 offset:24832
  v_accvgpr_write_b32 a158, v218
  v_mfma_f32_16x16x32_bf16 v[156:159], v[112:115], a[68:71], v[156:159]
  v_accvgpr_write_b32 a159, v219
  s_waitcnt lgkmcnt(3)
  v_mfma_f32_16x16x32_bf16 v[144:147], v[92:95], a[16:19], v[144:147]
  ds_read_b128 v[108:111], v12 offset:16640
  v_mul_f32 v168, s45, v168
  v_mfma_f32_16x16x32_bf16 v[152:155], v[92:95], a[72:75], v[152:155]
  s_add_u32 m0, s47, 6144
  s_add_u32 s44, s42, 884736
  buffer_load_dwordx4 v24, s[24:27], s44 offen lds
  v_mul_f32 v169, s45, v169
  s_waitcnt lgkmcnt(3)
  v_mfma_f32_16x16x32_bf16 v[148:151], v[96:99], a[16:19], v[148:151]
  ds_read_b128 v[112:115], v12 offset:24832
  v_mul_f32 v170, s45, v170
  v_mfma_f32_16x16x32_bf16 v[156:159], v[96:99], a[72:75], v[156:159]
  v_mul_f32 v171, s45, v171
  s_waitcnt lgkmcnt(3)
  v_mfma_f32_16x16x32_bf16 v[144:147], v[100:103], a[20:23], v[144:147]
  ds_read_b128 v[92:95], v13 offset:16640
  v_mul_f32 v172, s45, v172
  v_mfma_f32_16x16x32_bf16 v[152:155], v[100:103], a[76:79], v[152:155]
  v_mul_f32 v173, s45, v173
  s_waitcnt lgkmcnt(3)
  v_mfma_f32_16x16x32_bf16 v[148:151], v[104:107], a[20:23], v[148:151]
  ds_read_b128 v[96:99], v13 offset:24832
  v_mul_f32 v174, s45, v174
  v_mfma_f32_16x16x32_bf16 v[156:159], v[104:107], a[76:79], v[156:159]
  s_add_u32 m0, s47, 7168
  s_add_u32 s44, s42, 901120
  buffer_load_dwordx4 v25, s[24:27], s44 offen lds
  v_mul_f32 v175, s45, v175
  s_waitcnt lgkmcnt(3)
  v_mfma_f32_16x16x32_bf16 v[144:147], v[108:111], a[24:27], v[144:147]
  ds_read_b128 v[100:103], v10 offset:32768
  v_cvt_pk_bf16_f32 v220, v168, v169
  v_mfma_f32_16x16x32_bf16 v[152:155], v[108:111], a[80:83], v[152:155]
  v_cvt_pk_bf16_f32 v221, v170, v171
  s_waitcnt lgkmcnt(3)
  v_mfma_f32_16x16x32_bf16 v[148:151], v[112:115], a[24:27], v[148:151]
  ds_read_b128 v[104:107], v10 offset:40960
  v_cvt_pk_bf16_f32 v222, v172, v173
  v_mfma_f32_16x16x32_bf16 v[156:159], v[112:115], a[80:83], v[156:159]
  v_cvt_pk_bf16_f32 v223, v174, v175
  s_waitcnt lgkmcnt(3)
  v_mfma_f32_16x16x32_bf16 v[144:147], v[92:95], a[28:31], v[144:147]
  ds_read_b128 v[108:111], v11 offset:32768
  v_accvgpr_write_b32 a212, v220
  v_mfma_f32_16x16x32_bf16 v[152:155], v[92:95], a[84:87], v[152:155]
  s_waitcnt vmcnt(8)
  ds_read_b128 a[168:171], v14 offset:8192
  v_accvgpr_write_b32 a213, v221
  s_waitcnt lgkmcnt(4)
  v_mfma_f32_16x16x32_bf16 v[148:151], v[96:99], a[28:31], v[148:151]
  ds_read_b128 v[112:115], v11 offset:40960
  v_accvgpr_write_b32 a214, v222
  v_mfma_f32_16x16x32_bf16 v[156:159], v[96:99], a[84:87], v[156:159]
  v_accvgpr_write_b32 a215, v223
  s_waitcnt lgkmcnt(4)
  v_mfma_f32_16x16x32_bf16 v[160:163], v[100:103], a[0:3], 0
  ds_read_b128 v[92:95], v12 offset:32768
  v_mfma_f32_16x16x32_bf16 v[168:171], v[100:103], a[56:59], 0
  s_waitcnt lgkmcnt(4)
  v_mfma_f32_16x16x32_bf16 v[164:167], v[104:107], a[0:3], 0
  ds_read_b128 v[96:99], v12 offset:40960
  v_mfma_f32_16x16x32_bf16 v[172:175], v[104:107], a[56:59], 0
  v_mul_f32 v144, s45, v144
  v_mul_f32 v145, s45, v145
  s_waitcnt lgkmcnt(4)
  v_mfma_f32_16x16x32_bf16 v[160:163], v[108:111], a[4:7], v[160:163]
  ds_read_b128 v[100:103], v13 offset:32768
  v_mul_f32 v146, s45, v146
  v_mul_f32 v147, s45, v147
  v_mfma_f32_16x16x32_bf16 v[168:171], v[108:111], a[60:63], v[168:171]
  ds_read_b128 a[172:175], v15 offset:8192
  v_mul_f32 v148, s45, v148
  v_mul_f32 v149, s45, v149
  s_waitcnt lgkmcnt(4)
  v_mfma_f32_16x16x32_bf16 v[164:167], v[112:115], a[4:7], v[164:167]
  ds_read_b128 v[104:107], v13 offset:40960
  v_mul_f32 v150, s45, v150
  v_mfma_f32_16x16x32_bf16 v[172:175], v[112:115], a[60:63], v[172:175]
  v_mul_f32 v151, s45, v151
  s_waitcnt lgkmcnt(4)
  v_mfma_f32_16x16x32_bf16 v[160:163], v[92:95], a[8:11], v[160:163]
  ds_read_b128 v[108:111], v10 offset:33024
  v_cvt_pk_bf16_f32 v224, v144, v145
  v_mfma_f32_16x16x32_bf16 v[168:171], v[92:95], a[64:67], v[168:171]
  v_cvt_pk_bf16_f32 v225, v146, v147
  s_waitcnt lgkmcnt(4)
  v_mfma_f32_16x16x32_bf16 v[164:167], v[96:99], a[8:11], v[164:167]
  ds_read_b128 v[112:115], v10 offset:41216
  v_cvt_pk_bf16_f32 v226, v148, v149
  v_mfma_f32_16x16x32_bf16 v[172:175], v[96:99], a[64:67], v[172:175]
  ds_read_b128 a[176:179], v16 offset:8192
  v_cvt_pk_bf16_f32 v227, v150, v151
  s_waitcnt lgkmcnt(5)
  v_mfma_f32_16x16x32_bf16 v[160:163], v[100:103], a[12:15], v[160:163]
  ds_read_b128 v[92:95], v11 offset:33024
  v_accvgpr_write_b32 a160, v224
  v_mfma_f32_16x16x32_bf16 v[168:171], v[100:103], a[68:71], v[168:171]
  v_accvgpr_write_b32 a161, v225
  s_waitcnt lgkmcnt(4)
  v_mfma_f32_16x16x32_bf16 v[164:167], v[104:107], a[12:15], v[164:167]
  ds_read_b128 v[96:99], v11 offset:41216
  v_accvgpr_write_b32 a162, v226
  v_mfma_f32_16x16x32_bf16 v[172:175], v[104:107], a[68:71], v[172:175]
  v_accvgpr_write_b32 a163, v227
  s_waitcnt lgkmcnt(4)
  v_mfma_f32_16x16x32_bf16 v[160:163], v[108:111], a[16:19], v[160:163]
  ds_read_b128 v[100:103], v12 offset:33024
  v_mul_f32 v152, s45, v152
  v_mfma_f32_16x16x32_bf16 v[168:171], v[108:111], a[72:75], v[168:171]
  ds_read_b128 a[180:183], v17 offset:8192
  v_mul_f32 v153, s45, v153
  s_waitcnt lgkmcnt(5)
  v_mfma_f32_16x16x32_bf16 v[164:167], v[112:115], a[16:19], v[164:167]
  ds_read_b128 v[104:107], v12 offset:41216
  v_mul_f32 v154, s45, v154
  v_mfma_f32_16x16x32_bf16 v[172:175], v[112:115], a[72:75], v[172:175]
  v_mul_f32 v155, s45, v155
  s_waitcnt lgkmcnt(4)
  v_mfma_f32_16x16x32_bf16 v[160:163], v[92:95], a[20:23], v[160:163]
  ds_read_b128 v[108:111], v13 offset:33024
  v_mul_f32 v156, s45, v156
  v_mfma_f32_16x16x32_bf16 v[168:171], v[92:95], a[76:79], v[168:171]
  v_mul_f32 v157, s45, v157
  s_waitcnt lgkmcnt(4)
  v_mfma_f32_16x16x32_bf16 v[164:167], v[96:99], a[20:23], v[164:167]
  ds_read_b128 v[112:115], v13 offset:41216
  v_mul_f32 v158, s45, v158
  v_mfma_f32_16x16x32_bf16 v[172:175], v[96:99], a[76:79], v[172:175]
  ds_read_b128 a[184:187], v14 offset:8448
  v_mul_f32 v159, s45, v159
  s_waitcnt lgkmcnt(5)
  v_mfma_f32_16x16x32_bf16 v[160:163], v[100:103], a[24:27], v[160:163]
  v_cvt_pk_bf16_f32 v228, v152, v153
  v_mfma_f32_16x16x32_bf16 v[168:171], v[100:103], a[80:83], v[168:171]
  v_cvt_pk_bf16_f32 v229, v154, v155
  s_waitcnt lgkmcnt(3)
  v_mfma_f32_16x16x32_bf16 v[164:167], v[104:107], a[24:27], v[164:167]
  v_cvt_pk_bf16_f32 v230, v156, v157
  v_mfma_f32_16x16x32_bf16 v[172:175], v[104:107], a[80:83], v[172:175]
  v_cvt_pk_bf16_f32 v231, v158, v159
  s_waitcnt lgkmcnt(2)
  v_mfma_f32_16x16x32_bf16 v[160:163], v[108:111], a[28:31], v[160:163]
  v_accvgpr_write_b32 a216, v228
  v_mfma_f32_16x16x32_bf16 v[168:171], v[108:111], a[84:87], v[168:171]
  ds_read_b128 a[188:191], v15 offset:8448
  v_accvgpr_write_b32 a217, v229
  s_waitcnt lgkmcnt(2)
  v_mfma_f32_16x16x32_bf16 v[164:167], v[112:115], a[28:31], v[164:167]
  v_accvgpr_write_b32 a218, v230
  v_mfma_f32_16x16x32_bf16 v[172:175], v[112:115], a[84:87], v[172:175]
  v_accvgpr_write_b32 a219, v231
  ds_read_b128 a[192:195], v16 offset:8448
  ds_read_b128 a[196:199], v17 offset:8448
  ds_read_b128 v[92:95], v6 offset:0
  ds_read_b128 v[96:99], v6 offset:8192
  ds_read_b128 v[100:103], v7 offset:0
  ds_read_b128 v[104:107], v7 offset:8192
  s_waitcnt lgkmcnt(3)
  v_mfma_f32_16x16x32_bf16 v[144:147], v[92:95], a[112:115], 0
  ds_read_b128 v[108:111], v8 offset:0
  v_mfma_f32_16x16x32_bf16 v[152:155], v[92:95], a[168:171], 0
  s_waitcnt lgkmcnt(3)
  v_mfma_f32_16x16x32_bf16 v[148:151], v[96:99], a[112:115], 0
  ds_read_b128 v[112:115], v8 offset:8192
  v_mfma_f32_16x16x32_bf16 v[156:159], v[96:99], a[168:171], 0
  v_mul_f32 v160, s45, v160
  v_mul_f32 v161, s45, v161
  s_waitcnt lgkmcnt(3)
  v_mfma_f32_16x16x32_bf16 v[144:147], v[100:103], a[116:119], v[144:147]
  ds_read_b128 v[92:95], v9 offset:0
  v_mul_f32 v162, s45, v162
  v_mul_f32 v163, s45, v163
  v_mfma_f32_16x16x32_bf16 v[152:155], v[100:103], a[172:175], v[152:155]
  v_mul_f32 v164, s45, v164
  v_mul_f32 v165, s45, v165
  s_waitcnt lgkmcnt(3)
  v_mfma_f32_16x16x32_bf16 v[148:151], v[104:107], a[116:119], v[148:151]
  ds_read_b128 v[96:99], v9 offset:8192
  v_mul_f32 v166, s45, v166
  v_mfma_f32_16x16x32_bf16 v[156:159], v[104:107], a[172:175], v[156:159]
  v_mul_f32 v167, s45, v167
  s_waitcnt lgkmcnt(3)
  v_mfma_f32_16x16x32_bf16 v[144:147], v[108:111], a[120:123], v[144:147]
  ds_read_b128 v[100:103], v6 offset:256
  v_cvt_pk_bf16_f32 v200, v160, v161
  v_mfma_f32_16x16x32_bf16 v[152:155], v[108:111], a[176:179], v[152:155]
  v_cvt_pk_bf16_f32 v201, v162, v163
  s_waitcnt lgkmcnt(3)
  v_mfma_f32_16x16x32_bf16 v[148:151], v[112:115], a[120:123], v[148:151]
  ds_read_b128 v[104:107], v6 offset:8448
  v_cvt_pk_bf16_f32 v202, v164, v165
  v_mfma_f32_16x16x32_bf16 v[156:159], v[112:115], a[176:179], v[156:159]
  v_cvt_pk_bf16_f32 v203, v166, v167
  s_waitcnt lgkmcnt(3)
  v_mfma_f32_16x16x32_bf16 v[144:147], v[92:95], a[124:127], v[144:147]
  ds_read_b128 v[108:111], v7 offset:256
  v_accvgpr_write_b32 a164, v200
  v_mfma_f32_16x16x32_bf16 v[152:155], v[92:95], a[180:183], v[152:155]
  v_accvgpr_write_b32 a165, v201
  s_waitcnt lgkmcnt(3)
  v_mfma_f32_16x16x32_bf16 v[148:151], v[96:99], a[124:127], v[148:151]
  ds_read_b128 v[112:115], v7 offset:8448
  v_accvgpr_write_b32 a166, v202
  v_mfma_f32_16x16x32_bf16 v[156:159], v[96:99], a[180:183], v[156:159]
  v_accvgpr_write_b32 a167, v203
  s_waitcnt lgkmcnt(3)
  v_mfma_f32_16x16x32_bf16 v[144:147], v[100:103], a[128:131], v[144:147]
  ds_read_b128 v[92:95], v8 offset:256
  v_mul_f32 v168, s45, v168
  v_mfma_f32_16x16x32_bf16 v[152:155], v[100:103], a[184:187], v[152:155]
  s_waitcnt vmcnt(0)
  ds_read_b128 a[224:227], v14 offset:0
  v_mul_f32 v169, s45, v169
  s_waitcnt lgkmcnt(4)
  v_mfma_f32_16x16x32_bf16 v[148:151], v[104:107], a[128:131], v[148:151]
  ds_read_b128 v[96:99], v8 offset:8448
  v_mul_f32 v170, s45, v170
  v_mfma_f32_16x16x32_bf16 v[156:159], v[104:107], a[184:187], v[156:159]
  v_mul_f32 v171, s45, v171
  s_waitcnt lgkmcnt(4)
  v_mfma_f32_16x16x32_bf16 v[144:147], v[108:111], a[132:135], v[144:147]
  ds_read_b128 v[100:103], v9 offset:256
  v_mul_f32 v172, s45, v172
  v_mfma_f32_16x16x32_bf16 v[152:155], v[108:111], a[188:191], v[152:155]
  v_mul_f32 v173, s45, v173
  s_waitcnt lgkmcnt(4)
  v_mfma_f32_16x16x32_bf16 v[148:151], v[112:115], a[132:135], v[148:151]
  ds_read_b128 v[104:107], v9 offset:8448
  v_mul_f32 v174, s45, v174
  v_mfma_f32_16x16x32_bf16 v[156:159], v[112:115], a[188:191], v[156:159]
  ds_read_b128 a[228:231], v15 offset:0
  v_mul_f32 v175, s45, v175
  s_waitcnt lgkmcnt(5)
  v_mfma_f32_16x16x32_bf16 v[144:147], v[92:95], a[136:139], v[144:147]
  ds_read_b128 v[108:111], v6 offset:16384
  v_cvt_pk_bf16_f32 v204, v168, v169
  v_mfma_f32_16x16x32_bf16 v[152:155], v[92:95], a[192:195], v[152:155]
  v_cvt_pk_bf16_f32 v205, v170, v171
  s_waitcnt lgkmcnt(4)
  v_mfma_f32_16x16x32_bf16 v[148:151], v[96:99], a[136:139], v[148:151]
  ds_read_b128 v[112:115], v6 offset:24576
  v_cvt_pk_bf16_f32 v206, v172, v173
  v_mfma_f32_16x16x32_bf16 v[156:159], v[96:99], a[192:195], v[156:159]
  v_cvt_pk_bf16_f32 v207, v174, v175
  s_waitcnt lgkmcnt(4)
  v_mfma_f32_16x16x32_bf16 v[144:147], v[100:103], a[140:143], v[144:147]
  ds_read_b128 v[92:95], v7 offset:16384
  v_accvgpr_write_b32 a220, v204
  v_mfma_f32_16x16x32_bf16 v[152:155], v[100:103], a[196:199], v[152:155]
  ds_read_b128 a[232:235], v16 offset:0
  v_accvgpr_write_b32 a221, v205
  s_waitcnt lgkmcnt(5)
  v_mfma_f32_16x16x32_bf16 v[148:151], v[104:107], a[140:143], v[148:151]
  ds_read_b128 v[96:99], v7 offset:24576
  v_accvgpr_write_b32 a222, v206
  v_mfma_f32_16x16x32_bf16 v[156:159], v[104:107], a[196:199], v[156:159]
  v_accvgpr_write_b32 a223, v207
  s_waitcnt lgkmcnt(4)
  v_mfma_f32_16x16x32_bf16 v[160:163], v[108:111], a[112:115], 0
  ds_read_b128 v[100:103], v8 offset:16384
  v_mfma_f32_16x16x32_bf16 v[168:171], v[108:111], a[168:171], 0
  s_waitcnt lgkmcnt(4)
  v_mfma_f32_16x16x32_bf16 v[164:167], v[112:115], a[112:115], 0
  ds_read_b128 v[104:107], v8 offset:24576
  v_mfma_f32_16x16x32_bf16 v[172:175], v[112:115], a[168:171], 0
  v_mul_f32 v144, s45, v144
  s_waitcnt lgkmcnt(4)
  v_mfma_f32_16x16x32_bf16 v[160:163], v[92:95], a[116:119], v[160:163]
  ds_read_b128 v[108:111], v9 offset:16384
  v_mul_f32 v145, s45, v145
  v_mfma_f32_16x16x32_bf16 v[168:171], v[92:95], a[172:175], v[168:171]
  ds_read_b128 a[236:239], v17 offset:0
  v_mul_f32 v146, s45, v146
  s_waitcnt lgkmcnt(4)
  v_mfma_f32_16x16x32_bf16 v[164:167], v[96:99], a[116:119], v[164:167]
  ds_read_b128 v[112:115], v9 offset:24576
  v_mul_f32 v147, s45, v147
  v_mfma_f32_16x16x32_bf16 v[172:175], v[96:99], a[172:175], v[172:175]
  v_mul_f32 v148, s45, v148
  s_waitcnt lgkmcnt(4)
  v_mfma_f32_16x16x32_bf16 v[160:163], v[100:103], a[120:123], v[160:163]
  ds_read_b128 v[92:95], v6 offset:16640
  v_mul_f32 v149, s45, v149
  v_mfma_f32_16x16x32_bf16 v[168:171], v[100:103], a[176:179], v[168:171]
  v_mul_f32 v150, s45, v150
  s_waitcnt lgkmcnt(4)
  v_mfma_f32_16x16x32_bf16 v[164:167], v[104:107], a[120:123], v[164:167]
  ds_read_b128 v[96:99], v6 offset:24832
  v_mul_f32 v151, s45, v151
  v_mfma_f32_16x16x32_bf16 v[172:175], v[104:107], a[176:179], v[172:175]
  ds_read_b128 a[240:243], v14 offset:256
  v_cvt_pk_bf16_f32 v120, v144, v145
  s_waitcnt lgkmcnt(5)
  v_mfma_f32_16x16x32_bf16 v[160:163], v[108:111], a[124:127], v[160:163]
  ds_read_b128 v[100:103], v7 offset:16640
  v_cvt_pk_bf16_f32 v121, v146, v147
  v_mfma_f32_16x16x32_bf16 v[168:171], v[108:111], a[180:183], v[168:171]
  v_cvt_pk_bf16_f32 v122, v148, v149
  s_waitcnt lgkmcnt(4)
  v_mfma_f32_16x16x32_bf16 v[164:167], v[112:115], a[124:127], v[164:167]
  ds_read_b128 v[104:107], v7 offset:24832
  v_cvt_pk_bf16_f32 v123, v150, v151
  v_mfma_f32_16x16x32_bf16 v[172:175], v[112:115], a[180:183], v[172:175]
  v_mul_f32 v152, s45, v152
  s_waitcnt lgkmcnt(4)
  v_mfma_f32_16x16x32_bf16 v[160:163], v[92:95], a[128:131], v[160:163]
  ds_read_b128 v[108:111], v8 offset:16640
  v_mul_f32 v153, s45, v153
  v_mfma_f32_16x16x32_bf16 v[168:171], v[92:95], a[184:187], v[168:171]
  ds_read_b128 a[244:247], v15 offset:256
  v_mul_f32 v154, s45, v154
  s_waitcnt lgkmcnt(5)
  v_mfma_f32_16x16x32_bf16 v[164:167], v[96:99], a[128:131], v[164:167]
  ds_read_b128 v[112:115], v8 offset:24832
  v_mul_f32 v155, s45, v155
  v_mfma_f32_16x16x32_bf16 v[172:175], v[96:99], a[184:187], v[172:175]
  v_mul_f32 v156, s45, v156
  s_waitcnt lgkmcnt(4)
  v_mfma_f32_16x16x32_bf16 v[160:163], v[100:103], a[132:135], v[160:163]
  ds_read_b128 v[92:95], v9 offset:16640
  v_mul_f32 v157, s45, v157
  v_mfma_f32_16x16x32_bf16 v[168:171], v[100:103], a[188:191], v[168:171]
  v_mul_f32 v158, s45, v158
  s_waitcnt lgkmcnt(4)
  v_mfma_f32_16x16x32_bf16 v[164:167], v[104:107], a[132:135], v[164:167]
  ds_read_b128 v[96:99], v9 offset:24832
  v_mul_f32 v159, s45, v159
  v_mfma_f32_16x16x32_bf16 v[172:175], v[104:107], a[188:191], v[172:175]
  ds_read_b128 a[248:251], v16 offset:256
  v_cvt_pk_bf16_f32 v176, v152, v153
  s_waitcnt lgkmcnt(5)
  v_mfma_f32_16x16x32_bf16 v[160:163], v[108:111], a[136:139], v[160:163]
  ds_read_b128 v[100:103], v6 offset:32768
  v_cvt_pk_bf16_f32 v177, v154, v155
  v_mfma_f32_16x16x32_bf16 v[168:171], v[108:111], a[192:195], v[168:171]
  v_cvt_pk_bf16_f32 v178, v156, v157
  s_waitcnt lgkmcnt(4)
  v_mfma_f32_16x16x32_bf16 v[164:167], v[112:115], a[136:139], v[164:167]
  ds_read_b128 v[104:107], v6 offset:40960
  v_cvt_pk_bf16_f32 v179, v158, v159
  v_mfma_f32_16x16x32_bf16 v[172:175], v[112:115], a[192:195], v[172:175]
  s_waitcnt lgkmcnt(4)
  v_mfma_f32_16x16x32_bf16 v[160:163], v[92:95], a[140:143], v[160:163]
  ds_read_b128 v[108:111], v7 offset:32768
  v_mfma_f32_16x16x32_bf16 v[168:171], v[92:95], a[196:199], v[168:171]
  ds_read_b128 a[252:255], v17 offset:256
  s_waitcnt lgkmcnt(5)
  v_mfma_f32_16x16x32_bf16 v[164:167], v[96:99], a[140:143], v[164:167]
  ds_read_b128 v[112:115], v7 offset:40960
  v_mfma_f32_16x16x32_bf16 v[172:175], v[96:99], a[196:199], v[172:175]
  s_waitcnt lgkmcnt(4)
  v_mfma_f32_16x16x32_bf16 v[144:147], v[100:103], a[112:115], 0
  ds_read_b128 v[92:95], v8 offset:32768
  v_mfma_f32_16x16x32_bf16 v[152:155], v[100:103], a[168:171], 0
  s_waitcnt lgkmcnt(4)
  v_mfma_f32_16x16x32_bf16 v[148:151], v[104:107], a[112:115], 0
  ds_read_b128 v[96:99], v8 offset:40960
  v_mfma_f32_16x16x32_bf16 v[156:159], v[104:107], a[168:171], 0
  v_mul_f32 v160, s45, v160
  s_waitcnt lgkmcnt(4)
  v_mfma_f32_16x16x32_bf16 v[144:147], v[108:111], a[116:119], v[144:147]
  ds_read_b128 v[100:103], v9 offset:32768
  v_mul_f32 v161, s45, v161
  v_mfma_f32_16x16x32_bf16 v[152:155], v[108:111], a[172:175], v[152:155]
  v_mul_f32 v162, s45, v162
  s_waitcnt lgkmcnt(3)
  v_mfma_f32_16x16x32_bf16 v[148:151], v[112:115], a[116:119], v[148:151]
  ds_read_b128 v[104:107], v9 offset:40960
  v_mul_f32 v163, s45, v163
  v_mfma_f32_16x16x32_bf16 v[156:159], v[112:115], a[172:175], v[156:159]
  v_mul_f32 v164, s45, v164
  s_waitcnt lgkmcnt(3)
  v_mfma_f32_16x16x32_bf16 v[144:147], v[92:95], a[120:123], v[144:147]
  ds_read_b128 v[108:111], v6 offset:33024
  v_mul_f32 v165, s45, v165
  v_mfma_f32_16x16x32_bf16 v[152:155], v[92:95], a[176:179], v[152:155]
  v_mul_f32 v166, s45, v166
  s_waitcnt lgkmcnt(3)
  v_mfma_f32_16x16x32_bf16 v[148:151], v[96:99], a[120:123], v[148:151]
  ds_read_b128 v[112:115], v6 offset:41216
  v_mul_f32 v167, s45, v167
  v_mfma_f32_16x16x32_bf16 v[156:159], v[96:99], a[176:179], v[156:159]
  v_cvt_pk_bf16_f32 v124, v160, v161
  s_waitcnt lgkmcnt(3)
  v_mfma_f32_16x16x32_bf16 v[144:147], v[100:103], a[124:127], v[144:147]
  ds_read_b128 v[92:95], v7 offset:33024
  v_cvt_pk_bf16_f32 v125, v162, v163
  v_mfma_f32_16x16x32_bf16 v[152:155], v[100:103], a[180:183], v[152:155]
  v_cvt_pk_bf16_f32 v126, v164, v165
  s_waitcnt lgkmcnt(3)
  v_mfma_f32_16x16x32_bf16 v[148:151], v[104:107], a[124:127], v[148:151]
  ds_read_b128 v[96:99], v7 offset:41216
  v_cvt_pk_bf16_f32 v127, v166, v167
  v_mfma_f32_16x16x32_bf16 v[156:159], v[104:107], a[180:183], v[156:159]
  v_mul_f32 v168, s45, v168
  s_waitcnt lgkmcnt(3)
  v_mfma_f32_16x16x32_bf16 v[144:147], v[108:111], a[128:131], v[144:147]
  ds_read_b128 v[100:103], v8 offset:33024
  v_mul_f32 v169, s45, v169
  v_mfma_f32_16x16x32_bf16 v[152:155], v[108:111], a[184:187], v[152:155]
  v_mul_f32 v170, s45, v170
  s_waitcnt lgkmcnt(3)
  v_mfma_f32_16x16x32_bf16 v[148:151], v[112:115], a[128:131], v[148:151]
  ds_read_b128 v[104:107], v8 offset:41216
  v_mul_f32 v171, s45, v171
  v_mfma_f32_16x16x32_bf16 v[156:159], v[112:115], a[184:187], v[156:159]
  v_mul_f32 v172, s45, v172
  s_waitcnt lgkmcnt(3)
  v_mfma_f32_16x16x32_bf16 v[144:147], v[92:95], a[132:135], v[144:147]
  ds_read_b128 v[108:111], v9 offset:33024
  v_mul_f32 v173, s45, v173
  v_mfma_f32_16x16x32_bf16 v[152:155], v[92:95], a[188:191], v[152:155]
  v_mul_f32 v174, s45, v174
  s_waitcnt lgkmcnt(3)
  v_mfma_f32_16x16x32_bf16 v[148:151], v[96:99], a[132:135], v[148:151]
  ds_read_b128 v[112:115], v9 offset:41216
  v_mul_f32 v175, s45, v175
  v_mfma_f32_16x16x32_bf16 v[156:159], v[96:99], a[188:191], v[156:159]
  v_cvt_pk_bf16_f32 v180, v168, v169
  s_waitcnt lgkmcnt(3)
  v_mfma_f32_16x16x32_bf16 v[144:147], v[100:103], a[136:139], v[144:147]
  ds_read_b128 v[92:95], v10 offset:0
  v_cvt_pk_bf16_f32 v181, v170, v171
  v_mfma_f32_16x16x32_bf16 v[152:155], v[100:103], a[192:195], v[152:155]
  v_cvt_pk_bf16_f32 v182, v172, v173
  s_waitcnt lgkmcnt(3)
  v_mfma_f32_16x16x32_bf16 v[148:151], v[104:107], a[136:139], v[148:151]
  ds_read_b128 v[96:99], v10 offset:8192
  v_cvt_pk_bf16_f32 v183, v174, v175
  v_mfma_f32_16x16x32_bf16 v[156:159], v[104:107], a[192:195], v[156:159]
  s_waitcnt lgkmcnt(3)
  v_mfma_f32_16x16x32_bf16 v[144:147], v[108:111], a[140:143], v[144:147]
  ds_read_b128 v[100:103], v11 offset:0
  v_mfma_f32_16x16x32_bf16 v[152:155], v[108:111], a[196:199], v[152:155]
  s_waitcnt lgkmcnt(3)
  v_mfma_f32_16x16x32_bf16 v[148:151], v[112:115], a[140:143], v[148:151]
  ds_read_b128 v[104:107], v11 offset:8192
  v_mfma_f32_16x16x32_bf16 v[156:159], v[112:115], a[196:199], v[156:159]
  s_waitcnt lgkmcnt(3)
  v_mfma_f32_16x16x32_bf16 v[160:163], v[92:95], a[112:115], 0
  ds_read_b128 v[108:111], v12 offset:0
  v_mfma_f32_16x16x32_bf16 v[168:171], v[92:95], a[168:171], 0
  s_waitcnt lgkmcnt(3)
  v_mfma_f32_16x16x32_bf16 v[164:167], v[96:99], a[112:115], 0
  ds_read_b128 v[112:115], v12 offset:8192
  v_mfma_f32_16x16x32_bf16 v[172:175], v[96:99], a[168:171], 0
  v_mul_f32 v144, s45, v144
  s_waitcnt lgkmcnt(3)
  v_mfma_f32_16x16x32_bf16 v[160:163], v[100:103], a[116:119], v[160:163]
  ds_read_b128 v[92:95], v13 offset:0
  v_mul_f32 v145, s45, v145
  v_mfma_f32_16x16x32_bf16 v[168:171], v[100:103], a[172:175], v[168:171]
  v_mul_f32 v146, s45, v146
  s_waitcnt lgkmcnt(3)
  v_mfma_f32_16x16x32_bf16 v[164:167], v[104:107], a[116:119], v[164:167]
  ds_read_b128 v[96:99], v13 offset:8192
  v_mul_f32 v147, s45, v147
  v_mfma_f32_16x16x32_bf16 v[172:175], v[104:107], a[172:175], v[172:175]
  v_mul_f32 v148, s45, v148
  s_waitcnt lgkmcnt(3)
  v_mfma_f32_16x16x32_bf16 v[160:163], v[108:111], a[120:123], v[160:163]
  ds_read_b128 v[100:103], v10 offset:256
  v_mul_f32 v149, s45, v149
  v_mfma_f32_16x16x32_bf16 v[168:171], v[108:111], a[176:179], v[168:171]
  v_mul_f32 v150, s45, v150
  s_waitcnt lgkmcnt(3)
  v_mfma_f32_16x16x32_bf16 v[164:167], v[112:115], a[120:123], v[164:167]
  ds_read_b128 v[104:107], v10 offset:8448
  v_mul_f32 v151, s45, v151
  v_mfma_f32_16x16x32_bf16 v[172:175], v[112:115], a[176:179], v[172:175]
  v_cvt_pk_bf16_f32 v128, v144, v145
  s_waitcnt lgkmcnt(3)
  v_mfma_f32_16x16x32_bf16 v[160:163], v[92:95], a[124:127], v[160:163]
  ds_read_b128 v[108:111], v11 offset:256
  v_cvt_pk_bf16_f32 v129, v146, v147
  v_mfma_f32_16x16x32_bf16 v[168:171], v[92:95], a[180:183], v[168:171]
  v_cvt_pk_bf16_f32 v130, v148, v149
  s_waitcnt lgkmcnt(3)
  v_mfma_f32_16x16x32_bf16 v[164:167], v[96:99], a[124:127], v[164:167]
  ds_read_b128 v[112:115], v11 offset:8448
  v_cvt_pk_bf16_f32 v131, v150, v151
  v_mfma_f32_16x16x32_bf16 v[172:175], v[96:99], a[180:183], v[172:175]
  v_mul_f32 v152, s45, v152
  s_waitcnt lgkmcnt(3)
  v_mfma_f32_16x16x32_bf16 v[160:163], v[100:103], a[128:131], v[160:163]
  ds_read_b128 v[92:95], v12 offset:256
  v_mul_f32 v153, s45, v153
  v_mfma_f32_16x16x32_bf16 v[168:171], v[100:103], a[184:187], v[168:171]
  v_mul_f32 v154, s45, v154
  s_waitcnt lgkmcnt(3)
  v_mfma_f32_16x16x32_bf16 v[164:167], v[104:107], a[128:131], v[164:167]
  ds_read_b128 v[96:99], v12 offset:8448
  v_mul_f32 v155, s45, v155
  v_mfma_f32_16x16x32_bf16 v[172:175], v[104:107], a[184:187], v[172:175]
  v_mul_f32 v156, s45, v156
  s_waitcnt lgkmcnt(3)
  v_mfma_f32_16x16x32_bf16 v[160:163], v[108:111], a[132:135], v[160:163]
  ds_read_b128 v[100:103], v13 offset:256
  v_mul_f32 v157, s45, v157
  v_mfma_f32_16x16x32_bf16 v[168:171], v[108:111], a[188:191], v[168:171]
  v_mul_f32 v158, s45, v158
  s_waitcnt lgkmcnt(3)
  v_mfma_f32_16x16x32_bf16 v[164:167], v[112:115], a[132:135], v[164:167]
  ds_read_b128 v[104:107], v13 offset:8448
  v_mul_f32 v159, s45, v159
  v_mfma_f32_16x16x32_bf16 v[172:175], v[112:115], a[188:191], v[172:175]
  v_cvt_pk_bf16_f32 v184, v152, v153
  s_waitcnt lgkmcnt(3)
  v_mfma_f32_16x16x32_bf16 v[160:163], v[92:95], a[136:139], v[160:163]
  ds_read_b128 v[108:111], v10 offset:16384
  v_cvt_pk_bf16_f32 v185, v154, v155
  v_mfma_f32_16x16x32_bf16 v[168:171], v[92:95], a[192:195], v[168:171]
  v_cvt_pk_bf16_f32 v186, v156, v157
  s_waitcnt lgkmcnt(3)
  v_mfma_f32_16x16x32_bf16 v[164:167], v[96:99], a[136:139], v[164:167]
  ds_read_b128 v[112:115], v10 offset:24576
  v_cvt_pk_bf16_f32 v187, v158, v159
  v_mfma_f32_16x16x32_bf16 v[172:175], v[96:99], a[192:195], v[172:175]
  s_waitcnt lgkmcnt(3)
  v_mfma_f32_16x16x32_bf16 v[160:163], v[100:103], a[140:143], v[160:163]
  ds_read_b128 v[92:95], v11 offset:16384
  v_mfma_f32_16x16x32_bf16 v[168:171], v[100:103], a[196:199], v[168:171]
  s_waitcnt lgkmcnt(3)
  v_mfma_f32_16x16x32_bf16 v[164:167], v[104:107], a[140:143], v[164:167]
  ds_read_b128 v[96:99], v11 offset:24576
  v_mfma_f32_16x16x32_bf16 v[172:175], v[104:107], a[196:199], v[172:175]
  s_waitcnt lgkmcnt(3)
  v_mfma_f32_16x16x32_bf16 v[144:147], v[108:111], a[112:115], 0
  ds_read_b128 v[100:103], v12 offset:16384
  v_mfma_f32_16x16x32_bf16 v[152:155], v[108:111], a[168:171], 0
  s_waitcnt lgkmcnt(3)
  v_mfma_f32_16x16x32_bf16 v[148:151], v[112:115], a[112:115], 0
  ds_read_b128 v[104:107], v12 offset:24576
  v_mfma_f32_16x16x32_bf16 v[156:159], v[112:115], a[168:171], 0
  v_mul_f32 v160, s45, v160
  s_waitcnt lgkmcnt(3)
  v_mfma_f32_16x16x32_bf16 v[144:147], v[92:95], a[116:119], v[144:147]
  ds_read_b128 v[108:111], v13 offset:16384
  v_mul_f32 v161, s45, v161
  v_mfma_f32_16x16x32_bf16 v[152:155], v[92:95], a[172:175], v[152:155]
  v_mul_f32 v162, s45, v162
  s_waitcnt lgkmcnt(3)
  v_mfma_f32_16x16x32_bf16 v[148:151], v[96:99], a[116:119], v[148:151]
  ds_read_b128 v[112:115], v13 offset:24576
  v_mul_f32 v163, s45, v163
  v_mfma_f32_16x16x32_bf16 v[156:159], v[96:99], a[172:175], v[156:159]
  v_mul_f32 v164, s45, v164
  s_waitcnt lgkmcnt(3)
  v_mfma_f32_16x16x32_bf16 v[144:147], v[100:103], a[120:123], v[144:147]
  ds_read_b128 v[92:95], v10 offset:16640
  v_mul_f32 v165, s45, v165
  v_mfma_f32_16x16x32_bf16 v[152:155], v[100:103], a[176:179], v[152:155]
  v_mul_f32 v166, s45, v166
  s_waitcnt lgkmcnt(3)
  v_mfma_f32_16x16x32_bf16 v[148:151], v[104:107], a[120:123], v[148:151]
  ds_read_b128 v[96:99], v10 offset:24832
  v_mul_f32 v167, s45, v167
  v_mfma_f32_16x16x32_bf16 v[156:159], v[104:107], a[176:179], v[156:159]
  v_cvt_pk_bf16_f32 v132, v160, v161
  s_waitcnt lgkmcnt(3)
  v_mfma_f32_16x16x32_bf16 v[144:147], v[108:111], a[124:127], v[144:147]
  ds_read_b128 v[100:103], v11 offset:16640
  v_cvt_pk_bf16_f32 v133, v162, v163
  v_mfma_f32_16x16x32_bf16 v[152:155], v[108:111], a[180:183], v[152:155]
  v_cvt_pk_bf16_f32 v134, v164, v165
  s_waitcnt lgkmcnt(3)
  v_mfma_f32_16x16x32_bf16 v[148:151], v[112:115], a[124:127], v[148:151]
  ds_read_b128 v[104:107], v11 offset:24832
  v_cvt_pk_bf16_f32 v135, v166, v167
  v_mfma_f32_16x16x32_bf16 v[156:159], v[112:115], a[180:183], v[156:159]
  v_mul_f32 v168, s45, v168
  s_waitcnt lgkmcnt(3)
  v_mfma_f32_16x16x32_bf16 v[144:147], v[92:95], a[128:131], v[144:147]
  ds_read_b128 v[108:111], v12 offset:16640
  v_mul_f32 v169, s45, v169
  v_mfma_f32_16x16x32_bf16 v[152:155], v[92:95], a[184:187], v[152:155]
  v_mul_f32 v170, s45, v170
  s_waitcnt lgkmcnt(3)
  v_mfma_f32_16x16x32_bf16 v[148:151], v[96:99], a[128:131], v[148:151]
  ds_read_b128 v[112:115], v12 offset:24832
  v_mul_f32 v171, s45, v171
  v_mfma_f32_16x16x32_bf16 v[156:159], v[96:99], a[184:187], v[156:159]
  v_mul_f32 v172, s45, v172
  s_waitcnt lgkmcnt(3)
  v_mfma_f32_16x16x32_bf16 v[144:147], v[100:103], a[132:135], v[144:147]
  ds_read_b128 v[92:95], v13 offset:16640
  v_mul_f32 v173, s45, v173
  v_mfma_f32_16x16x32_bf16 v[152:155], v[100:103], a[188:191], v[152:155]
  v_mul_f32 v174, s45, v174
  s_waitcnt lgkmcnt(3)
  v_mfma_f32_16x16x32_bf16 v[148:151], v[104:107], a[132:135], v[148:151]
  ds_read_b128 v[96:99], v13 offset:24832
  v_mul_f32 v175, s45, v175
  v_mfma_f32_16x16x32_bf16 v[156:159], v[104:107], a[188:191], v[156:159]
  v_cvt_pk_bf16_f32 v188, v168, v169
  s_waitcnt lgkmcnt(3)
  v_mfma_f32_16x16x32_bf16 v[144:147], v[108:111], a[136:139], v[144:147]
  ds_read_b128 v[100:103], v10 offset:32768
  v_cvt_pk_bf16_f32 v189, v170, v171
  v_mfma_f32_16x16x32_bf16 v[152:155], v[108:111], a[192:195], v[152:155]
  v_cvt_pk_bf16_f32 v190, v172, v173
  s_waitcnt lgkmcnt(3)
  v_mfma_f32_16x16x32_bf16 v[148:151], v[112:115], a[136:139], v[148:151]
  ds_read_b128 v[104:107], v10 offset:40960
  v_cvt_pk_bf16_f32 v191, v174, v175
  v_mfma_f32_16x16x32_bf16 v[156:159], v[112:115], a[192:195], v[156:159]
  s_waitcnt lgkmcnt(3)
  v_mfma_f32_16x16x32_bf16 v[144:147], v[92:95], a[140:143], v[144:147]
  ds_read_b128 v[108:111], v11 offset:32768
  v_mfma_f32_16x16x32_bf16 v[152:155], v[92:95], a[196:199], v[152:155]
  s_waitcnt lgkmcnt(3)
  v_mfma_f32_16x16x32_bf16 v[148:151], v[96:99], a[140:143], v[148:151]
  ds_read_b128 v[112:115], v11 offset:40960
  v_mfma_f32_16x16x32_bf16 v[156:159], v[96:99], a[196:199], v[156:159]
  s_waitcnt lgkmcnt(3)
  v_mfma_f32_16x16x32_bf16 v[160:163], v[100:103], a[112:115], 0
  ds_read_b128 v[92:95], v12 offset:32768
  v_mfma_f32_16x16x32_bf16 v[168:171], v[100:103], a[168:171], 0
  s_waitcnt lgkmcnt(3)
  v_mfma_f32_16x16x32_bf16 v[164:167], v[104:107], a[112:115], 0
  ds_read_b128 v[96:99], v12 offset:40960
  v_mfma_f32_16x16x32_bf16 v[172:175], v[104:107], a[168:171], 0
  v_mul_f32 v144, s45, v144
  s_waitcnt lgkmcnt(3)
  v_mfma_f32_16x16x32_bf16 v[160:163], v[108:111], a[116:119], v[160:163]
  ds_read_b128 v[100:103], v13 offset:32768
  v_mul_f32 v145, s45, v145
  v_mfma_f32_16x16x32_bf16 v[168:171], v[108:111], a[172:175], v[168:171]
  v_mul_f32 v146, s45, v146
  s_waitcnt lgkmcnt(3)
  v_mfma_f32_16x16x32_bf16 v[164:167], v[112:115], a[116:119], v[164:167]
  ds_read_b128 v[104:107], v13 offset:40960
  v_mul_f32 v147, s45, v147
  v_mfma_f32_16x16x32_bf16 v[172:175], v[112:115], a[172:175], v[172:175]
  v_mul_f32 v148, s45, v148
  s_waitcnt lgkmcnt(3)
  v_mfma_f32_16x16x32_bf16 v[160:163], v[92:95], a[120:123], v[160:163]
  ds_read_b128 v[108:111], v10 offset:33024
  v_mul_f32 v149, s45, v149
  v_mfma_f32_16x16x32_bf16 v[168:171], v[92:95], a[176:179], v[168:171]
  v_mul_f32 v150, s45, v150
  s_waitcnt lgkmcnt(3)
  v_mfma_f32_16x16x32_bf16 v[164:167], v[96:99], a[120:123], v[164:167]
  ds_read_b128 v[112:115], v10 offset:41216
  v_mul_f32 v151, s45, v151
  v_mfma_f32_16x16x32_bf16 v[172:175], v[96:99], a[176:179], v[172:175]
  v_cvt_pk_bf16_f32 v136, v144, v145
  s_waitcnt lgkmcnt(3)
  v_mfma_f32_16x16x32_bf16 v[160:163], v[100:103], a[124:127], v[160:163]
  ds_read_b128 v[92:95], v11 offset:33024
  v_cvt_pk_bf16_f32 v137, v146, v147
  v_mfma_f32_16x16x32_bf16 v[168:171], v[100:103], a[180:183], v[168:171]
  v_cvt_pk_bf16_f32 v138, v148, v149
  s_waitcnt lgkmcnt(3)
  v_mfma_f32_16x16x32_bf16 v[164:167], v[104:107], a[124:127], v[164:167]
  ds_read_b128 v[96:99], v11 offset:41216
  v_cvt_pk_bf16_f32 v139, v150, v151
  v_mfma_f32_16x16x32_bf16 v[172:175], v[104:107], a[180:183], v[172:175]
  v_mul_f32 v152, s45, v152
  s_waitcnt lgkmcnt(3)
  v_mfma_f32_16x16x32_bf16 v[160:163], v[108:111], a[128:131], v[160:163]
  ds_read_b128 v[100:103], v12 offset:33024
  v_mul_f32 v153, s45, v153
  v_mfma_f32_16x16x32_bf16 v[168:171], v[108:111], a[184:187], v[168:171]
  v_mul_f32 v154, s45, v154
  s_waitcnt lgkmcnt(3)
  v_mfma_f32_16x16x32_bf16 v[164:167], v[112:115], a[128:131], v[164:167]
  ds_read_b128 v[104:107], v12 offset:41216
  v_mul_f32 v155, s45, v155
  v_mfma_f32_16x16x32_bf16 v[172:175], v[112:115], a[184:187], v[172:175]
  v_mul_f32 v156, s45, v156
  s_waitcnt lgkmcnt(3)
  v_mfma_f32_16x16x32_bf16 v[160:163], v[92:95], a[132:135], v[160:163]
  ds_read_b128 v[108:111], v13 offset:33024
  v_mul_f32 v157, s45, v157
  v_mfma_f32_16x16x32_bf16 v[168:171], v[92:95], a[188:191], v[168:171]
  v_mul_f32 v158, s45, v158
  s_waitcnt lgkmcnt(3)
  v_mfma_f32_16x16x32_bf16 v[164:167], v[96:99], a[132:135], v[164:167]
  ds_read_b128 v[112:115], v13 offset:41216
  v_mul_f32 v159, s45, v159
  v_mfma_f32_16x16x32_bf16 v[172:175], v[96:99], a[188:191], v[172:175]
  v_cvt_pk_bf16_f32 v192, v152, v153
  s_waitcnt lgkmcnt(3)
  v_mfma_f32_16x16x32_bf16 v[160:163], v[100:103], a[136:139], v[160:163]
  v_cvt_pk_bf16_f32 v193, v154, v155
  v_mfma_f32_16x16x32_bf16 v[168:171], v[100:103], a[192:195], v[168:171]
  v_cvt_pk_bf16_f32 v194, v156, v157
  s_waitcnt lgkmcnt(2)
  v_mfma_f32_16x16x32_bf16 v[164:167], v[104:107], a[136:139], v[164:167]
  v_cvt_pk_bf16_f32 v195, v158, v159
  v_mfma_f32_16x16x32_bf16 v[172:175], v[104:107], a[192:195], v[172:175]
  s_waitcnt lgkmcnt(1)
  v_mfma_f32_16x16x32_bf16 v[160:163], v[108:111], a[140:143], v[160:163]
  v_mfma_f32_16x16x32_bf16 v[168:171], v[108:111], a[196:199], v[168:171]
  s_waitcnt lgkmcnt(0)
  v_mfma_f32_16x16x32_bf16 v[164:167], v[112:115], a[140:143], v[164:167]
  v_mfma_f32_16x16x32_bf16 v[172:175], v[112:115], a[196:199], v[172:175]
  global_load_dword v27, v26, s[56:57] sc1
  ds_read_b128 v[92:95], v6 offset:0
  ds_read_b128 v[96:99], v6 offset:8192
  ds_read_b128 v[100:103], v7 offset:0
  ds_read_b128 v[104:107], v7 offset:8192
  s_waitcnt lgkmcnt(3)
  v_mfma_f32_16x16x32_bf16 v[144:147], v[92:95], a[224:227], 0
  ds_read_b128 v[108:111], v8 offset:0
  s_waitcnt lgkmcnt(3)
  v_mfma_f32_16x16x32_bf16 v[148:151], v[96:99], a[224:227], 0
  ds_read_b128 v[112:115], v8 offset:8192
  s_waitcnt lgkmcnt(3)
  v_mfma_f32_16x16x32_bf16 v[144:147], v[100:103], a[228:231], v[144:147]
  ds_read_b128 v[92:95], v9 offset:0
  s_waitcnt lgkmcnt(3)
  v_mfma_f32_16x16x32_bf16 v[148:151], v[104:107], a[228:231], v[148:151]
  ds_read_b128 v[96:99], v9 offset:8192
  v_mul_f32 v160, s45, v160
  v_mul_f32 v161, s45, v161
  s_waitcnt lgkmcnt(3)
  v_mfma_f32_16x16x32_bf16 v[144:147], v[108:111], a[232:235], v[144:147]
  ds_read_b128 v[100:103], v6 offset:256
  v_mul_f32 v162, s45, v162
  v_mul_f32 v163, s45, v163
  s_waitcnt lgkmcnt(3)
  v_mfma_f32_16x16x32_bf16 v[148:151], v[112:115], a[232:235], v[148:151]
  ds_read_b128 v[104:107], v6 offset:8448
  v_mul_f32 v164, s45, v164
  v_mul_f32 v165, s45, v165
  s_waitcnt lgkmcnt(3)
  v_mfma_f32_16x16x32_bf16 v[144:147], v[92:95], a[236:239], v[144:147]
  ds_read_b128 v[108:111], v7 offset:256
  v_mul_f32 v166, s45, v166
  v_mul_f32 v167, s45, v167
  s_waitcnt lgkmcnt(3)
  v_mfma_f32_16x16x32_bf16 v[148:151], v[96:99], a[236:239], v[148:151]
  ds_read_b128 v[112:115], v7 offset:8448
  v_cvt_pk_bf16_f32 v140, v160, v161
  v_cvt_pk_bf16_f32 v141, v162, v163
  s_waitcnt lgkmcnt(3)
  v_mfma_f32_16x16x32_bf16 v[144:147], v[100:103], a[240:243], v[144:147]
  ds_read_b128 v[92:95], v8 offset:256
  v_cvt_pk_bf16_f32 v142, v164, v165
  v_cvt_pk_bf16_f32 v143, v166, v167
  s_waitcnt lgkmcnt(3)
  v_mfma_f32_16x16x32_bf16 v[148:151], v[104:107], a[240:243], v[148:151]
  ds_read_b128 v[96:99], v8 offset:8448
  v_mul_f32 v168, s45, v168
  v_mul_f32 v169, s45, v169
  s_waitcnt lgkmcnt(3)
  v_mfma_f32_16x16x32_bf16 v[144:147], v[108:111], a[244:247], v[144:147]
  ds_read_b128 v[100:103], v9 offset:256
  v_mul_f32 v170, s45, v170
  v_mul_f32 v171, s45, v171
  s_waitcnt lgkmcnt(3)
  v_mfma_f32_16x16x32_bf16 v[148:151], v[112:115], a[244:247], v[148:151]
  ds_read_b128 v[104:107], v9 offset:8448
  v_mul_f32 v172, s45, v172
  v_mul_f32 v173, s45, v173
  s_waitcnt lgkmcnt(3)
  v_mfma_f32_16x16x32_bf16 v[144:147], v[92:95], a[248:251], v[144:147]
  ds_read_b128 v[108:111], v6 offset:16384
  v_mul_f32 v174, s45, v174
  v_mul_f32 v175, s45, v175
  s_waitcnt lgkmcnt(3)
  v_mfma_f32_16x16x32_bf16 v[148:151], v[96:99], a[248:251], v[148:151]
  ds_read_b128 v[112:115], v6 offset:24576
  v_cvt_pk_bf16_f32 v196, v168, v169
  v_cvt_pk_bf16_f32 v197, v170, v171
  s_waitcnt lgkmcnt(3)
  v_mfma_f32_16x16x32_bf16 v[144:147], v[100:103], a[252:255], v[144:147]
  ds_read_b128 v[92:95], v7 offset:16384
  v_cvt_pk_bf16_f32 v198, v172, v173
  s_waitcnt lgkmcnt(3)
  v_mfma_f32_16x16x32_bf16 v[148:151], v[104:107], a[252:255], v[148:151]
  ds_read_b128 v[96:99], v7 offset:24576
  v_cvt_pk_bf16_f32 v199, v174, v175
  s_waitcnt lgkmcnt(3)
  v_mfma_f32_16x16x32_bf16 v[160:163], v[108:111], a[224:227], 0
  ds_read_b128 v[100:103], v8 offset:16384
  s_waitcnt lgkmcnt(3)
  v_mfma_f32_16x16x32_bf16 v[164:167], v[112:115], a[224:227], 0
  ds_read_b128 v[104:107], v8 offset:24576
  s_waitcnt lgkmcnt(3)
  v_mfma_f32_16x16x32_bf16 v[160:163], v[92:95], a[228:231], v[160:163]
  ds_read_b128 v[108:111], v9 offset:16384
  s_waitcnt lgkmcnt(3)
  v_mfma_f32_16x16x32_bf16 v[164:167], v[96:99], a[228:231], v[164:167]
  ds_read_b128 v[112:115], v9 offset:24576
  v_mul_f32 v144, s45, v144
  s_waitcnt lgkmcnt(3)
  v_mfma_f32_16x16x32_bf16 v[160:163], v[100:103], a[232:235], v[160:163]
  ds_read_b128 v[92:95], v6 offset:16640
  v_mul_f32 v145, s45, v145
  s_waitcnt lgkmcnt(3)
  v_mfma_f32_16x16x32_bf16 v[164:167], v[104:107], a[232:235], v[164:167]
  ds_read_b128 v[96:99], v6 offset:24832
  v_mul_f32 v146, s45, v146
  s_waitcnt lgkmcnt(3)
  v_mfma_f32_16x16x32_bf16 v[160:163], v[108:111], a[236:239], v[160:163]
  ds_read_b128 v[100:103], v7 offset:16640
  v_mul_f32 v147, s45, v147
  s_waitcnt lgkmcnt(3)
  v_mfma_f32_16x16x32_bf16 v[164:167], v[112:115], a[236:239], v[164:167]
  ds_read_b128 v[104:107], v7 offset:24832
  v_mul_f32 v148, s45, v148
  s_waitcnt lgkmcnt(3)
  v_mfma_f32_16x16x32_bf16 v[160:163], v[92:95], a[240:243], v[160:163]
  ds_read_b128 v[108:111], v8 offset:16640
  v_mul_f32 v149, s45, v149
  s_waitcnt lgkmcnt(3)
  v_mfma_f32_16x16x32_bf16 v[164:167], v[96:99], a[240:243], v[164:167]
  ds_read_b128 v[112:115], v8 offset:24832
  v_mul_f32 v150, s45, v150
  s_waitcnt lgkmcnt(3)
  v_mfma_f32_16x16x32_bf16 v[160:163], v[100:103], a[244:247], v[160:163]
  ds_read_b128 v[92:95], v9 offset:16640
  v_mul_f32 v151, s45, v151
  s_waitcnt lgkmcnt(3)
  v_mfma_f32_16x16x32_bf16 v[164:167], v[104:107], a[244:247], v[164:167]
  ds_read_b128 v[96:99], v9 offset:24832
  v_cvt_pk_bf16_f32 v232, v144, v145
  s_waitcnt lgkmcnt(3)
  v_mfma_f32_16x16x32_bf16 v[160:163], v[108:111], a[248:251], v[160:163]
  ds_read_b128 v[100:103], v6 offset:32768
  v_cvt_pk_bf16_f32 v233, v146, v147
  s_waitcnt lgkmcnt(3)
  v_mfma_f32_16x16x32_bf16 v[164:167], v[112:115], a[248:251], v[164:167]
  ds_read_b128 v[104:107], v6 offset:40960
  v_cvt_pk_bf16_f32 v234, v148, v149
  s_waitcnt lgkmcnt(3)
  v_mfma_f32_16x16x32_bf16 v[160:163], v[92:95], a[252:255], v[160:163]
  ds_read_b128 v[108:111], v7 offset:32768
  v_cvt_pk_bf16_f32 v235, v150, v151
  s_waitcnt lgkmcnt(3)
  v_mfma_f32_16x16x32_bf16 v[164:167], v[96:99], a[252:255], v[164:167]
  ds_read_b128 v[112:115], v7 offset:40960
  s_waitcnt lgkmcnt(3)
  v_mfma_f32_16x16x32_bf16 v[144:147], v[100:103], a[224:227], 0
  ds_read_b128 v[92:95], v8 offset:32768
  s_waitcnt lgkmcnt(3)
  v_mfma_f32_16x16x32_bf16 v[148:151], v[104:107], a[224:227], 0
  ds_read_b128 v[96:99], v8 offset:40960
  s_waitcnt lgkmcnt(3)
  v_mfma_f32_16x16x32_bf16 v[144:147], v[108:111], a[228:231], v[144:147]
  ds_read_b128 v[100:103], v9 offset:32768
  s_waitcnt lgkmcnt(3)
  v_mfma_f32_16x16x32_bf16 v[148:151], v[112:115], a[228:231], v[148:151]
  ds_read_b128 v[104:107], v9 offset:40960
  v_mul_f32 v160, s45, v160
  s_waitcnt lgkmcnt(3)
  v_mfma_f32_16x16x32_bf16 v[144:147], v[92:95], a[232:235], v[144:147]
  ds_read_b128 v[108:111], v6 offset:33024
  v_mul_f32 v161, s45, v161
  s_waitcnt lgkmcnt(3)
  v_mfma_f32_16x16x32_bf16 v[148:151], v[96:99], a[232:235], v[148:151]
  ds_read_b128 v[112:115], v6 offset:41216
  v_mul_f32 v162, s45, v162
  s_waitcnt lgkmcnt(3)
  v_mfma_f32_16x16x32_bf16 v[144:147], v[100:103], a[236:239], v[144:147]
  ds_read_b128 v[92:95], v7 offset:33024
  v_mul_f32 v163, s45, v163
  s_waitcnt lgkmcnt(3)
  v_mfma_f32_16x16x32_bf16 v[148:151], v[104:107], a[236:239], v[148:151]
  ds_read_b128 v[96:99], v7 offset:41216
  v_mul_f32 v164, s45, v164
  s_waitcnt lgkmcnt(3)
  v_mfma_f32_16x16x32_bf16 v[144:147], v[108:111], a[240:243], v[144:147]
  ds_read_b128 v[100:103], v8 offset:33024
  v_mul_f32 v165, s45, v165
  s_waitcnt lgkmcnt(3)
  v_mfma_f32_16x16x32_bf16 v[148:151], v[112:115], a[240:243], v[148:151]
  ds_read_b128 v[104:107], v8 offset:41216
  v_mul_f32 v166, s45, v166
  s_waitcnt lgkmcnt(3)
  v_mfma_f32_16x16x32_bf16 v[144:147], v[92:95], a[244:247], v[144:147]
  ds_read_b128 v[108:111], v9 offset:33024
  v_mul_f32 v167, s45, v167
  s_waitcnt lgkmcnt(3)
  v_mfma_f32_16x16x32_bf16 v[148:151], v[96:99], a[244:247], v[148:151]
  ds_read_b128 v[112:115], v9 offset:41216
  v_cvt_pk_bf16_f32 v236, v160, v161
  s_waitcnt lgkmcnt(3)
  v_mfma_f32_16x16x32_bf16 v[144:147], v[100:103], a[248:251], v[144:147]
  ds_read_b128 v[92:95], v10 offset:0
  v_cvt_pk_bf16_f32 v237, v162, v163
  s_waitcnt lgkmcnt(3)
  v_mfma_f32_16x16x32_bf16 v[148:151], v[104:107], a[248:251], v[148:151]
  ds_read_b128 v[96:99], v10 offset:8192
  v_cvt_pk_bf16_f32 v238, v164, v165
  s_waitcnt lgkmcnt(3)
  v_mfma_f32_16x16x32_bf16 v[144:147], v[108:111], a[252:255], v[144:147]
  ds_read_b128 v[100:103], v11 offset:0
  v_cvt_pk_bf16_f32 v239, v166, v167
  s_waitcnt lgkmcnt(3)
  v_mfma_f32_16x16x32_bf16 v[148:151], v[112:115], a[252:255], v[148:151]
  ds_read_b128 v[104:107], v11 offset:8192
  s_waitcnt lgkmcnt(3)
  v_mfma_f32_16x16x32_bf16 v[160:163], v[92:95], a[224:227], 0
  ds_read_b128 v[108:111], v12 offset:0
  s_waitcnt lgkmcnt(3)
  v_mfma_f32_16x16x32_bf16 v[164:167], v[96:99], a[224:227], 0
  ds_read_b128 v[112:115], v12 offset:8192
  s_waitcnt lgkmcnt(3)
  v_mfma_f32_16x16x32_bf16 v[160:163], v[100:103], a[228:231], v[160:163]
  ds_read_b128 v[92:95], v13 offset:0
  s_waitcnt lgkmcnt(3)
  v_mfma_f32_16x16x32_bf16 v[164:167], v[104:107], a[228:231], v[164:167]
  ds_read_b128 v[96:99], v13 offset:8192
  v_mul_f32 v144, s45, v144
  s_waitcnt lgkmcnt(3)
  v_mfma_f32_16x16x32_bf16 v[160:163], v[108:111], a[232:235], v[160:163]
  ds_read_b128 v[100:103], v10 offset:256
  v_mul_f32 v145, s45, v145
  s_waitcnt lgkmcnt(3)
  v_mfma_f32_16x16x32_bf16 v[164:167], v[112:115], a[232:235], v[164:167]
  ds_read_b128 v[104:107], v10 offset:8448
  v_mul_f32 v146, s45, v146
  s_waitcnt lgkmcnt(3)
  v_mfma_f32_16x16x32_bf16 v[160:163], v[92:95], a[236:239], v[160:163]
  ds_read_b128 v[108:111], v11 offset:256
  v_mul_f32 v147, s45, v147
  s_waitcnt lgkmcnt(3)
  v_mfma_f32_16x16x32_bf16 v[164:167], v[96:99], a[236:239], v[164:167]
  ds_read_b128 v[112:115], v11 offset:8448
  v_mul_f32 v148, s45, v148
  s_waitcnt lgkmcnt(3)
  v_mfma_f32_16x16x32_bf16 v[160:163], v[100:103], a[240:243], v[160:163]
  ds_read_b128 v[92:95], v12 offset:256
  v_mul_f32 v149, s45, v149
  s_waitcnt lgkmcnt(3)
  v_mfma_f32_16x16x32_bf16 v[164:167], v[104:107], a[240:243], v[164:167]
  ds_read_b128 v[96:99], v12 offset:8448
  v_mul_f32 v150, s45, v150
  s_waitcnt lgkmcnt(3)
  v_mfma_f32_16x16x32_bf16 v[160:163], v[108:111], a[244:247], v[160:163]
  ds_read_b128 v[100:103], v13 offset:256
  v_mul_f32 v151, s45, v151
  s_waitcnt lgkmcnt(3)
  v_mfma_f32_16x16x32_bf16 v[164:167], v[112:115], a[244:247], v[164:167]
  ds_read_b128 v[104:107], v13 offset:8448
  v_cvt_pk_bf16_f32 v240, v144, v145
  s_waitcnt lgkmcnt(3)
  v_mfma_f32_16x16x32_bf16 v[160:163], v[92:95], a[248:251], v[160:163]
  ds_read_b128 v[108:111], v10 offset:16384
  v_cvt_pk_bf16_f32 v241, v146, v147
  s_waitcnt lgkmcnt(3)
  v_mfma_f32_16x16x32_bf16 v[164:167], v[96:99], a[248:251], v[164:167]
  ds_read_b128 v[112:115], v10 offset:24576
  v_cvt_pk_bf16_f32 v242, v148, v149
  s_waitcnt lgkmcnt(3)
  v_mfma_f32_16x16x32_bf16 v[160:163], v[100:103], a[252:255], v[160:163]
  ds_read_b128 v[92:95], v11 offset:16384
  v_cvt_pk_bf16_f32 v243, v150, v151
  s_waitcnt lgkmcnt(3)
  v_mfma_f32_16x16x32_bf16 v[164:167], v[104:107], a[252:255], v[164:167]
  ds_read_b128 v[96:99], v11 offset:24576
  s_waitcnt lgkmcnt(3)
  v_mfma_f32_16x16x32_bf16 v[144:147], v[108:111], a[224:227], 0
  ds_read_b128 v[100:103], v12 offset:16384
  s_waitcnt lgkmcnt(3)
  v_mfma_f32_16x16x32_bf16 v[148:151], v[112:115], a[224:227], 0
  ds_read_b128 v[104:107], v12 offset:24576
  s_waitcnt lgkmcnt(3)
  v_mfma_f32_16x16x32_bf16 v[144:147], v[92:95], a[228:231], v[144:147]
  ds_read_b128 v[108:111], v13 offset:16384
  s_waitcnt lgkmcnt(3)
  v_mfma_f32_16x16x32_bf16 v[148:151], v[96:99], a[228:231], v[148:151]
  ds_read_b128 v[112:115], v13 offset:24576
  v_mul_f32 v160, s45, v160
  s_waitcnt lgkmcnt(3)
  v_mfma_f32_16x16x32_bf16 v[144:147], v[100:103], a[232:235], v[144:147]
  ds_read_b128 v[92:95], v10 offset:16640
  v_mul_f32 v161, s45, v161
  s_waitcnt lgkmcnt(3)
  v_mfma_f32_16x16x32_bf16 v[148:151], v[104:107], a[232:235], v[148:151]
  ds_read_b128 v[96:99], v10 offset:24832
  v_mul_f32 v162, s45, v162
  s_waitcnt lgkmcnt(3)
  v_mfma_f32_16x16x32_bf16 v[144:147], v[108:111], a[236:239], v[144:147]
  ds_read_b128 v[100:103], v11 offset:16640
  v_mul_f32 v163, s45, v163
  s_waitcnt lgkmcnt(3)
  v_mfma_f32_16x16x32_bf16 v[148:151], v[112:115], a[236:239], v[148:151]
  ds_read_b128 v[104:107], v11 offset:24832
  v_mul_f32 v164, s45, v164
  s_waitcnt lgkmcnt(3)
  v_mfma_f32_16x16x32_bf16 v[144:147], v[92:95], a[240:243], v[144:147]
  ds_read_b128 v[108:111], v12 offset:16640
  v_mul_f32 v165, s45, v165
  s_waitcnt lgkmcnt(3)
  v_mfma_f32_16x16x32_bf16 v[148:151], v[96:99], a[240:243], v[148:151]
  ds_read_b128 v[112:115], v12 offset:24832
  v_mul_f32 v166, s45, v166
  s_waitcnt lgkmcnt(3)
  v_mfma_f32_16x16x32_bf16 v[144:147], v[100:103], a[244:247], v[144:147]
  ds_read_b128 v[92:95], v13 offset:16640
  v_mul_f32 v167, s45, v167
  s_waitcnt lgkmcnt(3)
  v_mfma_f32_16x16x32_bf16 v[148:151], v[104:107], a[244:247], v[148:151]
  ds_read_b128 v[96:99], v13 offset:24832
  v_cvt_pk_bf16_f32 v244, v160, v161
  s_waitcnt lgkmcnt(3)
  v_mfma_f32_16x16x32_bf16 v[144:147], v[108:111], a[248:251], v[144:147]
  ds_read_b128 v[100:103], v10 offset:32768
  v_cvt_pk_bf16_f32 v245, v162, v163
  s_waitcnt lgkmcnt(3)
  v_mfma_f32_16x16x32_bf16 v[148:151], v[112:115], a[248:251], v[148:151]
  ds_read_b128 v[104:107], v10 offset:40960
  v_cvt_pk_bf16_f32 v246, v164, v165
  s_waitcnt lgkmcnt(3)
  v_mfma_f32_16x16x32_bf16 v[144:147], v[92:95], a[252:255], v[144:147]
  ds_read_b128 v[108:111], v11 offset:32768
  v_cvt_pk_bf16_f32 v247, v166, v167
  s_waitcnt lgkmcnt(3)
  v_mfma_f32_16x16x32_bf16 v[148:151], v[96:99], a[252:255], v[148:151]
  ds_read_b128 v[112:115], v11 offset:40960
  s_waitcnt lgkmcnt(3)
  v_mfma_f32_16x16x32_bf16 v[160:163], v[100:103], a[224:227], 0
  ds_read_b128 v[92:95], v12 offset:32768
  s_waitcnt lgkmcnt(3)
  v_mfma_f32_16x16x32_bf16 v[164:167], v[104:107], a[224:227], 0
  ds_read_b128 v[96:99], v12 offset:40960
  s_waitcnt lgkmcnt(3)
  v_mfma_f32_16x16x32_bf16 v[160:163], v[108:111], a[228:231], v[160:163]
  ds_read_b128 v[100:103], v13 offset:32768
  s_waitcnt lgkmcnt(3)
  v_mfma_f32_16x16x32_bf16 v[164:167], v[112:115], a[228:231], v[164:167]
  ds_read_b128 v[104:107], v13 offset:40960
  v_mul_f32 v144, s45, v144
  s_waitcnt lgkmcnt(3)
  v_mfma_f32_16x16x32_bf16 v[160:163], v[92:95], a[232:235], v[160:163]
  ds_read_b128 v[108:111], v10 offset:33024
  v_mul_f32 v145, s45, v145
  s_waitcnt lgkmcnt(3)
  v_mfma_f32_16x16x32_bf16 v[164:167], v[96:99], a[232:235], v[164:167]
  ds_read_b128 v[112:115], v10 offset:41216
  v_mul_f32 v146, s45, v146
  s_waitcnt lgkmcnt(3)
  v_mfma_f32_16x16x32_bf16 v[160:163], v[100:103], a[236:239], v[160:163]
  ds_read_b128 v[92:95], v11 offset:33024
  v_mul_f32 v147, s45, v147
  s_waitcnt lgkmcnt(3)
  v_mfma_f32_16x16x32_bf16 v[164:167], v[104:107], a[236:239], v[164:167]
  ds_read_b128 v[96:99], v11 offset:41216
  v_mul_f32 v148, s45, v148
  s_waitcnt lgkmcnt(3)
  v_mfma_f32_16x16x32_bf16 v[160:163], v[108:111], a[240:243], v[160:163]
  ds_read_b128 v[100:103], v12 offset:33024
  v_mul_f32 v149, s45, v149
  s_waitcnt lgkmcnt(3)
  v_mfma_f32_16x16x32_bf16 v[164:167], v[112:115], a[240:243], v[164:167]
  ds_read_b128 v[104:107], v12 offset:41216
  v_mul_f32 v150, s45, v150
  s_waitcnt lgkmcnt(3)
  v_mfma_f32_16x16x32_bf16 v[160:163], v[92:95], a[244:247], v[160:163]
  ds_read_b128 v[108:111], v13 offset:33024
  v_mul_f32 v151, s45, v151
  s_waitcnt lgkmcnt(3)
  v_mfma_f32_16x16x32_bf16 v[164:167], v[96:99], a[244:247], v[164:167]
  ds_read_b128 v[112:115], v13 offset:41216
  v_cvt_pk_bf16_f32 v248, v144, v145
  s_waitcnt lgkmcnt(3)
  v_mfma_f32_16x16x32_bf16 v[160:163], v[100:103], a[248:251], v[160:163]
  v_cvt_pk_bf16_f32 v249, v146, v147
  s_waitcnt lgkmcnt(2)
  v_mfma_f32_16x16x32_bf16 v[164:167], v[104:107], a[248:251], v[164:167]
  v_cvt_pk_bf16_f32 v250, v148, v149
  s_waitcnt lgkmcnt(1)
  v_mfma_f32_16x16x32_bf16 v[160:163], v[108:111], a[252:255], v[160:163]
  v_cvt_pk_bf16_f32 v251, v150, v151
  s_waitcnt lgkmcnt(0)
  v_mfma_f32_16x16x32_bf16 v[164:167], v[112:115], a[252:255], v[164:167]
  s_nop 3
  v_mul_f32 v160, s45, v160
  v_mul_f32 v161, s45, v161
  v_mul_f32 v162, s45, v162
  v_mul_f32 v163, s45, v163
  v_mul_f32 v164, s45, v164
  v_mul_f32 v165, s45, v165
  v_mul_f32 v166, s45, v166
  v_mul_f32 v167, s45, v167
  v_cvt_pk_bf16_f32 v252, v160, v161
  v_cvt_pk_bf16_f32 v253, v162, v163
  v_cvt_pk_bf16_f32 v254, v164, v165
  v_cvt_pk_bf16_f32 v255, v166, v167
  s_branch inid_13
ini_11:
  v_mov_b64 v[12:13], 0
  v_mov_b64 v[14:15], 0
  s_lshl_b32 s34, s18, 10
  s_add_u32 s34, s34, 46858240
  s_and_b32 s35, s18, 7
  s_lshl_b32 s35, s35, 10
  s_add_u32 s35, s35, 46923776
  buffer_store_dwordx4 v[12:15], v3, s[12:15], s34 offen sc1
  s_cmp_lt_u32 s18, 56
  s_cbranch_scc1 zf_14a
  buffer_store_dwordx4 v[12:15], v3, s[12:15], s35 offen sc1
zf_14a:
  s_waitcnt vmcnt(0)
  s_barrier
  s_cmp_lg_u32 s17, 0
  s_cbranch_scc1 zf_14
  s_mov_b32 s2, 1
  s_atomic_add s2, s[56:57], 132 glc
zf_14:
  s_mov_b32 s28, s64
  s_mov_b32 s29, s65
  s_mov_b32 s30, 1835008
  s_mov_b32 s31, 0x20000
  v_bfe_u32 v1, v0, 2, 2
  v_lshlrev_b32 v2, 3, v1
  v_bfe_u32 v1, v0, 0, 2
  v_lshl_add_u32 v2, v1, 0, v2
  v_mul_u32_u24 v2, 896, v2
  v_bfe_u32 v1, v0, 5, 1
  v_lshlrev_b32 v5, 5, v1
  v_bfe_u32 v1, v0, 4, 1
  v_lshl_add_u32 v5, v1, 3, v5
  v_add_u32 v5, v5, v2
  s_lshl_b32 s60, s18, 1
  s_add_u32 s60, s60, 0
  s_min_u32 s60, s60, 222
  s_mul_i32 s34, s60, 2341
  s_lshr_b32 s34, s34, 16
  s_mul_i32 s35, s34, 28
  s_sub_u32 s35, s60, s35
  s_mul_i32 s36, s34, 28672
  s_cmp_ge_u32 s35, 14
  s_cselect_b32 s37, 2688, 0
  s_add_u32 s36, s36, s37
  s_lshl_b32 s37, s35, 6
  s_add_u32 s36, s36, s37
  buffer_load_dwordx2 v[24:25], v5, s[28:31], s36 offen offset:0
  buffer_load_dwordx2 v[26:27], v5, s[28:31], s36 offen offset:16
  buffer_load_dwordx2 v[28:29], v5, s[28:31], s36 offen offset:64
  buffer_load_dwordx2 v[30:31], v5, s[28:31], s36 offen offset:80
  s_lshl_b32 s61, s18, 1
  s_add_u32 s61, s61, 128
  s_min_u32 s61, s61, 222
  s_mul_i32 s34, s61, 2341
  s_lshr_b32 s34, s34, 16
  s_mul_i32 s35, s34, 28
  s_sub_u32 s35, s61, s35
  s_mul_i32 s36, s34, 28672
  s_cmp_ge_u32 s35, 14
  s_cselect_b32 s37, 2688, 0
  s_add_u32 s36, s36, s37
  s_lshl_b32 s37, s35, 6
  s_add_u32 s36, s36, s37
  buffer_load_dwordx2 v[32:33], v5, s[28:31], s36 offen offset:0
  buffer_load_dwordx2 v[34:35], v5, s[28:31], s36 offen offset:16
  buffer_load_dwordx2 v[36:37], v5, s[28:31], s36 offen offset:64
  buffer_load_dwordx2 v[38:39], v5, s[28:31], s36 offen offset:80
  v_mov_b64 v[8:9], -1
  v_mov_b64 v[10:11], -1
  s_mul_i32 s34, s18, 26
  s_lshr_b32 s34, s34, 8
  s_mul_i32 s34, s34, 22528
  s_add_u32 s34, s34, 46145536
  s_cmp_ge_u32 s18, 40
  s_cselect_b32 s34, 46235648, s34
  s_cmp_ge_u32 s18, 47
  s_cselect_b32 s34, 46236672, s34
  s_cmp_ge_u32 s18, 54
  s_cselect_b32 s34, 54986752, s34
  s_cmp_ge_u32 s18, 61
  s_cselect_b32 s34, 46074880, s34
  s_cbranch_scc0 n3_18
  v_lshl_add_u32 v1, v0, 2, 0
  v_and_b32 v1, 63, v1
  v_cmp_gt_u32 vcc, 14, v1
  s_nop 1
  v_cndmask_b32 v8, 0, 1, vcc
  v_lshl_add_u32 v1, v0, 2, 1
  v_and_b32 v1, 63, v1
  v_cmp_gt_u32 vcc, 14, v1
  s_nop 1
  v_cndmask_b32 v9, 0, 1, vcc
  v_lshl_add_u32 v1, v0, 2, 2
  v_and_b32 v1, 63, v1
  v_cmp_gt_u32 vcc, 14, v1
  s_nop 1
  v_cndmask_b32 v10, 0, 1, vcc
  v_lshl_add_u32 v1, v0, 2, 3
  v_and_b32 v1, 63, v1
  v_cmp_gt_u32 vcc, 14, v1
  s_nop 1
  v_cndmask_b32 v11, 0, 1, vcc
n3_18:
  s_min_u32 s35, s18, 62
  s_lshl_b32 s35, s35, 10
  s_add_u32 s34, s34, s35
  buffer_store_dwordx4 v[8:11], v3, s[12:15], s34 offen sc1
  s_cmp_ge_u32 s18, 36
  s_cbranch_scc1 n2_17
  v_mov_b64 v[12:13], 0
  v_mov_b64 v[14:15], 0
  s_lshl_b32 s34, s18, 10
  s_add_u32 s34, s34, 46989312
  buffer_store_dwordx4 v[12:15], v3, s[12:15], s34 offen sc1
n2_17:
  s_sub_u32 s36, s18, 56
  s_cmp_ge_u32 s36, 7
  s_cbranch_scc1 n4_19
  s_mov_b32 s20, s72
  s_mov_b32 s21, s73
  s_mov_b32 s22, 7168
  s_mov_b32 s23, 0x20000
  v_bfe_u32 v1, v0, 2, 2
  v_lshlrev_b32 v2, 1, v1
  v_bfe_u32 v1, v0, 0, 1
  v_lshl_add_u32 v2, v1, 0, v2
  v_mul_u32_u24 v2, 896, v2
  v_bfe_u32 v1, v0, 4, 2
  v_lshlrev_b32 v4, 5, v1
  v_bfe_u32 v1, v0, 1, 1
  v_lshl_add_u32 v4, v1, 4, v4
  v_add_u32 v4, v4, v2
  s_lshl_b32 s34, s36, 7
  buffer_load_dwordx4 v[12:15], v4, s[20:23], s34 offen
  s_waitcnt vmcnt(0)
  v_min_u32 v12, -2, v12
  v_min_u32 v13, -2, v13
  v_min_u32 v14, -2, v14
  v_min_u32 v15, -2, v15
  s_lshl_b32 s34, s36, 10
  s_add_u32 s35, s34, 46268416
  s_add_u32 s34, s34, 54525952
  buffer_store_dwordx4 v[12:15], v3, s[12:15], s35 offen sc1
  buffer_store_dwordx4 v[12:15], v3, s[12:15], s34 offen sc1
n4_19:
  s_waitcnt vmcnt(0)
  s_lshl_b32 s34, s60, 10
  s_add_u32 s34, s34, 56623104
  v_swap_b32 v25, v26
  buffer_store_dwordx4 v[24:27], v3, s[12:15], s34 offen offset:0 sc1
  v_swap_b32 v29, v30
  buffer_store_dwordx4 v[28:31], v3, s[12:15], s34 offen offset:1024 sc1
  s_lshl_b32 s34, s61, 10
  s_add_u32 s34, s34, 56623104
  v_swap_b32 v33, v34
  buffer_store_dwordx4 v[32:35], v3, s[12:15], s34 offen offset:0 sc1
  v_swap_b32 v37, v38
  buffer_store_dwordx4 v[36:39], v3, s[12:15], s34 offen offset:1024 sc1
inid_12:
  s_add_u32 s45, s46, 512
  s_cmp_lg_u32 s17, 0
  s_cbranch_scc1 sg_20
  s_mov_b32 s23, 300000
  v_mov_b32 v1, 0
w0l_22:
  global_load_dword v2, v1, s[56:57] offset:132 sc1
  s_waitcnt vmcnt(0)
  v_cmp_gt_u32 vcc, 16, v2
  s_cbranch_vccz w0d_23
  s_sleep 4
  s_sub_u32 s23, s23, 1
  s_cbranch_scc0 w0l_22
  s_branch L_exit
w0d_23:
sg_20:
  s_waitcnt vmcnt(0)
  s_barrier
  s_cmp_lg_u32 s17, 0
  s_cbranch_scc1 sg_21
  s_lshl_b32 s62, s45, 7
  s_add_u32 s62, s62, 46858240
  s_waitcnt lgkmcnt(0)
  s_mov_b32 s2, 1
  s_atomic_or s2, s[58:59], s62 glc
sg_21:
inid_13:
  s_mov_b32 s42, 0
  s_mov_b32 s43, 0
  s_and_b32 s16, s46, 15
  s_cmp_ge_u32 s46, 30
  s_cbranch_scc1 L_rolePF
  s_cmp_ge_u32 s46, 16
  s_cbranch_scc1 L_roleB
  s_mov_b32 s54, 0
  s_waitcnt vmcnt(0)
  v_cmp_gt_u32 vcc, v2, v27
  s_cbranch_vccz L_Aknown
  s_mov_b32 s23, 300000
  v_mov_b32 v1, 0
w0l_24:
  global_load_dword v2, v1, s[56:57] offset:132 sc1
  s_waitcnt vmcnt(0)
  v_cmp_gt_u32 vcc, 16, v2
  s_cbranch_vccz w0d_25
  s_sleep 4
  s_sub_u32 s23, s23, 1
  s_cbranch_scc0 w0l_24
  s_branch L_exit
w0d_25:
  s_mov_b32 s54, 0
  s_mov_b32 s23, 300000
  v_mbcnt_lo_u32_b32 v16, -1, 0
  v_cmp_gt_u32 vcc, 8, v16
  v_lshlrev_b32 v16, 5, v16
  s_nop 0
  v_cndmask_b32 v16, 4, v16, vcc
cs_28:
  global_load_dword v17, v16, s[56:57] sc1
  s_waitcnt vmcnt(0)
  v_min_u32 v18, 32, v17
  v_readlane_b32 s35, v17, 8
  v_readlane_b32 s34, v18, 0
  s_cmp_eq_u32 s34, 32
  s_cbranch_scc1 fast_26
  s_add_u32 s35, s35, s34
  v_readlane_b32 s34, v18, 1
  s_add_u32 s35, s35, s34
  v_readlane_b32 s34, v18, 2
  s_add_u32 s35, s35, s34
  v_readlane_b32 s34, v18, 3
  s_add_u32 s35, s35, s34
  v_readlane_b32 s34, v18, 4
  s_add_u32 s35, s35, s34
  v_readlane_b32 s34, v18, 5
  s_add_u32 s35, s35, s34
  v_readlane_b32 s34, v18, 6
  s_add_u32 s35, s35, s34
  v_readlane_b32 s34, v18, 7
  s_add_u32 s35, s35, s34
  s_cmp_ge_u32 s35, 256
  s_cbranch_scc1 slow_27
  s_sub_u32 s23, s23, 1
  s_cbranch_scc0 cs_28
  s_branch L_exit
slow_27:
  s_mov_b32 s54, 1
fast_26:
L_Aknown:
  s_cmp_lg_u32 s17, 0
  s_cbranch_scc1 wm_29
  v_and_b32 v16, 15, v0
  v_min_u32 v16, 7, v16
  v_lshlrev_b32 v16, 7, v16
  s_lshl_b32 s34, s16, 11
  v_add_u32 v16, s34, v16
  v_and_b32 v17, 15, v0
  v_lshlrev_b32 v17, 7, v17
  v_add_u32 v17, 67584, v17
  v_cmp_gt_u32 vcc, 32, v0
  s_nop 1
  v_cndmask_b32 v16, v17, v16, vcc
  s_mov_b32 s34, 0
  s_add_u32 s34, s34, 46858240
  s_mov_b32 s23, 300000
fp_30:
  buffer_load_dword v17, v16, s[12:15], s34 offen sc1
  s_waitcnt vmcnt(0)
  v_cmp_gt_u32 vcc, 1, v17
  s_cbranch_vccz fpd_31
  s_sleep 1
  s_sub_u32 s23, s23, 1
  s_cbranch_scc0 fp_30
  s_branch L_exit
fpd_31:
wm_29:
  s_barrier
  v_mov_b32 v16, v0
  v_lshlrev_b32 v0, 4, v16
  v_bfe_u32 v17, v16, 1, 1
  v_mov_b32 v1, 0xaaaa
  v_mul_u32_u24 v1, v1, v17
  v_add_u32 v1, 0x4444, v1
  s_lshl_b32 s34, s17, 11
  v_bfe_u32 v17, v16, 2, 2
  v_lshlrev_b32 v18, 0, v17
  v_bfe_u32 v17, v16, 4, 2
  v_lshl_add_u32 v18, v17, 0, v18
  v_and_b32 v18, 3, v18
  v_bfe_u32 v17, v16, 0, 4
  v_lshlrev_b32 v2, 5, v17
  v_add_u32 v2, s34, v2
  v_lshl_add_u32 v2, v18, 3, v2
  v_bfe_u32 v17, v16, 3, 1
  v_lshlrev_b32 v18, 0, v17
  v_bfe_u32 v17, v16, 4, 2
  v_lshl_add_u32 v18, v17, 0, v18
  v_and_b32 v18, 3, v18
  v_bfe_u32 v17, v16, 3, 1
  v_lshlrev_b32 v3, 7, v17
  v_bfe_u32 v17, v16, 2, 1
  v_lshl_add_u32 v3, v17, 6, v3
  v_bfe_u32 v17, v16, 0, 1
  v_lshl_add_u32 v3, v17, 5, v3
  v_bfe_u32 v17, v16, 1, 1
  v_lshl_add_u32 v3, v17, 2, v3
  v_add_u32 v3, s34, v3
  v_lshl_add_u32 v3, v18, 3, v3
  v_bfe_u32 v17, v16, 0, 2
  v_lshlrev_b32 v18, 0, v17
  v_bfe_u32 v17, v16, 4, 2
  v_lshl_add_u32 v18, v17, 0, v18
  v_and_b32 v18, 3, v18
  v_bfe_u32 v17, v16, 2, 4
  v_lshlrev_b32 v4, 5, v17
  v_add_u32 v4, s34, v4
  v_lshl_add_u32 v4, v18, 3, v4
  v_bfe_u32 v17, v16, 0, 6
  v_lshlrev_b32 v18, 2, v17
  v_add_u32 v18, s34, v18
  v_add_u32 v18, 1792, v18
  v_mov_b32 v17, 0
  ds_write_b32 v18, v17
  s_mul_i32 s35, s17, 1792
  v_bfe_u32 v17, v16, 4, 1
  v_lshlrev_b32 v5, 9, v17
  v_bfe_u32 v17, v16, 5, 1
  v_lshl_add_u32 v5, v17, 5, v5
  v_bfe_u32 v17, v16, 1, 2
  v_lshl_add_u32 v5, v17, 6, v5
  v_bfe_u32 v17, v16, 0, 1
  v_lshl_add_u32 v5, v17, 4, v5
  v_add_u32 v5, s35, v5
  v_add_u32 v5, 16384, v5
  v_bfe_u32 v17, v16, 0, 6
  v_lshlrev_b32 v18, 2, v17
  v_add_u32 v18, 23552, v18
  v_mov_b32 v17, 0
  ds_write_b32 v18, v17
  s_lshl_b32 s35, s17, 10
  v_bfe_u32 v17, v16, 4, 2
  v_lshlrev_b32 v6, 8, v17
  v_bfe_u32 v17, v16, 0, 4
  v_lshl_add_u32 v6, v17, 3, v6
  v_add_u32 v6, s35, v6
  v_add_u32 v6, 8192, v6
  s_lshl_b32 s35, s17, 2
  v_bfe_u32 v17, v16, 0, 6
  v_lshlrev_b32 v7, 4, v17
  v_add_u32 v7, s35, v7
  v_add_u32 v7, 12288, v7
  s_lshr_b32 s35, s16, 2
  s_lshl_b32 s35, s35, 10
  s_and_b32 s36, s16, 1
  s_lshl_b32 s36, s36, 9
  s_add_u32 s35, s35, s36
  s_and_b32 s36, s16, 2
  s_lshl_b32 s36, s36, 11
  s_add_u32 s35, s35, s36
  s_lshr_b32 s37, s16, 1
  s_lshl_b32 s37, s37, 8
  s_and_b32 s36, s16, 1
  s_lshl_b32 s36, s36, 3
  s_add_u32 s37, s37, s36
  v_bfe_u32 v17, v16, 2, 1
  v_lshlrev_b32 v8, 8, v17
  v_bfe_u32 v17, v16, 4, 2
  v_lshl_add_u32 v8, v17, 6, v8
  v_bfe_u32 v17, v16, 1, 1
  v_lshl_add_u32 v8, v17, 5, v8
  v_bfe_u32 v17, v16, 3, 1
  v_lshl_add_u32 v8, v17, 4, v8
  v_bfe_u32 v17, v16, 0, 1
  v_lshl_add_u32 v8, v17, 3, v8
  v_add_u32 v8, s35, v8
  v_add_u32 v8, 8192, v8
  v_bfe_u32 v17, v16, 1, 2
  v_lshlrev_b32 v9, 6, v17
  v_bfe_u32 v17, v16, 4, 2
  v_lshl_add_u32 v9, v17, 4, v9
  v_bfe_u32 v17, v16, 3, 1
  v_lshl_add_u32 v9, v17, 2, v9
  v_bfe_u32 v17, v16, 0, 1
  v_lshl_add_u32 v9, v17, 30, v9
  v_add_u32 v9, s37, v9
  v_add_u32 v9, 16384, v9
  s_lshl_b32 s35, s16, 2
  s_add_u32 s35, s35, 128
  v_lshlrev_b32 v10, 8, v16
  v_add_u32 v10, s35, v10
  v_mov_b32 v17, 0x40000000
  v_cmp_gt_u32 vcc, 2, v16
  s_nop 1
  v_cndmask_b32 v10, v17, v10, vcc
  s_cmp_lg_u32 s17, 2
  s_cbranch_scc1 sk_32
  v_min_u32 v10, 14, v16
  v_lshlrev_b32 v10, 2, v10
  v_add_u32 v10, 0, v10
  s_and_b32 s38, s16, 1
  s_lshl_b32 s38, s38, 8
  v_add_u32 v10, s38, v10
sk_32:
  s_mov_b32 s44, 0x42700000
  s_mul_i32 s35, s16, 52
  s_lshr_b32 s35, s35, 8
  s_mul_i32 s35, s35, 5
  s_sub_u32 s47, s16, s35
  s_lshl_b32 s35, s47, 10
  s_add_u32 s35, s35, 16384
  v_add_u32 v15, s35, v0
  s_add_u32 s35, s47, s17
  s_add_u32 s35, s35, 0
  s_cmp_ge_u32 s35, 7
  s_cselect_b32 s36, 7, 0
  s_sub_u32 s35, s35, s36
  s_lshl_b32 s51, s35, 10
  s_min_u32 s35, s17, 2
  s_add_u32 s35, s35, s47
  s_add_u32 s35, s35, 4
  s_cmp_ge_u32 s35, 7
  s_cselect_b32 s36, 7, 0
  s_sub_u32 s35, s35, s36
  s_lshl_b32 s52, s35, 10
  s_mul_i32 s34, s16, 401408
  s_mul_i32 s35, s17, 100352
  s_add_u32 s34, s34, s35
  s_add_u32 s35, s17, 0
  s_and_b32 s35, s35, 3
  s_add_u32 s35, s35, s47
  s_add_u32 s35, s35, 3
  s_cmp_ge_u32 s35, 7
  s_cselect_b32 s36, 7, 0
  s_sub_u32 s35, s35, s36
  s_lshl_b32 s24, s35, 10
  s_lshl_b32 s35, s35, 11
  s_add_u32 s35, s35, s34
  buffer_load_dwordx4 a[0:3], v0, s[12:15], s35 offen sc1
  buffer_load_dwordx4 a[4:7], v0, s[12:15], s35 offen offset:1024 sc1
  s_add_u32 s35, s35, 14336
  buffer_load_dwordx4 a[56:59], v0, s[12:15], s35 offen sc1
  buffer_load_dwordx4 a[60:63], v0, s[12:15], s35 offen offset:1024 sc1
  s_add_u32 s35, s35, 14336
  buffer_load_dwordx4 a[112:115], v0, s[12:15], s35 offen sc1
  buffer_load_dwordx4 a[116:119], v0, s[12:15], s35 offen offset:1024 sc1
  s_add_u32 s35, s35, 14336
  buffer_load_dwordx4 a[168:171], v0, s[12:15], s35 offen sc1
  buffer_load_dwordx4 a[172:175], v0, s[12:15], s35 offen offset:1024 sc1
  s_add_u32 s35, s35, 14336
  buffer_load_dwordx4 a[224:227], v0, s[12:15], s35 offen sc1
  buffer_load_dwordx4 a[228:231], v0, s[12:15], s35 offen offset:1024 sc1
  s_add_u32 s35, s35, 14336
  buffer_load_dwordx4 v[144:147], v0, s[12:15], s35 offen sc1
  buffer_load_dwordx4 v[148:151], v0, s[12:15], s35 offen offset:1024 sc1
  s_add_u32 s35, s35, 14336
  buffer_load_dwordx4 v[200:203], v0, s[12:15], s35 offen sc1
  buffer_load_dwordx4 v[204:207], v0, s[12:15], s35 offen offset:1024 sc1
  s_add_u32 s35, s17, 1
  s_and_b32 s35, s35, 3
  s_add_u32 s35, s35, s47
  s_add_u32 s35, s35, 3
  s_cmp_ge_u32 s35, 7
  s_cselect_b32 s36, 7, 0
  s_sub_u32 s35, s35, s36
  s_lshl_b32 s25, s35, 10
  s_lshl_b32 s35, s35, 11
  s_add_u32 s35, s35, s34
  buffer_load_dwordx4 a[8:11], v0, s[12:15], s35 offen sc1
  buffer_load_dwordx4 a[12:15], v0, s[12:15], s35 offen offset:1024 sc1
  s_add_u32 s35, s35, 14336
  buffer_load_dwordx4 a[64:67], v0, s[12:15], s35 offen sc1
  buffer_load_dwordx4 a[68:71], v0, s[12:15], s35 offen offset:1024 sc1
  s_add_u32 s35, s35, 14336
  buffer_load_dwordx4 a[120:123], v0, s[12:15], s35 offen sc1
  buffer_load_dwordx4 a[124:127], v0, s[12:15], s35 offen offset:1024 sc1
  s_add_u32 s35, s35, 14336
  buffer_load_dwordx4 a[176:179], v0, s[12:15], s35 offen sc1
  buffer_load_dwordx4 a[180:183], v0, s[12:15], s35 offen offset:1024 sc1
  s_add_u32 s35, s35, 14336
  buffer_load_dwordx4 a[232:235], v0, s[12:15], s35 offen sc1
  buffer_load_dwordx4 a[236:239], v0, s[12:15], s35 offen offset:1024 sc1
  s_add_u32 s35, s35, 14336
  buffer_load_dwordx4 v[152:155], v0, s[12:15], s35 offen sc1
  buffer_load_dwordx4 v[156:159], v0, s[12:15], s35 offen offset:1024 sc1
  s_add_u32 s35, s35, 14336
  buffer_load_dwordx4 v[208:211], v0, s[12:15], s35 offen sc1
  buffer_load_dwordx4 v[212:215], v0, s[12:15], s35 offen offset:1024 sc1
  s_add_u32 s35, s17, 2
  s_and_b32 s35, s35, 3
  s_add_u32 s35, s35, s47
  s_add_u32 s35, s35, 3
  s_cmp_ge_u32 s35, 7
  s_cselect_b32 s36, 7, 0
  s_sub_u32 s35, s35, s36
  s_lshl_b32 s26, s35, 10
  s_lshl_b32 s35, s35, 11
  s_add_u32 s35, s35, s34
  buffer_load_dwordx4 a[16:19], v0, s[12:15], s35 offen sc1
  buffer_load_dwordx4 a[20:23], v0, s[12:15], s35 offen offset:1024 sc1
  s_add_u32 s35, s35, 14336
  buffer_load_dwordx4 a[72:75], v0, s[12:15], s35 offen sc1
  buffer_load_dwordx4 a[76:79], v0, s[12:15], s35 offen offset:1024 sc1
  s_add_u32 s35, s35, 14336
  buffer_load_dwordx4 a[128:131], v0, s[12:15], s35 offen sc1
  buffer_load_dwordx4 a[132:135], v0, s[12:15], s35 offen offset:1024 sc1
  s_add_u32 s35, s35, 14336
  buffer_load_dwordx4 a[184:187], v0, s[12:15], s35 offen sc1
  buffer_load_dwordx4 a[188:191], v0, s[12:15], s35 offen offset:1024 sc1
  s_add_u32 s35, s35, 14336
  buffer_load_dwordx4 a[240:243], v0, s[12:15], s35 offen sc1
  buffer_load_dwordx4 a[244:247], v0, s[12:15], s35 offen offset:1024 sc1
  s_add_u32 s35, s35, 14336
  buffer_load_dwordx4 v[160:163], v0, s[12:15], s35 offen sc1
  buffer_load_dwordx4 v[164:167], v0, s[12:15], s35 offen offset:1024 sc1
  s_add_u32 s35, s35, 14336
  buffer_load_dwordx4 v[216:219], v0, s[12:15], s35 offen sc1
  buffer_load_dwordx4 v[220:223], v0, s[12:15], s35 offen offset:1024 sc1
  s_add_u32 s35, s17, 3
  s_and_b32 s35, s35, 3
  s_add_u32 s35, s35, s47
  s_add_u32 s35, s35, 3
  s_cmp_ge_u32 s35, 7
  s_cselect_b32 s36, 7, 0
  s_sub_u32 s35, s35, s36
  s_lshl_b32 s27, s35, 10
  s_lshl_b32 s35, s35, 11
  s_add_u32 s35, s35, s34
  buffer_load_dwordx4 a[24:27], v0, s[12:15], s35 offen sc1
  buffer_load_dwordx4 a[28:31], v0, s[12:15], s35 offen offset:1024 sc1
  s_add_u32 s35, s35, 14336
  buffer_load_dwordx4 a[80:83], v0, s[12:15], s35 offen sc1
  buffer_load_dwordx4 a[84:87], v0, s[12:15], s35 offen offset:1024 sc1
  s_add_u32 s35, s35, 14336
  buffer_load_dwordx4 a[136:139], v0, s[12:15], s35 offen sc1
  buffer_load_dwordx4 a[140:143], v0, s[12:15], s35 offen offset:1024 sc1
  s_add_u32 s35, s35, 14336
  buffer_load_dwordx4 a[192:195], v0, s[12:15], s35 offen sc1
  buffer_load_dwordx4 a[196:199], v0, s[12:15], s35 offen offset:1024 sc1
  s_add_u32 s35, s35, 14336
  buffer_load_dwordx4 a[248:251], v0, s[12:15], s35 offen sc1
  buffer_load_dwordx4 a[252:255], v0, s[12:15], s35 offen offset:1024 sc1
  s_add_u32 s35, s35, 14336
  buffer_load_dwordx4 v[168:171], v0, s[12:15], s35 offen sc1
  buffer_load_dwordx4 v[172:175], v0, s[12:15], s35 offen offset:1024 sc1
  s_add_u32 s35, s35, 14336
  buffer_load_dwordx4 v[224:227], v0, s[12:15], s35 offen sc1
  buffer_load_dwordx4 v[228:231], v0, s[12:15], s35 offen offset:1024 sc1
  s_add_u32 s35, s47, 0
  s_lshl_b32 s28, s35, 10
  s_lshl_b32 s35, s35, 11
  s_add_u32 s35, s35, s34
  s_add_u32 s35, s47, 1
  s_lshl_b32 s29, s35, 10
  s_lshl_b32 s35, s35, 11
  s_add_u32 s35, s35, s34
  s_add_u32 s35, s47, 2
  s_lshl_b32 s30, s35, 10
  s_lshl_b32 s35, s35, 11
  s_add_u32 s35, s35, s34
  s_cmp_lg_u32 s54, 0
  s_cbranch_scc1 L_Aslow
  s_mov_b32 s18, 0
  s_mov_b32 s64, 4096
  s_mov_b32 s65, 8192
  s_mov_b32 s66, 12288
  s_mov_b32 s67, 16384
  s_mov_b32 s68, 20480
  s_mov_b32 s69, 24576
  s_mov_b32 s70, 28672
  s_lshl_b32 s45, s17, 10
  s_add_u32 s45, s45, 13631488
  s_waitcnt vmcnt(0)
.p2align 5
A_top_f:
  s_lshl_b32 s48, s18, 13
  s_add_u32 s48, s48, 131072
  s_add_u32 s49, s48, 8192
  s_add_u32 s50, s48, 24576
  s_and_b32 s34, s18, 3
  s_lshl_b32 s19, s34, 15
  s_add_u32 s22, s18, 1
  s_add_u32 s34, s18, 3
  s_and_b32 s34, s34, 3
  s_lshl_b32 s21, s34, 15
  v_add_u32 v11, s48, v0
  s_mov_b32 s32, 0
  v_add_u32 v13, s45, v0
  v_mov_b32 v12, s22
  s_cmp_lt_u32 s17, 1
  s_cbranch_scc1 Aw0_34
  v_mov_b64 v[112:113], -1
  v_mov_b64 v[114:115], -1
  s_mul_i32 s34, s17, 2048
  v_add_u32 v116, s34, v0
  ds_write_b128 v116, v[112:115] offset:14336
  ds_write_b128 v116, v[112:115] offset:15360
  ds_write_b128 v116, v[112:115] offset:16384
  s_waitcnt lgkmcnt(0)
  s_cmp_lg_u32 s17, 2
  s_cbranch_scc1 Anp_33
  s_mov_b32 s23, 200000
  buffer_load_dword v104, v10, s[4:7], 0 offen sc1
  buffer_load_dword v105, v10, s[4:7], 0 offen sc1
  buffer_load_dword v106, v10, s[4:7], 0 offen sc1
  buffer_load_dword v107, v10, s[4:7], 0 offen sc1
  buffer_load_dword v108, v10, s[4:7], 0 offen sc1
  buffer_load_dword v109, v10, s[4:7], 0 offen sc1
poll_35:
  s_waitcnt vmcnt(5)
  v_cmp_gt_u32 vcc, s22, v104
  buffer_load_dword v104, v10, s[4:7], 0 offen sc1
  s_cbranch_vccz polld_36
  s_waitcnt vmcnt(5)
  v_cmp_gt_u32 vcc, s22, v105
  buffer_load_dword v105, v10, s[4:7], 0 offen sc1
  s_cbranch_vccz polld_36
  s_waitcnt vmcnt(5)
  v_cmp_gt_u32 vcc, s22, v106
  buffer_load_dword v106, v10, s[4:7], 0 offen sc1
  s_cbranch_vccz polld_36
  s_waitcnt vmcnt(5)
  v_cmp_gt_u32 vcc, s22, v107
  buffer_load_dword v107, v10, s[4:7], 0 offen sc1
  s_cbranch_vccz polld_36
  s_waitcnt vmcnt(5)
  v_cmp_gt_u32 vcc, s22, v108
  buffer_load_dword v108, v10, s[4:7], 0 offen sc1
  s_cbranch_vccz polld_36
  s_waitcnt vmcnt(5)
  v_cmp_gt_u32 vcc, s22, v109
  buffer_load_dword v109, v10, s[4:7], 0 offen sc1
  s_cbranch_vccz polld_36
  s_waitcnt vmcnt(5)
  v_cmp_gt_u32 vcc, s22, v104
  buffer_load_dword v104, v10, s[4:7], 0 offen sc1
  s_cbranch_vccz polld_36
  s_waitcnt vmcnt(5)
  v_cmp_gt_u32 vcc, s22, v105
  buffer_load_dword v105, v10, s[4:7], 0 offen sc1
  s_cbranch_vccz polld_36
  s_waitcnt vmcnt(5)
  v_cmp_gt_u32 vcc, s22, v106
  buffer_load_dword v106, v10, s[4:7], 0 offen sc1
  s_cbranch_vccz polld_36
  s_waitcnt vmcnt(5)
  v_cmp_gt_u32 vcc, s22, v107
  buffer_load_dword v107, v10, s[4:7], 0 offen sc1
  s_cbranch_vccz polld_36
  s_waitcnt vmcnt(5)
  v_cmp_gt_u32 vcc, s22, v108
  buffer_load_dword v108, v10, s[4:7], 0 offen sc1
  s_cbranch_vccz polld_36
  s_waitcnt vmcnt(5)
  v_cmp_gt_u32 vcc, s22, v109
  buffer_load_dword v109, v10, s[4:7], 0 offen sc1
  s_cbranch_vccz polld_36
  s_waitcnt vmcnt(5)
  v_cmp_gt_u32 vcc, s22, v104
  buffer_load_dword v104, v10, s[4:7], 0 offen sc1
  s_cbranch_vccz polld_36
  s_waitcnt vmcnt(5)
  v_cmp_gt_u32 vcc, s22, v105
  buffer_load_dword v105, v10, s[4:7], 0 offen sc1
  s_cbranch_vccz polld_36
  s_waitcnt vmcnt(5)
  v_cmp_gt_u32 vcc, s22, v106
  buffer_load_dword v106, v10, s[4:7], 0 offen sc1
  s_cbranch_vccz polld_36
  s_waitcnt vmcnt(5)
  v_cmp_gt_u32 vcc, s22, v107
  buffer_load_dword v107, v10, s[4:7], 0 offen sc1
  s_cbranch_vccz polld_36
  s_waitcnt vmcnt(5)
  v_cmp_gt_u32 vcc, s22, v108
  buffer_load_dword v108, v10, s[4:7], 0 offen sc1
  s_cbranch_vccz polld_36
  s_waitcnt vmcnt(5)
  v_cmp_gt_u32 vcc, s22, v109
  buffer_load_dword v109, v10, s[4:7], 0 offen sc1
  s_cbranch_vccz polld_36
  s_waitcnt vmcnt(5)
  v_cmp_gt_u32 vcc, s22, v104
  buffer_load_dword v104, v10, s[4:7], 0 offen sc1
  s_cbranch_vccz polld_36
  s_waitcnt vmcnt(5)
  v_cmp_gt_u32 vcc, s22, v105
  buffer_load_dword v105, v10, s[4:7], 0 offen sc1
  s_cbranch_vccz polld_36
  s_waitcnt vmcnt(5)
  v_cmp_gt_u32 vcc, s22, v106
  buffer_load_dword v106, v10, s[4:7], 0 offen sc1
  s_cbranch_vccz polld_36
  s_waitcnt vmcnt(5)
  v_cmp_gt_u32 vcc, s22, v107
  buffer_load_dword v107, v10, s[4:7], 0 offen sc1
  s_cbranch_vccz polld_36
  s_waitcnt vmcnt(5)
  v_cmp_gt_u32 vcc, s22, v108
  buffer_load_dword v108, v10, s[4:7], 0 offen sc1
  s_cbranch_vccz polld_36
  s_waitcnt vmcnt(5)
  v_cmp_gt_u32 vcc, s22, v109
  buffer_load_dword v109, v10, s[4:7], 0 offen sc1
  s_sub_u32 s23, s23, 1
  s_cbranch_vccz polld_36
  s_cbranch_scc0 poll_35
  s_branch L_exit
.p2align 5
  s_nop 0
polld_36:
Anp_33:
  s_barrier
Arestart_37:
  s_add_u32 m0, s51, 16384
  buffer_load_dwordx4 v[16:19], v11, s[4:7], s24 offen sc1
  v_mov_b32 v44, 0
  v_mov_b32 v45, 0
  buffer_load_dwordx4 v[20:23], v11, s[4:7], s25 offen sc1
  v_mov_b32 v46, 0
  v_mov_b32 v47, 0
  v_mov_b32 v48, 0
  buffer_load_dwordx4 v[24:27], v11, s[4:7], s26 offen sc1
  v_mov_b32 v49, 0
  v_mov_b32 v50, 0
  v_mov_b32 v51, 0
  v_mov_b32 v52, 0
  v_mov_b32 v53, 0
  buffer_load_dwordx4 v11, s[4:7], s51 offen sc1 lds
  s_add_u32 m0, s52, 16384
  v_mov_b32 v54, 0
  v_mov_b32 v55, 0
  v_mov_b32 v56, 0
  v_mov_b32 v57, 0
  v_mov_b32 v58, 0
  v_mov_b32 v59, 0
  v_mov_b32 v60, 0
  v_mov_b32 v61, 0
  v_mov_b32 v62, 0
  v_mov_b32 v63, 0
  v_mov_b32 v64, 0
  v_mov_b32 v65, 0
  v_mov_b32 v66, 0
  v_mov_b32 v67, 0
  v_mov_b32 v68, 0
  v_mov_b32 v69, 0
  v_mov_b32 v70, 0
  v_mov_b32 v71, 0
  s_waitcnt vmcnt(3)
  v_smfmac_f32_16x16x64_bf16 v[44:47], v[16:19], a[0:7], v1
  v_cmp_eq_u32 vcc, -1, v16
  v_smfmac_f32_16x16x64_bf16 v[48:51], v[16:19], a[56:63], v1
  buffer_load_dwordx4 v[28:31], v11, s[4:7], s27 offen sc1
  v_smfmac_f32_16x16x64_bf16 v[52:55], v[16:19], a[112:119], v1
  s_cbranch_vccnz Ars_38
  v_smfmac_f32_16x16x64_bf16 v[56:59], v[16:19], a[168:175], v1
  buffer_load_dwordx4 v11, s[4:7], s52 offen sc1 lds
  v_smfmac_f32_16x16x64_bf16 v[60:63], v[16:19], a[224:231], v1
  s_waitcnt vmcnt(4)
  v_cmp_eq_u32 vcc, -1, v20
  v_smfmac_f32_16x16x64_bf16 v[64:67], v[16:19], v[144:151], v1
  v_smfmac_f32_16x16x64_bf16 v[68:71], v[16:19], v[200:207], v1
  s_cbranch_vccnz Aretry_39
Aback_40:
  v_smfmac_f32_16x16x64_bf16 v[44:47], v[20:23], a[8:15], v1
  v_mov_b64 v[16:17], 0
  v_smfmac_f32_16x16x64_bf16 v[48:51], v[20:23], a[64:71], v1
  v_mov_b64 v[18:19], 0
  v_smfmac_f32_16x16x64_bf16 v[52:55], v[20:23], a[120:127], v1
  buffer_load_dwordx4 v[88:91], v13, s[12:15], s67 offen sc1
  v_smfmac_f32_16x16x64_bf16 v[56:59], v[20:23], a[176:183], v1
  v_smfmac_f32_16x16x64_bf16 v[60:63], v[20:23], a[232:239], v1
  s_waitcnt vmcnt(4)
  v_cmp_eq_u32 vcc, -1, v24
  v_smfmac_f32_16x16x64_bf16 v[64:67], v[20:23], v[152:159], v1
  buffer_load_dwordx4 v[92:95], v13, s[12:15], s68 offen sc1
  v_smfmac_f32_16x16x64_bf16 v[68:71], v[20:23], v[208:215], v1
  s_cbranch_vccnz Aretry_41
Aback_42:
  v_smfmac_f32_16x16x64_bf16 v[44:47], v[24:27], a[16:23], v1
  v_mov_b64 v[20:21], 0
  v_smfmac_f32_16x16x64_bf16 v[48:51], v[24:27], a[72:79], v1
  v_mov_b64 v[22:23], 0
  v_smfmac_f32_16x16x64_bf16 v[52:55], v[24:27], a[128:135], v1
  buffer_load_dwordx4 v[72:75], v13, s[12:15], 0 offen sc1
  v_smfmac_f32_16x16x64_bf16 v[56:59], v[24:27], a[184:191], v1
  v_smfmac_f32_16x16x64_bf16 v[60:63], v[24:27], a[240:247], v1
  buffer_load_dwordx4 v[76:79], v13, s[12:15], s64 offen sc1
  v_smfmac_f32_16x16x64_bf16 v[64:67], v[24:27], v[160:167], v1
  s_waitcnt vmcnt(5)
  ds_read_b128 v[32:35], v15 offset:0
  v_smfmac_f32_16x16x64_bf16 v[68:71], v[24:27], v[216:223], v1
  ds_read_b128 v[36:39], v15 offset:1024
  v_smfmac_f32_16x16x64_bf16 v[44:47], v[28:31], a[24:31], v1
  ds_read_b128 v[40:43], v15 offset:2048
  v_smfmac_f32_16x16x64_bf16 v[48:51], v[28:31], a[80:87], v1
  buffer_load_dwordx4 v[80:83], v13, s[12:15], s65 offen sc1
  v_mov_b64 v[24:25], 0
  v_smfmac_f32_16x16x64_bf16 v[56:59], v[28:31], a[192:199], v1
  v_mov_b64 v[26:27], 0
  v_smfmac_f32_16x16x64_bf16 v[64:67], v[28:31], v[168:175], v1
  s_waitcnt lgkmcnt(2)
  v_smfmac_f32_16x16x64_bf16 v[44:47], v[32:35], a[32:39], v1
  buffer_load_dwordx4 v[84:87], v13, s[12:15], s66 offen sc1
  s_waitcnt lgkmcnt(1)
  v_smfmac_f32_16x16x64_bf16 v[44:47], v[36:39], a[40:47], v1
  s_waitcnt lgkmcnt(0)
  v_smfmac_f32_16x16x64_bf16 v[44:47], v[40:43], a[48:55], v1
  v_smfmac_f32_16x16x64_bf16 v[48:51], v[32:35], a[88:95], v1
  buffer_load_dwordx4 v[96:99], v13, s[12:15], s69 offen sc1
  v_smfmac_f32_16x16x64_bf16 v[48:51], v[36:39], a[96:103], v1
  v_add_f32 v44, v44, v46
  v_smfmac_f32_16x16x64_bf16 v[48:51], v[40:43], a[104:111], v1
  v_add_f32 v45, v45, v47
  v_smfmac_f32_16x16x64_bf16 v[52:55], v[28:31], a[136:143], v1
  buffer_load_dwordx4 v[100:103], v13, s[12:15], s70 offen sc1
  v_cvt_pk_bf16_f32 v46, v44, v45
  v_smfmac_f32_16x16x64_bf16 v[52:55], v[32:35], a[144:151], v1
  s_waitcnt vmcnt(7)
  ds_read_b128 v[104:107], v5 offset:0
  v_add_f32 v48, v48, v50
  v_smfmac_f32_16x16x64_bf16 v[52:55], v[36:39], a[152:159], v1
  ds_read_b128 v[108:111], v5 offset:256
  v_add_f32 v49, v49, v51
  v_smfmac_f32_16x16x64_bf16 v[52:55], v[40:43], a[160:167], v1
  ds_read_b128 v[112:115], v5 offset:1024
  v_cvt_pk_bf16_f32 v47, v48, v49
  v_smfmac_f32_16x16x64_bf16 v[56:59], v[32:35], a[200:207], v1
  ds_write_b64 v2, v[46:47] offset:0
  v_smfmac_f32_16x16x64_bf16 v[56:59], v[36:39], a[208:215], v1
  ds_read_b64_tr_b16 v[48:49], v4 offset:0
  v_add_f32 v52, v52, v54
  v_smfmac_f32_16x16x64_bf16 v[56:59], v[40:43], a[216:223], v1
  ds_read_b128 v[116:119], v5 offset:1280
  v_add_f32 v53, v53, v55
  v_smfmac_f32_16x16x64_bf16 v[60:63], v[28:31], a[248:255], v1
  v_cvt_pk_bf16_f32 v54, v52, v53
  v_smfmac_f32_16x16x64_bf16 v[60:63], v[32:35], v[120:127], v1
  v_add_f32 v56, v56, v58
  v_smfmac_f32_16x16x64_bf16 v[60:63], v[36:39], v[128:135], v1
  v_add_f32 v57, v57, v59
  v_smfmac_f32_16x16x64_bf16 v[60:63], v[40:43], v[136:143], v1
  v_cvt_pk_bf16_f32 v55, v56, v57
  v_smfmac_f32_16x16x64_bf16 v[64:67], v[32:35], v[176:183], v1
  ds_write_b64 v2, v[54:55] offset:512
  v_smfmac_f32_16x16x64_bf16 v[64:67], v[36:39], v[184:191], v1
  ds_read_b64_tr_b16 v[50:51], v4 offset:512
  v_add_f32 v60, v60, v62
  v_smfmac_f32_16x16x64_bf16 v[64:67], v[40:43], v[192:199], v1
  v_add_f32 v61, v61, v63
  v_smfmac_f32_16x16x64_bf16 v[68:71], v[28:31], v[224:231], v1
  v_cvt_pk_bf16_f32 v62, v60, v61
  v_smfmac_f32_16x16x64_bf16 v[68:71], v[32:35], v[232:239], v1
  v_add_f32 v64, v64, v66
  v_add_f32 v65, v65, v67
  v_smfmac_f32_16x16x64_bf16 v[68:71], v[36:39], v[240:247], v1
  v_cvt_pk_bf16_f32 v63, v64, v65
  v_smfmac_f32_16x16x64_bf16 v[68:71], v[40:43], v[248:255], v1
  ds_write_b64 v2, v[62:63] offset:1024
Aj_43:
  s_waitcnt vmcnt(4)
  s_waitcnt lgkmcnt(1)
  v_smfmac_f32_16x16x64_bf16 v[20:23], v[48:51], v[88:95], v1
  ds_read_b64_tr_b16 v[56:57], v4 offset:1024
  s_nop 2
  v_add_f32 v68, v68, v70
  v_add_f32 v69, v69, v71
  v_cvt_pk_bf16_f32 v70, v68, v69
  ds_write_b32 v3, v70 offset:1536
  ds_read_b64_tr_b16 v[58:59], v4 offset:1536
  v_smfmac_f32_16x16x64_bf16 v[16:19], v[48:51], v[72:79], v1
  v_smfmac_f32_16x16x64_bf16 v[24:27], v[48:51], v[104:111], v1
  s_cmp_ge_u32 s17, 1
  s_cbranch_scc1 Aoth_44
  s_waitcnt vmcnt(0) lgkmcnt(0)
  v_smfmac_f32_16x16x64_bf16 v[24:27], v[56:59], v[112:119], v1
  v_smfmac_f32_16x16x64_bf16 v[16:19], v[56:59], v[80:87], v1
  v_smfmac_f32_16x16x64_bf16 v[20:23], v[56:59], v[96:103], v1
  v_add_f32_dpp v68, v24, v26 quad_perm:[0,1,2,3] row_mask:0xf bank_mask:0x3
  s_nop 0
  v_add_f32 v64, v16, v18
  v_add_f32 v66, v17, v19
  v_add_f32_dpp v68, v25, v27 quad_perm:[0,1,2,3] row_mask:0xf bank_mask:0xc
  v_cmp_u_f32 vcc, v68, v68
  v_add_f32 v65, v20, v22
  v_add_f32 v67, v21, v23
  ds_write2_b64 v6, v[64:65], v[66:67] offset0:0 offset1:16
  ds_write_b32 v7, v68
  s_cbranch_vccnz Anan_47
Ananb_48:
  s_barrier
  ds_read_b128 v[32:35], v0 offset:12288
  ds_read_b128 v[16:19], v0 offset:8192
  ds_read_b128 v[20:23], v0 offset:9216
  ds_read_b128 v[24:27], v0 offset:10240
  ds_read_b128 v[28:31], v0 offset:11264
  s_waitcnt lgkmcnt(4)
  v_pk_add_f32 v[32:33], v[32:33], v[34:35]
  v_add_f32 v32, v32, v33
  v_exp_f32 v40, v32
  s_waitcnt lgkmcnt(2)
  v_pk_add_f32 v[16:17], v[16:17], v[20:21]
  v_pk_add_f32 v[18:19], v[18:19], v[22:23]
  s_waitcnt lgkmcnt(1)
  v_pk_add_f32 v[16:17], v[16:17], v[24:25]
  v_pk_add_f32 v[18:19], v[18:19], v[26:27]
  s_waitcnt lgkmcnt(0)
  v_pk_add_f32 v[16:17], v[16:17], v[28:29]
  v_pk_add_f32 v[18:19], v[18:19], v[30:31]
  v_exp_f32 v36, v16
  v_exp_f32 v37, v17
  v_exp_f32 v38, v18
  v_exp_f32 v39, v19
  v_add_f32 v104, v40, v36
  v_add_f32 v105, v37, v38
  v_add_f32 v104, v104, v39
  v_add_f32 v104, v104, v105
  v_maximum3_f32 v110, abs(v16), abs(v17), abs(v18)
  v_maximum3_f32 v110, v110, abs(v19), abs(v32)
  v_add_f32_dpp v104, v104, v104 quad_perm:[1,0,3,2] row_mask:0xf bank_mask:0xf
  v_cmp_nge_f32 vcc, s44, v110
  v_mov_b32_dpp v41, v40 quad_perm:[1,0,3,2] row_mask:0xf bank_mask:0xf
  v_add_f32_dpp v104, v104, v104 quad_perm:[2,3,0,1] row_mask:0xf bank_mask:0xf
  s_nop 1
  v_add_f32_dpp v104, v104, v104 row_half_mirror row_mask:0xf bank_mask:0xf
  v_rcp_f32 v104, v104
  s_cbranch_vccnz Aslow_50
  v_pk_mul_f32 v[36:37], v[36:37], v[104:105] op_sel_hi:[1,0] clamp
  v_pk_mul_f32 v[38:39], v[38:39], v[104:105] op_sel_hi:[1,0] clamp
  v_cvt_pk_bf16_f32 v106, v36, v37
  v_cvt_pk_bf16_f32 v107, v38, v39
  v_pk_mul_f32 v[40:41], v[40:41], v[104:105] op_sel_hi:[1,0] clamp
  v_cvt_pk_bf16_f32 v109, v40, v41
  buffer_store_dwordx2 v[106:107], v8, s[4:7], s19 offen
  buffer_store_dword v109, v9, s[4:7], s19 offen
  s_barrier
Asj_51:
  s_branch Ajoin_46
.p2align 5
Aoth_44:
  s_waitcnt vmcnt(0) lgkmcnt(0)
  v_smfmac_f32_16x16x64_bf16 v[24:27], v[56:59], v[112:119], v1
  v_smfmac_f32_16x16x64_bf16 v[16:19], v[56:59], v[80:87], v1
  v_smfmac_f32_16x16x64_bf16 v[20:23], v[56:59], v[96:103], v1
  v_add_f32_dpp v68, v24, v26 quad_perm:[0,1,2,3] row_mask:0xf bank_mask:0x3
  s_nop 0
  v_add_f32 v64, v16, v18
  v_add_f32 v66, v17, v19
  v_add_f32_dpp v68, v25, v27 quad_perm:[0,1,2,3] row_mask:0xf bank_mask:0xc
  v_cmp_u_f32 vcc, v68, v68
  v_add_f32 v65, v20, v22
  v_add_f32 v67, v21, v23
  ds_write2_b64 v6, v[64:65], v[66:67] offset0:0 offset1:16
  ds_write_b32 v7, v68
  s_cbranch_vccnz Anan_47
Ananb_49:
  s_barrier
  s_cmp_lg_u32 s17, 3
  s_cbranch_scc1 Ajoin_45
  s_waitcnt lgkmcnt(0)
  buffer_store_dword v12, v10, s[4:7], 0 offen
  v_mov_b64 v[104:105], -1
  buffer_store_dwordx2 v[104:105], v8, s[4:7], s21 offen
  buffer_store_dword v104, v9, s[4:7], s21 offen
Ajoin_45:
  s_waitcnt lgkmcnt(0)
  s_barrier
Ajoin_46:
  s_add_u32 s45, s45, 32768
  s_add_u32 s18, s18, 1
  s_cmp_lt_u32 s18, 63
  s_cbranch_scc1 A_top_f
  s_lshl_b32 s34, s16, 2
  s_add_u32 s34, s34, s17
  s_cmp_lg_u32 s34, 2
  s_cbranch_scc1 mh_52
  v_mov_b32 v104, 1
  v_mov_b32 v105, 1
  v_mov_b32 v106, 0
  s_mov_b32 s34, 47005632
  buffer_store_dwordx2 v[104:105], v106, s[12:15], s34 offen sc1
mh_52:
  s_branch L_fin
Aslow_50:
  s_barrier
  ds_read_b128 v[16:19], v0 offset:8192
  ds_read_b128 v[20:23], v0 offset:9216
  ds_read_b128 v[24:27], v0 offset:10240
  ds_read_b128 v[28:31], v0 offset:11264
  ds_read_b128 v[32:35], v0 offset:12288
  s_waitcnt lgkmcnt(0)
  v_pk_add_f32 v[16:17], v[16:17], v[20:21]
  v_pk_add_f32 v[18:19], v[18:19], v[22:23]
  v_pk_add_f32 v[16:17], v[16:17], v[24:25]
  v_pk_add_f32 v[18:19], v[18:19], v[26:27]
  v_pk_add_f32 v[16:17], v[16:17], v[28:29]
  v_pk_add_f32 v[18:19], v[18:19], v[30:31]
  v_pk_add_f32 v[32:33], v[32:33], v[34:35]
  v_add_f32 v32, v32, v33
  v_max3_f32 v104, v16, v17, v18
  v_max3_f32 v104, v104, v19, v32
  s_nop 1
  v_max_f32_dpp v104, v104, v104 quad_perm:[1,0,3,2] row_mask:0xf bank_mask:0xf
  s_nop 1
  v_max_f32_dpp v104, v104, v104 quad_perm:[2,3,0,1] row_mask:0xf bank_mask:0xf
  s_nop 1
  v_max_f32_dpp v104, v104, v104 row_half_mirror row_mask:0xf bank_mask:0xf
  v_sub_f32 v16, v16, v104
  v_sub_f32 v17, v17, v104
  v_sub_f32 v18, v18, v104
  v_sub_f32 v19, v19, v104
  v_sub_f32 v32, v32, v104
  v_exp_f32 v40, v32
  v_exp_f32 v36, v16
  v_exp_f32 v37, v17
  v_exp_f32 v38, v18
  v_exp_f32 v39, v19
  s_nop 0
  v_add_f32 v104, v40, v36
  v_add_f32 v105, v37, v38
  v_add_f32 v104, v104, v39
  v_add_f32 v104, v104, v105
  v_mov_b32_dpp v41, v40 quad_perm:[1,0,3,2] row_mask:0xf bank_mask:0xf
  s_nop 0
  v_add_f32_dpp v104, v104, v104 quad_perm:[1,0,3,2] row_mask:0xf bank_mask:0xf
  s_nop 1
  v_add_f32_dpp v104, v104, v104 quad_perm:[2,3,0,1] row_mask:0xf bank_mask:0xf
  s_nop 1
  v_add_f32_dpp v104, v104, v104 row_half_mirror row_mask:0xf bank_mask:0xf
  v_rcp_f32 v104, v104
  s_nop 0
  v_pk_mul_f32 v[36:37], v[36:37], v[104:105] op_sel_hi:[1,0] clamp
  v_pk_mul_f32 v[38:39], v[38:39], v[104:105] op_sel_hi:[1,0] clamp
  v_cvt_pk_bf16_f32 v106, v36, v37
  v_cvt_pk_bf16_f32 v107, v38, v39
  v_pk_mul_f32 v[40:41], v[40:41], v[104:105] op_sel_hi:[1,0] clamp
  v_cvt_pk_bf16_f32 v109, v40, v41
  buffer_store_dwordx2 v[106:107], v8, s[4:7], s19 offen
  buffer_store_dword v109, v9, s[4:7], s19 offen
  s_branch Asj_51
Aw0_34:
  v_mov_b64 v[112:113], -1
  v_mov_b64 v[114:115], -1
  ds_write_b128 v0, v[112:115] offset:8192
  ds_write_b128 v0, v[112:115] offset:9216
  ds_write_b128 v0, v[112:115] offset:10240
  ds_write_b128 v0, v[112:115] offset:11264
  ds_write_b128 v0, v[112:115] offset:12288
  s_waitcnt lgkmcnt(0)
  s_branch Anp_33
Ars_38:
  s_add_u32 s42, s42, 1
  s_waitcnt vmcnt(0)
  s_cmp_lt_u32 s42, 200000
  s_cbranch_scc1 Arestart_37
  s_branch L_exit
Aretry_39:
  s_mov_b32 s23, 200000
l_53:
  buffer_load_dwordx4 v[20:23], v11, s[4:7], s25 offen sc1
  buffer_load_dwordx4 v[24:27], v11, s[4:7], s26 offen sc1
  buffer_load_dwordx4 v[28:31], v11, s[4:7], s27 offen sc1
  s_add_u32 m0, s51, 16384
  s_nop 0
  buffer_load_dwordx4 v11, s[4:7], s51 offen sc1 lds
  s_add_u32 m0, s52, 16384
  s_nop 0
  buffer_load_dwordx4 v11, s[4:7], s52 offen sc1 lds
  s_waitcnt vmcnt(0)
  v_cmp_eq_u32 vcc, -1, v20
  s_cbranch_vccz Aback_40
  s_sub_u32 s23, s23, 1
  s_cbranch_scc0 l_53
  s_branch L_exit
Aretry_41:
  s_mov_b32 s23, 200000
l_54:
  buffer_load_dwordx4 v[24:27], v11, s[4:7], s26 offen sc1
  buffer_load_dwordx4 v[28:31], v11, s[4:7], s27 offen sc1
  s_add_u32 m0, s51, 16384
  s_nop 0
  buffer_load_dwordx4 v11, s[4:7], s51 offen sc1 lds
  s_add_u32 m0, s52, 16384
  s_nop 0
  buffer_load_dwordx4 v11, s[4:7], s52 offen sc1 lds
  s_waitcnt vmcnt(0)
  v_cmp_eq_u32 vcc, -1, v24
  s_cbranch_vccz Aback_42
  s_sub_u32 s23, s23, 1
  s_cbranch_scc0 l_54
  s_branch L_exit
Anan_47:
  s_cmp_eq_u32 s32, 0
  s_cbranch_scc1 ok_55
  s_cmp_lt_u32 s17, 1
  s_cbranch_scc1 Ananb_48
  s_branch Ananb_49
ok_55:
  s_mov_b32 s32, 1
  s_mov_b32 s23, 200000
  s_waitcnt lgkmcnt(0)
l_56:
  buffer_load_dwordx4 v[16:19], v11, s[4:7], s24 offen sc1
  buffer_load_dwordx4 v[20:23], v11, s[4:7], s25 offen sc1
  buffer_load_dwordx4 v[24:27], v11, s[4:7], s26 offen sc1
  buffer_load_dwordx4 v[28:31], v11, s[4:7], s27 offen sc1
  buffer_load_dwordx4 v[32:35], v11, s[4:7], s28 offen sc1
  buffer_load_dwordx4 v[36:39], v11, s[4:7], s29 offen sc1
  buffer_load_dwordx4 v[40:43], v11, s[4:7], s30 offen sc1
  s_waitcnt vmcnt(0)
  v_max_u32 v104, v16, v17
  v_max3_u32 v104, v104, v18, v19
  v_max3_u32 v104, v104, v20, v21
  v_max3_u32 v104, v104, v22, v23
  v_max3_u32 v104, v104, v24, v25
  v_max3_u32 v104, v104, v26, v27
  v_max3_u32 v104, v104, v28, v29
  v_max3_u32 v104, v104, v30, v31
  v_max3_u32 v104, v104, v32, v33
  v_max3_u32 v104, v104, v34, v35
  v_max3_u32 v104, v104, v36, v37
  v_max3_u32 v104, v104, v38, v39
  v_max3_u32 v104, v104, v40, v41
  v_max3_u32 v104, v104, v42, v43
  v_cmp_eq_u32 vcc, -1, v104
  s_cbranch_vccz gd_57
  s_sub_u32 s23, s23, 1
  s_cbranch_scc0 l_56
  s_branch L_exit
gd_57:
  s_add_u32 s34, s17, 1
  s_lshl_b32 s34, s34, 13
  v_add_u32 v14, s34, v5
  v_add_u32 v105, s34, v0
  ds_write_b128 v105, v[16:19] offset:23552
  v_add_u32 v104, s24, v105
  ds_write_b128 v104, v[16:19] offset:16384
  v_add_u32 v104, s25, v105
  ds_write_b128 v104, v[20:23] offset:16384
  v_add_u32 v104, s26, v105
  ds_write_b128 v104, v[24:27] offset:16384
  v_add_u32 v104, s27, v105
  ds_write_b128 v104, v[28:31] offset:16384
  v_add_u32 v104, s28, v105
  ds_write_b128 v104, v[32:35] offset:16384
  v_add_u32 v104, s29, v105
  ds_write_b128 v104, v[36:39] offset:16384
  v_add_u32 v104, s30, v105
  ds_write_b128 v104, v[40:43] offset:16384
  s_waitcnt lgkmcnt(0)
  v_mov_b64 v[44:45], 0
  v_mov_b64 v[46:47], 0
  v_mov_b64 v[48:49], 0
  v_mov_b64 v[50:51], 0
  v_mov_b64 v[52:53], 0
  v_mov_b64 v[54:55], 0
  v_mov_b64 v[56:57], 0
  v_mov_b64 v[58:59], 0
  v_mov_b64 v[60:61], 0
  v_mov_b64 v[62:63], 0
  v_mov_b64 v[64:65], 0
  v_mov_b64 v[66:67], 0
  v_mov_b64 v[68:69], 0
  v_mov_b64 v[70:71], 0
  v_smfmac_f32_16x16x64_bf16 v[44:47], v[16:19], a[0:7], v1
  v_smfmac_f32_16x16x64_bf16 v[48:51], v[16:19], a[56:63], v1
  v_smfmac_f32_16x16x64_bf16 v[52:55], v[16:19], a[112:119], v1
  v_smfmac_f32_16x16x64_bf16 v[56:59], v[16:19], a[168:175], v1
  v_smfmac_f32_16x16x64_bf16 v[60:63], v[16:19], a[224:231], v1
  v_smfmac_f32_16x16x64_bf16 v[64:67], v[16:19], v[144:151], v1
  v_smfmac_f32_16x16x64_bf16 v[68:71], v[16:19], v[200:207], v1
  v_smfmac_f32_16x16x64_bf16 v[44:47], v[20:23], a[8:15], v1
  v_mov_b64 v[16:17], 0
  v_smfmac_f32_16x16x64_bf16 v[48:51], v[20:23], a[64:71], v1
  v_mov_b64 v[18:19], 0
  v_smfmac_f32_16x16x64_bf16 v[52:55], v[20:23], a[120:127], v1
  v_smfmac_f32_16x16x64_bf16 v[56:59], v[20:23], a[176:183], v1
  v_smfmac_f32_16x16x64_bf16 v[60:63], v[20:23], a[232:239], v1
  v_smfmac_f32_16x16x64_bf16 v[64:67], v[20:23], v[152:159], v1
  v_smfmac_f32_16x16x64_bf16 v[68:71], v[20:23], v[208:215], v1
  v_smfmac_f32_16x16x64_bf16 v[44:47], v[24:27], a[16:23], v1
  v_mov_b64 v[20:21], 0
  v_smfmac_f32_16x16x64_bf16 v[48:51], v[24:27], a[72:79], v1
  v_mov_b64 v[22:23], 0
  v_smfmac_f32_16x16x64_bf16 v[52:55], v[24:27], a[128:135], v1
  v_smfmac_f32_16x16x64_bf16 v[56:59], v[24:27], a[184:191], v1
  v_smfmac_f32_16x16x64_bf16 v[60:63], v[24:27], a[240:247], v1
  v_smfmac_f32_16x16x64_bf16 v[64:67], v[24:27], v[160:167], v1
  v_smfmac_f32_16x16x64_bf16 v[68:71], v[24:27], v[216:223], v1
  v_smfmac_f32_16x16x64_bf16 v[44:47], v[28:31], a[24:31], v1
  v_smfmac_f32_16x16x64_bf16 v[48:51], v[28:31], a[80:87], v1
  v_mov_b64 v[24:25], 0
  v_smfmac_f32_16x16x64_bf16 v[56:59], v[28:31], a[192:199], v1
  v_mov_b64 v[26:27], 0
  v_smfmac_f32_16x16x64_bf16 v[64:67], v[28:31], v[168:175], v1
  v_smfmac_f32_16x16x64_bf16 v[44:47], v[32:35], a[32:39], v1
  v_smfmac_f32_16x16x64_bf16 v[44:47], v[36:39], a[40:47], v1
  v_smfmac_f32_16x16x64_bf16 v[44:47], v[40:43], a[48:55], v1
  v_smfmac_f32_16x16x64_bf16 v[48:51], v[32:35], a[88:95], v1
  v_smfmac_f32_16x16x64_bf16 v[48:51], v[36:39], a[96:103], v1
  v_add_f32 v44, v44, v46
  v_smfmac_f32_16x16x64_bf16 v[48:51], v[40:43], a[104:111], v1
  v_add_f32 v45, v45, v47
  v_smfmac_f32_16x16x64_bf16 v[52:55], v[28:31], a[136:143], v1
  v_cvt_pk_bf16_f32 v46, v44, v45
  v_smfmac_f32_16x16x64_bf16 v[52:55], v[32:35], a[144:151], v1
  ds_read_b128 v[104:107], v14 offset:0
  v_add_f32 v48, v48, v50
  v_smfmac_f32_16x16x64_bf16 v[52:55], v[36:39], a[152:159], v1
  ds_read_b128 v[108:111], v14 offset:256
  v_add_f32 v49, v49, v51
  v_smfmac_f32_16x16x64_bf16 v[52:55], v[40:43], a[160:167], v1
  ds_read_b128 v[112:115], v14 offset:1024
  v_cvt_pk_bf16_f32 v47, v48, v49
  v_smfmac_f32_16x16x64_bf16 v[56:59], v[32:35], a[200:207], v1
  ds_write_b64 v2, v[46:47] offset:0
  v_smfmac_f32_16x16x64_bf16 v[56:59], v[36:39], a[208:215], v1
  ds_read_b64_tr_b16 v[48:49], v4 offset:0
  v_add_f32 v52, v52, v54
  v_smfmac_f32_16x16x64_bf16 v[56:59], v[40:43], a[216:223], v1
  ds_read_b128 v[116:119], v14 offset:1280
  v_add_f32 v53, v53, v55
  v_smfmac_f32_16x16x64_bf16 v[60:63], v[28:31], a[248:255], v1
  v_cvt_pk_bf16_f32 v54, v52, v53
  v_smfmac_f32_16x16x64_bf16 v[60:63], v[32:35], v[120:127], v1
  v_add_f32 v56, v56, v58
  v_smfmac_f32_16x16x64_bf16 v[60:63], v[36:39], v[128:135], v1
  v_add_f32 v57, v57, v59
  v_smfmac_f32_16x16x64_bf16 v[60:63], v[40:43], v[136:143], v1
  v_cvt_pk_bf16_f32 v55, v56, v57
  v_smfmac_f32_16x16x64_bf16 v[64:67], v[32:35], v[176:183], v1
  ds_write_b64 v2, v[54:55] offset:512
  v_smfmac_f32_16x16x64_bf16 v[64:67], v[36:39], v[184:191], v1
  ds_read_b64_tr_b16 v[50:51], v4 offset:512
  v_add_f32 v60, v60, v62
  v_smfmac_f32_16x16x64_bf16 v[64:67], v[40:43], v[192:199], v1
  v_add_f32 v61, v61, v63
  v_smfmac_f32_16x16x64_bf16 v[68:71], v[28:31], v[224:231], v1
  v_cvt_pk_bf16_f32 v62, v60, v61
  v_smfmac_f32_16x16x64_bf16 v[68:71], v[32:35], v[232:239], v1
  v_add_f32 v64, v64, v66
  v_add_f32 v65, v65, v67
  v_smfmac_f32_16x16x64_bf16 v[68:71], v[36:39], v[240:247], v1
  v_cvt_pk_bf16_f32 v63, v64, v65
  v_smfmac_f32_16x16x64_bf16 v[68:71], v[40:43], v[248:255], v1
  ds_write_b64 v2, v[62:63] offset:1024
  s_branch Aj_43
L_Aslow:
  s_mov_b32 s18, 0
  s_mov_b32 s64, 4096
  s_mov_b32 s65, 8192
  s_mov_b32 s66, 12288
  s_mov_b32 s67, 16384
  s_mov_b32 s68, 20480
  s_mov_b32 s69, 24576
  s_mov_b32 s70, 28672
  s_lshl_b32 s45, s17, 10
  s_add_u32 s45, s45, 13631488
  s_waitcnt vmcnt(0)
.p2align 5
A_top_s:
  s_lshl_b32 s48, s18, 13
  s_add_u32 s48, s48, 131072
  s_add_u32 s49, s48, 8192
  s_add_u32 s50, s48, 24576
  s_and_b32 s34, s18, 3
  s_lshl_b32 s19, s34, 15
  s_add_u32 s22, s18, 1
  s_add_u32 s34, s18, 3
  s_and_b32 s34, s34, 3
  s_lshl_b32 s21, s34, 15
  v_add_u32 v11, s48, v0
  s_mov_b32 s32, 0
  v_add_u32 v13, s45, v0
  v_mov_b32 v12, s22
  s_cmp_lt_u32 s17, 1
  s_cbranch_scc1 Aw0_59
  v_mov_b64 v[112:113], -1
  v_mov_b64 v[114:115], -1
  s_mul_i32 s34, s17, 2048
  v_add_u32 v116, s34, v0
  ds_write_b128 v116, v[112:115] offset:14336
  ds_write_b128 v116, v[112:115] offset:15360
  ds_write_b128 v116, v[112:115] offset:16384
  s_waitcnt lgkmcnt(0)
  s_cmp_lg_u32 s17, 2
  s_cbranch_scc1 Anp_58
  s_mov_b32 s23, 200000
  buffer_load_dword v104, v10, s[4:7], 0 offen sc1
  buffer_load_dword v105, v10, s[4:7], 0 offen sc1
  buffer_load_dword v106, v10, s[4:7], 0 offen sc1
  buffer_load_dword v107, v10, s[4:7], 0 offen sc1
  buffer_load_dword v108, v10, s[4:7], 0 offen sc1
  buffer_load_dword v109, v10, s[4:7], 0 offen sc1
poll_60:
  s_waitcnt vmcnt(5)
  v_cmp_gt_u32 vcc, s22, v104
  buffer_load_dword v104, v10, s[4:7], 0 offen sc1
  s_cbranch_vccz polld_61
  s_waitcnt vmcnt(5)
  v_cmp_gt_u32 vcc, s22, v105
  buffer_load_dword v105, v10, s[4:7], 0 offen sc1
  s_cbranch_vccz polld_61
  s_waitcnt vmcnt(5)
  v_cmp_gt_u32 vcc, s22, v106
  buffer_load_dword v106, v10, s[4:7], 0 offen sc1
  s_cbranch_vccz polld_61
  s_waitcnt vmcnt(5)
  v_cmp_gt_u32 vcc, s22, v107
  buffer_load_dword v107, v10, s[4:7], 0 offen sc1
  s_cbranch_vccz polld_61
  s_waitcnt vmcnt(5)
  v_cmp_gt_u32 vcc, s22, v108
  buffer_load_dword v108, v10, s[4:7], 0 offen sc1
  s_cbranch_vccz polld_61
  s_waitcnt vmcnt(5)
  v_cmp_gt_u32 vcc, s22, v109
  buffer_load_dword v109, v10, s[4:7], 0 offen sc1
  s_cbranch_vccz polld_61
  s_waitcnt vmcnt(5)
  v_cmp_gt_u32 vcc, s22, v104
  buffer_load_dword v104, v10, s[4:7], 0 offen sc1
  s_cbranch_vccz polld_61
  s_waitcnt vmcnt(5)
  v_cmp_gt_u32 vcc, s22, v105
  buffer_load_dword v105, v10, s[4:7], 0 offen sc1
  s_cbranch_vccz polld_61
  s_waitcnt vmcnt(5)
  v_cmp_gt_u32 vcc, s22, v106
  buffer_load_dword v106, v10, s[4:7], 0 offen sc1
  s_cbranch_vccz polld_61
  s_waitcnt vmcnt(5)
  v_cmp_gt_u32 vcc, s22, v107
  buffer_load_dword v107, v10, s[4:7], 0 offen sc1
  s_cbranch_vccz polld_61
  s_waitcnt vmcnt(5)
  v_cmp_gt_u32 vcc, s22, v108
  buffer_load_dword v108, v10, s[4:7], 0 offen sc1
  s_cbranch_vccz polld_61
  s_waitcnt vmcnt(5)
  v_cmp_gt_u32 vcc, s22, v109
  buffer_load_dword v109, v10, s[4:7], 0 offen sc1
  s_cbranch_vccz polld_61
  s_waitcnt vmcnt(5)
  v_cmp_gt_u32 vcc, s22, v104
  buffer_load_dword v104, v10, s[4:7], 0 offen sc1
  s_cbranch_vccz polld_61
  s_waitcnt vmcnt(5)
  v_cmp_gt_u32 vcc, s22, v105
  buffer_load_dword v105, v10, s[4:7], 0 offen sc1
  s_cbranch_vccz polld_61
  s_waitcnt vmcnt(5)
  v_cmp_gt_u32 vcc, s22, v106
  buffer_load_dword v106, v10, s[4:7], 0 offen sc1
  s_cbranch_vccz polld_61
  s_waitcnt vmcnt(5)
  v_cmp_gt_u32 vcc, s22, v107
  buffer_load_dword v107, v10, s[4:7], 0 offen sc1
  s_cbranch_vccz polld_61
  s_waitcnt vmcnt(5)
  v_cmp_gt_u32 vcc, s22, v108
  buffer_load_dword v108, v10, s[4:7], 0 offen sc1
  s_cbranch_vccz polld_61
  s_waitcnt vmcnt(5)
  v_cmp_gt_u32 vcc, s22, v109
  buffer_load_dword v109, v10, s[4:7], 0 offen sc1
  s_cbranch_vccz polld_61
  s_waitcnt vmcnt(5)
  v_cmp_gt_u32 vcc, s22, v104
  buffer_load_dword v104, v10, s[4:7], 0 offen sc1
  s_cbranch_vccz polld_61
  s_waitcnt vmcnt(5)
  v_cmp_gt_u32 vcc, s22, v105
  buffer_load_dword v105, v10, s[4:7], 0 offen sc1
  s_cbranch_vccz polld_61
  s_waitcnt vmcnt(5)
  v_cmp_gt_u32 vcc, s22, v106
  buffer_load_dword v106, v10, s[4:7], 0 offen sc1
  s_cbranch_vccz polld_61
  s_waitcnt vmcnt(5)
  v_cmp_gt_u32 vcc, s22, v107
  buffer_load_dword v107, v10, s[4:7], 0 offen sc1
  s_cbranch_vccz polld_61
  s_waitcnt vmcnt(5)
  v_cmp_gt_u32 vcc, s22, v108
  buffer_load_dword v108, v10, s[4:7], 0 offen sc1
  s_cbranch_vccz polld_61
  s_waitcnt vmcnt(5)
  v_cmp_gt_u32 vcc, s22, v109
  buffer_load_dword v109, v10, s[4:7], 0 offen sc1
  s_sub_u32 s23, s23, 1
  s_cbranch_vccz polld_61
  s_cbranch_scc0 poll_60
  s_branch L_exit
.p2align 5
  s_nop 0
polld_61:
Anp_58:
  s_barrier
Arestart_62:
  s_add_u32 m0, s51, 16384
  buffer_load_dwordx4 v[16:19], v11, s[4:7], s24 offen sc1
  v_mov_b32 v44, 0
  v_mov_b32 v45, 0
  buffer_load_dwordx4 v[20:23], v11, s[4:7], s25 offen sc1
  v_mov_b32 v46, 0
  v_mov_b32 v47, 0
  v_mov_b32 v48, 0
  buffer_load_dwordx4 v[24:27], v11, s[4:7], s26 offen sc1
  v_mov_b32 v49, 0
  v_mov_b32 v50, 0
  v_mov_b32 v51, 0
  v_mov_b32 v52, 0
  v_mov_b32 v53, 0
  buffer_load_dwordx4 v11, s[4:7], s51 offen sc1 lds
  s_add_u32 m0, s52, 16384
  v_mov_b32 v54, 0
  v_mov_b32 v55, 0
  v_mov_b32 v56, 0
  v_mov_b32 v57, 0
  v_mov_b32 v58, 0
  v_mov_b32 v59, 0
  v_mov_b32 v60, 0
  v_mov_b32 v61, 0
  v_mov_b32 v62, 0
  v_mov_b32 v63, 0
  v_mov_b32 v64, 0
  v_mov_b32 v65, 0
  v_mov_b32 v66, 0
  v_mov_b32 v67, 0
  v_mov_b32 v68, 0
  v_mov_b32 v69, 0
  v_mov_b32 v70, 0
  v_mov_b32 v71, 0
  s_waitcnt vmcnt(3)
  v_smfmac_f32_16x16x64_bf16 v[44:47], v[16:19], a[0:7], v1
  v_cmp_eq_u32 vcc, -1, v16
  v_smfmac_f32_16x16x64_bf16 v[48:51], v[16:19], a[56:63], v1
  buffer_load_dwordx4 v[28:31], v11, s[4:7], s27 offen sc1
  v_smfmac_f32_16x16x64_bf16 v[52:55], v[16:19], a[112:119], v1
  s_cbranch_vccnz Ars_63
  v_smfmac_f32_16x16x64_bf16 v[56:59], v[16:19], a[168:175], v1
  buffer_load_dwordx4 v11, s[4:7], s52 offen sc1 lds
  v_smfmac_f32_16x16x64_bf16 v[60:63], v[16:19], a[224:231], v1
  s_waitcnt vmcnt(4)
  v_cmp_eq_u32 vcc, -1, v20
  v_smfmac_f32_16x16x64_bf16 v[64:67], v[16:19], v[144:151], v1
  v_smfmac_f32_16x16x64_bf16 v[68:71], v[16:19], v[200:207], v1
  s_cbranch_vccnz Aretry_64
Aback_65:
  v_smfmac_f32_16x16x64_bf16 v[44:47], v[20:23], a[8:15], v1
  v_mov_b64 v[16:17], 0
  v_smfmac_f32_16x16x64_bf16 v[48:51], v[20:23], a[64:71], v1
  v_mov_b64 v[18:19], 0
  v_smfmac_f32_16x16x64_bf16 v[52:55], v[20:23], a[120:127], v1
  buffer_load_dwordx4 v[88:91], v13, s[12:15], s67 offen sc1
  v_smfmac_f32_16x16x64_bf16 v[56:59], v[20:23], a[176:183], v1
  v_smfmac_f32_16x16x64_bf16 v[60:63], v[20:23], a[232:239], v1
  s_waitcnt vmcnt(4)
  v_cmp_eq_u32 vcc, -1, v24
  v_smfmac_f32_16x16x64_bf16 v[64:67], v[20:23], v[152:159], v1
  buffer_load_dwordx4 v[92:95], v13, s[12:15], s68 offen sc1
  v_smfmac_f32_16x16x64_bf16 v[68:71], v[20:23], v[208:215], v1
  s_cbranch_vccnz Aretry_66
Aback_67:
  v_smfmac_f32_16x16x64_bf16 v[44:47], v[24:27], a[16:23], v1
  v_mov_b64 v[20:21], 0
  v_smfmac_f32_16x16x64_bf16 v[48:51], v[24:27], a[72:79], v1
  v_mov_b64 v[22:23], 0
  v_smfmac_f32_16x16x64_bf16 v[52:55], v[24:27], a[128:135], v1
  buffer_load_dwordx4 v[72:75], v13, s[12:15], 0 offen sc1
  v_smfmac_f32_16x16x64_bf16 v[56:59], v[24:27], a[184:191], v1
  v_smfmac_f32_16x16x64_bf16 v[60:63], v[24:27], a[240:247], v1
  buffer_load_dwordx4 v[76:79], v13, s[12:15], s64 offen sc1
  v_smfmac_f32_16x16x64_bf16 v[64:67], v[24:27], v[160:167], v1
  s_waitcnt vmcnt(5)
  ds_read_b128 v[32:35], v15 offset:0
  v_smfmac_f32_16x16x64_bf16 v[68:71], v[24:27], v[216:223], v1
  ds_read_b128 v[36:39], v15 offset:1024
  v_smfmac_f32_16x16x64_bf16 v[44:47], v[28:31], a[24:31], v1
  ds_read_b128 v[40:43], v15 offset:2048
  v_smfmac_f32_16x16x64_bf16 v[48:51], v[28:31], a[80:87], v1
  buffer_load_dwordx4 v[80:83], v13, s[12:15], s65 offen sc1
  v_mov_b64 v[24:25], 0
  v_smfmac_f32_16x16x64_bf16 v[56:59], v[28:31], a[192:199], v1
  v_mov_b64 v[26:27], 0
  v_smfmac_f32_16x16x64_bf16 v[64:67], v[28:31], v[168:175], v1
  s_waitcnt lgkmcnt(2)
  v_smfmac_f32_16x16x64_bf16 v[44:47], v[32:35], a[32:39], v1
  buffer_load_dwordx4 v[84:87], v13, s[12:15], s66 offen sc1
  s_waitcnt lgkmcnt(1)
  v_smfmac_f32_16x16x64_bf16 v[44:47], v[36:39], a[40:47], v1
  s_waitcnt lgkmcnt(0)
  v_smfmac_f32_16x16x64_bf16 v[44:47], v[40:43], a[48:55], v1
  v_smfmac_f32_16x16x64_bf16 v[48:51], v[32:35], a[88:95], v1
  buffer_load_dwordx4 v[96:99], v13, s[12:15], s69 offen sc1
  v_smfmac_f32_16x16x64_bf16 v[48:51], v[36:39], a[96:103], v1
  v_add_f32 v44, v44, v46
  v_smfmac_f32_16x16x64_bf16 v[48:51], v[40:43], a[104:111], v1
  v_add_f32 v45, v45, v47
  v_smfmac_f32_16x16x64_bf16 v[52:55], v[28:31], a[136:143], v1
  buffer_load_dwordx4 v[100:103], v13, s[12:15], s70 offen sc1
  v_cvt_pk_bf16_f32 v46, v44, v45
  v_smfmac_f32_16x16x64_bf16 v[52:55], v[32:35], a[144:151], v1
  s_waitcnt vmcnt(7)
  ds_read_b128 v[104:107], v5 offset:0
  v_add_f32 v48, v48, v50
  v_smfmac_f32_16x16x64_bf16 v[52:55], v[36:39], a[152:159], v1
  ds_read_b128 v[108:111], v5 offset:256
  v_add_f32 v49, v49, v51
  v_smfmac_f32_16x16x64_bf16 v[52:55], v[40:43], a[160:167], v1
  ds_read_b128 v[112:115], v5 offset:1024
  v_cvt_pk_bf16_f32 v47, v48, v49
  v_smfmac_f32_16x16x64_bf16 v[56:59], v[32:35], a[200:207], v1
  ds_write_b64 v2, v[46:47] offset:0
  v_smfmac_f32_16x16x64_bf16 v[56:59], v[36:39], a[208:215], v1
  ds_read_b64_tr_b16 v[48:49], v4 offset:0
  v_add_f32 v52, v52, v54
  v_smfmac_f32_16x16x64_bf16 v[56:59], v[40:43], a[216:223], v1
  ds_read_b128 v[116:119], v5 offset:1280
  v_add_f32 v53, v53, v55
  v_smfmac_f32_16x16x64_bf16 v[60:63], v[28:31], a[248:255], v1
  v_cvt_pk_bf16_f32 v54, v52, v53
  v_smfmac_f32_16x16x64_bf16 v[60:63], v[32:35], v[120:127], v1
  v_add_f32 v56, v56, v58
  v_smfmac_f32_16x16x64_bf16 v[60:63], v[36:39], v[128:135], v1
  v_add_f32 v57, v57, v59
  v_smfmac_f32_16x16x64_bf16 v[60:63], v[40:43], v[136:143], v1
  v_cvt_pk_bf16_f32 v55, v56, v57
  v_smfmac_f32_16x16x64_bf16 v[64:67], v[32:35], v[176:183], v1
  ds_write_b64 v2, v[54:55] offset:512
  v_smfmac_f32_16x16x64_bf16 v[64:67], v[36:39], v[184:191], v1
  ds_read_b64_tr_b16 v[50:51], v4 offset:512
  v_add_f32 v60, v60, v62
  v_smfmac_f32_16x16x64_bf16 v[64:67], v[40:43], v[192:199], v1
  v_add_f32 v61, v61, v63
  v_smfmac_f32_16x16x64_bf16 v[68:71], v[28:31], v[224:231], v1
  v_cvt_pk_bf16_f32 v62, v60, v61
  v_smfmac_f32_16x16x64_bf16 v[68:71], v[32:35], v[232:239], v1
  v_add_f32 v64, v64, v66
  v_add_f32 v65, v65, v67
  v_smfmac_f32_16x16x64_bf16 v[68:71], v[36:39], v[240:247], v1
  v_cvt_pk_bf16_f32 v63, v64, v65
  v_smfmac_f32_16x16x64_bf16 v[68:71], v[40:43], v[248:255], v1
  ds_write_b64 v2, v[62:63] offset:1024
Aj_68:
  s_waitcnt vmcnt(4)
  s_waitcnt lgkmcnt(1)
  v_smfmac_f32_16x16x64_bf16 v[20:23], v[48:51], v[88:95], v1
  ds_read_b64_tr_b16 v[56:57], v4 offset:1024
  s_nop 2
  v_add_f32 v68, v68, v70
  v_add_f32 v69, v69, v71
  v_cvt_pk_bf16_f32 v70, v68, v69
  ds_write_b32 v3, v70 offset:1536
  ds_read_b64_tr_b16 v[58:59], v4 offset:1536
  v_smfmac_f32_16x16x64_bf16 v[16:19], v[48:51], v[72:79], v1
  v_smfmac_f32_16x16x64_bf16 v[24:27], v[48:51], v[104:111], v1
  s_cmp_ge_u32 s17, 1
  s_cbranch_scc1 Aoth_69
  s_waitcnt vmcnt(0) lgkmcnt(0)
  v_smfmac_f32_16x16x64_bf16 v[24:27], v[56:59], v[112:119], v1
  v_smfmac_f32_16x16x64_bf16 v[16:19], v[56:59], v[80:87], v1
  v_smfmac_f32_16x16x64_bf16 v[20:23], v[56:59], v[96:103], v1
  v_add_f32_dpp v68, v24, v26 quad_perm:[0,1,2,3] row_mask:0xf bank_mask:0x3
  s_nop 0
  v_add_f32 v64, v16, v18
  v_add_f32 v66, v17, v19
  v_add_f32_dpp v68, v25, v27 quad_perm:[0,1,2,3] row_mask:0xf bank_mask:0xc
  v_cmp_u_f32 vcc, v68, v68
  v_add_f32 v65, v20, v22
  v_add_f32 v67, v21, v23
  ds_write2_b64 v6, v[64:65], v[66:67] offset0:0 offset1:16
  ds_write_b32 v7, v68
  s_cbranch_vccnz Anan_72
Ananb_73:
  s_barrier
  ds_read_b128 v[32:35], v0 offset:12288
  ds_read_b128 v[16:19], v0 offset:8192
  ds_read_b128 v[20:23], v0 offset:9216
  ds_read_b128 v[24:27], v0 offset:10240
  ds_read_b128 v[28:31], v0 offset:11264
  s_waitcnt lgkmcnt(4)
  v_pk_add_f32 v[32:33], v[32:33], v[34:35]
  v_add_f32 v32, v32, v33
  v_exp_f32 v40, v32
  s_waitcnt lgkmcnt(2)
  v_pk_add_f32 v[16:17], v[16:17], v[20:21]
  v_pk_add_f32 v[18:19], v[18:19], v[22:23]
  s_waitcnt lgkmcnt(1)
  v_pk_add_f32 v[16:17], v[16:17], v[24:25]
  v_pk_add_f32 v[18:19], v[18:19], v[26:27]
  s_waitcnt lgkmcnt(0)
  v_pk_add_f32 v[16:17], v[16:17], v[28:29]
  v_pk_add_f32 v[18:19], v[18:19], v[30:31]
  v_exp_f32 v36, v16
  v_exp_f32 v37, v17
  v_exp_f32 v38, v18
  v_exp_f32 v39, v19
  v_add_f32 v104, v40, v36
  v_add_f32 v105, v37, v38
  v_add_f32 v104, v104, v39
  v_add_f32 v104, v104, v105
  v_maximum3_f32 v110, abs(v16), abs(v17), abs(v18)
  v_maximum3_f32 v110, v110, abs(v19), abs(v32)
  v_add_f32_dpp v104, v104, v104 quad_perm:[1,0,3,2] row_mask:0xf bank_mask:0xf
  v_cmp_nge_f32 vcc, s44, v110
  v_mov_b32_dpp v41, v40 quad_perm:[1,0,3,2] row_mask:0xf bank_mask:0xf
  v_add_f32_dpp v104, v104, v104 quad_perm:[2,3,0,1] row_mask:0xf bank_mask:0xf
  s_nop 1
  v_add_f32_dpp v104, v104, v104 row_half_mirror row_mask:0xf bank_mask:0xf
  v_rcp_f32 v104, v104
  s_cbranch_vccnz Aslow_75
  v_pk_mul_f32 v[36:37], v[36:37], v[104:105] op_sel_hi:[1,0] clamp
  v_pk_mul_f32 v[38:39], v[38:39], v[104:105] op_sel_hi:[1,0] clamp
  v_cvt_pk_bf16_f32 v106, v36, v37
  v_cvt_pk_bf16_f32 v107, v38, v39
  v_pk_mul_f32 v[40:41], v[40:41], v[104:105] op_sel_hi:[1,0] clamp
  v_cvt_pk_bf16_f32 v109, v40, v41
  buffer_store_dwordx2 v[106:107], v8, s[4:7], s19 offen sc1
  buffer_store_dword v109, v9, s[4:7], s19 offen sc1
  s_barrier
Asj_76:
  s_branch Ajoin_71
.p2align 5
Aoth_69:
  s_waitcnt vmcnt(0) lgkmcnt(0)
  v_smfmac_f32_16x16x64_bf16 v[24:27], v[56:59], v[112:119], v1
  v_smfmac_f32_16x16x64_bf16 v[16:19], v[56:59], v[80:87], v1
  v_smfmac_f32_16x16x64_bf16 v[20:23], v[56:59], v[96:103], v1
  v_add_f32_dpp v68, v24, v26 quad_perm:[0,1,2,3] row_mask:0xf bank_mask:0x3
  s_nop 0
  v_add_f32 v64, v16, v18
  v_add_f32 v66, v17, v19
  v_add_f32_dpp v68, v25, v27 quad_perm:[0,1,2,3] row_mask:0xf bank_mask:0xc
  v_cmp_u_f32 vcc, v68, v68
  v_add_f32 v65, v20, v22
  v_add_f32 v67, v21, v23
  ds_write2_b64 v6, v[64:65], v[66:67] offset0:0 offset1:16
  ds_write_b32 v7, v68
  s_cbranch_vccnz Anan_72
Ananb_74:
  s_barrier
  s_cmp_lg_u32 s17, 3
  s_cbranch_scc1 Ajoin_70
  s_waitcnt lgkmcnt(0)
  buffer_store_dword v12, v10, s[4:7], 0 offen sc1
  v_mov_b64 v[104:105], -1
  buffer_store_dwordx2 v[104:105], v8, s[4:7], s21 offen sc1
  buffer_store_dword v104, v9, s[4:7], s21 offen sc1
Ajoin_70:
  s_waitcnt lgkmcnt(0)
  s_barrier
Ajoin_71:
  s_add_u32 s45, s45, 32768
  s_add_u32 s18, s18, 1
  s_cmp_lt_u32 s18, 63
  s_cbranch_scc1 A_top_s
  s_lshl_b32 s34, s16, 2
  s_add_u32 s34, s34, s17
  s_cmp_lg_u32 s34, 2
  s_cbranch_scc1 mh_77
  v_mov_b32 v104, 1
  v_mov_b32 v105, 1
  v_mov_b32 v106, 0
  s_mov_b32 s34, 47005632
  buffer_store_dwordx2 v[104:105], v106, s[12:15], s34 offen sc1
mh_77:
  s_branch L_fin
Aslow_75:
  s_barrier
  ds_read_b128 v[16:19], v0 offset:8192
  ds_read_b128 v[20:23], v0 offset:9216
  ds_read_b128 v[24:27], v0 offset:10240
  ds_read_b128 v[28:31], v0 offset:11264
  ds_read_b128 v[32:35], v0 offset:12288
  s_waitcnt lgkmcnt(0)
  v_pk_add_f32 v[16:17], v[16:17], v[20:21]
  v_pk_add_f32 v[18:19], v[18:19], v[22:23]
  v_pk_add_f32 v[16:17], v[16:17], v[24:25]
  v_pk_add_f32 v[18:19], v[18:19], v[26:27]
  v_pk_add_f32 v[16:17], v[16:17], v[28:29]
  v_pk_add_f32 v[18:19], v[18:19], v[30:31]
  v_pk_add_f32 v[32:33], v[32:33], v[34:35]
  v_add_f32 v32, v32, v33
  v_max3_f32 v104, v16, v17, v18
  v_max3_f32 v104, v104, v19, v32
  s_nop 1
  v_max_f32_dpp v104, v104, v104 quad_perm:[1,0,3,2] row_mask:0xf bank_mask:0xf
  s_nop 1
  v_max_f32_dpp v104, v104, v104 quad_perm:[2,3,0,1] row_mask:0xf bank_mask:0xf
  s_nop 1
  v_max_f32_dpp v104, v104, v104 row_half_mirror row_mask:0xf bank_mask:0xf
  v_sub_f32 v16, v16, v104
  v_sub_f32 v17, v17, v104
  v_sub_f32 v18, v18, v104
  v_sub_f32 v19, v19, v104
  v_sub_f32 v32, v32, v104
  v_exp_f32 v40, v32
  v_exp_f32 v36, v16
  v_exp_f32 v37, v17
  v_exp_f32 v38, v18
  v_exp_f32 v39, v19
  s_nop 0
  v_add_f32 v104, v40, v36
  v_add_f32 v105, v37, v38
  v_add_f32 v104, v104, v39
  v_add_f32 v104, v104, v105
  v_mov_b32_dpp v41, v40 quad_perm:[1,0,3,2] row_mask:0xf bank_mask:0xf
  s_nop 0
  v_add_f32_dpp v104, v104, v104 quad_perm:[1,0,3,2] row_mask:0xf bank_mask:0xf
  s_nop 1
  v_add_f32_dpp v104, v104, v104 quad_perm:[2,3,0,1] row_mask:0xf bank_mask:0xf
  s_nop 1
  v_add_f32_dpp v104, v104, v104 row_half_mirror row_mask:0xf bank_mask:0xf
  v_rcp_f32 v104, v104
  s_nop 0
  v_pk_mul_f32 v[36:37], v[36:37], v[104:105] op_sel_hi:[1,0] clamp
  v_pk_mul_f32 v[38:39], v[38:39], v[104:105] op_sel_hi:[1,0] clamp
  v_cvt_pk_bf16_f32 v106, v36, v37
  v_cvt_pk_bf16_f32 v107, v38, v39
  v_pk_mul_f32 v[40:41], v[40:41], v[104:105] op_sel_hi:[1,0] clamp
  v_cvt_pk_bf16_f32 v109, v40, v41
  buffer_store_dwordx2 v[106:107], v8, s[4:7], s19 offen sc1
  buffer_store_dword v109, v9, s[4:7], s19 offen sc1
  s_branch Asj_76
Aw0_59:
  v_mov_b64 v[112:113], -1
  v_mov_b64 v[114:115], -1
  ds_write_b128 v0, v[112:115] offset:8192
  ds_write_b128 v0, v[112:115] offset:9216
  ds_write_b128 v0, v[112:115] offset:10240
  ds_write_b128 v0, v[112:115] offset:11264
  ds_write_b128 v0, v[112:115] offset:12288
  s_waitcnt lgkmcnt(0)
  s_branch Anp_58
Ars_63:
  s_add_u32 s42, s42, 1
  s_waitcnt vmcnt(0)
  s_cmp_lt_u32 s42, 200000
  s_cbranch_scc1 Arestart_62
  s_branch L_exit
Aretry_64:
  s_mov_b32 s23, 200000
l_78:
  buffer_load_dwordx4 v[20:23], v11, s[4:7], s25 offen sc1
  buffer_load_dwordx4 v[24:27], v11, s[4:7], s26 offen sc1
  buffer_load_dwordx4 v[28:31], v11, s[4:7], s27 offen sc1
  s_add_u32 m0, s51, 16384
  s_nop 0
  buffer_load_dwordx4 v11, s[4:7], s51 offen sc1 lds
  s_add_u32 m0, s52, 16384
  s_nop 0
  buffer_load_dwordx4 v11, s[4:7], s52 offen sc1 lds
  s_waitcnt vmcnt(0)
  v_cmp_eq_u32 vcc, -1, v20
  s_cbranch_vccz Aback_65
  s_sub_u32 s23, s23, 1
  s_cbranch_scc0 l_78
  s_branch L_exit
Aretry_66:
  s_mov_b32 s23, 200000
l_79:
  buffer_load_dwordx4 v[24:27], v11, s[4:7], s26 offen sc1
  buffer_load_dwordx4 v[28:31], v11, s[4:7], s27 offen sc1
  s_add_u32 m0, s51, 16384
  s_nop 0
  buffer_load_dwordx4 v11, s[4:7], s51 offen sc1 lds
  s_add_u32 m0, s52, 16384
  s_nop 0
  buffer_load_dwordx4 v11, s[4:7], s52 offen sc1 lds
  s_waitcnt vmcnt(0)
  v_cmp_eq_u32 vcc, -1, v24
  s_cbranch_vccz Aback_67
  s_sub_u32 s23, s23, 1
  s_cbranch_scc0 l_79
  s_branch L_exit
Anan_72:
  s_cmp_eq_u32 s32, 0
  s_cbranch_scc1 ok_80
  s_cmp_lt_u32 s17, 1
  s_cbranch_scc1 Ananb_73
  s_branch Ananb_74
ok_80:
  s_mov_b32 s32, 1
  s_mov_b32 s23, 200000
  s_waitcnt lgkmcnt(0)
l_81:
  buffer_load_dwordx4 v[16:19], v11, s[4:7], s24 offen sc1
  buffer_load_dwordx4 v[20:23], v11, s[4:7], s25 offen sc1
  buffer_load_dwordx4 v[24:27], v11, s[4:7], s26 offen sc1
  buffer_load_dwordx4 v[28:31], v11, s[4:7], s27 offen sc1
  buffer_load_dwordx4 v[32:35], v11, s[4:7], s28 offen sc1
  buffer_load_dwordx4 v[36:39], v11, s[4:7], s29 offen sc1
  buffer_load_dwordx4 v[40:43], v11, s[4:7], s30 offen sc1
  s_waitcnt vmcnt(0)
  v_max_u32 v104, v16, v17
  v_max3_u32 v104, v104, v18, v19
  v_max3_u32 v104, v104, v20, v21
  v_max3_u32 v104, v104, v22, v23
  v_max3_u32 v104, v104, v24, v25
  v_max3_u32 v104, v104, v26, v27
  v_max3_u32 v104, v104, v28, v29
  v_max3_u32 v104, v104, v30, v31
  v_max3_u32 v104, v104, v32, v33
  v_max3_u32 v104, v104, v34, v35
  v_max3_u32 v104, v104, v36, v37
  v_max3_u32 v104, v104, v38, v39
  v_max3_u32 v104, v104, v40, v41
  v_max3_u32 v104, v104, v42, v43
  v_cmp_eq_u32 vcc, -1, v104
  s_cbranch_vccz gd_82
  s_sub_u32 s23, s23, 1
  s_cbranch_scc0 l_81
  s_branch L_exit
gd_82:
  s_add_u32 s34, s17, 1
  s_lshl_b32 s34, s34, 13
  v_add_u32 v14, s34, v5
  v_add_u32 v105, s34, v0
  ds_write_b128 v105, v[16:19] offset:23552
  v_add_u32 v104, s24, v105
  ds_write_b128 v104, v[16:19] offset:16384
  v_add_u32 v104, s25, v105
  ds_write_b128 v104, v[20:23] offset:16384
  v_add_u32 v104, s26, v105
  ds_write_b128 v104, v[24:27] offset:16384
  v_add_u32 v104, s27, v105
  ds_write_b128 v104, v[28:31] offset:16384
  v_add_u32 v104, s28, v105
  ds_write_b128 v104, v[32:35] offset:16384
  v_add_u32 v104, s29, v105
  ds_write_b128 v104, v[36:39] offset:16384
  v_add_u32 v104, s30, v105
  ds_write_b128 v104, v[40:43] offset:16384
  s_waitcnt lgkmcnt(0)
  v_mov_b64 v[44:45], 0
  v_mov_b64 v[46:47], 0
  v_mov_b64 v[48:49], 0
  v_mov_b64 v[50:51], 0
  v_mov_b64 v[52:53], 0
  v_mov_b64 v[54:55], 0
  v_mov_b64 v[56:57], 0
  v_mov_b64 v[58:59], 0
  v_mov_b64 v[60:61], 0
  v_mov_b64 v[62:63], 0
  v_mov_b64 v[64:65], 0
  v_mov_b64 v[66:67], 0
  v_mov_b64 v[68:69], 0
  v_mov_b64 v[70:71], 0
  v_smfmac_f32_16x16x64_bf16 v[44:47], v[16:19], a[0:7], v1
  v_smfmac_f32_16x16x64_bf16 v[48:51], v[16:19], a[56:63], v1
  v_smfmac_f32_16x16x64_bf16 v[52:55], v[16:19], a[112:119], v1
  v_smfmac_f32_16x16x64_bf16 v[56:59], v[16:19], a[168:175], v1
  v_smfmac_f32_16x16x64_bf16 v[60:63], v[16:19], a[224:231], v1
  v_smfmac_f32_16x16x64_bf16 v[64:67], v[16:19], v[144:151], v1
  v_smfmac_f32_16x16x64_bf16 v[68:71], v[16:19], v[200:207], v1
  v_smfmac_f32_16x16x64_bf16 v[44:47], v[20:23], a[8:15], v1
  v_mov_b64 v[16:17], 0
  v_smfmac_f32_16x16x64_bf16 v[48:51], v[20:23], a[64:71], v1
  v_mov_b64 v[18:19], 0
  v_smfmac_f32_16x16x64_bf16 v[52:55], v[20:23], a[120:127], v1
  v_smfmac_f32_16x16x64_bf16 v[56:59], v[20:23], a[176:183], v1
  v_smfmac_f32_16x16x64_bf16 v[60:63], v[20:23], a[232:239], v1
  v_smfmac_f32_16x16x64_bf16 v[64:67], v[20:23], v[152:159], v1
  v_smfmac_f32_16x16x64_bf16 v[68:71], v[20:23], v[208:215], v1
  v_smfmac_f32_16x16x64_bf16 v[44:47], v[24:27], a[16:23], v1
  v_mov_b64 v[20:21], 0
  v_smfmac_f32_16x16x64_bf16 v[48:51], v[24:27], a[72:79], v1
  v_mov_b64 v[22:23], 0
  v_smfmac_f32_16x16x64_bf16 v[52:55], v[24:27], a[128:135], v1
  v_smfmac_f32_16x16x64_bf16 v[56:59], v[24:27], a[184:191], v1
  v_smfmac_f32_16x16x64_bf16 v[60:63], v[24:27], a[240:247], v1
  v_smfmac_f32_16x16x64_bf16 v[64:67], v[24:27], v[160:167], v1
  v_smfmac_f32_16x16x64_bf16 v[68:71], v[24:27], v[216:223], v1
  v_smfmac_f32_16x16x64_bf16 v[44:47], v[28:31], a[24:31], v1
  v_smfmac_f32_16x16x64_bf16 v[48:51], v[28:31], a[80:87], v1
  v_mov_b64 v[24:25], 0
  v_smfmac_f32_16x16x64_bf16 v[56:59], v[28:31], a[192:199], v1
  v_mov_b64 v[26:27], 0
  v_smfmac_f32_16x16x64_bf16 v[64:67], v[28:31], v[168:175], v1
  v_smfmac_f32_16x16x64_bf16 v[44:47], v[32:35], a[32:39], v1
  v_smfmac_f32_16x16x64_bf16 v[44:47], v[36:39], a[40:47], v1
  v_smfmac_f32_16x16x64_bf16 v[44:47], v[40:43], a[48:55], v1
  v_smfmac_f32_16x16x64_bf16 v[48:51], v[32:35], a[88:95], v1
  v_smfmac_f32_16x16x64_bf16 v[48:51], v[36:39], a[96:103], v1
  v_add_f32 v44, v44, v46
  v_smfmac_f32_16x16x64_bf16 v[48:51], v[40:43], a[104:111], v1
  v_add_f32 v45, v45, v47
  v_smfmac_f32_16x16x64_bf16 v[52:55], v[28:31], a[136:143], v1
  v_cvt_pk_bf16_f32 v46, v44, v45
  v_smfmac_f32_16x16x64_bf16 v[52:55], v[32:35], a[144:151], v1
  ds_read_b128 v[104:107], v14 offset:0
  v_add_f32 v48, v48, v50
  v_smfmac_f32_16x16x64_bf16 v[52:55], v[36:39], a[152:159], v1
  ds_read_b128 v[108:111], v14 offset:256
  v_add_f32 v49, v49, v51
  v_smfmac_f32_16x16x64_bf16 v[52:55], v[40:43], a[160:167], v1
  ds_read_b128 v[112:115], v14 offset:1024
  v_cvt_pk_bf16_f32 v47, v48, v49
  v_smfmac_f32_16x16x64_bf16 v[56:59], v[32:35], a[200:207], v1
  ds_write_b64 v2, v[46:47] offset:0
  v_smfmac_f32_16x16x64_bf16 v[56:59], v[36:39], a[208:215], v1
  ds_read_b64_tr_b16 v[48:49], v4 offset:0
  v_add_f32 v52, v52, v54
  v_smfmac_f32_16x16x64_bf16 v[56:59], v[40:43], a[216:223], v1
  ds_read_b128 v[116:119], v14 offset:1280
  v_add_f32 v53, v53, v55
  v_smfmac_f32_16x16x64_bf16 v[60:63], v[28:31], a[248:255], v1
  v_cvt_pk_bf16_f32 v54, v52, v53
  v_smfmac_f32_16x16x64_bf16 v[60:63], v[32:35], v[120:127], v1
  v_add_f32 v56, v56, v58
  v_smfmac_f32_16x16x64_bf16 v[60:63], v[36:39], v[128:135], v1
  v_add_f32 v57, v57, v59
  v_smfmac_f32_16x16x64_bf16 v[60:63], v[40:43], v[136:143], v1
  v_cvt_pk_bf16_f32 v55, v56, v57
  v_smfmac_f32_16x16x64_bf16 v[64:67], v[32:35], v[176:183], v1
  ds_write_b64 v2, v[54:55] offset:512
  v_smfmac_f32_16x16x64_bf16 v[64:67], v[36:39], v[184:191], v1
  ds_read_b64_tr_b16 v[50:51], v4 offset:512
  v_add_f32 v60, v60, v62
  v_smfmac_f32_16x16x64_bf16 v[64:67], v[40:43], v[192:199], v1
  v_add_f32 v61, v61, v63
  v_smfmac_f32_16x16x64_bf16 v[68:71], v[28:31], v[224:231], v1
  v_cvt_pk_bf16_f32 v62, v60, v61
  v_smfmac_f32_16x16x64_bf16 v[68:71], v[32:35], v[232:239], v1
  v_add_f32 v64, v64, v66
  v_add_f32 v65, v65, v67
  v_smfmac_f32_16x16x64_bf16 v[68:71], v[36:39], v[240:247], v1
  v_cvt_pk_bf16_f32 v63, v64, v65
  v_smfmac_f32_16x16x64_bf16 v[68:71], v[40:43], v[248:255], v1
  ds_write_b64 v2, v[62:63] offset:1024
  s_branch Aj_68
L_roleB:
  s_mov_b32 s54, 0
  s_mov_b32 s23, 300000
  v_mbcnt_lo_u32_b32 v16, -1, 0
  v_cmp_gt_u32 vcc, 8, v16
  v_lshlrev_b32 v16, 5, v16
  s_nop 0
  v_cndmask_b32 v16, 4, v16, vcc
cs_85:
  global_load_dword v17, v16, s[56:57] sc1
  s_waitcnt vmcnt(0)
  v_min_u32 v18, 32, v17
  v_readlane_b32 s35, v17, 8
  v_readlane_b32 s34, v18, 0
  s_cmp_eq_u32 s34, 32
  s_cbranch_scc1 fast_83
  s_add_u32 s35, s35, s34
  v_readlane_b32 s34, v18, 1
  s_add_u32 s35, s35, s34
  v_readlane_b32 s34, v18, 2
  s_add_u32 s35, s35, s34
  v_readlane_b32 s34, v18, 3
  s_add_u32 s35, s35, s34
  v_readlane_b32 s34, v18, 4
  s_add_u32 s35, s35, s34
  v_readlane_b32 s34, v18, 5
  s_add_u32 s35, s35, s34
  v_readlane_b32 s34, v18, 6
  s_add_u32 s35, s35, s34
  v_readlane_b32 s34, v18, 7
  s_add_u32 s35, s35, s34
  s_cmp_ge_u32 s35, 256
  s_cbranch_scc1 slow_84
  s_sub_u32 s23, s23, 1
  s_cbranch_scc0 cs_85
  s_branch L_exit
slow_84:
  s_mov_b32 s54, 1
fast_83:
  s_lshl_b32 s35, s17, 2
  s_add_u32 s35, s35, 16
  v_and_b32 v16, 15, v0
  v_min_u32 v16, 13, v16
  v_and_b32 v17, 48, v0
  v_add_u32 v16, v16, v17
  v_lshlrev_b32 v16, 7, v16
  s_lshl_b32 s34, s35, 11
  s_add_u32 s34, s34, 46858240
  s_mov_b32 s23, 300000
fp_87:
  buffer_load_dword v17, v16, s[12:15], s34 offen sc1
  s_waitcnt vmcnt(0)
  v_cmp_gt_u32 vcc, 1, v17
  s_cbranch_vccz fpd_88
  s_sleep 1
  s_sub_u32 s23, s23, 1
  s_cbranch_scc0 fp_87
  s_branch L_exit
fpd_88:
wm_86:
  v_mov_b32 v16, v0
  v_lshlrev_b32 v0, 4, v16
  v_bfe_u32 v17, v16, 1, 1
  v_mov_b32 v1, 0xaaaa
  v_mul_u32_u24 v1, v1, v17
  v_add_u32 v1, 0x4444, v1
  s_mul_i32 s34, s17, 12288
  s_add_u32 s34, s34, 16384
  v_add_u32 v2, s34, v0
  s_and_b32 s36, s17, 1
  s_mul_i32 s62, s36, 1024
  v_add_u32 v6, s62, v0
  s_lshl_b32 s35, s16, 1
  s_add_u32 s36, s35, s17
  s_lshl_b32 s36, s36, 8
  v_bfe_u32 v17, v16, 0, 6
  v_lshlrev_b32 v3, 2, v17
  v_add_u32 v3, s36, v3
  v_bfe_u32 v17, v16, 0, 4
  v_lshlrev_b32 v4, 2, v17
  v_add_u32 v4, 128, v4
  s_and_b32 s38, s16, 1
  s_lshl_b32 s38, s38, 8
  v_add_u32 v4, s38, v4
  v_min_u32 v111, 13, v16
  v_lshlrev_b32 v111, 2, v111
  v_add_u32 v111, 0, v111
  s_and_b32 s38, s16, 1
  s_lshl_b32 s38, s38, 8
  v_add_u32 v111, s38, v111
  s_lshl_b32 s36, s16, 2
  s_add_u32 s36, s36, 0
  v_lshlrev_b32 v5, 8, v16
  v_add_u32 v5, s36, v5
  v_mov_b32 v17, 0x40000000
  v_cmp_gt_u32 vcc, 2, v16
  s_nop 1
  v_cndmask_b32 v5, v17, v5, vcc
  s_lshl_b32 s36, s17, 10
  v_bfe_u32 v17, v16, 0, 6
  v_lshlrev_b32 v7, 4, v17
  v_add_u32 v7, s36, v7
  v_add_u32 v7, 8192, v7
  s_lshl_b32 s36, s17, 9
  v_bfe_u32 v17, v16, 0, 6
  v_lshlrev_b32 v8, 2, v17
  v_add_u32 v8, s36, v8
  v_add_u32 v8, 16384, v8
  s_mul_i32 s36, s35, 16384
  s_lshl_b32 s37, s17, 10
  s_add_u32 s36, s36, s37
  s_add_u32 s36, s36, 16777216
  v_add_u32 v9, s36, v0
  s_mov_b32 s64, 4096
  s_mov_b32 s65, 8192
  s_mov_b32 s66, 12288
  s_mov_b32 s67, 16384
  s_mov_b32 s68, 20480
  s_mov_b32 s69, 24576
  s_mov_b32 s70, 28672
  s_mul_i32 s36, s17, 544
  v_bfe_u32 v17, v16, 4, 2
  v_lshlrev_b32 v11, 7, v17
  v_bfe_u32 v17, v16, 4, 2
  v_lshl_add_u32 v11, v17, 3, v11
  v_bfe_u32 v17, v16, 0, 4
  v_lshl_add_u32 v11, v17, 3, v11
  v_add_u32 v11, s36, v11
  v_add_u32 v11, 8192, v11
  s_mul_i32 s36, s17, 2560
  v_bfe_u32 v17, v16, 4, 2
  v_lshlrev_b32 v12, 7, v17
  v_bfe_u32 v17, v16, 4, 2
  v_lshl_add_u32 v12, v17, 3, v12
  v_bfe_u32 v17, v16, 3, 1
  v_lshl_add_u32 v12, v17, 6, v12
  v_bfe_u32 v17, v16, 0, 2
  v_lshl_add_u32 v12, v17, 4, v12
  v_bfe_u32 v17, v16, 2, 1
  v_lshl_add_u32 v12, v17, 2, v12
  v_add_u32 v12, s36, v12
  v_add_u32 v12, 8192, v12
  v_add_u32 v14, 1088, v12
  s_mul_i32 s36, s17, 1605632
  s_mul_i32 s37, s35, 14336
  s_add_u32 s36, s36, s37
  s_add_u32 s36, s36, 6422528
  s_add_u32 s37, s36, 0
  buffer_load_dwordx4 a[0:3], v0, s[12:15], s37 offen sc1
  buffer_load_dwordx4 a[4:7], v0, s[12:15], s37 offen offset:1024 sc1
  s_add_u32 s37, s36, 401408
  buffer_load_dwordx4 a[8:11], v0, s[12:15], s37 offen sc1
  buffer_load_dwordx4 a[12:15], v0, s[12:15], s37 offen offset:1024 sc1
  s_add_u32 s37, s36, 802816
  buffer_load_dwordx4 a[16:19], v0, s[12:15], s37 offen sc1
  buffer_load_dwordx4 a[20:23], v0, s[12:15], s37 offen offset:1024 sc1
  s_add_u32 s37, s36, 1204224
  buffer_load_dwordx4 a[24:27], v0, s[12:15], s37 offen sc1
  buffer_load_dwordx4 a[28:31], v0, s[12:15], s37 offen offset:1024 sc1
  s_add_u32 s37, s36, 14336
  buffer_load_dwordx4 a[32:35], v0, s[12:15], s37 offen sc1
  buffer_load_dwordx4 a[36:39], v0, s[12:15], s37 offen offset:1024 sc1
  s_add_u32 s37, s36, 415744
  buffer_load_dwordx4 a[40:43], v0, s[12:15], s37 offen sc1
  buffer_load_dwordx4 a[44:47], v0, s[12:15], s37 offen offset:1024 sc1
  s_add_u32 s37, s36, 817152
  buffer_load_dwordx4 a[48:51], v0, s[12:15], s37 offen sc1
  buffer_load_dwordx4 a[52:55], v0, s[12:15], s37 offen offset:1024 sc1
  s_add_u32 s37, s36, 1218560
  buffer_load_dwordx4 a[56:59], v0, s[12:15], s37 offen sc1
  buffer_load_dwordx4 a[60:63], v0, s[12:15], s37 offen offset:1024 sc1
  s_add_u32 s37, s36, 2048
  buffer_load_dwordx4 a[64:67], v0, s[12:15], s37 offen sc1
  buffer_load_dwordx4 a[68:71], v0, s[12:15], s37 offen offset:1024 sc1
  s_add_u32 s37, s36, 403456
  s_add_u32 m0, s34, 0
  s_nop 0
  buffer_load_dwordx4 v0, s[12:15], s37 offen sc1 lds
  buffer_load_dwordx4 v0, s[12:15], s37 offen offset:1024 sc1 lds
  s_add_u32 s37, s36, 804864
  buffer_load_dwordx4 a[72:75], v0, s[12:15], s37 offen sc1
  buffer_load_dwordx4 a[76:79], v0, s[12:15], s37 offen offset:1024 sc1
  s_add_u32 s37, s36, 1206272
  buffer_load_dwordx4 a[80:83], v0, s[12:15], s37 offen sc1
  buffer_load_dwordx4 a[84:87], v0, s[12:15], s37 offen offset:1024 sc1
  s_add_u32 s37, s36, 16384
  buffer_load_dwordx4 a[88:91], v0, s[12:15], s37 offen sc1
  buffer_load_dwordx4 a[92:95], v0, s[12:15], s37 offen offset:1024 sc1
  s_add_u32 s37, s36, 417792
  buffer_load_dwordx4 a[96:99], v0, s[12:15], s37 offen sc1
  buffer_load_dwordx4 a[100:103], v0, s[12:15], s37 offen offset:1024 sc1
  s_add_u32 s37, s36, 819200
  buffer_load_dwordx4 a[104:107], v0, s[12:15], s37 offen sc1
  buffer_load_dwordx4 a[108:111], v0, s[12:15], s37 offen offset:1024 sc1
  s_add_u32 s37, s36, 1220608
  buffer_load_dwordx4 a[112:115], v0, s[12:15], s37 offen sc1
  buffer_load_dwordx4 a[116:119], v0, s[12:15], s37 offen offset:1024 sc1
  s_add_u32 s37, s36, 4096
  buffer_load_dwordx4 a[120:123], v0, s[12:15], s37 offen sc1
  buffer_load_dwordx4 a[124:127], v0, s[12:15], s37 offen offset:1024 sc1
  s_add_u32 s37, s36, 405504
  buffer_load_dwordx4 a[128:131], v0, s[12:15], s37 offen sc1
  buffer_load_dwordx4 a[132:135], v0, s[12:15], s37 offen offset:1024 sc1
  s_add_u32 s37, s36, 806912
  s_add_u32 m0, s34, 2048
  s_nop 0
  buffer_load_dwordx4 v0, s[12:15], s37 offen sc1 lds
  buffer_load_dwordx4 v0, s[12:15], s37 offen offset:1024 sc1 lds
  s_add_u32 s37, s36, 1208320
  buffer_load_dwordx4 a[136:139], v0, s[12:15], s37 offen sc1
  buffer_load_dwordx4 a[140:143], v0, s[12:15], s37 offen offset:1024 sc1
  s_add_u32 s37, s36, 18432
  buffer_load_dwordx4 a[144:147], v0, s[12:15], s37 offen sc1
  buffer_load_dwordx4 a[148:151], v0, s[12:15], s37 offen offset:1024 sc1
  s_add_u32 s37, s36, 419840
  buffer_load_dwordx4 a[152:155], v0, s[12:15], s37 offen sc1
  buffer_load_dwordx4 a[156:159], v0, s[12:15], s37 offen offset:1024 sc1
  s_add_u32 s37, s36, 821248
  buffer_load_dwordx4 a[160:163], v0, s[12:15], s37 offen sc1
  buffer_load_dwordx4 a[164:167], v0, s[12:15], s37 offen offset:1024 sc1
  s_add_u32 s37, s36, 1222656
  buffer_load_dwordx4 a[168:171], v0, s[12:15], s37 offen sc1
  buffer_load_dwordx4 a[172:175], v0, s[12:15], s37 offen offset:1024 sc1
  s_add_u32 s37, s36, 6144
  buffer_load_dwordx4 a[176:179], v0, s[12:15], s37 offen sc1
  buffer_load_dwordx4 a[180:183], v0, s[12:15], s37 offen offset:1024 sc1
  s_add_u32 s37, s36, 407552
  buffer_load_dwordx4 a[184:187], v0, s[12:15], s37 offen sc1
  buffer_load_dwordx4 a[188:191], v0, s[12:15], s37 offen offset:1024 sc1
  s_add_u32 s37, s36, 808960
  buffer_load_dwordx4 a[192:195], v0, s[12:15], s37 offen sc1
  buffer_load_dwordx4 a[196:199], v0, s[12:15], s37 offen offset:1024 sc1
  s_add_u32 s37, s36, 1210368
  s_add_u32 m0, s34, 4096
  s_nop 0
  buffer_load_dwordx4 v0, s[12:15], s37 offen sc1 lds
  buffer_load_dwordx4 v0, s[12:15], s37 offen offset:1024 sc1 lds
  s_add_u32 s37, s36, 20480
  buffer_load_dwordx4 a[200:203], v0, s[12:15], s37 offen sc1
  buffer_load_dwordx4 a[204:207], v0, s[12:15], s37 offen offset:1024 sc1
  s_add_u32 s37, s36, 421888
  buffer_load_dwordx4 a[208:211], v0, s[12:15], s37 offen sc1
  buffer_load_dwordx4 a[212:215], v0, s[12:15], s37 offen offset:1024 sc1
  s_add_u32 s37, s36, 823296
  buffer_load_dwordx4 a[216:219], v0, s[12:15], s37 offen sc1
  buffer_load_dwordx4 a[220:223], v0, s[12:15], s37 offen offset:1024 sc1
  s_add_u32 s37, s36, 1224704
  buffer_load_dwordx4 a[224:227], v0, s[12:15], s37 offen sc1
  buffer_load_dwordx4 a[228:231], v0, s[12:15], s37 offen offset:1024 sc1
  s_add_u32 s37, s36, 8192
  buffer_load_dwordx4 a[232:235], v0, s[12:15], s37 offen sc1
  buffer_load_dwordx4 a[236:239], v0, s[12:15], s37 offen offset:1024 sc1
  s_add_u32 s37, s36, 409600
  buffer_load_dwordx4 a[240:243], v0, s[12:15], s37 offen sc1
  buffer_load_dwordx4 a[244:247], v0, s[12:15], s37 offen offset:1024 sc1
  s_add_u32 s37, s36, 811008
  buffer_load_dwordx4 a[248:251], v0, s[12:15], s37 offen sc1
  buffer_load_dwordx4 a[252:255], v0, s[12:15], s37 offen offset:1024 sc1
  s_add_u32 s37, s36, 1212416
  buffer_load_dwordx4 v[112:115], v0, s[12:15], s37 offen sc1
  buffer_load_dwordx4 v[116:119], v0, s[12:15], s37 offen offset:1024 sc1
  s_add_u32 s37, s36, 22528
  s_add_u32 m0, s34, 6144
  s_nop 0
  buffer_load_dwordx4 v0, s[12:15], s37 offen sc1 lds
  buffer_load_dwordx4 v0, s[12:15], s37 offen offset:1024 sc1 lds
  s_add_u32 s37, s36, 423936
  buffer_load_dwordx4 v[120:123], v0, s[12:15], s37 offen sc1
  buffer_load_dwordx4 v[124:127], v0, s[12:15], s37 offen offset:1024 sc1
  s_add_u32 s37, s36, 825344
  buffer_load_dwordx4 v[128:131], v0, s[12:15], s37 offen sc1
  buffer_load_dwordx4 v[132:135], v0, s[12:15], s37 offen offset:1024 sc1
  s_add_u32 s37, s36, 1226752
  buffer_load_dwordx4 v[136:139], v0, s[12:15], s37 offen sc1
  buffer_load_dwordx4 v[140:143], v0, s[12:15], s37 offen offset:1024 sc1
  s_add_u32 s37, s36, 10240
  buffer_load_dwordx4 v[144:147], v0, s[12:15], s37 offen sc1
  buffer_load_dwordx4 v[148:151], v0, s[12:15], s37 offen offset:1024 sc1
  s_add_u32 s37, s36, 411648
  buffer_load_dwordx4 v[152:155], v0, s[12:15], s37 offen sc1
  buffer_load_dwordx4 v[156:159], v0, s[12:15], s37 offen offset:1024 sc1
  s_add_u32 s37, s36, 813056
  buffer_load_dwordx4 v[160:163], v0, s[12:15], s37 offen sc1
  buffer_load_dwordx4 v[164:167], v0, s[12:15], s37 offen offset:1024 sc1
  s_add_u32 s37, s36, 1214464
  buffer_load_dwordx4 v[168:171], v0, s[12:15], s37 offen sc1
  buffer_load_dwordx4 v[172:175], v0, s[12:15], s37 offen offset:1024 sc1
  s_add_u32 s37, s36, 24576
  buffer_load_dwordx4 v[176:179], v0, s[12:15], s37 offen sc1
  buffer_load_dwordx4 v[180:183], v0, s[12:15], s37 offen offset:1024 sc1
  s_add_u32 s37, s36, 425984
  s_add_u32 m0, s34, 8192
  s_nop 0
  buffer_load_dwordx4 v0, s[12:15], s37 offen sc1 lds
  buffer_load_dwordx4 v0, s[12:15], s37 offen offset:1024 sc1 lds
  s_add_u32 s37, s36, 827392
  buffer_load_dwordx4 v[184:187], v0, s[12:15], s37 offen sc1
  buffer_load_dwordx4 v[188:191], v0, s[12:15], s37 offen offset:1024 sc1
  s_add_u32 s37, s36, 1228800
  buffer_load_dwordx4 v[192:195], v0, s[12:15], s37 offen sc1
  buffer_load_dwordx4 v[196:199], v0, s[12:15], s37 offen offset:1024 sc1
  s_add_u32 s37, s36, 12288
  buffer_load_dwordx4 v[200:203], v0, s[12:15], s37 offen sc1
  buffer_load_dwordx4 v[204:207], v0, s[12:15], s37 offen offset:1024 sc1
  s_add_u32 s37, s36, 413696
  buffer_load_dwordx4 v[208:211], v0, s[12:15], s37 offen sc1
  buffer_load_dwordx4 v[212:215], v0, s[12:15], s37 offen offset:1024 sc1
  s_add_u32 s37, s36, 815104
  buffer_load_dwordx4 v[216:219], v0, s[12:15], s37 offen sc1
  buffer_load_dwordx4 v[220:223], v0, s[12:15], s37 offen offset:1024 sc1
  s_add_u32 s37, s36, 1216512
  buffer_load_dwordx4 v[224:227], v0, s[12:15], s37 offen sc1
  buffer_load_dwordx4 v[228:231], v0, s[12:15], s37 offen offset:1024 sc1
  s_add_u32 s37, s36, 26624
  buffer_load_dwordx4 v[232:235], v0, s[12:15], s37 offen sc1
  buffer_load_dwordx4 v[236:239], v0, s[12:15], s37 offen offset:1024 sc1
  s_add_u32 s37, s36, 428032
  buffer_load_dwordx4 v[240:243], v0, s[12:15], s37 offen sc1
  buffer_load_dwordx4 v[244:247], v0, s[12:15], s37 offen offset:1024 sc1
  s_add_u32 s37, s36, 829440
  s_add_u32 m0, s34, 10240
  s_nop 0
  buffer_load_dwordx4 v0, s[12:15], s37 offen sc1 lds
  buffer_load_dwordx4 v0, s[12:15], s37 offen offset:1024 sc1 lds
  s_add_u32 s37, s36, 1230848
  buffer_load_dwordx4 v[248:251], v0, s[12:15], s37 offen sc1
  buffer_load_dwordx4 v[252:255], v0, s[12:15], s37 offen offset:1024 sc1
  s_cmp_lg_u32 s17, 0
  s_cbranch_scc1 wi_89
  v_bfe_u32 v16, v0, 4, 4
  v_lshlrev_b32 v16, 7, v16
  s_mov_b32 s34, 46925824
  s_mov_b32 s23, 300000
fp_90:
  buffer_load_dword v17, v16, s[12:15], s34 offen sc1
  s_waitcnt vmcnt(0)
  v_cmp_gt_u32 vcc, 1, v17
  s_cbranch_vccz fpd_91
  s_sleep 1
  s_sub_u32 s23, s23, 1
  s_cbranch_scc0 fp_90
  s_branch L_exit
fpd_91:
wi_89:
  s_barrier
  v_mov_b32 v16, 0
  s_mov_b32 s34, 46137400
  s_mov_b32 s23, 300000
wp_92:
  buffer_load_dword v17, v16, s[12:15], s34 offen sc1
  s_waitcnt vmcnt(0)
  v_cmp_gt_u32 vcc, 1, v17
  s_cbranch_vccz wpd_93
  s_sleep 1
  s_sub_u32 s23, s23, 1
  s_cbranch_scc0 wp_92
  s_branch L_exit
wpd_93:
  s_cmp_lg_u32 s54, 0
  s_cbranch_scc1 L_Bslow
  s_mov_b32 s18, 0
  s_waitcnt vmcnt(0)
  s_add_u32 m0, s62, 0
  s_cmp_gt_u32 s17, 1
  s_cbranch_scc1 B_top_f
  s_barrier
.p2align 5
B_top_f:
  s_cmp_lt_u32 s17, 2
  s_cbranch_scc1 nq_94
  s_waitcnt lgkmcnt(0)
  s_barrier
  buffer_load_dword v106, v111, s[4:7], 0 offen sc1
  s_lshl_b32 s48, s18, 13
  s_add_u32 s48, s48, 131072
  s_add_u32 s49, s48, 8192
  s_add_u32 s50, s48, 24576
  s_and_b32 s34, s18, 3
  s_lshl_b32 s19, s34, 15
  s_add_u32 s22, s18, 1
  s_add_u32 s34, s18, 3
  s_and_b32 s34, s34, 3
  s_lshl_b32 s21, s34, 15
  s_mov_b32 s60, 0
  s_add_u32 s53, s19, 4096
  s_add_u32 s36, s22, 1
  v_mov_b32 v10, s36
  v_mov_b32 v48, 0
  v_mov_b32 v49, 0
  buffer_load_dword v107, v111, s[4:7], 0 offen sc1
  v_mov_b32 v50, 0
  v_mov_b32 v51, 0
  v_mov_b32 v52, 0
  v_mov_b32 v53, 0
  v_mov_b32 v54, 0
  v_mov_b32 v55, 0
  v_mov_b32 v56, 0
  v_mov_b32 v57, 0
  v_mov_b32 v58, 0
  v_mov_b32 v59, 0
  buffer_load_dword v108, v111, s[4:7], 0 offen sc1
  v_mov_b32 v60, 0
  v_mov_b32 v61, 0
  v_mov_b32 v62, 0
  v_mov_b32 v63, 0
  v_mov_b32 v64, 0
  v_mov_b32 v65, 0
  v_mov_b32 v66, 0
  v_mov_b32 v67, 0
  v_mov_b32 v68, 0
  v_mov_b32 v69, 0
  v_mov_b32 v70, 0
  v_mov_b32 v71, 0
  v_mov_b32 v72, 0
  v_mov_b32 v73, 0
  v_mov_b32 v74, 0
  v_mov_b32 v75, 0
  v_mov_b32 v76, 0
  v_mov_b32 v77, 0
  v_mov_b32 v78, 0
  v_mov_b32 v79, 0
  s_add_u32 m0, s62, 0
  s_add_u32 s39, s48, 4096
  buffer_load_dwordx4 v6, s[4:7], s48 offen offset:0 sc1 lds
  buffer_load_dwordx4 v6, s[4:7], s48 offen offset:2048 sc1 lds
  s_add_u32 m0, m0, 4096
  s_nop 0
  buffer_load_dwordx4 v6, s[4:7], s39 offen offset:0 sc1 lds
  buffer_load_dwordx4 v6, s[4:7], s39 offen offset:2048 sc1 lds
  s_waitcnt vmcnt(6)
  v_cmp_gt_u32 vcc, s22, v106
  s_cbranch_vccz Blb_96
  s_add_u32 s42, s42, 1
  buffer_load_dword v106, v111, s[4:7], 0 offen sc1
  s_waitcnt vmcnt(6)
  v_cmp_gt_u32 vcc, s22, v107
  s_cbranch_vccz ok_97
  buffer_load_dword v107, v111, s[4:7], 0 offen sc1
  s_waitcnt vmcnt(6)
  v_cmp_gt_u32 vcc, s22, v108
  s_cbranch_vccz ok_97
  buffer_load_dword v108, v111, s[4:7], 0 offen sc1
  s_mov_b32 s23, 200000
poll_98:
  s_waitcnt vmcnt(2)
  v_cmp_gt_u32 vcc, s22, v106
  buffer_load_dword v106, v111, s[4:7], 0 offen sc1
  s_cbranch_vccz polld_99
  s_waitcnt vmcnt(2)
  v_cmp_gt_u32 vcc, s22, v107
  buffer_load_dword v107, v111, s[4:7], 0 offen sc1
  s_cbranch_vccz polld_99
  s_waitcnt vmcnt(2)
  v_cmp_gt_u32 vcc, s22, v108
  buffer_load_dword v108, v111, s[4:7], 0 offen sc1
  s_sub_u32 s23, s23, 1
  s_cbranch_vccz polld_99
  s_cbranch_scc0 poll_98
  s_branch L_exit
polld_99:
ok_97:
  s_add_u32 m0, s62, 0
  s_add_u32 s39, s48, 4096
  buffer_load_dwordx4 v6, s[4:7], s48 offen offset:0 sc1 lds
  buffer_load_dwordx4 v6, s[4:7], s48 offen offset:2048 sc1 lds
  s_add_u32 m0, m0, 4096
  s_nop 0
  buffer_load_dwordx4 v6, s[4:7], s39 offen offset:0 sc1 lds
  buffer_load_dwordx4 v6, s[4:7], s39 offen offset:2048 sc1 lds
  s_branch Blb_96
nq_94:
  s_lshl_b32 s48, s18, 13
  s_add_u32 s48, s48, 131072
  s_add_u32 s49, s48, 8192
  s_add_u32 s50, s48, 24576
  s_and_b32 s34, s18, 3
  s_lshl_b32 s19, s34, 15
  s_add_u32 s22, s18, 1
  s_add_u32 s34, s18, 3
  s_and_b32 s34, s34, 3
  s_lshl_b32 s21, s34, 15
  s_mov_b32 s60, 0
  s_add_u32 s53, s19, 4096
  s_add_u32 s36, s22, 1
  v_mov_b32 v10, s36
  v_mov_b64 v[48:49], 0
  v_mov_b64 v[50:51], 0
  v_mov_b64 v[52:53], 0
  v_mov_b64 v[54:55], 0
  v_mov_b64 v[56:57], 0
  v_mov_b64 v[58:59], 0
  v_mov_b64 v[60:61], 0
  v_mov_b64 v[62:63], 0
  v_mov_b64 v[64:65], 0
  v_mov_b64 v[66:67], 0
  v_mov_b64 v[68:69], 0
  v_mov_b64 v[70:71], 0
  v_mov_b64 v[72:73], 0
  v_mov_b64 v[74:75], 0
  v_mov_b64 v[76:77], 0
  v_mov_b64 v[78:79], 0
Blb_96:
  s_barrier
  buffer_load_dwordx4 v[16:19], v9, s[12:15], 0 offen sc1
  buffer_load_dwordx4 v[20:23], v9, s[12:15], s64 offen sc1
  buffer_load_dwordx4 v[24:27], v9, s[12:15], s65 offen sc1
  s_waitcnt vmcnt(6)
  s_barrier
Bredo_102:
  ds_read_b128 v[80:83], v0 offset:0
  ds_read_b128 v[84:87], v0 offset:1024
  s_waitcnt lgkmcnt(1)
  v_smfmac_f32_16x16x64_bf16 v[48:51], v[80:83], a[0:7], v1
  buffer_load_dwordx4 v[28:31], v9, s[12:15], s66 offen sc1
  v_smfmac_f32_16x16x64_bf16 v[52:55], v[80:83], a[8:15], v1
  v_smfmac_f32_16x16x64_bf16 v[56:59], v[80:83], a[16:23], v1
  ds_read_b128 v[88:91], v2 offset:0
  v_smfmac_f32_16x16x64_bf16 v[60:63], v[80:83], a[24:31], v1
  ds_read_b128 v[92:95], v2 offset:1024
  v_smfmac_f32_16x16x64_bf16 v[64:67], v[80:83], a[32:39], v1
  buffer_load_dwordx4 v[32:35], v9, s[12:15], s67 offen sc1
  v_smfmac_f32_16x16x64_bf16 v[68:71], v[80:83], a[40:47], v1
  buffer_load_dwordx4 v[36:39], v9, s[12:15], s68 offen sc1
  v_smfmac_f32_16x16x64_bf16 v[72:75], v[80:83], a[48:55], v1
  buffer_load_dwordx4 v[40:43], v9, s[12:15], s69 offen sc1
  v_smfmac_f32_16x16x64_bf16 v[76:79], v[80:83], a[56:63], v1
  s_waitcnt lgkmcnt(2)
  v_smfmac_f32_16x16x64_bf16 v[48:51], v[84:87], a[64:71], v1
  buffer_load_dwordx4 v[44:47], v9, s[12:15], s70 offen sc1
  s_waitcnt lgkmcnt(0)
  v_smfmac_f32_16x16x64_bf16 v[52:55], v[84:87], v[88:95], v1
  v_smfmac_f32_16x16x64_bf16 v[56:59], v[84:87], a[72:79], v1
  s_waitcnt vmcnt(8)
  s_barrier
  v_smfmac_f32_16x16x64_bf16 v[60:63], v[84:87], a[80:87], v1
  ds_read_b128 v[80:83], v0 offset:2048
  v_smfmac_f32_16x16x64_bf16 v[64:67], v[84:87], a[88:95], v1
  ds_read_b128 v[88:91], v2 offset:2048
  v_smfmac_f32_16x16x64_bf16 v[68:71], v[84:87], a[96:103], v1
  ds_read_b128 v[92:95], v2 offset:3072
  v_smfmac_f32_16x16x64_bf16 v[72:75], v[84:87], a[104:111], v1
  v_smfmac_f32_16x16x64_bf16 v[76:79], v[84:87], a[112:119], v1
  s_waitcnt lgkmcnt(2)
  v_smfmac_f32_16x16x64_bf16 v[48:51], v[80:83], a[120:127], v1
  ds_read_b128 v[84:87], v0 offset:3072
  v_smfmac_f32_16x16x64_bf16 v[52:55], v[80:83], a[128:135], v1
  s_waitcnt lgkmcnt(1)
  v_smfmac_f32_16x16x64_bf16 v[56:59], v[80:83], v[88:95], v1
  v_smfmac_f32_16x16x64_bf16 v[60:63], v[80:83], a[136:143], v1
  v_smfmac_f32_16x16x64_bf16 v[64:67], v[80:83], a[144:151], v1
  ds_read_b128 v[88:91], v2 offset:4096
  v_smfmac_f32_16x16x64_bf16 v[68:71], v[80:83], a[152:159], v1
  ds_read_b128 v[92:95], v2 offset:5120
  v_smfmac_f32_16x16x64_bf16 v[72:75], v[80:83], a[160:167], v1
  v_mov_b64 v[96:97], -1
  v_smfmac_f32_16x16x64_bf16 v[76:79], v[80:83], a[168:175], v1
  ds_write2st64_b64 v11, v[96:97], v[96:97] offset0:0 offset1:5
  s_waitcnt lgkmcnt(3)
  v_smfmac_f32_16x16x64_bf16 v[48:51], v[84:87], a[176:183], v1
  ds_read_b128 v[80:83], v0 offset:4096
  v_smfmac_f32_16x16x64_bf16 v[52:55], v[84:87], a[184:191], v1
  v_smfmac_f32_16x16x64_bf16 v[56:59], v[84:87], a[192:199], v1
  s_waitcnt lgkmcnt(2)
  v_smfmac_f32_16x16x64_bf16 v[60:63], v[84:87], v[88:95], v1
  v_smfmac_f32_16x16x64_bf16 v[64:67], v[84:87], a[200:207], v1
  v_smfmac_f32_16x16x64_bf16 v[68:71], v[84:87], a[208:215], v1
  ds_read_b128 v[88:91], v2 offset:6144
  v_smfmac_f32_16x16x64_bf16 v[72:75], v[84:87], a[216:223], v1
  ds_read_b128 v[92:95], v2 offset:7168
  v_smfmac_f32_16x16x64_bf16 v[76:79], v[84:87], a[224:231], v1
  s_waitcnt lgkmcnt(2)
  v_smfmac_f32_16x16x64_bf16 v[48:51], v[80:83], a[232:239], v1
  ds_read_b128 v[84:87], v0 offset:5120
  v_smfmac_f32_16x16x64_bf16 v[52:55], v[80:83], a[240:247], v1
  v_smfmac_f32_16x16x64_bf16 v[56:59], v[80:83], a[248:255], v1
  v_smfmac_f32_16x16x64_bf16 v[60:63], v[80:83], v[112:119], v1
  s_waitcnt lgkmcnt(1)
  v_smfmac_f32_16x16x64_bf16 v[64:67], v[80:83], v[88:95], v1
  v_smfmac_f32_16x16x64_bf16 v[68:71], v[80:83], v[120:127], v1
  v_smfmac_f32_16x16x64_bf16 v[72:75], v[80:83], v[128:135], v1
  ds_read_b128 v[88:91], v2 offset:8192
  v_smfmac_f32_16x16x64_bf16 v[76:79], v[80:83], v[136:143], v1
  ds_read_b128 v[92:95], v2 offset:9216
  s_waitcnt lgkmcnt(2)
  v_smfmac_f32_16x16x64_bf16 v[48:51], v[84:87], v[144:151], v1
  ds_read_b128 v[80:83], v0 offset:6144
  v_smfmac_f32_16x16x64_bf16 v[52:55], v[84:87], v[152:159], v1
  v_smfmac_f32_16x16x64_bf16 v[56:59], v[84:87], v[160:167], v1
  v_smfmac_f32_16x16x64_bf16 v[60:63], v[84:87], v[168:175], v1
  v_smfmac_f32_16x16x64_bf16 v[64:67], v[84:87], v[176:183], v1
  s_waitcnt lgkmcnt(1)
  v_smfmac_f32_16x16x64_bf16 v[68:71], v[84:87], v[88:95], v1
  v_smfmac_f32_16x16x64_bf16 v[72:75], v[84:87], v[184:191], v1
  v_smfmac_f32_16x16x64_bf16 v[76:79], v[84:87], v[192:199], v1
  ds_read_b128 v[88:91], v2 offset:10240
  s_waitcnt lgkmcnt(1)
  v_smfmac_f32_16x16x64_bf16 v[48:51], v[80:83], v[200:207], v1
  ds_read_b128 v[92:95], v2 offset:11264
  v_smfmac_f32_16x16x64_bf16 v[52:55], v[80:83], v[208:215], v1
  v_smfmac_f32_16x16x64_bf16 v[56:59], v[80:83], v[216:223], v1
  v_smfmac_f32_16x16x64_bf16 v[60:63], v[80:83], v[224:231], v1
  v_maximum3_f32 v15, v48, v49, v50
  v_smfmac_f32_16x16x64_bf16 v[64:67], v[80:83], v[232:239], v1
  v_cmp_u_f32 vcc, v15, v51
  v_smfmac_f32_16x16x64_bf16 v[68:71], v[80:83], v[240:247], v1
  s_waitcnt lgkmcnt(0)
  v_smfmac_f32_16x16x64_bf16 v[72:75], v[80:83], v[88:95], v1
  v_smfmac_f32_16x16x64_bf16 v[76:79], v[80:83], v[248:255], v1
  s_cbranch_vccnz Bnan_100
Bnanb_101:
  s_cmp_eq_u32 s17, 3
  s_cbranch_scc1 pw_108
  v_pk_add_f32 v[48:49], v[48:49], v[50:51]
  v_cvt_pk_bf16_f32 v88, v48, v49
  v_pk_add_f32 v[52:53], v[52:53], v[54:55]
  v_cvt_pk_bf16_f32 v89, v52, v53
  v_pk_add_f32 v[56:57], v[56:57], v[58:59]
  v_cvt_pk_bf16_f32 v90, v56, v57
  v_pk_add_f32 v[60:61], v[60:61], v[62:63]
  v_cvt_pk_bf16_f32 v91, v60, v61
  v_pk_add_f32 v[64:65], v[64:65], v[66:67]
  v_cvt_pk_bf16_f32 v92, v64, v65
  v_pk_add_f32 v[68:69], v[68:69], v[70:71]
  v_cvt_pk_bf16_f32 v93, v68, v69
  v_pk_add_f32 v[72:73], v[72:73], v[74:75]
  v_cvt_pk_bf16_f32 v94, v72, v73
  v_pk_add_f32 v[76:77], v[76:77], v[78:79]
  v_cvt_pk_bf16_f32 v95, v76, v77
  v_mov_b64 v[80:81], 0
  v_mov_b64 v[82:83], 0
  v_mov_b64 v[84:85], 0
  v_mov_b64 v[86:87], 0
  s_branch np_107
.p2align 5
pw_108:
  buffer_load_dword v96, v4, s[4:7], 0 offen sc1
  v_add_f32 v48, v48, v50
  v_add_f32 v49, v49, v51
  v_cvt_pk_bf16_f32 v88, v48, v49
  v_mov_b32 v80, 0
  v_add_f32 v52, v52, v54
  buffer_load_dword v97, v4, s[4:7], 0 offen sc1
  v_add_f32 v53, v53, v55
  v_cvt_pk_bf16_f32 v89, v52, v53
  v_mov_b32 v81, 0
  v_add_f32 v56, v56, v58
  v_add_f32 v57, v57, v59
  buffer_load_dword v98, v4, s[4:7], 0 offen sc1
  v_cvt_pk_bf16_f32 v90, v56, v57
  v_mov_b32 v82, 0
  v_add_f32 v60, v60, v62
  v_add_f32 v61, v61, v63
  v_cvt_pk_bf16_f32 v91, v60, v61
  v_mov_b32 v83, 0
  buffer_load_dword v99, v4, s[4:7], 0 offen sc1
  v_add_f32 v64, v64, v66
  v_add_f32 v65, v65, v67
  v_cvt_pk_bf16_f32 v92, v64, v65
  v_mov_b32 v84, 0
  v_add_f32 v68, v68, v70
  buffer_load_dword v100, v4, s[4:7], 0 offen sc1
  v_add_f32 v69, v69, v71
  v_cvt_pk_bf16_f32 v93, v68, v69
  v_mov_b32 v85, 0
  v_add_f32 v72, v72, v74
  v_add_f32 v73, v73, v75
  buffer_load_dword v101, v4, s[4:7], 0 offen sc1
  v_cvt_pk_bf16_f32 v94, v72, v73
  v_mov_b32 v86, 0
  v_add_f32 v76, v76, v78
  v_add_f32 v77, v77, v79
  v_cvt_pk_bf16_f32 v95, v76, v77
  v_mov_b32 v87, 0
  buffer_load_dword v102, v4, s[4:7], 0 offen sc1
  s_mov_b32 s23, 200000
poll_109:
  s_waitcnt vmcnt(6)
  v_cmp_gt_u32 vcc, s22, v96
  buffer_load_dword v96, v4, s[4:7], 0 offen sc1
  s_cbranch_vccz polld_110
  s_waitcnt vmcnt(6)
  v_cmp_gt_u32 vcc, s22, v97
  buffer_load_dword v97, v4, s[4:7], 0 offen sc1
  s_cbranch_vccz polld_110
  s_waitcnt vmcnt(6)
  v_cmp_gt_u32 vcc, s22, v98
  buffer_load_dword v98, v4, s[4:7], 0 offen sc1
  s_cbranch_vccz polld_110
  s_waitcnt vmcnt(6)
  v_cmp_gt_u32 vcc, s22, v99
  buffer_load_dword v99, v4, s[4:7], 0 offen sc1
  s_cbranch_vccz polld_110
  s_waitcnt vmcnt(6)
  v_cmp_gt_u32 vcc, s22, v100
  buffer_load_dword v100, v4, s[4:7], 0 offen sc1
  s_cbranch_vccz polld_110
  s_waitcnt vmcnt(6)
  v_cmp_gt_u32 vcc, s22, v101
  buffer_load_dword v101, v4, s[4:7], 0 offen sc1
  s_cbranch_vccz polld_110
  s_waitcnt vmcnt(6)
  v_cmp_gt_u32 vcc, s22, v102
  buffer_load_dword v102, v4, s[4:7], 0 offen sc1
  s_cbranch_vccz polld_110
  s_waitcnt vmcnt(6)
  v_cmp_gt_u32 vcc, s22, v96
  buffer_load_dword v96, v4, s[4:7], 0 offen sc1
  s_cbranch_vccz polld_110
  s_waitcnt vmcnt(6)
  v_cmp_gt_u32 vcc, s22, v97
  buffer_load_dword v97, v4, s[4:7], 0 offen sc1
  s_cbranch_vccz polld_110
  s_waitcnt vmcnt(6)
  v_cmp_gt_u32 vcc, s22, v98
  buffer_load_dword v98, v4, s[4:7], 0 offen sc1
  s_cbranch_vccz polld_110
  s_waitcnt vmcnt(6)
  v_cmp_gt_u32 vcc, s22, v99
  buffer_load_dword v99, v4, s[4:7], 0 offen sc1
  s_cbranch_vccz polld_110
  s_waitcnt vmcnt(6)
  v_cmp_gt_u32 vcc, s22, v100
  buffer_load_dword v100, v4, s[4:7], 0 offen sc1
  s_cbranch_vccz polld_110
  s_waitcnt vmcnt(6)
  v_cmp_gt_u32 vcc, s22, v101
  buffer_load_dword v101, v4, s[4:7], 0 offen sc1
  s_cbranch_vccz polld_110
  s_waitcnt vmcnt(6)
  v_cmp_gt_u32 vcc, s22, v102
  buffer_load_dword v102, v4, s[4:7], 0 offen sc1
  s_cbranch_vccz polld_110
  s_waitcnt vmcnt(6)
  v_cmp_gt_u32 vcc, s22, v96
  buffer_load_dword v96, v4, s[4:7], 0 offen sc1
  s_cbranch_vccz polld_110
  s_waitcnt vmcnt(6)
  v_cmp_gt_u32 vcc, s22, v97
  buffer_load_dword v97, v4, s[4:7], 0 offen sc1
  s_cbranch_vccz polld_110
  s_waitcnt vmcnt(6)
  v_cmp_gt_u32 vcc, s22, v98
  buffer_load_dword v98, v4, s[4:7], 0 offen sc1
  s_cbranch_vccz polld_110
  s_waitcnt vmcnt(6)
  v_cmp_gt_u32 vcc, s22, v99
  buffer_load_dword v99, v4, s[4:7], 0 offen sc1
  s_cbranch_vccz polld_110
  s_waitcnt vmcnt(6)
  v_cmp_gt_u32 vcc, s22, v100
  buffer_load_dword v100, v4, s[4:7], 0 offen sc1
  s_cbranch_vccz polld_110
  s_waitcnt vmcnt(6)
  v_cmp_gt_u32 vcc, s22, v101
  buffer_load_dword v101, v4, s[4:7], 0 offen sc1
  s_cbranch_vccz polld_110
  s_waitcnt vmcnt(6)
  v_cmp_gt_u32 vcc, s22, v102
  buffer_load_dword v102, v4, s[4:7], 0 offen sc1
  s_cbranch_vccz polld_110
  s_waitcnt vmcnt(6)
  v_cmp_gt_u32 vcc, s22, v96
  buffer_load_dword v96, v4, s[4:7], 0 offen sc1
  s_cbranch_vccz polld_110
  s_waitcnt vmcnt(6)
  v_cmp_gt_u32 vcc, s22, v97
  buffer_load_dword v97, v4, s[4:7], 0 offen sc1
  s_cbranch_vccz polld_110
  s_waitcnt vmcnt(6)
  v_cmp_gt_u32 vcc, s22, v98
  buffer_load_dword v98, v4, s[4:7], 0 offen sc1
  s_cbranch_vccz polld_110
  s_waitcnt vmcnt(6)
  v_cmp_gt_u32 vcc, s22, v99
  buffer_load_dword v99, v4, s[4:7], 0 offen sc1
  s_cbranch_vccz polld_110
  s_waitcnt vmcnt(6)
  v_cmp_gt_u32 vcc, s22, v100
  buffer_load_dword v100, v4, s[4:7], 0 offen sc1
  s_cbranch_vccz polld_110
  s_waitcnt vmcnt(6)
  v_cmp_gt_u32 vcc, s22, v101
  buffer_load_dword v101, v4, s[4:7], 0 offen sc1
  s_cbranch_vccz polld_110
  s_waitcnt vmcnt(6)
  v_cmp_gt_u32 vcc, s22, v102
  buffer_load_dword v102, v4, s[4:7], 0 offen sc1
  s_sub_u32 s23, s23, 1
  s_cbranch_vccz polld_110
  s_cbranch_scc0 poll_109
  s_branch L_exit
.p2align 5
polld_110:
np_107:
  s_barrier
  buffer_load_dwordx4 v[96:99], v7, s[4:7], s19 offen sc1
  s_mov_b32 s23, 200000
  s_mov_b32 s60, 0
  s_add_u32 s49, s48, 8192
  buffer_load_dword v104, v8, s[4:7], s19 offen sc1
  buffer_load_dword v105, v8, s[4:7], s19 offen offset:256 sc1
  s_add_u32 s50, s48, 24576
  s_add_u32 s38, s22, 1
  v_mov_b32 v10, s38
  buffer_load_dwordx4 v[100:103], v7, s[4:7], s53 offen sc1
  s_mov_b32 s23, 200000
  s_cmp_gt_u32 s17, 1
  s_cbranch_scc1 Both_104
Crs_114:
  s_waitcnt vmcnt(3)
  v_smfmac_f32_16x16x64_bf16 v[80:83], v[96:99], v[16:23], v1
  v_smfmac_f32_16x16x64_bf16 v[84:87], v[96:99], v[32:39], v1
  s_waitcnt vmcnt(1)
  v_smfmac_f32_16x16x32_bf16 v[80:83], v[104:105], v[88:91], v1
  v_smfmac_f32_16x16x32_bf16 v[84:87], v[104:105], v[92:95], v1
  s_waitcnt vmcnt(0)
  v_smfmac_f32_16x16x64_bf16 v[80:83], v[100:103], v[24:31], v1
  v_smfmac_f32_16x16x64_bf16 v[84:87], v[100:103], v[40:47], v1
Ct_116:
  s_nop 3
  v_pk_add_f32 v[80:81], v[80:81], v[82:83]
  v_cmp_u_f32 vcc, v80, v81
  s_nop 1
  v_pk_add_f32 v[84:85], v[84:85], v[86:87]
  ds_write2st64_b64 v11, v[80:81], v[84:85] offset0:0 offset1:5
  s_cbranch_vccnz Cnan_112
Cnanb_113:
  s_barrier
  ds_read2_b32 v[68:69], v12 offset0:0 offset1:2
  ds_read2_b32 v[70:71], v12 offset0:136 offset1:138
  ds_read2_b32 v[72:73], v14 offset0:0 offset1:2
  ds_read2_b32 v[74:75], v14 offset0:136 offset1:138
  s_waitcnt lgkmcnt(2)
  v_pk_add_f32 v[68:69], v[68:69], v[70:71]
  s_waitcnt lgkmcnt(1)
  v_pk_add_f32 v[68:69], v[68:69], v[72:73]
  s_waitcnt lgkmcnt(0)
  v_pk_add_f32 v[68:69], v[68:69], v[74:75]
  v_cmp_u_f32 vcc, v68, v69
  v_cvt_pk_bf16_f32 v13, v68, v69
  s_nop 0
  v_cndmask_b32 v13, v13, -1, vcc
  buffer_store_dword v13, v3, s[4:7], s49 offen
  s_cbranch_vccnz Cslow_117
  s_cmp_eq_u32 s18, 62
  s_cbranch_scc1 Blast_103
  s_barrier
Ccj_118:
  v_mov_b32 v15, -1
  buffer_store_dword v15, v3, s[4:7], s50 offen
  s_branch Bjoin_105
.p2align 5
Both_104:
  s_cmp_eq_u32 s17, 3
  s_cbranch_scc1 Bo3_111
Crs_121:
  s_waitcnt vmcnt(3)
  v_smfmac_f32_16x16x64_bf16 v[80:83], v[96:99], v[16:23], v1
  v_smfmac_f32_16x16x64_bf16 v[84:87], v[96:99], v[32:39], v1
  s_waitcnt vmcnt(1)
  v_smfmac_f32_16x16x32_bf16 v[80:83], v[104:105], v[88:91], v1
  v_smfmac_f32_16x16x32_bf16 v[84:87], v[104:105], v[92:95], v1
  s_waitcnt vmcnt(0)
  v_smfmac_f32_16x16x64_bf16 v[80:83], v[100:103], v[24:31], v1
  v_smfmac_f32_16x16x64_bf16 v[84:87], v[100:103], v[40:47], v1
Ct_123:
  s_nop 3
  v_pk_add_f32 v[80:81], v[80:81], v[82:83]
  v_cmp_u_f32 vcc, v80, v81
  s_nop 1
  v_pk_add_f32 v[84:85], v[84:85], v[86:87]
  ds_write2st64_b64 v11, v[80:81], v[84:85] offset0:0 offset1:5
  s_cbranch_vccnz Cnan_119
Cnanb_120:
  s_barrier
  s_branch Bjoin_105
.p2align 5
Bo3_111:
Crs_126:
  s_waitcnt vmcnt(3)
  v_smfmac_f32_16x16x64_bf16 v[80:83], v[96:99], v[16:23], v1
  v_smfmac_f32_16x16x64_bf16 v[84:87], v[96:99], v[32:39], v1
  s_waitcnt vmcnt(1)
  v_smfmac_f32_16x16x32_bf16 v[80:83], v[104:105], v[88:91], v1
  v_smfmac_f32_16x16x32_bf16 v[84:87], v[104:105], v[92:95], v1
  s_waitcnt vmcnt(0)
  v_smfmac_f32_16x16x64_bf16 v[80:83], v[100:103], v[24:31], v1
  v_smfmac_f32_16x16x64_bf16 v[84:87], v[100:103], v[40:47], v1
Ct_128:
  buffer_store_dword v10, v5, s[4:7], 0 offen
  s_nop 2
  v_pk_add_f32 v[80:81], v[80:81], v[82:83]
  v_cmp_u_f32 vcc, v80, v81
  s_nop 1
  v_pk_add_f32 v[84:85], v[84:85], v[86:87]
  ds_write2st64_b64 v11, v[80:81], v[84:85] offset0:0 offset1:5
  s_cbranch_vccnz Cnan_124
Cnanb_125:
  s_barrier
Bjoin_105:
  v_add_u32 v9, 458752, v9
  s_add_u32 s18, s18, 1
  s_cmp_lt_u32 s18, 63
  s_cbranch_scc1 B_top_f
  s_branch L_fin
Blast_103:
  s_mov_b32 s62, 55042048
  buffer_store_dword v13, v3, s[12:15], s62 offen sc1
  s_branch L_fin
Bnan_100:
  s_mov_b32 s23, 200000
  s_add_u32 s34, s48, 4096
  s_waitcnt lgkmcnt(0)
  s_nop 7
l_129:
  buffer_load_dwordx4 v[48:51], v0, s[4:7], s48 offen offset:0 sc1
  buffer_load_dwordx4 v[52:55], v0, s[4:7], s48 offen offset:1024 sc1
  buffer_load_dwordx4 v[56:59], v0, s[4:7], s48 offen offset:2048 sc1
  buffer_load_dwordx4 v[60:63], v0, s[4:7], s48 offen offset:3072 sc1
  buffer_load_dwordx4 v[64:67], v0, s[4:7], s34 offen offset:0 sc1
  buffer_load_dwordx4 v[68:71], v0, s[4:7], s34 offen offset:1024 sc1
  buffer_load_dwordx4 v[72:75], v0, s[4:7], s34 offen offset:2048 sc1
  s_waitcnt vmcnt(0)
  v_max_u32 v15, v48, v49
  v_max3_u32 v15, v15, v50, v51
  v_max3_u32 v15, v15, v52, v53
  v_max3_u32 v15, v15, v54, v55
  v_max3_u32 v15, v15, v56, v57
  v_max3_u32 v15, v15, v58, v59
  v_max3_u32 v15, v15, v60, v61
  v_max3_u32 v15, v15, v62, v63
  v_max3_u32 v15, v15, v64, v65
  v_max3_u32 v15, v15, v66, v67
  v_max3_u32 v15, v15, v68, v69
  v_max3_u32 v15, v15, v70, v71
  v_max3_u32 v15, v15, v72, v73
  v_max3_u32 v15, v15, v74, v75
  v_cmp_eq_u32 vcc, -1, v15
  s_sub_u32 s23, s23, 1
  s_cbranch_scc1 L_exit
  s_cbranch_vccnz l_129
  ds_write_b128 v0, v[48:51] offset:0
  ds_write_b128 v0, v[52:55] offset:1024
  ds_write_b128 v0, v[56:59] offset:2048
  ds_write_b128 v0, v[60:63] offset:3072
  ds_write_b128 v0, v[64:67] offset:4096
  ds_write_b128 v0, v[68:71] offset:5120
  ds_write_b128 v0, v[72:75] offset:6144
  s_waitcnt lgkmcnt(0)
  v_mov_b64 v[48:49], 0
  v_mov_b64 v[50:51], 0
  v_mov_b64 v[52:53], 0
  v_mov_b64 v[54:55], 0
  v_mov_b64 v[56:57], 0
  v_mov_b64 v[58:59], 0
  v_mov_b64 v[60:61], 0
  v_mov_b64 v[62:63], 0
  v_mov_b64 v[64:65], 0
  v_mov_b64 v[66:67], 0
  v_mov_b64 v[68:69], 0
  v_mov_b64 v[70:71], 0
  v_mov_b64 v[72:73], 0
  v_mov_b64 v[74:75], 0
  v_mov_b64 v[76:77], 0
  v_mov_b64 v[78:79], 0
  ds_read_b128 v[80:83], v0 offset:0
  ds_read_b128 v[84:87], v0 offset:1024
  s_waitcnt lgkmcnt(1)
  v_smfmac_f32_16x16x64_bf16 v[48:51], v[80:83], a[0:7], v1
  v_smfmac_f32_16x16x64_bf16 v[52:55], v[80:83], a[8:15], v1
  v_smfmac_f32_16x16x64_bf16 v[56:59], v[80:83], a[16:23], v1
  ds_read_b128 v[88:91], v2 offset:0
  v_smfmac_f32_16x16x64_bf16 v[60:63], v[80:83], a[24:31], v1
  ds_read_b128 v[92:95], v2 offset:1024
  v_smfmac_f32_16x16x64_bf16 v[64:67], v[80:83], a[32:39], v1
  v_smfmac_f32_16x16x64_bf16 v[68:71], v[80:83], a[40:47], v1
  v_smfmac_f32_16x16x64_bf16 v[72:75], v[80:83], a[48:55], v1
  v_smfmac_f32_16x16x64_bf16 v[76:79], v[80:83], a[56:63], v1
  s_waitcnt lgkmcnt(2)
  v_smfmac_f32_16x16x64_bf16 v[48:51], v[84:87], a[64:71], v1
  s_waitcnt lgkmcnt(0)
  v_smfmac_f32_16x16x64_bf16 v[52:55], v[84:87], v[88:95], v1
  v_smfmac_f32_16x16x64_bf16 v[56:59], v[84:87], a[72:79], v1
  v_smfmac_f32_16x16x64_bf16 v[60:63], v[84:87], a[80:87], v1
  ds_read_b128 v[80:83], v0 offset:2048
  v_smfmac_f32_16x16x64_bf16 v[64:67], v[84:87], a[88:95], v1
  ds_read_b128 v[88:91], v2 offset:2048
  v_smfmac_f32_16x16x64_bf16 v[68:71], v[84:87], a[96:103], v1
  ds_read_b128 v[92:95], v2 offset:3072
  v_smfmac_f32_16x16x64_bf16 v[72:75], v[84:87], a[104:111], v1
  v_smfmac_f32_16x16x64_bf16 v[76:79], v[84:87], a[112:119], v1
  s_waitcnt lgkmcnt(2)
  v_smfmac_f32_16x16x64_bf16 v[48:51], v[80:83], a[120:127], v1
  ds_read_b128 v[84:87], v0 offset:3072
  v_smfmac_f32_16x16x64_bf16 v[52:55], v[80:83], a[128:135], v1
  s_waitcnt lgkmcnt(1)
  v_smfmac_f32_16x16x64_bf16 v[56:59], v[80:83], v[88:95], v1
  v_smfmac_f32_16x16x64_bf16 v[60:63], v[80:83], a[136:143], v1
  v_smfmac_f32_16x16x64_bf16 v[64:67], v[80:83], a[144:151], v1
  ds_read_b128 v[88:91], v2 offset:4096
  v_smfmac_f32_16x16x64_bf16 v[68:71], v[80:83], a[152:159], v1
  ds_read_b128 v[92:95], v2 offset:5120
  v_smfmac_f32_16x16x64_bf16 v[72:75], v[80:83], a[160:167], v1
  v_mov_b64 v[96:97], -1
  v_smfmac_f32_16x16x64_bf16 v[76:79], v[80:83], a[168:175], v1
  ds_write2st64_b64 v11, v[96:97], v[96:97] offset0:0 offset1:5
  s_waitcnt lgkmcnt(3)
  v_smfmac_f32_16x16x64_bf16 v[48:51], v[84:87], a[176:183], v1
  ds_read_b128 v[80:83], v0 offset:4096
  v_smfmac_f32_16x16x64_bf16 v[52:55], v[84:87], a[184:191], v1
  v_smfmac_f32_16x16x64_bf16 v[56:59], v[84:87], a[192:199], v1
  s_waitcnt lgkmcnt(2)
  v_smfmac_f32_16x16x64_bf16 v[60:63], v[84:87], v[88:95], v1
  v_smfmac_f32_16x16x64_bf16 v[64:67], v[84:87], a[200:207], v1
  v_smfmac_f32_16x16x64_bf16 v[68:71], v[84:87], a[208:215], v1
  ds_read_b128 v[88:91], v2 offset:6144
  v_smfmac_f32_16x16x64_bf16 v[72:75], v[84:87], a[216:223], v1
  ds_read_b128 v[92:95], v2 offset:7168
  v_smfmac_f32_16x16x64_bf16 v[76:79], v[84:87], a[224:231], v1
  s_waitcnt lgkmcnt(2)
  v_smfmac_f32_16x16x64_bf16 v[48:51], v[80:83], a[232:239], v1
  ds_read_b128 v[84:87], v0 offset:5120
  v_smfmac_f32_16x16x64_bf16 v[52:55], v[80:83], a[240:247], v1
  v_smfmac_f32_16x16x64_bf16 v[56:59], v[80:83], a[248:255], v1
  v_smfmac_f32_16x16x64_bf16 v[60:63], v[80:83], v[112:119], v1
  s_waitcnt lgkmcnt(1)
  v_smfmac_f32_16x16x64_bf16 v[64:67], v[80:83], v[88:95], v1
  v_smfmac_f32_16x16x64_bf16 v[68:71], v[80:83], v[120:127], v1
  v_smfmac_f32_16x16x64_bf16 v[72:75], v[80:83], v[128:135], v1
  ds_read_b128 v[88:91], v2 offset:8192
  v_smfmac_f32_16x16x64_bf16 v[76:79], v[80:83], v[136:143], v1
  ds_read_b128 v[92:95], v2 offset:9216
  s_waitcnt lgkmcnt(2)
  v_smfmac_f32_16x16x64_bf16 v[48:51], v[84:87], v[144:151], v1
  ds_read_b128 v[80:83], v0 offset:6144
  v_smfmac_f32_16x16x64_bf16 v[52:55], v[84:87], v[152:159], v1
  v_smfmac_f32_16x16x64_bf16 v[56:59], v[84:87], v[160:167], v1
  v_smfmac_f32_16x16x64_bf16 v[60:63], v[84:87], v[168:175], v1
  v_smfmac_f32_16x16x64_bf16 v[64:67], v[84:87], v[176:183], v1
  s_waitcnt lgkmcnt(1)
  v_smfmac_f32_16x16x64_bf16 v[68:71], v[84:87], v[88:95], v1
  v_smfmac_f32_16x16x64_bf16 v[72:75], v[84:87], v[184:191], v1
  v_smfmac_f32_16x16x64_bf16 v[76:79], v[84:87], v[192:199], v1
  ds_read_b128 v[88:91], v2 offset:10240
  s_waitcnt lgkmcnt(1)
  v_smfmac_f32_16x16x64_bf16 v[48:51], v[80:83], v[200:207], v1
  ds_read_b128 v[92:95], v2 offset:11264
  v_smfmac_f32_16x16x64_bf16 v[52:55], v[80:83], v[208:215], v1
  v_smfmac_f32_16x16x64_bf16 v[56:59], v[80:83], v[216:223], v1
  v_smfmac_f32_16x16x64_bf16 v[60:63], v[80:83], v[224:231], v1
  v_smfmac_f32_16x16x64_bf16 v[64:67], v[80:83], v[232:239], v1
  v_smfmac_f32_16x16x64_bf16 v[68:71], v[80:83], v[240:247], v1
  s_waitcnt lgkmcnt(0)
  v_smfmac_f32_16x16x64_bf16 v[72:75], v[80:83], v[88:95], v1
  v_smfmac_f32_16x16x64_bf16 v[76:79], v[80:83], v[248:255], v1
  s_branch Bnanb_101
Cnan_112:
  s_cmp_lg_u32 s60, 0
  s_cbranch_scc1 Cnanb_113
  s_mov_b32 s60, 1
  v_mov_b32 v106, s22
  buffer_store_dword v106, v5, s[4:7], 0 offen
  s_mov_b32 s23, 200000
l_130:
  buffer_load_dwordx4 v[96:99], v7, s[4:7], s19 offen sc1
  buffer_load_dword v104, v8, s[4:7], s19 offen sc1
  buffer_load_dword v105, v8, s[4:7], s19 offen offset:256 sc1
  buffer_load_dwordx4 v[100:103], v7, s[4:7], s53 offen sc1
  s_waitcnt vmcnt(0) lgkmcnt(0)
  v_mov_b64 v[80:81], 0
  v_mov_b64 v[82:83], 0
  v_mov_b64 v[84:85], 0
  v_mov_b64 v[86:87], 0
  v_max_u32 v15, v96, v97
  v_max3_u32 v15, v15, v98, v99
  v_max3_u32 v15, v15, v100, v101
  v_max3_u32 v15, v15, v102, v103
  v_max3_u32 v15, v15, v104, v105
  v_cmp_eq_u32 vcc, -1, v15
  s_cbranch_vccz g2_131
  s_sub_u32 s23, s23, 1
  s_cbranch_scc0 l_130
  s_branch L_exit
g2_131:
  v_smfmac_f32_16x16x64_bf16 v[80:83], v[96:99], v[16:23], v1
  v_smfmac_f32_16x16x64_bf16 v[84:87], v[96:99], v[32:39], v1
  v_smfmac_f32_16x16x32_bf16 v[80:83], v[104:105], v[88:91], v1
  v_smfmac_f32_16x16x32_bf16 v[84:87], v[104:105], v[92:95], v1
  v_smfmac_f32_16x16x64_bf16 v[80:83], v[100:103], v[24:31], v1
  v_smfmac_f32_16x16x64_bf16 v[84:87], v[100:103], v[40:47], v1
  buffer_store_dword v10, v5, s[4:7], 0 offen
  s_branch Ct_116
Cslow_117:
  s_barrier
  ds_read2_b32 v[68:69], v12 offset0:0 offset1:2
  ds_read2_b32 v[70:71], v12 offset0:136 offset1:138
  ds_read2_b32 v[72:73], v14 offset0:0 offset1:2
  ds_read2_b32 v[74:75], v14 offset0:136 offset1:138
  s_waitcnt lgkmcnt(2)
  v_pk_add_f32 v[68:69], v[68:69], v[70:71]
  s_waitcnt lgkmcnt(1)
  v_pk_add_f32 v[68:69], v[68:69], v[72:73]
  s_waitcnt lgkmcnt(0)
  v_pk_add_f32 v[68:69], v[68:69], v[74:75]
  v_cvt_pk_bf16_f32 v13, v68, v69
  v_min_u32 v13, -2, v13
  buffer_store_dword v13, v3, s[4:7], s49 offen
  s_cmp_eq_u32 s18, 62
  s_cbranch_scc1 Blast_103
  s_branch Ccj_118
Cnan_119:
  s_cmp_lg_u32 s60, 0
  s_cbranch_scc1 Cnanb_120
  s_mov_b32 s60, 1
  v_mov_b32 v106, s22
  buffer_store_dword v106, v5, s[4:7], 0 offen
  s_mov_b32 s23, 200000
l_132:
  buffer_load_dwordx4 v[96:99], v7, s[4:7], s19 offen sc1
  buffer_load_dword v104, v8, s[4:7], s19 offen sc1
  buffer_load_dword v105, v8, s[4:7], s19 offen offset:256 sc1
  buffer_load_dwordx4 v[100:103], v7, s[4:7], s53 offen sc1
  s_waitcnt vmcnt(0) lgkmcnt(0)
  v_mov_b64 v[80:81], 0
  v_mov_b64 v[82:83], 0
  v_mov_b64 v[84:85], 0
  v_mov_b64 v[86:87], 0
  v_max_u32 v15, v96, v97
  v_max3_u32 v15, v15, v98, v99
  v_max3_u32 v15, v15, v100, v101
  v_max3_u32 v15, v15, v102, v103
  v_max3_u32 v15, v15, v104, v105
  v_cmp_eq_u32 vcc, -1, v15
  s_cbranch_vccz g2_133
  s_sub_u32 s23, s23, 1
  s_cbranch_scc0 l_132
  s_branch L_exit
g2_133:
  v_smfmac_f32_16x16x64_bf16 v[80:83], v[96:99], v[16:23], v1
  v_smfmac_f32_16x16x64_bf16 v[84:87], v[96:99], v[32:39], v1
  v_smfmac_f32_16x16x32_bf16 v[80:83], v[104:105], v[88:91], v1
  v_smfmac_f32_16x16x32_bf16 v[84:87], v[104:105], v[92:95], v1
  v_smfmac_f32_16x16x64_bf16 v[80:83], v[100:103], v[24:31], v1
  v_smfmac_f32_16x16x64_bf16 v[84:87], v[100:103], v[40:47], v1
  buffer_store_dword v10, v5, s[4:7], 0 offen
  s_branch Ct_123
Cnan_124:
  s_cmp_lg_u32 s60, 0
  s_cbranch_scc1 Cnanb_125
  s_mov_b32 s60, 1
  v_mov_b32 v106, s22
  buffer_store_dword v106, v5, s[4:7], 0 offen
  s_mov_b32 s23, 200000
l_134:
  buffer_load_dwordx4 v[96:99], v7, s[4:7], s19 offen sc1
  buffer_load_dword v104, v8, s[4:7], s19 offen sc1
  buffer_load_dword v105, v8, s[4:7], s19 offen offset:256 sc1
  buffer_load_dwordx4 v[100:103], v7, s[4:7], s53 offen sc1
  s_waitcnt vmcnt(0) lgkmcnt(0)
  v_mov_b64 v[80:81], 0
  v_mov_b64 v[82:83], 0
  v_mov_b64 v[84:85], 0
  v_mov_b64 v[86:87], 0
  v_max_u32 v15, v96, v97
  v_max3_u32 v15, v15, v98, v99
  v_max3_u32 v15, v15, v100, v101
  v_max3_u32 v15, v15, v102, v103
  v_max3_u32 v15, v15, v104, v105
  v_cmp_eq_u32 vcc, -1, v15
  s_cbranch_vccz g2_135
  s_sub_u32 s23, s23, 1
  s_cbranch_scc0 l_134
  s_branch L_exit
g2_135:
  v_smfmac_f32_16x16x64_bf16 v[80:83], v[96:99], v[16:23], v1
  v_smfmac_f32_16x16x64_bf16 v[84:87], v[96:99], v[32:39], v1
  v_smfmac_f32_16x16x32_bf16 v[80:83], v[104:105], v[88:91], v1
  v_smfmac_f32_16x16x32_bf16 v[84:87], v[104:105], v[92:95], v1
  v_smfmac_f32_16x16x64_bf16 v[80:83], v[100:103], v[24:31], v1
  v_smfmac_f32_16x16x64_bf16 v[84:87], v[100:103], v[40:47], v1
  s_branch Ct_128
L_Bslow:
  s_mov_b32 s18, 0
  s_waitcnt vmcnt(0)
  s_add_u32 m0, s62, 0
  s_cmp_gt_u32 s17, 1
  s_cbranch_scc1 B_top_s
  s_barrier
.p2align 5
B_top_s:
  s_cmp_lt_u32 s17, 2
  s_cbranch_scc1 nq_136
  s_waitcnt lgkmcnt(0)
  s_barrier
  buffer_load_dword v106, v111, s[4:7], 0 offen sc1
  s_lshl_b32 s48, s18, 13
  s_add_u32 s48, s48, 131072
  s_add_u32 s49, s48, 8192
  s_add_u32 s50, s48, 24576
  s_and_b32 s34, s18, 3
  s_lshl_b32 s19, s34, 15
  s_add_u32 s22, s18, 1
  s_add_u32 s34, s18, 3
  s_and_b32 s34, s34, 3
  s_lshl_b32 s21, s34, 15
  s_mov_b32 s60, 0
  s_add_u32 s53, s19, 4096
  s_add_u32 s36, s22, 1
  v_mov_b32 v10, s36
  v_mov_b32 v48, 0
  v_mov_b32 v49, 0
  buffer_load_dword v107, v111, s[4:7], 0 offen sc1
  v_mov_b32 v50, 0
  v_mov_b32 v51, 0
  v_mov_b32 v52, 0
  v_mov_b32 v53, 0
  v_mov_b32 v54, 0
  v_mov_b32 v55, 0
  v_mov_b32 v56, 0
  v_mov_b32 v57, 0
  v_mov_b32 v58, 0
  v_mov_b32 v59, 0
  buffer_load_dword v108, v111, s[4:7], 0 offen sc1
  v_mov_b32 v60, 0
  v_mov_b32 v61, 0
  v_mov_b32 v62, 0
  v_mov_b32 v63, 0
  v_mov_b32 v64, 0
  v_mov_b32 v65, 0
  v_mov_b32 v66, 0
  v_mov_b32 v67, 0
  v_mov_b32 v68, 0
  v_mov_b32 v69, 0
  v_mov_b32 v70, 0
  v_mov_b32 v71, 0
  v_mov_b32 v72, 0
  v_mov_b32 v73, 0
  v_mov_b32 v74, 0
  v_mov_b32 v75, 0
  v_mov_b32 v76, 0
  v_mov_b32 v77, 0
  v_mov_b32 v78, 0
  v_mov_b32 v79, 0
  s_add_u32 m0, s62, 0
  s_add_u32 s39, s48, 4096
  buffer_load_dwordx4 v6, s[4:7], s48 offen offset:0 sc1 lds
  buffer_load_dwordx4 v6, s[4:7], s48 offen offset:2048 sc1 lds
  s_add_u32 m0, m0, 4096
  s_nop 0
  buffer_load_dwordx4 v6, s[4:7], s39 offen offset:0 sc1 lds
  buffer_load_dwordx4 v6, s[4:7], s39 offen offset:2048 sc1 lds
  s_waitcnt vmcnt(6)
  v_cmp_gt_u32 vcc, s22, v106
  s_cbranch_vccz Blb_138
  s_add_u32 s42, s42, 1
  buffer_load_dword v106, v111, s[4:7], 0 offen sc1
  s_waitcnt vmcnt(6)
  v_cmp_gt_u32 vcc, s22, v107
  s_cbranch_vccz ok_139
  buffer_load_dword v107, v111, s[4:7], 0 offen sc1
  s_waitcnt vmcnt(6)
  v_cmp_gt_u32 vcc, s22, v108
  s_cbranch_vccz ok_139
  buffer_load_dword v108, v111, s[4:7], 0 offen sc1
  s_mov_b32 s23, 200000
poll_140:
  s_waitcnt vmcnt(2)
  v_cmp_gt_u32 vcc, s22, v106
  buffer_load_dword v106, v111, s[4:7], 0 offen sc1
  s_cbranch_vccz polld_141
  s_waitcnt vmcnt(2)
  v_cmp_gt_u32 vcc, s22, v107
  buffer_load_dword v107, v111, s[4:7], 0 offen sc1
  s_cbranch_vccz polld_141
  s_waitcnt vmcnt(2)
  v_cmp_gt_u32 vcc, s22, v108
  buffer_load_dword v108, v111, s[4:7], 0 offen sc1
  s_sub_u32 s23, s23, 1
  s_cbranch_vccz polld_141
  s_cbranch_scc0 poll_140
  s_branch L_exit
polld_141:
ok_139:
  s_add_u32 m0, s62, 0
  s_add_u32 s39, s48, 4096
  buffer_load_dwordx4 v6, s[4:7], s48 offen offset:0 sc1 lds
  buffer_load_dwordx4 v6, s[4:7], s48 offen offset:2048 sc1 lds
  s_add_u32 m0, m0, 4096
  s_nop 0
  buffer_load_dwordx4 v6, s[4:7], s39 offen offset:0 sc1 lds
  buffer_load_dwordx4 v6, s[4:7], s39 offen offset:2048 sc1 lds
  s_branch Blb_138
nq_136:
  s_lshl_b32 s48, s18, 13
  s_add_u32 s48, s48, 131072
  s_add_u32 s49, s48, 8192
  s_add_u32 s50, s48, 24576
  s_and_b32 s34, s18, 3
  s_lshl_b32 s19, s34, 15
  s_add_u32 s22, s18, 1
  s_add_u32 s34, s18, 3
  s_and_b32 s34, s34, 3
  s_lshl_b32 s21, s34, 15
  s_mov_b32 s60, 0
  s_add_u32 s53, s19, 4096
  s_add_u32 s36, s22, 1
  v_mov_b32 v10, s36
  v_mov_b64 v[48:49], 0
  v_mov_b64 v[50:51], 0
  v_mov_b64 v[52:53], 0
  v_mov_b64 v[54:55], 0
  v_mov_b64 v[56:57], 0
  v_mov_b64 v[58:59], 0
  v_mov_b64 v[60:61], 0
  v_mov_b64 v[62:63], 0
  v_mov_b64 v[64:65], 0
  v_mov_b64 v[66:67], 0
  v_mov_b64 v[68:69], 0
  v_mov_b64 v[70:71], 0
  v_mov_b64 v[72:73], 0
  v_mov_b64 v[74:75], 0
  v_mov_b64 v[76:77], 0
  v_mov_b64 v[78:79], 0
Blb_138:
  s_barrier
  buffer_load_dwordx4 v[16:19], v9, s[12:15], 0 offen sc1
  buffer_load_dwordx4 v[20:23], v9, s[12:15], s64 offen sc1
  buffer_load_dwordx4 v[24:27], v9, s[12:15], s65 offen sc1
  s_waitcnt vmcnt(6)
  s_barrier
Bredo_144:
  ds_read_b128 v[80:83], v0 offset:0
  ds_read_b128 v[84:87], v0 offset:1024
  s_waitcnt lgkmcnt(1)
  v_smfmac_f32_16x16x64_bf16 v[48:51], v[80:83], a[0:7], v1
  buffer_load_dwordx4 v[28:31], v9, s[12:15], s66 offen sc1
  v_smfmac_f32_16x16x64_bf16 v[52:55], v[80:83], a[8:15], v1
  v_smfmac_f32_16x16x64_bf16 v[56:59], v[80:83], a[16:23], v1
  ds_read_b128 v[88:91], v2 offset:0
  v_smfmac_f32_16x16x64_bf16 v[60:63], v[80:83], a[24:31], v1
  ds_read_b128 v[92:95], v2 offset:1024
  v_smfmac_f32_16x16x64_bf16 v[64:67], v[80:83], a[32:39], v1
  buffer_load_dwordx4 v[32:35], v9, s[12:15], s67 offen sc1
  v_smfmac_f32_16x16x64_bf16 v[68:71], v[80:83], a[40:47], v1
  buffer_load_dwordx4 v[36:39], v9, s[12:15], s68 offen sc1
  v_smfmac_f32_16x16x64_bf16 v[72:75], v[80:83], a[48:55], v1
  buffer_load_dwordx4 v[40:43], v9, s[12:15], s69 offen sc1
  v_smfmac_f32_16x16x64_bf16 v[76:79], v[80:83], a[56:63], v1
  s_waitcnt lgkmcnt(2)
  v_smfmac_f32_16x16x64_bf16 v[48:51], v[84:87], a[64:71], v1
  buffer_load_dwordx4 v[44:47], v9, s[12:15], s70 offen sc1
  s_waitcnt lgkmcnt(0)
  v_smfmac_f32_16x16x64_bf16 v[52:55], v[84:87], v[88:95], v1
  v_smfmac_f32_16x16x64_bf16 v[56:59], v[84:87], a[72:79], v1
  s_waitcnt vmcnt(8)
  s_barrier
  v_smfmac_f32_16x16x64_bf16 v[60:63], v[84:87], a[80:87], v1
  ds_read_b128 v[80:83], v0 offset:2048
  v_smfmac_f32_16x16x64_bf16 v[64:67], v[84:87], a[88:95], v1
  ds_read_b128 v[88:91], v2 offset:2048
  v_smfmac_f32_16x16x64_bf16 v[68:71], v[84:87], a[96:103], v1
  ds_read_b128 v[92:95], v2 offset:3072
  v_smfmac_f32_16x16x64_bf16 v[72:75], v[84:87], a[104:111], v1
  v_smfmac_f32_16x16x64_bf16 v[76:79], v[84:87], a[112:119], v1
  s_waitcnt lgkmcnt(2)
  v_smfmac_f32_16x16x64_bf16 v[48:51], v[80:83], a[120:127], v1
  ds_read_b128 v[84:87], v0 offset:3072
  v_smfmac_f32_16x16x64_bf16 v[52:55], v[80:83], a[128:135], v1
  s_waitcnt lgkmcnt(1)
  v_smfmac_f32_16x16x64_bf16 v[56:59], v[80:83], v[88:95], v1
  v_smfmac_f32_16x16x64_bf16 v[60:63], v[80:83], a[136:143], v1
  v_smfmac_f32_16x16x64_bf16 v[64:67], v[80:83], a[144:151], v1
  ds_read_b128 v[88:91], v2 offset:4096
  v_smfmac_f32_16x16x64_bf16 v[68:71], v[80:83], a[152:159], v1
  ds_read_b128 v[92:95], v2 offset:5120
  v_smfmac_f32_16x16x64_bf16 v[72:75], v[80:83], a[160:167], v1
  v_mov_b64 v[96:97], -1
  v_smfmac_f32_16x16x64_bf16 v[76:79], v[80:83], a[168:175], v1
  ds_write2st64_b64 v11, v[96:97], v[96:97] offset0:0 offset1:5
  s_waitcnt lgkmcnt(3)
  v_smfmac_f32_16x16x64_bf16 v[48:51], v[84:87], a[176:183], v1
  ds_read_b128 v[80:83], v0 offset:4096
  v_smfmac_f32_16x16x64_bf16 v[52:55], v[84:87], a[184:191], v1
  v_smfmac_f32_16x16x64_bf16 v[56:59], v[84:87], a[192:199], v1
  s_waitcnt lgkmcnt(2)
  v_smfmac_f32_16x16x64_bf16 v[60:63], v[84:87], v[88:95], v1
  v_smfmac_f32_16x16x64_bf16 v[64:67], v[84:87], a[200:207], v1
  v_smfmac_f32_16x16x64_bf16 v[68:71], v[84:87], a[208:215], v1
  ds_read_b128 v[88:91], v2 offset:6144
  v_smfmac_f32_16x16x64_bf16 v[72:75], v[84:87], a[216:223], v1
  ds_read_b128 v[92:95], v2 offset:7168
  v_smfmac_f32_16x16x64_bf16 v[76:79], v[84:87], a[224:231], v1
  s_waitcnt lgkmcnt(2)
  v_smfmac_f32_16x16x64_bf16 v[48:51], v[80:83], a[232:239], v1
  ds_read_b128 v[84:87], v0 offset:5120
  v_smfmac_f32_16x16x64_bf16 v[52:55], v[80:83], a[240:247], v1
  v_smfmac_f32_16x16x64_bf16 v[56:59], v[80:83], a[248:255], v1
  v_smfmac_f32_16x16x64_bf16 v[60:63], v[80:83], v[112:119], v1
  s_waitcnt lgkmcnt(1)
  v_smfmac_f32_16x16x64_bf16 v[64:67], v[80:83], v[88:95], v1
  v_smfmac_f32_16x16x64_bf16 v[68:71], v[80:83], v[120:127], v1
  v_smfmac_f32_16x16x64_bf16 v[72:75], v[80:83], v[128:135], v1
  ds_read_b128 v[88:91], v2 offset:8192
  v_smfmac_f32_16x16x64_bf16 v[76:79], v[80:83], v[136:143], v1
  ds_read_b128 v[92:95], v2 offset:9216
  s_waitcnt lgkmcnt(2)
  v_smfmac_f32_16x16x64_bf16 v[48:51], v[84:87], v[144:151], v1
  ds_read_b128 v[80:83], v0 offset:6144
  v_smfmac_f32_16x16x64_bf16 v[52:55], v[84:87], v[152:159], v1
  v_smfmac_f32_16x16x64_bf16 v[56:59], v[84:87], v[160:167], v1
  v_smfmac_f32_16x16x64_bf16 v[60:63], v[84:87], v[168:175], v1
  v_smfmac_f32_16x16x64_bf16 v[64:67], v[84:87], v[176:183], v1
  s_waitcnt lgkmcnt(1)
  v_smfmac_f32_16x16x64_bf16 v[68:71], v[84:87], v[88:95], v1
  v_smfmac_f32_16x16x64_bf16 v[72:75], v[84:87], v[184:191], v1
  v_smfmac_f32_16x16x64_bf16 v[76:79], v[84:87], v[192:199], v1
  ds_read_b128 v[88:91], v2 offset:10240
  s_waitcnt lgkmcnt(1)
  v_smfmac_f32_16x16x64_bf16 v[48:51], v[80:83], v[200:207], v1
  ds_read_b128 v[92:95], v2 offset:11264
  v_smfmac_f32_16x16x64_bf16 v[52:55], v[80:83], v[208:215], v1
  v_smfmac_f32_16x16x64_bf16 v[56:59], v[80:83], v[216:223], v1
  v_smfmac_f32_16x16x64_bf16 v[60:63], v[80:83], v[224:231], v1
  v_maximum3_f32 v15, v48, v49, v50
  v_smfmac_f32_16x16x64_bf16 v[64:67], v[80:83], v[232:239], v1
  v_cmp_u_f32 vcc, v15, v51
  v_smfmac_f32_16x16x64_bf16 v[68:71], v[80:83], v[240:247], v1
  s_waitcnt lgkmcnt(0)
  v_smfmac_f32_16x16x64_bf16 v[72:75], v[80:83], v[88:95], v1
  v_smfmac_f32_16x16x64_bf16 v[76:79], v[80:83], v[248:255], v1
  s_cbranch_vccnz Bnan_142
Bnanb_143:
  s_cmp_eq_u32 s17, 3
  s_cbranch_scc1 pw_150
  v_pk_add_f32 v[48:49], v[48:49], v[50:51]
  v_cvt_pk_bf16_f32 v88, v48, v49
  v_pk_add_f32 v[52:53], v[52:53], v[54:55]
  v_cvt_pk_bf16_f32 v89, v52, v53
  v_pk_add_f32 v[56:57], v[56:57], v[58:59]
  v_cvt_pk_bf16_f32 v90, v56, v57
  v_pk_add_f32 v[60:61], v[60:61], v[62:63]
  v_cvt_pk_bf16_f32 v91, v60, v61
  v_pk_add_f32 v[64:65], v[64:65], v[66:67]
  v_cvt_pk_bf16_f32 v92, v64, v65
  v_pk_add_f32 v[68:69], v[68:69], v[70:71]
  v_cvt_pk_bf16_f32 v93, v68, v69
  v_pk_add_f32 v[72:73], v[72:73], v[74:75]
  v_cvt_pk_bf16_f32 v94, v72, v73
  v_pk_add_f32 v[76:77], v[76:77], v[78:79]
  v_cvt_pk_bf16_f32 v95, v76, v77
  v_mov_b64 v[80:81], 0
  v_mov_b64 v[82:83], 0
  v_mov_b64 v[84:85], 0
  v_mov_b64 v[86:87], 0
  s_branch np_149
.p2align 5
pw_150:
  buffer_load_dword v96, v4, s[4:7], 0 offen sc1
  v_add_f32 v48, v48, v50
  v_add_f32 v49, v49, v51
  v_cvt_pk_bf16_f32 v88, v48, v49
  v_mov_b32 v80, 0
  v_add_f32 v52, v52, v54
  buffer_load_dword v97, v4, s[4:7], 0 offen sc1
  v_add_f32 v53, v53, v55
  v_cvt_pk_bf16_f32 v89, v52, v53
  v_mov_b32 v81, 0
  v_add_f32 v56, v56, v58
  v_add_f32 v57, v57, v59
  buffer_load_dword v98, v4, s[4:7], 0 offen sc1
  v_cvt_pk_bf16_f32 v90, v56, v57
  v_mov_b32 v82, 0
  v_add_f32 v60, v60, v62
  v_add_f32 v61, v61, v63
  v_cvt_pk_bf16_f32 v91, v60, v61
  v_mov_b32 v83, 0
  buffer_load_dword v99, v4, s[4:7], 0 offen sc1
  v_add_f32 v64, v64, v66
  v_add_f32 v65, v65, v67
  v_cvt_pk_bf16_f32 v92, v64, v65
  v_mov_b32 v84, 0
  v_add_f32 v68, v68, v70
  buffer_load_dword v100, v4, s[4:7], 0 offen sc1
  v_add_f32 v69, v69, v71
  v_cvt_pk_bf16_f32 v93, v68, v69
  v_mov_b32 v85, 0
  v_add_f32 v72, v72, v74
  v_add_f32 v73, v73, v75
  buffer_load_dword v101, v4, s[4:7], 0 offen sc1
  v_cvt_pk_bf16_f32 v94, v72, v73
  v_mov_b32 v86, 0
  v_add_f32 v76, v76, v78
  v_add_f32 v77, v77, v79
  v_cvt_pk_bf16_f32 v95, v76, v77
  v_mov_b32 v87, 0
  buffer_load_dword v102, v4, s[4:7], 0 offen sc1
  s_mov_b32 s23, 200000
poll_151:
  s_waitcnt vmcnt(6)
  v_cmp_gt_u32 vcc, s22, v96
  buffer_load_dword v96, v4, s[4:7], 0 offen sc1
  s_cbranch_vccz polld_152
  s_waitcnt vmcnt(6)
  v_cmp_gt_u32 vcc, s22, v97
  buffer_load_dword v97, v4, s[4:7], 0 offen sc1
  s_cbranch_vccz polld_152
  s_waitcnt vmcnt(6)
  v_cmp_gt_u32 vcc, s22, v98
  buffer_load_dword v98, v4, s[4:7], 0 offen sc1
  s_cbranch_vccz polld_152
  s_waitcnt vmcnt(6)
  v_cmp_gt_u32 vcc, s22, v99
  buffer_load_dword v99, v4, s[4:7], 0 offen sc1
  s_cbranch_vccz polld_152
  s_waitcnt vmcnt(6)
  v_cmp_gt_u32 vcc, s22, v100
  buffer_load_dword v100, v4, s[4:7], 0 offen sc1
  s_cbranch_vccz polld_152
  s_waitcnt vmcnt(6)
  v_cmp_gt_u32 vcc, s22, v101
  buffer_load_dword v101, v4, s[4:7], 0 offen sc1
  s_cbranch_vccz polld_152
  s_waitcnt vmcnt(6)
  v_cmp_gt_u32 vcc, s22, v102
  buffer_load_dword v102, v4, s[4:7], 0 offen sc1
  s_cbranch_vccz polld_152
  s_waitcnt vmcnt(6)
  v_cmp_gt_u32 vcc, s22, v96
  buffer_load_dword v96, v4, s[4:7], 0 offen sc1
  s_cbranch_vccz polld_152
  s_waitcnt vmcnt(6)
  v_cmp_gt_u32 vcc, s22, v97
  buffer_load_dword v97, v4, s[4:7], 0 offen sc1
  s_cbranch_vccz polld_152
  s_waitcnt vmcnt(6)
  v_cmp_gt_u32 vcc, s22, v98
  buffer_load_dword v98, v4, s[4:7], 0 offen sc1
  s_cbranch_vccz polld_152
  s_waitcnt vmcnt(6)
  v_cmp_gt_u32 vcc, s22, v99
  buffer_load_dword v99, v4, s[4:7], 0 offen sc1
  s_cbranch_vccz polld_152
  s_waitcnt vmcnt(6)
  v_cmp_gt_u32 vcc, s22, v100
  buffer_load_dword v100, v4, s[4:7], 0 offen sc1
  s_cbranch_vccz polld_152
  s_waitcnt vmcnt(6)
  v_cmp_gt_u32 vcc, s22, v101
  buffer_load_dword v101, v4, s[4:7], 0 offen sc1
  s_cbranch_vccz polld_152
  s_waitcnt vmcnt(6)
  v_cmp_gt_u32 vcc, s22, v102
  buffer_load_dword v102, v4, s[4:7], 0 offen sc1
  s_cbranch_vccz polld_152
  s_waitcnt vmcnt(6)
  v_cmp_gt_u32 vcc, s22, v96
  buffer_load_dword v96, v4, s[4:7], 0 offen sc1
  s_cbranch_vccz polld_152
  s_waitcnt vmcnt(6)
  v_cmp_gt_u32 vcc, s22, v97
  buffer_load_dword v97, v4, s[4:7], 0 offen sc1
  s_cbranch_vccz polld_152
  s_waitcnt vmcnt(6)
  v_cmp_gt_u32 vcc, s22, v98
  buffer_load_dword v98, v4, s[4:7], 0 offen sc1
  s_cbranch_vccz polld_152
  s_waitcnt vmcnt(6)
  v_cmp_gt_u32 vcc, s22, v99
  buffer_load_dword v99, v4, s[4:7], 0 offen sc1
  s_cbranch_vccz polld_152
  s_waitcnt vmcnt(6)
  v_cmp_gt_u32 vcc, s22, v100
  buffer_load_dword v100, v4, s[4:7], 0 offen sc1
  s_cbranch_vccz polld_152
  s_waitcnt vmcnt(6)
  v_cmp_gt_u32 vcc, s22, v101
  buffer_load_dword v101, v4, s[4:7], 0 offen sc1
  s_cbranch_vccz polld_152
  s_waitcnt vmcnt(6)
  v_cmp_gt_u32 vcc, s22, v102
  buffer_load_dword v102, v4, s[4:7], 0 offen sc1
  s_cbranch_vccz polld_152
  s_waitcnt vmcnt(6)
  v_cmp_gt_u32 vcc, s22, v96
  buffer_load_dword v96, v4, s[4:7], 0 offen sc1
  s_cbranch_vccz polld_152
  s_waitcnt vmcnt(6)
  v_cmp_gt_u32 vcc, s22, v97
  buffer_load_dword v97, v4, s[4:7], 0 offen sc1
  s_cbranch_vccz polld_152
  s_waitcnt vmcnt(6)
  v_cmp_gt_u32 vcc, s22, v98
  buffer_load_dword v98, v4, s[4:7], 0 offen sc1
  s_cbranch_vccz polld_152
  s_waitcnt vmcnt(6)
  v_cmp_gt_u32 vcc, s22, v99
  buffer_load_dword v99, v4, s[4:7], 0 offen sc1
  s_cbranch_vccz polld_152
  s_waitcnt vmcnt(6)
  v_cmp_gt_u32 vcc, s22, v100
  buffer_load_dword v100, v4, s[4:7], 0 offen sc1
  s_cbranch_vccz polld_152
  s_waitcnt vmcnt(6)
  v_cmp_gt_u32 vcc, s22, v101
  buffer_load_dword v101, v4, s[4:7], 0 offen sc1
  s_cbranch_vccz polld_152
  s_waitcnt vmcnt(6)
  v_cmp_gt_u32 vcc, s22, v102
  buffer_load_dword v102, v4, s[4:7], 0 offen sc1
  s_sub_u32 s23, s23, 1
  s_cbranch_vccz polld_152
  s_cbranch_scc0 poll_151
  s_branch L_exit
.p2align 5
polld_152:
np_149:
  s_barrier
  buffer_load_dwordx4 v[96:99], v7, s[4:7], s19 offen sc1
  s_mov_b32 s23, 200000
  s_mov_b32 s60, 0
  s_add_u32 s49, s48, 8192
  buffer_load_dword v104, v8, s[4:7], s19 offen sc1
  buffer_load_dword v105, v8, s[4:7], s19 offen offset:256 sc1
  s_add_u32 s50, s48, 24576
  s_add_u32 s38, s22, 1
  v_mov_b32 v10, s38
  buffer_load_dwordx4 v[100:103], v7, s[4:7], s53 offen sc1
  s_mov_b32 s23, 200000
  s_cmp_gt_u32 s17, 1
  s_cbranch_scc1 Both_146
Crs_156:
  s_waitcnt vmcnt(3)
  v_smfmac_f32_16x16x64_bf16 v[80:83], v[96:99], v[16:23], v1
  v_smfmac_f32_16x16x64_bf16 v[84:87], v[96:99], v[32:39], v1
  s_waitcnt vmcnt(1)
  v_smfmac_f32_16x16x32_bf16 v[80:83], v[104:105], v[88:91], v1
  v_smfmac_f32_16x16x32_bf16 v[84:87], v[104:105], v[92:95], v1
  s_waitcnt vmcnt(0)
  v_smfmac_f32_16x16x64_bf16 v[80:83], v[100:103], v[24:31], v1
  v_smfmac_f32_16x16x64_bf16 v[84:87], v[100:103], v[40:47], v1
Ct_158:
  s_nop 3
  v_pk_add_f32 v[80:81], v[80:81], v[82:83]
  v_cmp_u_f32 vcc, v80, v81
  s_nop 1
  v_pk_add_f32 v[84:85], v[84:85], v[86:87]
  ds_write2st64_b64 v11, v[80:81], v[84:85] offset0:0 offset1:5
  s_cbranch_vccnz Cnan_154
Cnanb_155:
  s_barrier
  ds_read2_b32 v[68:69], v12 offset0:0 offset1:2
  ds_read2_b32 v[70:71], v12 offset0:136 offset1:138
  ds_read2_b32 v[72:73], v14 offset0:0 offset1:2
  ds_read2_b32 v[74:75], v14 offset0:136 offset1:138
  s_waitcnt lgkmcnt(2)
  v_pk_add_f32 v[68:69], v[68:69], v[70:71]
  s_waitcnt lgkmcnt(1)
  v_pk_add_f32 v[68:69], v[68:69], v[72:73]
  s_waitcnt lgkmcnt(0)
  v_pk_add_f32 v[68:69], v[68:69], v[74:75]
  v_cmp_u_f32 vcc, v68, v69
  v_cvt_pk_bf16_f32 v13, v68, v69
  s_nop 0
  v_cndmask_b32 v13, v13, -1, vcc
  buffer_store_dword v13, v3, s[4:7], s49 offen sc1
  s_cbranch_vccnz Cslow_159
  s_cmp_eq_u32 s18, 62
  s_cbranch_scc1 Blast_145
  s_barrier
Ccj_160:
  v_mov_b32 v15, -1
  buffer_store_dword v15, v3, s[4:7], s50 offen sc1
  s_branch Bjoin_147
.p2align 5
Both_146:
  s_cmp_eq_u32 s17, 3
  s_cbranch_scc1 Bo3_153
Crs_163:
  s_waitcnt vmcnt(3)
  v_smfmac_f32_16x16x64_bf16 v[80:83], v[96:99], v[16:23], v1
  v_smfmac_f32_16x16x64_bf16 v[84:87], v[96:99], v[32:39], v1
  s_waitcnt vmcnt(1)
  v_smfmac_f32_16x16x32_bf16 v[80:83], v[104:105], v[88:91], v1
  v_smfmac_f32_16x16x32_bf16 v[84:87], v[104:105], v[92:95], v1
  s_waitcnt vmcnt(0)
  v_smfmac_f32_16x16x64_bf16 v[80:83], v[100:103], v[24:31], v1
  v_smfmac_f32_16x16x64_bf16 v[84:87], v[100:103], v[40:47], v1
Ct_165:
  s_nop 3
  v_pk_add_f32 v[80:81], v[80:81], v[82:83]
  v_cmp_u_f32 vcc, v80, v81
  s_nop 1
  v_pk_add_f32 v[84:85], v[84:85], v[86:87]
  ds_write2st64_b64 v11, v[80:81], v[84:85] offset0:0 offset1:5
  s_cbranch_vccnz Cnan_161
Cnanb_162:
  s_barrier
  s_branch Bjoin_147
.p2align 5
Bo3_153:
Crs_168:
  s_waitcnt vmcnt(3)
  v_smfmac_f32_16x16x64_bf16 v[80:83], v[96:99], v[16:23], v1
  v_smfmac_f32_16x16x64_bf16 v[84:87], v[96:99], v[32:39], v1
  s_waitcnt vmcnt(1)
  v_smfmac_f32_16x16x32_bf16 v[80:83], v[104:105], v[88:91], v1
  v_smfmac_f32_16x16x32_bf16 v[84:87], v[104:105], v[92:95], v1
  s_waitcnt vmcnt(0)
  v_smfmac_f32_16x16x64_bf16 v[80:83], v[100:103], v[24:31], v1
  v_smfmac_f32_16x16x64_bf16 v[84:87], v[100:103], v[40:47], v1
Ct_170:
  buffer_store_dword v10, v5, s[4:7], 0 offen sc1
  s_nop 2
  v_pk_add_f32 v[80:81], v[80:81], v[82:83]
  v_cmp_u_f32 vcc, v80, v81
  s_nop 1
  v_pk_add_f32 v[84:85], v[84:85], v[86:87]
  ds_write2st64_b64 v11, v[80:81], v[84:85] offset0:0 offset1:5
  s_cbranch_vccnz Cnan_166
Cnanb_167:
  s_barrier
Bjoin_147:
  v_add_u32 v9, 458752, v9
  s_add_u32 s18, s18, 1
  s_cmp_lt_u32 s18, 63
  s_cbranch_scc1 B_top_s
  s_branch L_fin
Blast_145:
  s_mov_b32 s62, 55042048
  buffer_store_dword v13, v3, s[12:15], s62 offen sc1
  s_branch L_fin
Bnan_142:
  s_mov_b32 s23, 200000
  s_add_u32 s34, s48, 4096
  s_waitcnt lgkmcnt(0)
  s_nop 7
l_171:
  buffer_load_dwordx4 v[48:51], v0, s[4:7], s48 offen offset:0 sc1
  buffer_load_dwordx4 v[52:55], v0, s[4:7], s48 offen offset:1024 sc1
  buffer_load_dwordx4 v[56:59], v0, s[4:7], s48 offen offset:2048 sc1
  buffer_load_dwordx4 v[60:63], v0, s[4:7], s48 offen offset:3072 sc1
  buffer_load_dwordx4 v[64:67], v0, s[4:7], s34 offen offset:0 sc1
  buffer_load_dwordx4 v[68:71], v0, s[4:7], s34 offen offset:1024 sc1
  buffer_load_dwordx4 v[72:75], v0, s[4:7], s34 offen offset:2048 sc1
  s_waitcnt vmcnt(0)
  v_max_u32 v15, v48, v49
  v_max3_u32 v15, v15, v50, v51
  v_max3_u32 v15, v15, v52, v53
  v_max3_u32 v15, v15, v54, v55
  v_max3_u32 v15, v15, v56, v57
  v_max3_u32 v15, v15, v58, v59
  v_max3_u32 v15, v15, v60, v61
  v_max3_u32 v15, v15, v62, v63
  v_max3_u32 v15, v15, v64, v65
  v_max3_u32 v15, v15, v66, v67
  v_max3_u32 v15, v15, v68, v69
  v_max3_u32 v15, v15, v70, v71
  v_max3_u32 v15, v15, v72, v73
  v_max3_u32 v15, v15, v74, v75
  v_cmp_eq_u32 vcc, -1, v15
  s_sub_u32 s23, s23, 1
  s_cbranch_scc1 L_exit
  s_cbranch_vccnz l_171
  ds_write_b128 v0, v[48:51] offset:0
  ds_write_b128 v0, v[52:55] offset:1024
  ds_write_b128 v0, v[56:59] offset:2048
  ds_write_b128 v0, v[60:63] offset:3072
  ds_write_b128 v0, v[64:67] offset:4096
  ds_write_b128 v0, v[68:71] offset:5120
  ds_write_b128 v0, v[72:75] offset:6144
  s_waitcnt lgkmcnt(0)
  v_mov_b64 v[48:49], 0
  v_mov_b64 v[50:51], 0
  v_mov_b64 v[52:53], 0
  v_mov_b64 v[54:55], 0
  v_mov_b64 v[56:57], 0
  v_mov_b64 v[58:59], 0
  v_mov_b64 v[60:61], 0
  v_mov_b64 v[62:63], 0
  v_mov_b64 v[64:65], 0
  v_mov_b64 v[66:67], 0
  v_mov_b64 v[68:69], 0
  v_mov_b64 v[70:71], 0
  v_mov_b64 v[72:73], 0
  v_mov_b64 v[74:75], 0
  v_mov_b64 v[76:77], 0
  v_mov_b64 v[78:79], 0
  ds_read_b128 v[80:83], v0 offset:0
  ds_read_b128 v[84:87], v0 offset:1024
  s_waitcnt lgkmcnt(1)
  v_smfmac_f32_16x16x64_bf16 v[48:51], v[80:83], a[0:7], v1
  v_smfmac_f32_16x16x64_bf16 v[52:55], v[80:83], a[8:15], v1
  v_smfmac_f32_16x16x64_bf16 v[56:59], v[80:83], a[16:23], v1
  ds_read_b128 v[88:91], v2 offset:0
  v_smfmac_f32_16x16x64_bf16 v[60:63], v[80:83], a[24:31], v1
  ds_read_b128 v[92:95], v2 offset:1024
  v_smfmac_f32_16x16x64_bf16 v[64:67], v[80:83], a[32:39], v1
  v_smfmac_f32_16x16x64_bf16 v[68:71], v[80:83], a[40:47], v1
  v_smfmac_f32_16x16x64_bf16 v[72:75], v[80:83], a[48:55], v1
  v_smfmac_f32_16x16x64_bf16 v[76:79], v[80:83], a[56:63], v1
  s_waitcnt lgkmcnt(2)
  v_smfmac_f32_16x16x64_bf16 v[48:51], v[84:87], a[64:71], v1
  s_waitcnt lgkmcnt(0)
  v_smfmac_f32_16x16x64_bf16 v[52:55], v[84:87], v[88:95], v1
  v_smfmac_f32_16x16x64_bf16 v[56:59], v[84:87], a[72:79], v1
  v_smfmac_f32_16x16x64_bf16 v[60:63], v[84:87], a[80:87], v1
  ds_read_b128 v[80:83], v0 offset:2048
  v_smfmac_f32_16x16x64_bf16 v[64:67], v[84:87], a[88:95], v1
  ds_read_b128 v[88:91], v2 offset:2048
  v_smfmac_f32_16x16x64_bf16 v[68:71], v[84:87], a[96:103], v1
  ds_read_b128 v[92:95], v2 offset:3072
  v_smfmac_f32_16x16x64_bf16 v[72:75], v[84:87], a[104:111], v1
  v_smfmac_f32_16x16x64_bf16 v[76:79], v[84:87], a[112:119], v1
  s_waitcnt lgkmcnt(2)
  v_smfmac_f32_16x16x64_bf16 v[48:51], v[80:83], a[120:127], v1
  ds_read_b128 v[84:87], v0 offset:3072
  v_smfmac_f32_16x16x64_bf16 v[52:55], v[80:83], a[128:135], v1
  s_waitcnt lgkmcnt(1)
  v_smfmac_f32_16x16x64_bf16 v[56:59], v[80:83], v[88:95], v1
  v_smfmac_f32_16x16x64_bf16 v[60:63], v[80:83], a[136:143], v1
  v_smfmac_f32_16x16x64_bf16 v[64:67], v[80:83], a[144:151], v1
  ds_read_b128 v[88:91], v2 offset:4096
  v_smfmac_f32_16x16x64_bf16 v[68:71], v[80:83], a[152:159], v1
  ds_read_b128 v[92:95], v2 offset:5120
  v_smfmac_f32_16x16x64_bf16 v[72:75], v[80:83], a[160:167], v1
  v_mov_b64 v[96:97], -1
  v_smfmac_f32_16x16x64_bf16 v[76:79], v[80:83], a[168:175], v1
  ds_write2st64_b64 v11, v[96:97], v[96:97] offset0:0 offset1:5
  s_waitcnt lgkmcnt(3)
  v_smfmac_f32_16x16x64_bf16 v[48:51], v[84:87], a[176:183], v1
  ds_read_b128 v[80:83], v0 offset:4096
  v_smfmac_f32_16x16x64_bf16 v[52:55], v[84:87], a[184:191], v1
  v_smfmac_f32_16x16x64_bf16 v[56:59], v[84:87], a[192:199], v1
  s_waitcnt lgkmcnt(2)
  v_smfmac_f32_16x16x64_bf16 v[60:63], v[84:87], v[88:95], v1
  v_smfmac_f32_16x16x64_bf16 v[64:67], v[84:87], a[200:207], v1
  v_smfmac_f32_16x16x64_bf16 v[68:71], v[84:87], a[208:215], v1
  ds_read_b128 v[88:91], v2 offset:6144
  v_smfmac_f32_16x16x64_bf16 v[72:75], v[84:87], a[216:223], v1
  ds_read_b128 v[92:95], v2 offset:7168
  v_smfmac_f32_16x16x64_bf16 v[76:79], v[84:87], a[224:231], v1
  s_waitcnt lgkmcnt(2)
  v_smfmac_f32_16x16x64_bf16 v[48:51], v[80:83], a[232:239], v1
  ds_read_b128 v[84:87], v0 offset:5120
  v_smfmac_f32_16x16x64_bf16 v[52:55], v[80:83], a[240:247], v1
  v_smfmac_f32_16x16x64_bf16 v[56:59], v[80:83], a[248:255], v1
  v_smfmac_f32_16x16x64_bf16 v[60:63], v[80:83], v[112:119], v1
  s_waitcnt lgkmcnt(1)
  v_smfmac_f32_16x16x64_bf16 v[64:67], v[80:83], v[88:95], v1
  v_smfmac_f32_16x16x64_bf16 v[68:71], v[80:83], v[120:127], v1
  v_smfmac_f32_16x16x64_bf16 v[72:75], v[80:83], v[128:135], v1
  ds_read_b128 v[88:91], v2 offset:8192
  v_smfmac_f32_16x16x64_bf16 v[76:79], v[80:83], v[136:143], v1
  ds_read_b128 v[92:95], v2 offset:9216
  s_waitcnt lgkmcnt(2)
  v_smfmac_f32_16x16x64_bf16 v[48:51], v[84:87], v[144:151], v1
  ds_read_b128 v[80:83], v0 offset:6144
  v_smfmac_f32_16x16x64_bf16 v[52:55], v[84:87], v[152:159], v1
  v_smfmac_f32_16x16x64_bf16 v[56:59], v[84:87], v[160:167], v1
  v_smfmac_f32_16x16x64_bf16 v[60:63], v[84:87], v[168:175], v1
  v_smfmac_f32_16x16x64_bf16 v[64:67], v[84:87], v[176:183], v1
  s_waitcnt lgkmcnt(1)
  v_smfmac_f32_16x16x64_bf16 v[68:71], v[84:87], v[88:95], v1
  v_smfmac_f32_16x16x64_bf16 v[72:75], v[84:87], v[184:191], v1
  v_smfmac_f32_16x16x64_bf16 v[76:79], v[84:87], v[192:199], v1
  ds_read_b128 v[88:91], v2 offset:10240
  s_waitcnt lgkmcnt(1)
  v_smfmac_f32_16x16x64_bf16 v[48:51], v[80:83], v[200:207], v1
  ds_read_b128 v[92:95], v2 offset:11264
  v_smfmac_f32_16x16x64_bf16 v[52:55], v[80:83], v[208:215], v1
  v_smfmac_f32_16x16x64_bf16 v[56:59], v[80:83], v[216:223], v1
  v_smfmac_f32_16x16x64_bf16 v[60:63], v[80:83], v[224:231], v1
  v_smfmac_f32_16x16x64_bf16 v[64:67], v[80:83], v[232:239], v1
  v_smfmac_f32_16x16x64_bf16 v[68:71], v[80:83], v[240:247], v1
  s_waitcnt lgkmcnt(0)
  v_smfmac_f32_16x16x64_bf16 v[72:75], v[80:83], v[88:95], v1
  v_smfmac_f32_16x16x64_bf16 v[76:79], v[80:83], v[248:255], v1
  s_branch Bnanb_143
Cnan_154:
  s_cmp_lg_u32 s60, 0
  s_cbranch_scc1 Cnanb_155
  s_mov_b32 s60, 1
  v_mov_b32 v106, s22
  buffer_store_dword v106, v5, s[4:7], 0 offen sc1
  s_mov_b32 s23, 200000
l_172:
  buffer_load_dwordx4 v[96:99], v7, s[4:7], s19 offen sc1
  buffer_load_dword v104, v8, s[4:7], s19 offen sc1
  buffer_load_dword v105, v8, s[4:7], s19 offen offset:256 sc1
  buffer_load_dwordx4 v[100:103], v7, s[4:7], s53 offen sc1
  s_waitcnt vmcnt(0) lgkmcnt(0)
  v_mov_b64 v[80:81], 0
  v_mov_b64 v[82:83], 0
  v_mov_b64 v[84:85], 0
  v_mov_b64 v[86:87], 0
  v_max_u32 v15, v96, v97
  v_max3_u32 v15, v15, v98, v99
  v_max3_u32 v15, v15, v100, v101
  v_max3_u32 v15, v15, v102, v103
  v_max3_u32 v15, v15, v104, v105
  v_cmp_eq_u32 vcc, -1, v15
  s_cbranch_vccz g2_173
  s_sub_u32 s23, s23, 1
  s_cbranch_scc0 l_172
  s_branch L_exit
g2_173:
  v_smfmac_f32_16x16x64_bf16 v[80:83], v[96:99], v[16:23], v1
  v_smfmac_f32_16x16x64_bf16 v[84:87], v[96:99], v[32:39], v1
  v_smfmac_f32_16x16x32_bf16 v[80:83], v[104:105], v[88:91], v1
  v_smfmac_f32_16x16x32_bf16 v[84:87], v[104:105], v[92:95], v1
  v_smfmac_f32_16x16x64_bf16 v[80:83], v[100:103], v[24:31], v1
  v_smfmac_f32_16x16x64_bf16 v[84:87], v[100:103], v[40:47], v1
  buffer_store_dword v10, v5, s[4:7], 0 offen sc1
  s_branch Ct_158
Cslow_159:
  s_barrier
  ds_read2_b32 v[68:69], v12 offset0:0 offset1:2
  ds_read2_b32 v[70:71], v12 offset0:136 offset1:138
  ds_read2_b32 v[72:73], v14 offset0:0 offset1:2
  ds_read2_b32 v[74:75], v14 offset0:136 offset1:138
  s_waitcnt lgkmcnt(2)
  v_pk_add_f32 v[68:69], v[68:69], v[70:71]
  s_waitcnt lgkmcnt(1)
  v_pk_add_f32 v[68:69], v[68:69], v[72:73]
  s_waitcnt lgkmcnt(0)
  v_pk_add_f32 v[68:69], v[68:69], v[74:75]
  v_cvt_pk_bf16_f32 v13, v68, v69
  v_min_u32 v13, -2, v13
  buffer_store_dword v13, v3, s[4:7], s49 offen sc1
  s_cmp_eq_u32 s18, 62
  s_cbranch_scc1 Blast_145
  s_branch Ccj_160
Cnan_161:
  s_cmp_lg_u32 s60, 0
  s_cbranch_scc1 Cnanb_162
  s_mov_b32 s60, 1
  v_mov_b32 v106, s22
  buffer_store_dword v106, v5, s[4:7], 0 offen sc1
  s_mov_b32 s23, 200000
l_174:
  buffer_load_dwordx4 v[96:99], v7, s[4:7], s19 offen sc1
  buffer_load_dword v104, v8, s[4:7], s19 offen sc1
  buffer_load_dword v105, v8, s[4:7], s19 offen offset:256 sc1
  buffer_load_dwordx4 v[100:103], v7, s[4:7], s53 offen sc1
  s_waitcnt vmcnt(0) lgkmcnt(0)
  v_mov_b64 v[80:81], 0
  v_mov_b64 v[82:83], 0
  v_mov_b64 v[84:85], 0
  v_mov_b64 v[86:87], 0
  v_max_u32 v15, v96, v97
  v_max3_u32 v15, v15, v98, v99
  v_max3_u32 v15, v15, v100, v101
  v_max3_u32 v15, v15, v102, v103
  v_max3_u32 v15, v15, v104, v105
  v_cmp_eq_u32 vcc, -1, v15
  s_cbranch_vccz g2_175
  s_sub_u32 s23, s23, 1
  s_cbranch_scc0 l_174
  s_branch L_exit
g2_175:
  v_smfmac_f32_16x16x64_bf16 v[80:83], v[96:99], v[16:23], v1
  v_smfmac_f32_16x16x64_bf16 v[84:87], v[96:99], v[32:39], v1
  v_smfmac_f32_16x16x32_bf16 v[80:83], v[104:105], v[88:91], v1
  v_smfmac_f32_16x16x32_bf16 v[84:87], v[104:105], v[92:95], v1
  v_smfmac_f32_16x16x64_bf16 v[80:83], v[100:103], v[24:31], v1
  v_smfmac_f32_16x16x64_bf16 v[84:87], v[100:103], v[40:47], v1
  buffer_store_dword v10, v5, s[4:7], 0 offen sc1
  s_branch Ct_165
Cnan_166:
  s_cmp_lg_u32 s60, 0
  s_cbranch_scc1 Cnanb_167
  s_mov_b32 s60, 1
  v_mov_b32 v106, s22
  buffer_store_dword v106, v5, s[4:7], 0 offen sc1
  s_mov_b32 s23, 200000
l_176:
  buffer_load_dwordx4 v[96:99], v7, s[4:7], s19 offen sc1
  buffer_load_dword v104, v8, s[4:7], s19 offen sc1
  buffer_load_dword v105, v8, s[4:7], s19 offen offset:256 sc1
  buffer_load_dwordx4 v[100:103], v7, s[4:7], s53 offen sc1
  s_waitcnt vmcnt(0) lgkmcnt(0)
  v_mov_b64 v[80:81], 0
  v_mov_b64 v[82:83], 0
  v_mov_b64 v[84:85], 0
  v_mov_b64 v[86:87], 0
  v_max_u32 v15, v96, v97
  v_max3_u32 v15, v15, v98, v99
  v_max3_u32 v15, v15, v100, v101
  v_max3_u32 v15, v15, v102, v103
  v_max3_u32 v15, v15, v104, v105
  v_cmp_eq_u32 vcc, -1, v15
  s_cbranch_vccz g2_177
  s_sub_u32 s23, s23, 1
  s_cbranch_scc0 l_176
  s_branch L_exit
g2_177:
  v_smfmac_f32_16x16x64_bf16 v[80:83], v[96:99], v[16:23], v1
  v_smfmac_f32_16x16x64_bf16 v[84:87], v[96:99], v[32:39], v1
  v_smfmac_f32_16x16x32_bf16 v[80:83], v[104:105], v[88:91], v1
  v_smfmac_f32_16x16x32_bf16 v[84:87], v[104:105], v[92:95], v1
  v_smfmac_f32_16x16x64_bf16 v[80:83], v[100:103], v[24:31], v1
  v_smfmac_f32_16x16x64_bf16 v[84:87], v[100:103], v[40:47], v1
  s_branch Ct_170
L_rolePF:
  s_and_b32 s16, s46, 1
  s_mov_b32 s54, 0
  s_mov_b32 s23, 300000
  v_mbcnt_lo_u32_b32 v16, -1, 0
  v_cmp_gt_u32 vcc, 8, v16
  v_lshlrev_b32 v16, 5, v16
  s_nop 0
  v_cndmask_b32 v16, 4, v16, vcc
cs_180:
  global_load_dword v17, v16, s[56:57] sc1
  s_waitcnt vmcnt(0)
  v_min_u32 v18, 32, v17
  v_readlane_b32 s35, v17, 8
  v_readlane_b32 s34, v18, 0
  s_cmp_eq_u32 s34, 32
  s_cbranch_scc1 fast_178
  s_add_u32 s35, s35, s34
  v_readlane_b32 s34, v18, 1
  s_add_u32 s35, s35, s34
  v_readlane_b32 s34, v18, 2
  s_add_u32 s35, s35, s34
  v_readlane_b32 s34, v18, 3
  s_add_u32 s35, s35, s34
  v_readlane_b32 s34, v18, 4
  s_add_u32 s35, s35, s34
  v_readlane_b32 s34, v18, 5
  s_add_u32 s35, s35, s34
  v_readlane_b32 s34, v18, 6
  s_add_u32 s35, s35, s34
  v_readlane_b32 s34, v18, 7
  s_add_u32 s35, s35, s34
  s_cmp_ge_u32 s35, 256
  s_cbranch_scc1 slow_179
  s_sub_u32 s23, s23, 1
  s_cbranch_scc0 cs_180
  s_branch L_exit
slow_179:
  s_mov_b32 s54, 1
fast_178:
  s_cmp_lg_u32 s16, 0
  s_cbranch_scc1 L_noagg
  v_and_b32 v16, 15, v0
  v_min_u32 v16, 13, v16
  v_and_b32 v17, 48, v0
  v_add_u32 v16, v16, v17
  v_lshlrev_b32 v16, 7, v16
  v_and_b32 v18, 15, v0
  v_lshlrev_b32 v18, 7, v18
  s_mov_b32 s34, 46925824
  s_mov_b32 s23, 300000
fp_182:
  buffer_load_dword v17, v18, s[12:15], s34 offen sc1
  s_waitcnt vmcnt(0)
  v_cmp_gt_u32 vcc, 1, v17
  s_cbranch_vccz fpd_183
  s_sleep 2
  s_sub_u32 s23, s23, 1
  s_cbranch_scc0 fp_182
  s_branch L_exit
fpd_183:
  s_lshl_b32 s34, s17, 13
  s_add_u32 s34, s34, 46891008
  s_mov_b32 s23, 300000
fp_184:
  buffer_load_dword v17, v16, s[12:15], s34 offen sc1
  s_waitcnt vmcnt(0)
  v_cmp_gt_u32 vcc, 3, v17
  s_cbranch_vccz fpd_185
  s_sleep 1
  s_sub_u32 s23, s23, 1
  s_cbranch_scc0 fp_184
  s_branch L_exit
fpd_185:
  s_barrier
  s_cmp_lg_u32 s17, 0
  s_cbranch_scc1 ag_181
  s_mov_b32 s34, 46927872
  v_mov_b32 v17, 1
  s_mov_b64 exec, 0xff
  buffer_store_dword v17, v18, s[12:15], s34 offen sc1
  s_mov_b64 exec, -1
ag_181:
L_noagg:
  s_cmp_lg_u32 s17, 0
  s_cbranch_scc1 wa_186
  s_lshr_b32 s34, s46, 5
  s_lshl_b32 s34, s34, 7
  s_add_u32 s34, s34, 46927872
  v_mov_b32 v16, 0
  s_mov_b32 s23, 300000
fp_187:
  buffer_load_dword v17, v16, s[12:15], s34 offen sc1
  s_waitcnt vmcnt(0)
  v_cmp_gt_u32 vcc, 1, v17
  s_cbranch_vccz fpd_188
  s_sleep 4
  s_sub_u32 s23, s23, 1
  s_cbranch_scc0 fp_187
  s_branch L_exit
fpd_188:
wa_186:
  s_barrier
  v_lshlrev_b32 v4, 7, v0
  v_bfe_u32 v3, v0, 0, 4
  v_lshlrev_b32 v1, 2, v3
  s_mul_i32 s28, s16, 3
  s_add_u32 s28, s28, s17
  s_sub_u32 s28, s28, 1
  v_lshlrev_b32 v5, 8, v0
  v_add_u32 v5, 56, v5
  v_mov_b32 v3, 0x40000000
  v_cmp_gt_u32 vcc, 2, v0
  s_nop 1
  v_cndmask_b32 v5, v3, v5, vcc
  s_lshl_b32 s34, s16, 30
  v_or_b32 v5, s34, v5
  s_mul_i32 s34, s16, 3072
  v_lshlrev_b32 v15, 4, v0
  v_add_u32 v15, s34, v15
  s_mov_b32 s30, 139264
  s_mov_b32 s31, 54534144
  v_bfe_u32 v3, v0, 5, 1
  v_lshlrev_b32 v37, 15, v3
  v_bfe_u32 v3, v0, 0, 5
  v_lshl_add_u32 v37, v3, 7, v37
  s_add_u32 s34, s28, 4294967291
  s_mul_i32 s35, s34, 37
  s_lshr_b32 s35, s35, 8
  s_mul_i32 s36, s35, 7
  s_sub_u32 s36, s34, s36
  s_lshl_b32 s36, s36, 16
  s_lshl_b32 s35, s35, 12
  s_sub_u32 s36, s36, s35
  s_add_u32 s60, s36, 16805888
  s_cmp_ge_u32 s34, 0
  s_cselect_b32 s60, 0x40000000, s60
  s_mov_b32 s66, 458752
  s_cmp_lt_u32 s28, 5
  s_cselect_b64 vcc, -1, 0
  v_cndmask_b32 v36, v37, v4, vcc
  s_lshl_b32 s34, s28, 13
  s_add_u32 s34, s34, 13631488
  s_cmp_lt_u32 s28, 4
  s_cselect_b32 s60, s34, s60
  s_cselect_b32 s66, 32768, s66
  s_cmp_eq_u32 s28, 4
  s_cselect_b32 s60, 46284800, s60
  s_cselect_b32 s66, 8192, s66
  s_cmp_lg_u32 s54, 0
  s_cbranch_scc1 L_Pslow
  v_mov_b32 v2, 0
  ds_write_b32 v2, v2
  s_waitcnt lgkmcnt(0)
  s_barrier
  s_cmp_eq_u32 s17, 0
  s_cbranch_scc1 PFpub_189
  s_mov_b32 s18, 0
PFtop_190:
  s_sub_i32 s34, s18, 1
  s_max_i32 s34, s34, 1
  s_mov_b32 s23, 2400000
PFg_191:
  ds_read_b32 v3, v2
  s_waitcnt lgkmcnt(0)
  v_cmp_gt_u32 vcc, s34, v3
  s_cbranch_vccz PFgo_192
  s_sleep 1
  s_sub_u32 s23, s23, 1
  s_cbranch_scc0 PFg_191
  s_branch L_exit
PFgo_192:
  s_cmp_lg_u32 s18, 0
  s_cbranch_scc1 nf_193
  s_lshl_b32 s34, s28, 15
  s_add_u32 s34, s34, 46145536
  s_add_u32 s35, s34, 2048
  s_cmp_ge_u32 s28, 4
  s_cselect_b32 s34, 46268416, s34
  s_cselect_b32 s35, 46276608, s35
  buffer_load_dword v8, v4, s[12:15], s34 offen sc1
  buffer_load_dword v8, v4, s[12:15], s35 offen sc1
nf_193:
  s_waitcnt vmcnt(1)
  buffer_load_dword v8, v36, s[12:15], s60 offen sc1
  s_add_u32 s60, s60, s66
  s_add_u32 s18, s18, 1
  s_cmp_lt_u32 s18, 63
  s_cbranch_scc1 PFtop_190
  s_branch L_fin
PFpub_189:
  s_mov_b32 s33, 46989312
  v_bfe_u32 v3, v0, 4, 2
  v_lshlrev_b32 v20, 8, v3
  v_bfe_u32 v3, v0, 0, 4
  v_lshl_add_u32 v20, v3, 2, v20
  s_mov_b32 s23, 300000
wp_194:
  buffer_load_dword v3, v20, s[12:15], s33 offen sc1
  s_waitcnt vmcnt(0)
  v_cmp_gt_u32 vcc, 1, v3
  s_cbranch_vccz wpd_195
  s_sleep 1
  s_sub_u32 s23, s23, 1
  s_cbranch_scc0 wp_194
  s_branch L_exit
wpd_195:
  s_add_u32 s33, s33, 1024
  s_mov_b32 s18, 0
  s_add_u32 s34, s18, 1
  v_mov_b32 v3, s34
  ds_write_b32 v2, v3
  s_add_u32 s34, s18, 3
  v_mov_b32 v6, s34
  buffer_store_dword v6, v5, s[4:7], 0 offen
  s_lshl_b32 s32, s16, 2
  s_add_u32 s32, s32, 46989504
  s_mov_b32 s18, 1
pubn_196:
  s_mov_b32 s23, 300000
  buffer_load_dwordx4 v[20:23], v15, s[4:7], s30 offen offset:0 sc1
  buffer_load_dwordx4 v[24:27], v15, s[4:7], s30 offen offset:1024 sc1
  buffer_load_dwordx4 v[28:31], v15, s[4:7], s30 offen offset:2048 sc1
  buffer_load_dwordx4 v[32:35], v15, s[4:7], s30 offen offset:3072 sc1
  buffer_load_dword v7, v1, s[12:15], s33 offen sc1
  s_waitcnt vmcnt(5)
  s_waitcnt lgkmcnt(0)
  s_mov_b32 s2, 1
  s_atomic_or s2, s[58:59], s32 glc
  s_add_u32 s32, s32, 256
pub_197:
  s_waitcnt vmcnt(0)
  v_subrev_u32 v3, 1, v7
  v_max3_u32 v3, v3, v20, v21
  v_max3_u32 v3, v3, v22, v23
  v_max3_u32 v3, v3, v24, v25
  v_max3_u32 v3, v3, v26, v27
  v_max3_u32 v3, v3, v28, v29
  v_max3_u32 v3, v3, v30, v31
  v_max3_u32 v3, v3, v32, v33
  v_max3_u32 v3, v3, v34, v35
  v_cmp_eq_u32 vcc, -1, v3
  s_cbranch_vccz pubok_198
  s_sleep 2
  buffer_load_dwordx4 v[20:23], v15, s[4:7], s30 offen offset:0 sc1
  buffer_load_dwordx4 v[24:27], v15, s[4:7], s30 offen offset:1024 sc1
  buffer_load_dwordx4 v[28:31], v15, s[4:7], s30 offen offset:2048 sc1
  buffer_load_dwordx4 v[32:35], v15, s[4:7], s30 offen offset:3072 sc1
  buffer_load_dword v7, v1, s[12:15], s33 offen sc1
  s_sub_u32 s23, s23, 1
  s_cbranch_scc0 pub_197
  s_branch L_exit
pubok_198:
  s_cmp_lt_u32 s18, 61
  s_cbranch_scc1 ne_200
  s_waitcnt lgkmcnt(0)
  s_mov_b32 s2, 1
  s_atomic_or s2, s[58:59], s32 glc
ne_200:
  buffer_store_dwordx4 v[20:23], v15, s[12:15], s31 offen offset:0 sc1
  buffer_store_dwordx4 v[24:27], v15, s[12:15], s31 offen offset:1024 sc1
  buffer_store_dwordx4 v[28:31], v15, s[12:15], s31 offen offset:2048 sc1
  buffer_store_dwordx4 v[32:35], v15, s[12:15], s31 offen offset:3072 sc1
  s_add_u32 s34, s18, 1
  v_mov_b32 v3, s34
  ds_write_b32 v2, v3
  s_add_u32 s34, s18, 3
  v_mov_b32 v6, s34
  buffer_store_dword v6, v5, s[4:7], 0 offen
  s_add_u32 s30, s30, 8192
  s_add_u32 s31, s31, 8192
  s_add_u32 s33, s33, 256
  s_min_u32 s33, s33, 47005440
  s_add_u32 s18, s18, 1
  s_cmp_lt_u32 s18, 63
  s_cbranch_scc1 pubn_196
  s_waitcnt vmcnt(0)
  s_waitcnt lgkmcnt(0)
  s_mov_b32 s2, 1
  s_atomic_or s2, s[58:59], s32 glc
  s_add_u32 s32, s32, 256
  s_branch L_fin
L_Pslow:
  v_mov_b32 v2, 0
  ds_write_b32 v2, v2
  s_waitcnt lgkmcnt(0)
  s_barrier
  s_cmp_eq_u32 s17, 0
  s_cbranch_scc1 PFpub_201
  s_mov_b32 s18, 0
PFtop_202:
  s_sub_i32 s34, s18, 1
  s_max_i32 s34, s34, 1
  s_mov_b32 s23, 2400000
PFg_203:
  ds_read_b32 v3, v2
  s_waitcnt lgkmcnt(0)
  v_cmp_gt_u32 vcc, s34, v3
  s_cbranch_vccz PFgo_204
  s_sleep 1
  s_sub_u32 s23, s23, 1
  s_cbranch_scc0 PFg_203
  s_branch L_exit
PFgo_204:
  s_cmp_lg_u32 s18, 0
  s_cbranch_scc1 nf_205
  s_lshl_b32 s34, s28, 15
  s_add_u32 s34, s34, 46145536
  s_add_u32 s35, s34, 2048
  s_cmp_ge_u32 s28, 4
  s_cselect_b32 s34, 46268416, s34
  s_cselect_b32 s35, 46276608, s35
  buffer_load_dword v8, v4, s[12:15], s34 offen sc1
  buffer_load_dword v8, v4, s[12:15], s35 offen sc1
nf_205:
  s_waitcnt vmcnt(1)
  buffer_load_dword v8, v36, s[12:15], s60 offen sc1
  s_add_u32 s60, s60, s66
  s_add_u32 s18, s18, 1
  s_cmp_lt_u32 s18, 63
  s_cbranch_scc1 PFtop_202
  s_branch L_fin
PFpub_201:
  s_mov_b32 s33, 46989312
  v_bfe_u32 v3, v0, 4, 2
  v_lshlrev_b32 v20, 8, v3
  v_bfe_u32 v3, v0, 0, 4
  v_lshl_add_u32 v20, v3, 2, v20
  s_mov_b32 s23, 300000
wp_206:
  buffer_load_dword v3, v20, s[12:15], s33 offen sc1
  s_waitcnt vmcnt(0)
  v_cmp_gt_u32 vcc, 1, v3
  s_cbranch_vccz wpd_207
  s_sleep 1
  s_sub_u32 s23, s23, 1
  s_cbranch_scc0 wp_206
  s_branch L_exit
wpd_207:
  s_add_u32 s33, s33, 1024
  s_mov_b32 s18, 0
  s_add_u32 s34, s18, 1
  v_mov_b32 v3, s34
  ds_write_b32 v2, v3
  s_add_u32 s34, s18, 3
  v_mov_b32 v6, s34
  buffer_store_dword v6, v5, s[4:7], 0 offen sc1
  s_lshl_b32 s32, s16, 2
  s_add_u32 s32, s32, 46989504
  s_mov_b32 s18, 1
pubn_208:
  s_mov_b32 s23, 300000
  buffer_load_dwordx4 v[20:23], v15, s[4:7], s30 offen offset:0 sc1
  buffer_load_dwordx4 v[24:27], v15, s[4:7], s30 offen offset:1024 sc1
  buffer_load_dwordx4 v[28:31], v15, s[4:7], s30 offen offset:2048 sc1
  buffer_load_dwordx4 v[32:35], v15, s[4:7], s30 offen offset:3072 sc1
  buffer_load_dword v7, v1, s[12:15], s33 offen sc1
  s_waitcnt vmcnt(5)
  s_waitcnt lgkmcnt(0)
  s_mov_b32 s2, 1
  s_atomic_or s2, s[58:59], s32 glc
  s_add_u32 s32, s32, 256
pub_209:
  s_waitcnt vmcnt(0)
  v_subrev_u32 v3, 1, v7
  v_max3_u32 v3, v3, v20, v21
  v_max3_u32 v3, v3, v22, v23
  v_max3_u32 v3, v3, v24, v25
  v_max3_u32 v3, v3, v26, v27
  v_max3_u32 v3, v3, v28, v29
  v_max3_u32 v3, v3, v30, v31
  v_max3_u32 v3, v3, v32, v33
  v_max3_u32 v3, v3, v34, v35
  v_cmp_eq_u32 vcc, -1, v3
  s_cbranch_vccz pubok_210
  s_sleep 2
  buffer_load_dwordx4 v[20:23], v15, s[4:7], s30 offen offset:0 sc1
  buffer_load_dwordx4 v[24:27], v15, s[4:7], s30 offen offset:1024 sc1
  buffer_load_dwordx4 v[28:31], v15, s[4:7], s30 offen offset:2048 sc1
  buffer_load_dwordx4 v[32:35], v15, s[4:7], s30 offen offset:3072 sc1
  buffer_load_dword v7, v1, s[12:15], s33 offen sc1
  s_sub_u32 s23, s23, 1
  s_cbranch_scc0 pub_209
  s_branch L_exit
pubok_210:
  s_cmp_lt_u32 s18, 61
  s_cbranch_scc1 ne_212
  s_waitcnt lgkmcnt(0)
  s_mov_b32 s2, 1
  s_atomic_or s2, s[58:59], s32 glc
ne_212:
  buffer_store_dwordx4 v[20:23], v15, s[12:15], s31 offen offset:0 sc1
  buffer_store_dwordx4 v[24:27], v15, s[12:15], s31 offen offset:1024 sc1
  buffer_store_dwordx4 v[28:31], v15, s[12:15], s31 offen offset:2048 sc1
  buffer_store_dwordx4 v[32:35], v15, s[12:15], s31 offen offset:3072 sc1
  s_add_u32 s34, s18, 1
  v_mov_b32 v3, s34
  ds_write_b32 v2, v3
  s_add_u32 s34, s18, 3
  v_mov_b32 v6, s34
  buffer_store_dword v6, v5, s[4:7], 0 offen sc1
  s_add_u32 s30, s30, 8192
  s_add_u32 s31, s31, 8192
  s_add_u32 s33, s33, 256
  s_min_u32 s33, s33, 47005440
  s_add_u32 s18, s18, 1
  s_cmp_lt_u32 s18, 63
  s_cbranch_scc1 pubn_208
  s_waitcnt vmcnt(0)
  s_waitcnt lgkmcnt(0)
  s_mov_b32 s2, 1
  s_atomic_or s2, s[58:59], s32 glc
  s_add_u32 s32, s32, 256
  s_branch L_fin
L_worker:
  s_lshr_b32 s34, s46, 5
  s_lshl_b32 s34, s34, 2
  s_lshr_b32 s34, 840238192, s34
  s_and_b32 s34, s34, 7
  s_lshl_b32 s32, s34, 5
  s_and_b32 s36, s46, 31
  s_add_u32 s32, s32, s36
  s_sub_u32 s18, s46, 32
  s_mul_i32 s34, s18, 4682
  s_lshr_b32 s34, s34, 16
  s_mul_i32 s35, s34, 14
  s_sub_u32 s35, s18, s35
  s_cmp_ge_u32 s35, 7
  s_cselect_b32 s36, 1, 0
  s_cselect_b32 s37, 7, 0
  s_sub_u32 s35, s35, s37
  s_mov_b32 s19, s34
  s_add_u32 s45, s19, 16
  s_mul_i32 s43, s45, 401408
  s_lshl_b32 s45, s45, 4
  s_add_u32 s45, s45, s35
  s_add_u32 s45, s45, s37
  s_lshr_b32 s37, s17, 1
  s_and_b32 s40, s17, 1
  s_mov_b32 s20, s78
  s_mov_b32 s21, s79
  s_mov_b32 s22, 3670016
  s_mov_b32 s23, 0x20000
  s_lshl_b32 s33, s35, 6
  s_lshl_b32 s39, s37, 5
  s_add_u32 s33, s33, s39
  s_lshl_b32 s39, s40, 1
  s_add_u32 s33, s33, s39
  s_lshl_b32 s33, s33, 13
  s_lshl_b32 s41, s19, 9
  s_add_u32 s33, s33, s41
  s_lshl_b32 s47, s17, 13
  v_xor_b32 v1, 0, v4
  s_add_u32 m0, s47, 0
  s_add_u32 s39, s33, 0
  buffer_load_dwordx4 v1, s[20:23], s39 offen lds
  v_xor_b32 v1, 32, v4
  s_add_u32 m0, s47, 1024
  s_add_u32 s39, s33, 65536
  buffer_load_dwordx4 v1, s[20:23], s39 offen lds
  v_xor_b32 v1, 64, v4
  s_add_u32 m0, s47, 2048
  s_add_u32 s39, s33, 32768
  buffer_load_dwordx4 v1, s[20:23], s39 offen lds
  v_xor_b32 v1, 96, v4
  s_add_u32 m0, s47, 3072
  s_add_u32 s39, s33, 98304
  buffer_load_dwordx4 v1, s[20:23], s39 offen lds
  v_xor_b32 v1, 128, v4
  s_add_u32 m0, s47, 4096
  s_add_u32 s39, s33, 131072
  buffer_load_dwordx4 v1, s[20:23], s39 offen lds
  v_xor_b32 v1, 160, v4
  s_add_u32 m0, s47, 5120
  s_add_u32 s39, s33, 196608
  buffer_load_dwordx4 v1, s[20:23], s39 offen lds
  v_xor_b32 v1, 192, v4
  s_add_u32 m0, s47, 6144
  s_add_u32 s39, s33, 163840
  buffer_load_dwordx4 v1, s[20:23], s39 offen lds
  v_xor_b32 v1, 224, v4
  s_add_u32 m0, s47, 7168
  s_add_u32 s39, s33, 229376
  buffer_load_dwordx4 v1, s[20:23], s39 offen lds
  s_mov_b32 s24, s80
  s_mov_b32 s25, s81
  s_mov_b32 s26, 3670016
  s_mov_b32 s27, 0x20000
  s_lshl_b32 s38, s36, 1
  s_add_u32 s38, s38, s37
  s_mul_i32 s39, s38, 100352
  s_add_u32 s43, s43, s39
  s_lshl_b32 s39, s35, 1
  s_add_u32 s39, s39, s40
  s_lshl_b32 s39, s39, 10
  s_add_u32 s43, s43, s39
  s_lshl_b32 s42, s19, 8
  s_lshl_b32 s39, s17, 4
  s_add_u32 s42, s42, s39
  s_mul_i32 s42, s42, 896
  s_mul_i32 s39, s36, 448
  s_add_u32 s42, s42, s39
  s_mul_i32 s47, s17, 7168
  s_add_u32 s47, s47, 32768
  s_add_u32 m0, s47, 0
  s_nop 0
  buffer_load_dwordx4 v14, s[24:27], s42 offen lds
  s_add_u32 m0, s47, 1024
  s_nop 0
  buffer_load_dwordx4 v15, s[24:27], s42 offen lds
  s_add_u32 m0, s47, 2048
  s_nop 0
  buffer_load_dwordx4 v16, s[24:27], s42 offen lds
  s_add_u32 m0, s47, 3072
  s_nop 0
  buffer_load_dwordx4 v17, s[24:27], s42 offen lds
  s_add_u32 m0, s47, 4096
  s_nop 0
  buffer_load_dwordx4 v18, s[24:27], s42 offen lds
  s_add_u32 m0, s47, 5120
  s_nop 0
  buffer_load_dwordx4 v19, s[24:27], s42 offen lds
  s_add_u32 m0, s47, 6144
  s_nop 0
  buffer_load_dwordx4 v20, s[24:27], s42 offen lds
  s_add_u32 m0, s47, 28672
  s_add_u32 s42, s42, 57344
  buffer_load_dwordx4 v14, s[24:27], s42 offen lds
  s_add_u32 m0, s47, 29696
  s_nop 0
  buffer_load_dwordx4 v15, s[24:27], s42 offen lds
  s_add_u32 m0, s47, 30720
  s_nop 0
  buffer_load_dwordx4 v16, s[24:27], s42 offen lds
  s_add_u32 m0, s47, 31744
  s_nop 0
  buffer_load_dwordx4 v17, s[24:27], s42 offen lds
  s_add_u32 m0, s47, 32768
  s_nop 0
  buffer_load_dwordx4 v18, s[24:27], s42 offen lds
  s_add_u32 m0, s47, 33792
  s_nop 0
  buffer_load_dwordx4 v19, s[24:27], s42 offen lds
  s_add_u32 m0, s47, 34816
  s_nop 0
  buffer_load_dwordx4 v20, s[24:27], s42 offen lds
  s_waitcnt vmcnt(7)
  s_barrier
  ds_read_b128 v[108:111], v6 offset:0
  ds_read_b128 v[112:115], v6 offset:8192
  ds_read_b64_tr_b16 v[116:117], v10 offset:0
  ds_read_b64_tr_b16 v[118:119], v10 offset:1792
  ds_read_b64_tr_b16 v[120:121], v11 offset:32
  ds_read_b64_tr_b16 v[122:123], v11 offset:1824
  ds_read_b64_tr_b16 v[124:125], v10 offset:64
  ds_read_b64_tr_b16 v[126:127], v10 offset:1856
  ds_read_b64_tr_b16 v[128:129], v11 offset:96
  ds_read_b64_tr_b16 v[130:131], v11 offset:1888
  ds_read_b64_tr_b16 v[132:133], v10 offset:128
  ds_read_b64_tr_b16 v[134:135], v10 offset:1920
  s_waitcnt lgkmcnt(8)
  v_mfma_f32_16x16x32_bf16 v[52:55], v[108:111], v[116:119], 0
  ds_read_b64_tr_b16 v[136:137], v11 offset:160
  ds_read_b64_tr_b16 v[138:139], v11 offset:1952
  v_mfma_f32_16x16x32_bf16 v[56:59], v[112:115], v[116:119], 0
  s_add_u32 m0, s47, 57344
  s_add_u32 s42, s42, 57344
  buffer_load_dwordx4 v14, s[24:27], s42 offen lds
  s_waitcnt lgkmcnt(8)
  v_mfma_f32_16x16x32_bf16 v[60:63], v[108:111], v[120:123], 0
  ds_read_b64_tr_b16 v[140:141], v10 offset:192
  ds_read_b64_tr_b16 v[142:143], v10 offset:1984
  v_mfma_f32_16x16x32_bf16 v[64:67], v[112:115], v[120:123], 0
  s_add_u32 m0, s47, 58368
  s_nop 0
  buffer_load_dwordx4 v15, s[24:27], s42 offen lds
  s_waitcnt lgkmcnt(8)
  v_mfma_f32_16x16x32_bf16 v[68:71], v[108:111], v[124:127], 0
  ds_read_b128 v[144:147], v7 offset:0
  v_mfma_f32_16x16x32_bf16 v[72:75], v[112:115], v[124:127], 0
  ds_read_b128 v[148:151], v7 offset:8192
  s_waitcnt lgkmcnt(8)
  v_mfma_f32_16x16x32_bf16 v[76:79], v[108:111], v[128:131], 0
  ds_read_b64_tr_b16 v[152:153], v10 offset:14336
  ds_read_b64_tr_b16 v[154:155], v10 offset:16128
  v_mfma_f32_16x16x32_bf16 v[80:83], v[112:115], v[128:131], 0
  ds_read_b64_tr_b16 v[156:157], v11 offset:14368
  ds_read_b64_tr_b16 v[158:159], v11 offset:16160
  s_waitcnt lgkmcnt(10)
  v_mfma_f32_16x16x32_bf16 v[84:87], v[108:111], v[132:135], 0
  ds_read_b64_tr_b16 v[160:161], v10 offset:14400
  ds_read_b64_tr_b16 v[162:163], v10 offset:16192
  v_mfma_f32_16x16x32_bf16 v[88:91], v[112:115], v[132:135], 0
  s_add_u32 m0, s47, 59392
  s_nop 0
  buffer_load_dwordx4 v16, s[24:27], s42 offen lds
  s_waitcnt lgkmcnt(10)
  v_mfma_f32_16x16x32_bf16 v[92:95], v[108:111], v[136:139], 0
  ds_read_b64_tr_b16 v[164:165], v11 offset:14432
  ds_read_b64_tr_b16 v[166:167], v11 offset:16224
  v_mfma_f32_16x16x32_bf16 v[96:99], v[112:115], v[136:139], 0
  s_add_u32 m0, s47, 60416
  s_nop 0
  buffer_load_dwordx4 v17, s[24:27], s42 offen lds
  s_waitcnt lgkmcnt(10)
  v_mfma_f32_16x16x32_bf16 v[100:103], v[108:111], v[140:143], 0
  ds_read_b64_tr_b16 v[168:169], v10 offset:14464
  ds_read_b64_tr_b16 v[170:171], v10 offset:16256
  v_mfma_f32_16x16x32_bf16 v[104:107], v[112:115], v[140:143], 0
  s_add_u32 m0, s47, 61440
  s_nop 0
  buffer_load_dwordx4 v18, s[24:27], s42 offen lds
  s_waitcnt lgkmcnt(8)
  v_mfma_f32_16x16x32_bf16 v[52:55], v[144:147], v[152:155], v[52:55]
  ds_read_b64_tr_b16 v[172:173], v11 offset:14496
  ds_read_b64_tr_b16 v[174:175], v11 offset:16288
  v_mfma_f32_16x16x32_bf16 v[56:59], v[148:151], v[152:155], v[56:59]
  s_add_u32 m0, s47, 62464
  s_nop 0
  buffer_load_dwordx4 v19, s[24:27], s42 offen lds
  s_waitcnt lgkmcnt(8)
  v_mfma_f32_16x16x32_bf16 v[60:63], v[144:147], v[156:159], v[60:63]
  ds_read_b64_tr_b16 v[176:177], v10 offset:14528
  ds_read_b64_tr_b16 v[178:179], v10 offset:16320
  v_mfma_f32_16x16x32_bf16 v[64:67], v[148:151], v[156:159], v[64:67]
  s_add_u32 m0, s47, 63488
  s_nop 0
  buffer_load_dwordx4 v20, s[24:27], s42 offen lds
  s_waitcnt lgkmcnt(8)
  v_mfma_f32_16x16x32_bf16 v[68:71], v[144:147], v[160:163], v[68:71]
  v_mfma_f32_16x16x32_bf16 v[72:75], v[148:151], v[160:163], v[72:75]
  s_waitcnt lgkmcnt(6)
  v_mfma_f32_16x16x32_bf16 v[76:79], v[144:147], v[164:167], v[76:79]
  v_mfma_f32_16x16x32_bf16 v[80:83], v[148:151], v[164:167], v[80:83]
  s_waitcnt lgkmcnt(4)
  v_mfma_f32_16x16x32_bf16 v[84:87], v[144:147], v[168:171], v[84:87]
  v_mfma_f32_16x16x32_bf16 v[88:91], v[148:151], v[168:171], v[88:91]
  s_waitcnt lgkmcnt(2)
  v_mfma_f32_16x16x32_bf16 v[92:95], v[144:147], v[172:175], v[92:95]
  v_mfma_f32_16x16x32_bf16 v[96:99], v[148:151], v[172:175], v[96:99]
  s_waitcnt lgkmcnt(0)
  v_mfma_f32_16x16x32_bf16 v[100:103], v[144:147], v[176:179], v[100:103]
  v_mfma_f32_16x16x32_bf16 v[104:107], v[148:151], v[176:179], v[104:107]
  s_waitcnt vmcnt(7)
  s_barrier
  ds_read_b128 v[108:111], v8 offset:0
  ds_read_b128 v[112:115], v8 offset:8192
  ds_read_b64_tr_b16 v[116:117], v10 offset:28672
  ds_read_b64_tr_b16 v[118:119], v10 offset:30464
  ds_read_b64_tr_b16 v[120:121], v11 offset:28704
  ds_read_b64_tr_b16 v[122:123], v11 offset:30496
  ds_read_b64_tr_b16 v[124:125], v10 offset:28736
  ds_read_b64_tr_b16 v[126:127], v10 offset:30528
  ds_read_b64_tr_b16 v[128:129], v11 offset:28768
  ds_read_b64_tr_b16 v[130:131], v11 offset:30560
  ds_read_b64_tr_b16 v[132:133], v10 offset:28800
  ds_read_b64_tr_b16 v[134:135], v10 offset:30592
  s_waitcnt lgkmcnt(8)
  v_mfma_f32_16x16x32_bf16 v[52:55], v[108:111], v[116:119], v[52:55]
  ds_read_b64_tr_b16 v[136:137], v11 offset:28832
  ds_read_b64_tr_b16 v[138:139], v11 offset:30624
  v_mfma_f32_16x16x32_bf16 v[56:59], v[112:115], v[116:119], v[56:59]
  s_add_u32 m0, s47, 86016
  s_add_u32 s42, s42, 57344
  buffer_load_dwordx4 v14, s[24:27], s42 offen lds
  s_waitcnt lgkmcnt(8)
  v_mfma_f32_16x16x32_bf16 v[60:63], v[108:111], v[120:123], v[60:63]
  ds_read_b64_tr_b16 v[140:141], v10 offset:28864
  ds_read_b64_tr_b16 v[142:143], v10 offset:30656
  v_mfma_f32_16x16x32_bf16 v[64:67], v[112:115], v[120:123], v[64:67]
  s_add_u32 m0, s47, 87040
  s_nop 0
  buffer_load_dwordx4 v15, s[24:27], s42 offen lds
  s_waitcnt lgkmcnt(8)
  v_mfma_f32_16x16x32_bf16 v[68:71], v[108:111], v[124:127], v[68:71]
  ds_read_b128 v[144:147], v9 offset:0
  v_mfma_f32_16x16x32_bf16 v[72:75], v[112:115], v[124:127], v[72:75]
  ds_read_b128 v[148:151], v9 offset:8192
  s_waitcnt lgkmcnt(8)
  v_mfma_f32_16x16x32_bf16 v[76:79], v[108:111], v[128:131], v[76:79]
  ds_read_b64_tr_b16 v[152:153], v10 offset:43008
  ds_read_b64_tr_b16 v[154:155], v10 offset:44800
  v_mfma_f32_16x16x32_bf16 v[80:83], v[112:115], v[128:131], v[80:83]
  ds_read_b64_tr_b16 v[156:157], v11 offset:43040
  ds_read_b64_tr_b16 v[158:159], v11 offset:44832
  s_waitcnt lgkmcnt(10)
  v_mfma_f32_16x16x32_bf16 v[84:87], v[108:111], v[132:135], v[84:87]
  ds_read_b64_tr_b16 v[160:161], v10 offset:43072
  ds_read_b64_tr_b16 v[162:163], v10 offset:44864
  v_mfma_f32_16x16x32_bf16 v[88:91], v[112:115], v[132:135], v[88:91]
  s_add_u32 m0, s47, 88064
  s_nop 0
  buffer_load_dwordx4 v16, s[24:27], s42 offen lds
  s_waitcnt lgkmcnt(10)
  v_mfma_f32_16x16x32_bf16 v[92:95], v[108:111], v[136:139], v[92:95]
  ds_read_b64_tr_b16 v[164:165], v11 offset:43104
  ds_read_b64_tr_b16 v[166:167], v11 offset:44896
  v_mfma_f32_16x16x32_bf16 v[96:99], v[112:115], v[136:139], v[96:99]
  s_add_u32 m0, s47, 89088
  s_nop 0
  buffer_load_dwordx4 v17, s[24:27], s42 offen lds
  s_waitcnt lgkmcnt(10)
  v_mfma_f32_16x16x32_bf16 v[100:103], v[108:111], v[140:143], v[100:103]
  ds_read_b64_tr_b16 v[168:169], v10 offset:43136
  ds_read_b64_tr_b16 v[170:171], v10 offset:44928
  v_mfma_f32_16x16x32_bf16 v[104:107], v[112:115], v[140:143], v[104:107]
  s_add_u32 m0, s47, 90112
  s_nop 0
  buffer_load_dwordx4 v18, s[24:27], s42 offen lds
  s_waitcnt lgkmcnt(8)
  v_mfma_f32_16x16x32_bf16 v[52:55], v[144:147], v[152:155], v[52:55]
  ds_read_b64_tr_b16 v[172:173], v11 offset:43168
  ds_read_b64_tr_b16 v[174:175], v11 offset:44960
  v_mfma_f32_16x16x32_bf16 v[56:59], v[148:151], v[152:155], v[56:59]
  s_add_u32 m0, s47, 91136
  s_nop 0
  buffer_load_dwordx4 v19, s[24:27], s42 offen lds
  s_waitcnt lgkmcnt(8)
  v_mfma_f32_16x16x32_bf16 v[60:63], v[144:147], v[156:159], v[60:63]
  ds_read_b64_tr_b16 v[176:177], v10 offset:43200
  ds_read_b64_tr_b16 v[178:179], v10 offset:44992
  v_mfma_f32_16x16x32_bf16 v[64:67], v[148:151], v[156:159], v[64:67]
  s_add_u32 m0, s47, 92160
  s_nop 0
  buffer_load_dwordx4 v20, s[24:27], s42 offen lds
  v_mov_b32 v1, 0
  global_load_dword v247, v1, s[56:57] offset:132 sc1
  s_waitcnt lgkmcnt(8)
  v_mfma_f32_16x16x32_bf16 v[68:71], v[144:147], v[160:163], v[68:71]
  v_mfma_f32_16x16x32_bf16 v[72:75], v[148:151], v[160:163], v[72:75]
  s_waitcnt lgkmcnt(6)
  v_mfma_f32_16x16x32_bf16 v[76:79], v[144:147], v[164:167], v[76:79]
  v_mfma_f32_16x16x32_bf16 v[80:83], v[148:151], v[164:167], v[80:83]
  s_waitcnt lgkmcnt(4)
  v_mfma_f32_16x16x32_bf16 v[84:87], v[144:147], v[168:171], v[84:87]
  v_mfma_f32_16x16x32_bf16 v[88:91], v[148:151], v[168:171], v[88:91]
  s_waitcnt lgkmcnt(2)
  v_mfma_f32_16x16x32_bf16 v[92:95], v[144:147], v[172:175], v[92:95]
  v_mfma_f32_16x16x32_bf16 v[96:99], v[148:151], v[172:175], v[96:99]
  s_waitcnt lgkmcnt(0)
  v_mfma_f32_16x16x32_bf16 v[100:103], v[144:147], v[176:179], v[100:103]
  v_mfma_f32_16x16x32_bf16 v[104:107], v[148:151], v[176:179], v[104:107]
  s_waitcnt vmcnt(8)
  s_barrier
  ds_read_b128 v[108:111], v6 offset:256
  ds_read_b128 v[112:115], v6 offset:8448
  ds_read_b64_tr_b16 v[116:117], v12 offset:0
  ds_read_b64_tr_b16 v[118:119], v12 offset:1792
  ds_read_b64_tr_b16 v[120:121], v13 offset:32
  ds_read_b64_tr_b16 v[122:123], v13 offset:1824
  ds_read_b64_tr_b16 v[124:125], v12 offset:64
  ds_read_b64_tr_b16 v[126:127], v12 offset:1856
  ds_read_b64_tr_b16 v[128:129], v13 offset:96
  ds_read_b64_tr_b16 v[130:131], v13 offset:1888
  ds_read_b64_tr_b16 v[132:133], v12 offset:128
  ds_read_b64_tr_b16 v[134:135], v12 offset:1920
  s_waitcnt lgkmcnt(8)
  v_mfma_f32_16x16x32_bf16 v[52:55], v[108:111], v[116:119], v[52:55]
  ds_read_b64_tr_b16 v[136:137], v13 offset:160
  ds_read_b64_tr_b16 v[138:139], v13 offset:1952
  v_mfma_f32_16x16x32_bf16 v[56:59], v[112:115], v[116:119], v[56:59]
  s_waitcnt lgkmcnt(8)
  v_mfma_f32_16x16x32_bf16 v[60:63], v[108:111], v[120:123], v[60:63]
  ds_read_b64_tr_b16 v[140:141], v12 offset:192
  ds_read_b64_tr_b16 v[142:143], v12 offset:1984
  v_mfma_f32_16x16x32_bf16 v[64:67], v[112:115], v[120:123], v[64:67]
  s_waitcnt lgkmcnt(8)
  v_mfma_f32_16x16x32_bf16 v[68:71], v[108:111], v[124:127], v[68:71]
  ds_read_b128 v[144:147], v7 offset:256
  v_mfma_f32_16x16x32_bf16 v[72:75], v[112:115], v[124:127], v[72:75]
  ds_read_b128 v[148:151], v7 offset:8448
  s_waitcnt lgkmcnt(8)
  v_mfma_f32_16x16x32_bf16 v[76:79], v[108:111], v[128:131], v[76:79]
  ds_read_b64_tr_b16 v[152:153], v12 offset:14336
  ds_read_b64_tr_b16 v[154:155], v12 offset:16128
  v_mfma_f32_16x16x32_bf16 v[80:83], v[112:115], v[128:131], v[80:83]
  ds_read_b64_tr_b16 v[156:157], v13 offset:14368
  ds_read_b64_tr_b16 v[158:159], v13 offset:16160
  s_waitcnt lgkmcnt(10)
  v_mfma_f32_16x16x32_bf16 v[84:87], v[108:111], v[132:135], v[84:87]
  ds_read_b64_tr_b16 v[160:161], v12 offset:14400
  ds_read_b64_tr_b16 v[162:163], v12 offset:16192
  v_mfma_f32_16x16x32_bf16 v[88:91], v[112:115], v[132:135], v[88:91]
  s_waitcnt lgkmcnt(10)
  v_mfma_f32_16x16x32_bf16 v[92:95], v[108:111], v[136:139], v[92:95]
  ds_read_b64_tr_b16 v[164:165], v13 offset:14432
  ds_read_b64_tr_b16 v[166:167], v13 offset:16224
  v_mfma_f32_16x16x32_bf16 v[96:99], v[112:115], v[136:139], v[96:99]
  s_waitcnt lgkmcnt(10)
  v_mfma_f32_16x16x32_bf16 v[100:103], v[108:111], v[140:143], v[100:103]
  ds_read_b64_tr_b16 v[168:169], v12 offset:14464
  ds_read_b64_tr_b16 v[170:171], v12 offset:16256
  v_mfma_f32_16x16x32_bf16 v[104:107], v[112:115], v[140:143], v[104:107]
  s_waitcnt lgkmcnt(8)
  v_mfma_f32_16x16x32_bf16 v[52:55], v[144:147], v[152:155], v[52:55]
  ds_read_b64_tr_b16 v[172:173], v13 offset:14496
  ds_read_b64_tr_b16 v[174:175], v13 offset:16288
  v_mfma_f32_16x16x32_bf16 v[56:59], v[148:151], v[152:155], v[56:59]
  s_waitcnt lgkmcnt(8)
  v_mfma_f32_16x16x32_bf16 v[60:63], v[144:147], v[156:159], v[60:63]
  ds_read_b64_tr_b16 v[176:177], v12 offset:14528
  ds_read_b64_tr_b16 v[178:179], v12 offset:16320
  v_mfma_f32_16x16x32_bf16 v[64:67], v[148:151], v[156:159], v[64:67]
  s_waitcnt lgkmcnt(8)
  v_mfma_f32_16x16x32_bf16 v[68:71], v[144:147], v[160:163], v[68:71]
  v_mfma_f32_16x16x32_bf16 v[72:75], v[148:151], v[160:163], v[72:75]
  s_waitcnt lgkmcnt(6)
  v_mfma_f32_16x16x32_bf16 v[76:79], v[144:147], v[164:167], v[76:79]
  v_mfma_f32_16x16x32_bf16 v[80:83], v[148:151], v[164:167], v[80:83]
  s_waitcnt lgkmcnt(4)
  v_mfma_f32_16x16x32_bf16 v[84:87], v[144:147], v[168:171], v[84:87]
  v_mfma_f32_16x16x32_bf16 v[88:91], v[148:151], v[168:171], v[88:91]
  s_waitcnt lgkmcnt(2)
  v_mfma_f32_16x16x32_bf16 v[92:95], v[144:147], v[172:175], v[92:95]
  v_mfma_f32_16x16x32_bf16 v[96:99], v[148:151], v[172:175], v[96:99]
  s_waitcnt lgkmcnt(0)
  v_mfma_f32_16x16x32_bf16 v[100:103], v[144:147], v[176:179], v[100:103]
  v_mfma_f32_16x16x32_bf16 v[104:107], v[148:151], v[176:179], v[104:107]
  s_waitcnt vmcnt(1)
  s_barrier
  ds_read_b128 v[108:111], v8 offset:256
  ds_read_b128 v[112:115], v8 offset:8448
  ds_read_b64_tr_b16 v[116:117], v12 offset:28672
  ds_read_b64_tr_b16 v[118:119], v12 offset:30464
  ds_read_b64_tr_b16 v[120:121], v13 offset:28704
  ds_read_b64_tr_b16 v[122:123], v13 offset:30496
  ds_read_b64_tr_b16 v[124:125], v12 offset:28736
  ds_read_b64_tr_b16 v[126:127], v12 offset:30528
  ds_read_b64_tr_b16 v[128:129], v13 offset:28768
  ds_read_b64_tr_b16 v[130:131], v13 offset:30560
  ds_read_b64_tr_b16 v[132:133], v12 offset:28800
  ds_read_b64_tr_b16 v[134:135], v12 offset:30592
  s_waitcnt lgkmcnt(8)
  v_mfma_f32_16x16x32_bf16 v[52:55], v[108:111], v[116:119], v[52:55]
  ds_read_b64_tr_b16 v[136:137], v13 offset:28832
  ds_read_b64_tr_b16 v[138:139], v13 offset:30624
  v_mfma_f32_16x16x32_bf16 v[56:59], v[112:115], v[116:119], v[56:59]
  s_waitcnt lgkmcnt(8)
  v_mfma_f32_16x16x32_bf16 v[60:63], v[108:111], v[120:123], v[60:63]
  ds_read_b64_tr_b16 v[140:141], v12 offset:28864
  ds_read_b64_tr_b16 v[142:143], v12 offset:30656
  v_mfma_f32_16x16x32_bf16 v[64:67], v[112:115], v[120:123], v[64:67]
  s_waitcnt lgkmcnt(8)
  v_mfma_f32_16x16x32_bf16 v[68:71], v[108:111], v[124:127], v[68:71]
  ds_read_b128 v[144:147], v9 offset:256
  v_mfma_f32_16x16x32_bf16 v[72:75], v[112:115], v[124:127], v[72:75]
  ds_read_b128 v[148:151], v9 offset:8448
  s_waitcnt lgkmcnt(8)
  v_mfma_f32_16x16x32_bf16 v[76:79], v[108:111], v[128:131], v[76:79]
  ds_read_b64_tr_b16 v[152:153], v12 offset:43008
  ds_read_b64_tr_b16 v[154:155], v12 offset:44800
  v_mfma_f32_16x16x32_bf16 v[80:83], v[112:115], v[128:131], v[80:83]
  ds_read_b64_tr_b16 v[156:157], v13 offset:43040
  ds_read_b64_tr_b16 v[158:159], v13 offset:44832
  s_waitcnt lgkmcnt(10)
  v_mfma_f32_16x16x32_bf16 v[84:87], v[108:111], v[132:135], v[84:87]
  ds_read_b64_tr_b16 v[160:161], v12 offset:43072
  ds_read_b64_tr_b16 v[162:163], v12 offset:44864
  v_mfma_f32_16x16x32_bf16 v[88:91], v[112:115], v[132:135], v[88:91]
  s_waitcnt lgkmcnt(10)
  v_mfma_f32_16x16x32_bf16 v[92:95], v[108:111], v[136:139], v[92:95]
  ds_read_b64_tr_b16 v[164:165], v13 offset:43104
  ds_read_b64_tr_b16 v[166:167], v13 offset:44896
  v_mfma_f32_16x16x32_bf16 v[96:99], v[112:115], v[136:139], v[96:99]
  s_waitcnt lgkmcnt(10)
  v_mfma_f32_16x16x32_bf16 v[100:103], v[108:111], v[140:143], v[100:103]
  ds_read_b64_tr_b16 v[168:169], v12 offset:43136
  ds_read_b64_tr_b16 v[170:171], v12 offset:44928
  v_mfma_f32_16x16x32_bf16 v[104:107], v[112:115], v[140:143], v[104:107]
  s_waitcnt lgkmcnt(8)
  v_mfma_f32_16x16x32_bf16 v[52:55], v[144:147], v[152:155], v[52:55]
  ds_read_b64_tr_b16 v[172:173], v13 offset:43168
  ds_read_b64_tr_b16 v[174:175], v13 offset:44960
  v_mfma_f32_16x16x32_bf16 v[56:59], v[148:151], v[152:155], v[56:59]
  s_waitcnt lgkmcnt(8)
  v_mfma_f32_16x16x32_bf16 v[60:63], v[144:147], v[156:159], v[60:63]
  ds_read_b64_tr_b16 v[176:177], v12 offset:43200
  ds_read_b64_tr_b16 v[178:179], v12 offset:44992
  v_mfma_f32_16x16x32_bf16 v[64:67], v[148:151], v[156:159], v[64:67]
  s_waitcnt lgkmcnt(8)
  v_mfma_f32_16x16x32_bf16 v[68:71], v[144:147], v[160:163], v[68:71]
  v_mfma_f32_16x16x32_bf16 v[72:75], v[148:151], v[160:163], v[72:75]
  s_waitcnt lgkmcnt(6)
  v_mfma_f32_16x16x32_bf16 v[76:79], v[144:147], v[164:167], v[76:79]
  v_mfma_f32_16x16x32_bf16 v[80:83], v[148:151], v[164:167], v[80:83]
  s_waitcnt lgkmcnt(4)
  v_mfma_f32_16x16x32_bf16 v[84:87], v[144:147], v[168:171], v[84:87]
  v_mfma_f32_16x16x32_bf16 v[88:91], v[148:151], v[168:171], v[88:91]
  s_waitcnt lgkmcnt(2)
  v_mfma_f32_16x16x32_bf16 v[92:95], v[144:147], v[172:175], v[92:95]
  v_mfma_f32_16x16x32_bf16 v[96:99], v[148:151], v[172:175], v[96:99]
  s_waitcnt lgkmcnt(0)
  v_mfma_f32_16x16x32_bf16 v[100:103], v[144:147], v[176:179], v[100:103]
  v_mfma_f32_16x16x32_bf16 v[104:107], v[148:151], v[176:179], v[104:107]
  v_cvt_pk_bf16_f32 v52, v52, v53
  v_cvt_pk_bf16_f32 v53, v54, v55
  v_cvt_pk_bf16_f32 v54, v56, v57
  v_cvt_pk_bf16_f32 v55, v58, v59
  buffer_store_dwordx4 v[52:55], v3, s[12:15], s43 offen sc1
  s_add_u32 s43, s43, 14336
  v_cvt_pk_bf16_f32 v60, v60, v61
  v_cvt_pk_bf16_f32 v61, v62, v63
  v_cvt_pk_bf16_f32 v62, v64, v65
  v_cvt_pk_bf16_f32 v63, v66, v67
  buffer_store_dwordx4 v[60:63], v3, s[12:15], s43 offen sc1
  s_add_u32 s43, s43, 14336
  v_cvt_pk_bf16_f32 v68, v68, v69
  v_cvt_pk_bf16_f32 v69, v70, v71
  v_cvt_pk_bf16_f32 v70, v72, v73
  v_cvt_pk_bf16_f32 v71, v74, v75
  buffer_store_dwordx4 v[68:71], v3, s[12:15], s43 offen sc1
  s_add_u32 s43, s43, 14336
  v_cvt_pk_bf16_f32 v76, v76, v77
  v_cvt_pk_bf16_f32 v77, v78, v79
  v_cvt_pk_bf16_f32 v78, v80, v81
  v_cvt_pk_bf16_f32 v79, v82, v83
  buffer_store_dwordx4 v[76:79], v3, s[12:15], s43 offen sc1
  s_add_u32 s43, s43, 14336
  v_cvt_pk_bf16_f32 v84, v84, v85
  v_cvt_pk_bf16_f32 v85, v86, v87
  v_cvt_pk_bf16_f32 v86, v88, v89
  v_cvt_pk_bf16_f32 v87, v90, v91
  buffer_store_dwordx4 v[84:87], v3, s[12:15], s43 offen sc1
  s_add_u32 s43, s43, 14336
  v_cvt_pk_bf16_f32 v92, v92, v93
  v_cvt_pk_bf16_f32 v93, v94, v95
  v_cvt_pk_bf16_f32 v94, v96, v97
  v_cvt_pk_bf16_f32 v95, v98, v99
  buffer_store_dwordx4 v[92:95], v3, s[12:15], s43 offen sc1
  s_add_u32 s43, s43, 14336
  v_cvt_pk_bf16_f32 v100, v100, v101
  v_cvt_pk_bf16_f32 v101, v102, v103
  v_cvt_pk_bf16_f32 v102, v104, v105
  v_cvt_pk_bf16_f32 v103, v106, v107
  buffer_store_dwordx4 v[100:103], v3, s[12:15], s43 offen sc1
  s_mov_b32 s16, s45
  s_barrier
  s_cmp_lt_u32 s32, 128
  s_cbranch_scc1 tg_213
  s_sub_u32 s34, s32, 128
  s_add_u32 s35, s18, 128
  s_cmp_lt_u32 s18, 32
  s_cselect_b32 s34, s35, s34
  s_lshl_b32 s60, s34, 3
  s_lshl_b32 s34, s17, 1
  s_add_u32 s60, s60, s34
  s_add_u32 s33, s60, 256
  s_add_u32 s42, s33, 256
  s_mov_b32 s28, s64
  s_mov_b32 s29, s65
  s_mov_b32 s30, 1835008
  s_mov_b32 s31, 0x20000
  v_bfe_u32 v1, v0, 2, 2
  v_lshlrev_b32 v2, 3, v1
  v_bfe_u32 v1, v0, 0, 2
  v_lshl_add_u32 v2, v1, 0, v2
  v_mul_u32_u24 v2, 896, v2
  v_bfe_u32 v1, v0, 5, 1
  v_lshlrev_b32 v21, 5, v1
  v_bfe_u32 v1, v0, 4, 1
  v_lshl_add_u32 v21, v1, 3, v21
  v_add_u32 v21, v21, v2
  s_mul_i32 s34, s60, 2341
  s_lshr_b32 s34, s34, 16
  s_mul_i32 s35, s34, 28
  s_sub_u32 s35, s60, s35
  s_mul_i32 s36, s34, 28672
  s_cmp_ge_u32 s35, 14
  s_cselect_b32 s37, 2688, 0
  s_add_u32 s36, s36, s37
  s_lshl_b32 s37, s35, 6
  s_add_u32 s36, s36, s37
  buffer_load_dwordx2 v[28:29], v21, s[28:31], s36 offen offset:0
  buffer_load_dwordx2 v[30:31], v21, s[28:31], s36 offen offset:16
  buffer_load_dwordx2 v[32:33], v21, s[28:31], s36 offen offset:64
  buffer_load_dwordx2 v[34:35], v21, s[28:31], s36 offen offset:80
  s_cmp_ge_u32 s60, 1344
  s_cbranch_scc1 wof_216
  s_mov_b32 s28, s66
  s_mov_b32 s29, s67
  s_mov_b32 s30, 1204224
  s_mov_b32 s31, 0x20000
  s_mul_i32 s36, s34, 21846
  s_lshr_b32 s36, s36, 16
  s_mul_i32 s37, s36, 3
  s_sub_u32 s37, s34, s37
  s_mul_i32 s37, s37, 896
  s_mul_i32 s36, s36, 56
  s_add_u32 s37, s37, s36
  s_mul_i32 s36, s35, 43008
  s_add_u32 s37, s37, s36
  s_add_u32 s48, s37, 0
  s_add_u32 s49, s37, 2688
  s_add_u32 s50, s37, 21504
  s_add_u32 s51, s37, 24192
  s_add_u32 s52, s37, 5376
  s_add_u32 s53, s37, 8064
  s_add_u32 s54, s37, 26880
  s_add_u32 s55, s37, 29568
  v_bfe_u32 v1, v0, 5, 1
  v_lshlrev_b32 v2, 0, v1
  v_mul_u32_u24 v2, 10752, v2
  v_bfe_u32 v1, v0, 0, 5
  v_lshlrev_b32 v22, 1, v1
  v_cmp_lt_u32 vcc, 27, v1
  v_add_u32 v22, v22, v2
  v_mov_b32 v1, 0x40000000
  v_cndmask_b32 v22, v22, v1, vcc
  v_mov_b32 v23, v22
  s_mov_b32 s61, 43008
  s_branch j_217
wof_216:
  s_mov_b32 s28, s68
  s_mov_b32 s29, s69
  s_mov_b32 s30, 401408
  s_mov_b32 s31, 0x20000
  s_sub_u32 s34, s60, 1344
  s_and_b32 s36, s34, 15
  s_lshr_b32 s34, s34, 4
  s_lshl_b32 s34, s34, 5
  s_mul_i32 s36, s36, 25088
  s_add_u32 s37, s34, s36
  s_add_u32 s48, s37, 0
  s_add_u32 s49, s37, 896
  s_add_u32 s50, s37, 1792
  s_add_u32 s51, s37, 2688
  s_add_u32 s52, s37, 7168
  s_add_u32 s53, s37, 8064
  s_add_u32 s54, s37, 8960
  s_add_u32 s55, s37, 9856
  v_bfe_u32 v1, v0, 5, 1
  v_lshlrev_b32 v2, 4, v1
  v_bfe_u32 v1, v0, 4, 1
  v_lshl_add_u32 v2, v1, 2, v2
  v_mul_u32_u24 v2, 896, v2
  v_bfe_u32 v1, v0, 0, 4
  v_lshlrev_b32 v22, 1, v1
  v_add_u32 v22, v22, v2
  v_cmp_lt_u32 vcc, 47, v0
  v_mov_b32 v1, 0x40000000
  s_nop 0
  v_cndmask_b32 v23, v22, v1, vcc
  s_mov_b32 s61, 25088
j_217:
  buffer_load_ushort v36, v22, s[28:31], s48 offen
  s_add_u32 s48, s48, s61
  buffer_load_ushort v37, v22, s[28:31], s49 offen
  s_add_u32 s49, s49, s61
  buffer_load_ushort v38, v22, s[28:31], s50 offen
  s_add_u32 s50, s50, s61
  buffer_load_ushort v39, v22, s[28:31], s51 offen
  s_add_u32 s51, s51, s61
  buffer_load_ushort v40, v23, s[28:31], s52 offen
  s_add_u32 s52, s52, s61
  buffer_load_ushort v41, v23, s[28:31], s53 offen
  s_add_u32 s53, s53, s61
  buffer_load_ushort v42, v23, s[28:31], s54 offen
  s_add_u32 s54, s54, s61
  buffer_load_ushort v43, v23, s[28:31], s55 offen
  s_add_u32 s55, s55, s61
  buffer_load_ushort v44, v22, s[28:31], s48 offen
  buffer_load_ushort v45, v22, s[28:31], s49 offen
  buffer_load_ushort v46, v22, s[28:31], s50 offen
  buffer_load_ushort v47, v22, s[28:31], s51 offen
  buffer_load_ushort v48, v23, s[28:31], s52 offen
  buffer_load_ushort v49, v23, s[28:31], s53 offen
  buffer_load_ushort v50, v23, s[28:31], s54 offen
  buffer_load_ushort v51, v23, s[28:31], s55 offen
  s_waitcnt vmcnt(20)
  s_cmp_lg_u32 s17, 0
  s_cbranch_scc1 ok_218
  v_cmp_gt_u32 vcc, 16, v247
  s_cbranch_vccz ok_218
  s_mov_b32 s23, 300000
  v_mov_b32 v1, 0
w0l_219:
  global_load_dword v2, v1, s[56:57] offset:132 sc1
  s_waitcnt vmcnt(0)
  v_cmp_gt_u32 vcc, 16, v2
  s_cbranch_vccz w0d_220
  s_sleep 4
  s_sub_u32 s23, s23, 1
  s_cbranch_scc0 w0l_219
  s_branch L_exit
w0d_220:
ok_218:
  s_waitcnt vmcnt(20)
  s_barrier
  s_cmp_lg_u32 s17, 0
  s_cbranch_scc1 sg_222
  s_lshl_b32 s62, s16, 7
  s_add_u32 s62, s62, 46858240
  s_waitcnt lgkmcnt(0)
  s_mov_b32 s2, 1
  s_atomic_or s2, s[58:59], s62 glc
sg_222:
  s_cmp_lt_u32 s18, 32
  s_cbranch_scc1 tv_223
  s_cmp_ge_u32 s60, 28
  s_cbranch_scc1 ng_224
  s_mov_b32 s28, s84
  s_mov_b32 s29, s85
  s_mov_b32 s30, 896
  s_mov_b32 s31, 0x20000
  s_lshl_b32 s34, s60, 5
  v_bfe_u32 v1, v0, 5, 1
  v_lshlrev_b32 v24, 3, v1
  s_mov_b32 exec_lo, 0x10000000
  s_mov_b32 exec_hi, 0x10000000
  buffer_load_ushort v36, v24, s[28:31], s34 offen offset:0
  buffer_load_ushort v37, v24, s[28:31], s34 offen offset:2
  buffer_load_ushort v38, v24, s[28:31], s34 offen offset:16
  buffer_load_ushort v39, v24, s[28:31], s34 offen offset:18
  buffer_load_ushort v40, v24, s[28:31], s34 offen offset:4
  buffer_load_ushort v41, v24, s[28:31], s34 offen offset:6
  buffer_load_ushort v42, v24, s[28:31], s34 offen offset:20
  buffer_load_ushort v43, v24, s[28:31], s34 offen offset:22
  buffer_load_ushort v44, v24, s[28:31], s34 offen offset:32
  buffer_load_ushort v45, v24, s[28:31], s34 offen offset:34
  buffer_load_ushort v46, v24, s[28:31], s34 offen offset:48
  buffer_load_ushort v47, v24, s[28:31], s34 offen offset:50
  buffer_load_ushort v48, v24, s[28:31], s34 offen offset:36
  buffer_load_ushort v49, v24, s[28:31], s34 offen offset:38
  buffer_load_ushort v50, v24, s[28:31], s34 offen offset:52
  buffer_load_ushort v51, v24, s[28:31], s34 offen offset:54
  s_mov_b64 exec, -1
  s_waitcnt vmcnt(0)
ng_224:
  s_waitcnt vmcnt(0)
  s_lshl_b32 s34, s60, 10
  s_add_u32 s35, s34, 56623104
  s_add_u32 s34, s34, 58720256
  v_swap_b32 v29, v30
  buffer_store_dwordx4 v[28:31], v3, s[12:15], s35 offen offset:0 sc1
  v_lshl_or_b32 v36, v37, 16, v36
  v_lshl_or_b32 v37, v39, 16, v38
  v_lshl_or_b32 v38, v41, 16, v40
  v_lshl_or_b32 v39, v43, 16, v42
  buffer_store_dwordx4 v[36:39], v3, s[12:15], s34 offen offset:0 sc1
  v_swap_b32 v33, v34
  buffer_store_dwordx4 v[32:35], v3, s[12:15], s35 offen offset:1024 sc1
  v_lshl_or_b32 v44, v45, 16, v44
  v_lshl_or_b32 v45, v47, 16, v46
  v_lshl_or_b32 v46, v49, 16, v48
  v_lshl_or_b32 v47, v51, 16, v50
  buffer_store_dwordx4 v[44:47], v3, s[12:15], s34 offen offset:1024 sc1
  s_branch tv_215
tv_223:
  s_mov_b32 s28, s64
  s_mov_b32 s29, s65
  s_mov_b32 s30, 1835008
  s_mov_b32 s31, 0x20000
  v_bfe_u32 v1, v0, 2, 2
  v_lshlrev_b32 v2, 3, v1
  v_bfe_u32 v1, v0, 0, 2
  v_lshl_add_u32 v2, v1, 0, v2
  v_mul_u32_u24 v2, 896, v2
  v_bfe_u32 v1, v0, 5, 1
  v_lshlrev_b32 v21, 5, v1
  v_bfe_u32 v1, v0, 4, 1
  v_lshl_add_u32 v21, v1, 3, v21
  v_add_u32 v21, v21, v2
  s_mul_i32 s34, s33, 2341
  s_lshr_b32 s34, s34, 16
  s_mul_i32 s35, s34, 28
  s_sub_u32 s35, s33, s35
  s_mul_i32 s36, s34, 28672
  s_cmp_ge_u32 s35, 14
  s_cselect_b32 s37, 2688, 0
  s_add_u32 s36, s36, s37
  s_lshl_b32 s37, s35, 6
  s_add_u32 s36, s36, s37
  buffer_load_dwordx2 v[108:109], v21, s[28:31], s36 offen offset:0
  buffer_load_dwordx2 v[110:111], v21, s[28:31], s36 offen offset:16
  buffer_load_dwordx2 v[112:113], v21, s[28:31], s36 offen offset:64
  buffer_load_dwordx2 v[114:115], v21, s[28:31], s36 offen offset:80
  s_cmp_ge_u32 s33, 1344
  s_cbranch_scc1 wof_225
  s_mov_b32 s28, s66
  s_mov_b32 s29, s67
  s_mov_b32 s30, 1204224
  s_mov_b32 s31, 0x20000
  s_mul_i32 s36, s34, 21846
  s_lshr_b32 s36, s36, 16
  s_mul_i32 s37, s36, 3
  s_sub_u32 s37, s34, s37
  s_mul_i32 s37, s37, 896
  s_mul_i32 s36, s36, 56
  s_add_u32 s37, s37, s36
  s_mul_i32 s36, s35, 43008
  s_add_u32 s37, s37, s36
  s_add_u32 s48, s37, 0
  s_add_u32 s49, s37, 2688
  s_add_u32 s50, s37, 21504
  s_add_u32 s51, s37, 24192
  s_add_u32 s52, s37, 5376
  s_add_u32 s53, s37, 8064
  s_add_u32 s54, s37, 26880
  s_add_u32 s55, s37, 29568
  v_bfe_u32 v1, v0, 5, 1
  v_lshlrev_b32 v2, 0, v1
  v_mul_u32_u24 v2, 10752, v2
  v_bfe_u32 v1, v0, 0, 5
  v_lshlrev_b32 v22, 1, v1
  v_cmp_lt_u32 vcc, 27, v1
  v_add_u32 v22, v22, v2
  v_mov_b32 v1, 0x40000000
  v_cndmask_b32 v22, v22, v1, vcc
  v_mov_b32 v23, v22
  s_mov_b32 s61, 43008
  s_branch j_226
wof_225:
  s_mov_b32 s28, s68
  s_mov_b32 s29, s69
  s_mov_b32 s30, 401408
  s_mov_b32 s31, 0x20000
  s_sub_u32 s34, s33, 1344
  s_and_b32 s36, s34, 15
  s_lshr_b32 s34, s34, 4
  s_lshl_b32 s34, s34, 5
  s_mul_i32 s36, s36, 25088
  s_add_u32 s37, s34, s36
  s_add_u32 s48, s37, 0
  s_add_u32 s49, s37, 896
  s_add_u32 s50, s37, 1792
  s_add_u32 s51, s37, 2688
  s_add_u32 s52, s37, 7168
  s_add_u32 s53, s37, 8064
  s_add_u32 s54, s37, 8960
  s_add_u32 s55, s37, 9856
  v_bfe_u32 v1, v0, 5, 1
  v_lshlrev_b32 v2, 4, v1
  v_bfe_u32 v1, v0, 4, 1
  v_lshl_add_u32 v2, v1, 2, v2
  v_mul_u32_u24 v2, 896, v2
  v_bfe_u32 v1, v0, 0, 4
  v_lshlrev_b32 v22, 1, v1
  v_add_u32 v22, v22, v2
  v_cmp_lt_u32 vcc, 47, v0
  v_mov_b32 v1, 0x40000000
  s_nop 0
  v_cndmask_b32 v23, v22, v1, vcc
  s_mov_b32 s61, 25088
j_226:
  buffer_load_ushort v116, v22, s[28:31], s48 offen
  s_add_u32 s48, s48, s61
  buffer_load_ushort v117, v22, s[28:31], s49 offen
  s_add_u32 s49, s49, s61
  buffer_load_ushort v118, v22, s[28:31], s50 offen
  s_add_u32 s50, s50, s61
  buffer_load_ushort v119, v22, s[28:31], s51 offen
  s_add_u32 s51, s51, s61
  buffer_load_ushort v120, v23, s[28:31], s52 offen
  s_add_u32 s52, s52, s61
  buffer_load_ushort v121, v23, s[28:31], s53 offen
  s_add_u32 s53, s53, s61
  buffer_load_ushort v122, v23, s[28:31], s54 offen
  s_add_u32 s54, s54, s61
  buffer_load_ushort v123, v23, s[28:31], s55 offen
  s_add_u32 s55, s55, s61
  buffer_load_ushort v124, v22, s[28:31], s48 offen
  buffer_load_ushort v125, v22, s[28:31], s49 offen
  buffer_load_ushort v126, v22, s[28:31], s50 offen
  buffer_load_ushort v127, v22, s[28:31], s51 offen
  buffer_load_ushort v128, v23, s[28:31], s52 offen
  buffer_load_ushort v129, v23, s[28:31], s53 offen
  buffer_load_ushort v130, v23, s[28:31], s54 offen
  buffer_load_ushort v131, v23, s[28:31], s55 offen
  s_cmp_ge_u32 s60, 28
  s_cbranch_scc1 ng_227
  s_mov_b32 s28, s84
  s_mov_b32 s29, s85
  s_mov_b32 s30, 896
  s_mov_b32 s31, 0x20000
  s_lshl_b32 s34, s60, 5
  v_bfe_u32 v1, v0, 5, 1
  v_lshlrev_b32 v24, 3, v1
  s_mov_b32 exec_lo, 0x10000000
  s_mov_b32 exec_hi, 0x10000000
  buffer_load_ushort v36, v24, s[28:31], s34 offen offset:0
  buffer_load_ushort v37, v24, s[28:31], s34 offen offset:2
  buffer_load_ushort v38, v24, s[28:31], s34 offen offset:16
  buffer_load_ushort v39, v24, s[28:31], s34 offen offset:18
  buffer_load_ushort v40, v24, s[28:31], s34 offen offset:4
  buffer_load_ushort v41, v24, s[28:31], s34 offen offset:6
  buffer_load_ushort v42, v24, s[28:31], s34 offen offset:20
  buffer_load_ushort v43, v24, s[28:31], s34 offen offset:22
  buffer_load_ushort v44, v24, s[28:31], s34 offen offset:32
  buffer_load_ushort v45, v24, s[28:31], s34 offen offset:34
  buffer_load_ushort v46, v24, s[28:31], s34 offen offset:48
  buffer_load_ushort v47, v24, s[28:31], s34 offen offset:50
  buffer_load_ushort v48, v24, s[28:31], s34 offen offset:36
  buffer_load_ushort v49, v24, s[28:31], s34 offen offset:38
  buffer_load_ushort v50, v24, s[28:31], s34 offen offset:52
  buffer_load_ushort v51, v24, s[28:31], s34 offen offset:54
  s_mov_b64 exec, -1
  s_waitcnt vmcnt(0)
ng_227:
  s_waitcnt vmcnt(20)
  s_lshl_b32 s34, s60, 10
  s_add_u32 s35, s34, 56623104
  s_add_u32 s34, s34, 58720256
  v_swap_b32 v29, v30
  buffer_store_dwordx4 v[28:31], v3, s[12:15], s35 offen offset:0 sc1
  v_lshl_or_b32 v36, v37, 16, v36
  v_lshl_or_b32 v37, v39, 16, v38
  v_lshl_or_b32 v38, v41, 16, v40
  v_lshl_or_b32 v39, v43, 16, v42
  buffer_store_dwordx4 v[36:39], v3, s[12:15], s34 offen offset:0 sc1
  v_swap_b32 v33, v34
  buffer_store_dwordx4 v[32:35], v3, s[12:15], s35 offen offset:1024 sc1
  v_lshl_or_b32 v44, v45, 16, v44
  v_lshl_or_b32 v45, v47, 16, v46
  v_lshl_or_b32 v46, v49, 16, v48
  v_lshl_or_b32 v47, v51, 16, v50
  buffer_store_dwordx4 v[44:47], v3, s[12:15], s34 offen offset:1024 sc1
  s_mov_b32 s28, s64
  s_mov_b32 s29, s65
  s_mov_b32 s30, 1835008
  s_mov_b32 s31, 0x20000
  v_bfe_u32 v1, v0, 2, 2
  v_lshlrev_b32 v2, 3, v1
  v_bfe_u32 v1, v0, 0, 2
  v_lshl_add_u32 v2, v1, 0, v2
  v_mul_u32_u24 v2, 896, v2
  v_bfe_u32 v1, v0, 5, 1
  v_lshlrev_b32 v21, 5, v1
  v_bfe_u32 v1, v0, 4, 1
  v_lshl_add_u32 v21, v1, 3, v21
  v_add_u32 v21, v21, v2
  s_mul_i32 s34, s42, 2341
  s_lshr_b32 s34, s34, 16
  s_mul_i32 s35, s34, 28
  s_sub_u32 s35, s42, s35
  s_mul_i32 s36, s34, 28672
  s_cmp_ge_u32 s35, 14
  s_cselect_b32 s37, 2688, 0
  s_add_u32 s36, s36, s37
  s_lshl_b32 s37, s35, 6
  s_add_u32 s36, s36, s37
  buffer_load_dwordx2 v[132:133], v21, s[28:31], s36 offen offset:0
  buffer_load_dwordx2 v[134:135], v21, s[28:31], s36 offen offset:16
  buffer_load_dwordx2 v[136:137], v21, s[28:31], s36 offen offset:64
  buffer_load_dwordx2 v[138:139], v21, s[28:31], s36 offen offset:80
  s_cmp_ge_u32 s42, 1344
  s_cbranch_scc1 wof_228
  s_mov_b32 s28, s66
  s_mov_b32 s29, s67
  s_mov_b32 s30, 1204224
  s_mov_b32 s31, 0x20000
  s_mul_i32 s36, s34, 21846
  s_lshr_b32 s36, s36, 16
  s_mul_i32 s37, s36, 3
  s_sub_u32 s37, s34, s37
  s_mul_i32 s37, s37, 896
  s_mul_i32 s36, s36, 56
  s_add_u32 s37, s37, s36
  s_mul_i32 s36, s35, 43008
  s_add_u32 s37, s37, s36
  s_add_u32 s48, s37, 0
  s_add_u32 s49, s37, 2688
  s_add_u32 s50, s37, 21504
  s_add_u32 s51, s37, 24192
  s_add_u32 s52, s37, 5376
  s_add_u32 s53, s37, 8064
  s_add_u32 s54, s37, 26880
  s_add_u32 s55, s37, 29568
  v_bfe_u32 v1, v0, 5, 1
  v_lshlrev_b32 v2, 0, v1
  v_mul_u32_u24 v2, 10752, v2
  v_bfe_u32 v1, v0, 0, 5
  v_lshlrev_b32 v22, 1, v1
  v_cmp_lt_u32 vcc, 27, v1
  v_add_u32 v22, v22, v2
  v_mov_b32 v1, 0x40000000
  v_cndmask_b32 v22, v22, v1, vcc
  v_mov_b32 v23, v22
  s_mov_b32 s61, 43008
  s_branch j_229
wof_228:
  s_mov_b32 s28, s68
  s_mov_b32 s29, s69
  s_mov_b32 s30, 401408
  s_mov_b32 s31, 0x20000
  s_sub_u32 s34, s42, 1344
  s_and_b32 s36, s34, 15
  s_lshr_b32 s34, s34, 4
  s_lshl_b32 s34, s34, 5
  s_mul_i32 s36, s36, 25088
  s_add_u32 s37, s34, s36
  s_add_u32 s48, s37, 0
  s_add_u32 s49, s37, 896
  s_add_u32 s50, s37, 1792
  s_add_u32 s51, s37, 2688
  s_add_u32 s52, s37, 7168
  s_add_u32 s53, s37, 8064
  s_add_u32 s54, s37, 8960
  s_add_u32 s55, s37, 9856
  v_bfe_u32 v1, v0, 5, 1
  v_lshlrev_b32 v2, 4, v1
  v_bfe_u32 v1, v0, 4, 1
  v_lshl_add_u32 v2, v1, 2, v2
  v_mul_u32_u24 v2, 896, v2
  v_bfe_u32 v1, v0, 0, 4
  v_lshlrev_b32 v22, 1, v1
  v_add_u32 v22, v22, v2
  v_cmp_lt_u32 vcc, 47, v0
  v_mov_b32 v1, 0x40000000
  s_nop 0
  v_cndmask_b32 v23, v22, v1, vcc
  s_mov_b32 s61, 25088
j_229:
  buffer_load_ushort v140, v22, s[28:31], s48 offen
  s_add_u32 s48, s48, s61
  buffer_load_ushort v141, v22, s[28:31], s49 offen
  s_add_u32 s49, s49, s61
  buffer_load_ushort v142, v22, s[28:31], s50 offen
  s_add_u32 s50, s50, s61
  buffer_load_ushort v143, v22, s[28:31], s51 offen
  s_add_u32 s51, s51, s61
  buffer_load_ushort v144, v23, s[28:31], s52 offen
  s_add_u32 s52, s52, s61
  buffer_load_ushort v145, v23, s[28:31], s53 offen
  s_add_u32 s53, s53, s61
  buffer_load_ushort v146, v23, s[28:31], s54 offen
  s_add_u32 s54, s54, s61
  buffer_load_ushort v147, v23, s[28:31], s55 offen
  s_add_u32 s55, s55, s61
  buffer_load_ushort v148, v22, s[28:31], s48 offen
  buffer_load_ushort v149, v22, s[28:31], s49 offen
  buffer_load_ushort v150, v22, s[28:31], s50 offen
  buffer_load_ushort v151, v22, s[28:31], s51 offen
  buffer_load_ushort v152, v23, s[28:31], s52 offen
  buffer_load_ushort v153, v23, s[28:31], s53 offen
  buffer_load_ushort v154, v23, s[28:31], s54 offen
  buffer_load_ushort v155, v23, s[28:31], s55 offen
  s_cmp_ge_u32 s33, 28
  s_cbranch_scc1 ng_230
  s_mov_b32 s28, s84
  s_mov_b32 s29, s85
  s_mov_b32 s30, 896
  s_mov_b32 s31, 0x20000
  s_lshl_b32 s34, s33, 5
  v_bfe_u32 v1, v0, 5, 1
  v_lshlrev_b32 v24, 3, v1
  s_mov_b32 exec_lo, 0x10000000
  s_mov_b32 exec_hi, 0x10000000
  buffer_load_ushort v116, v24, s[28:31], s34 offen offset:0
  buffer_load_ushort v117, v24, s[28:31], s34 offen offset:2
  buffer_load_ushort v118, v24, s[28:31], s34 offen offset:16
  buffer_load_ushort v119, v24, s[28:31], s34 offen offset:18
  buffer_load_ushort v120, v24, s[28:31], s34 offen offset:4
  buffer_load_ushort v121, v24, s[28:31], s34 offen offset:6
  buffer_load_ushort v122, v24, s[28:31], s34 offen offset:20
  buffer_load_ushort v123, v24, s[28:31], s34 offen offset:22
  buffer_load_ushort v124, v24, s[28:31], s34 offen offset:32
  buffer_load_ushort v125, v24, s[28:31], s34 offen offset:34
  buffer_load_ushort v126, v24, s[28:31], s34 offen offset:48
  buffer_load_ushort v127, v24, s[28:31], s34 offen offset:50
  buffer_load_ushort v128, v24, s[28:31], s34 offen offset:36
  buffer_load_ushort v129, v24, s[28:31], s34 offen offset:38
  buffer_load_ushort v130, v24, s[28:31], s34 offen offset:52
  buffer_load_ushort v131, v24, s[28:31], s34 offen offset:54
  s_mov_b64 exec, -1
  s_waitcnt vmcnt(0)
ng_230:
  s_waitcnt vmcnt(24)
  s_lshl_b32 s34, s33, 10
  s_add_u32 s35, s34, 56623104
  s_add_u32 s34, s34, 58720256
  v_swap_b32 v109, v110
  buffer_store_dwordx4 v[108:111], v3, s[12:15], s35 offen offset:0 sc1
  v_lshl_or_b32 v116, v117, 16, v116
  v_lshl_or_b32 v117, v119, 16, v118
  v_lshl_or_b32 v118, v121, 16, v120
  v_lshl_or_b32 v119, v123, 16, v122
  buffer_store_dwordx4 v[116:119], v3, s[12:15], s34 offen offset:0 sc1
  v_swap_b32 v113, v114
  buffer_store_dwordx4 v[112:115], v3, s[12:15], s35 offen offset:1024 sc1
  v_lshl_or_b32 v124, v125, 16, v124
  v_lshl_or_b32 v125, v127, 16, v126
  v_lshl_or_b32 v126, v129, 16, v128
  v_lshl_or_b32 v127, v131, 16, v130
  buffer_store_dwordx4 v[124:127], v3, s[12:15], s34 offen offset:1024 sc1
  s_cmp_ge_u32 s42, 28
  s_cbranch_scc1 ng_231
  s_mov_b32 s28, s84
  s_mov_b32 s29, s85
  s_mov_b32 s30, 896
  s_mov_b32 s31, 0x20000
  s_lshl_b32 s34, s42, 5
  v_bfe_u32 v1, v0, 5, 1
  v_lshlrev_b32 v24, 3, v1
  s_mov_b32 exec_lo, 0x10000000
  s_mov_b32 exec_hi, 0x10000000
  buffer_load_ushort v140, v24, s[28:31], s34 offen offset:0
  buffer_load_ushort v141, v24, s[28:31], s34 offen offset:2
  buffer_load_ushort v142, v24, s[28:31], s34 offen offset:16
  buffer_load_ushort v143, v24, s[28:31], s34 offen offset:18
  buffer_load_ushort v144, v24, s[28:31], s34 offen offset:4
  buffer_load_ushort v145, v24, s[28:31], s34 offen offset:6
  buffer_load_ushort v146, v24, s[28:31], s34 offen offset:20
  buffer_load_ushort v147, v24, s[28:31], s34 offen offset:22
  buffer_load_ushort v148, v24, s[28:31], s34 offen offset:32
  buffer_load_ushort v149, v24, s[28:31], s34 offen offset:34
  buffer_load_ushort v150, v24, s[28:31], s34 offen offset:48
  buffer_load_ushort v151, v24, s[28:31], s34 offen offset:50
  buffer_load_ushort v152, v24, s[28:31], s34 offen offset:36
  buffer_load_ushort v153, v24, s[28:31], s34 offen offset:38
  buffer_load_ushort v154, v24, s[28:31], s34 offen offset:52
  buffer_load_ushort v155, v24, s[28:31], s34 offen offset:54
  s_mov_b64 exec, -1
  s_waitcnt vmcnt(0)
ng_231:
  s_waitcnt vmcnt(4)
  s_lshl_b32 s34, s42, 10
  s_add_u32 s35, s34, 56623104
  s_add_u32 s34, s34, 58720256
  v_swap_b32 v133, v134
  buffer_store_dwordx4 v[132:135], v3, s[12:15], s35 offen offset:0 sc1
  v_lshl_or_b32 v140, v141, 16, v140
  v_lshl_or_b32 v141, v143, 16, v142
  v_lshl_or_b32 v142, v145, 16, v144
  v_lshl_or_b32 v143, v147, 16, v146
  buffer_store_dwordx4 v[140:143], v3, s[12:15], s34 offen offset:0 sc1
  v_swap_b32 v137, v138
  buffer_store_dwordx4 v[136:139], v3, s[12:15], s35 offen offset:1024 sc1
  v_lshl_or_b32 v148, v149, 16, v148
  v_lshl_or_b32 v149, v151, 16, v150
  v_lshl_or_b32 v150, v153, 16, v152
  v_lshl_or_b32 v151, v155, 16, v154
  buffer_store_dwordx4 v[148:151], v3, s[12:15], s34 offen offset:1024 sc1
  s_cmp_ge_u32 s18, 32
  s_cbranch_scc1 al_232
  v_mov_b64 v[52:53], -1
  v_mov_b64 v[54:55], -1
  s_lshl_b32 s34, s18, 2
  s_add_u32 s34, s34, s17
  s_min_u32 s35, s34, 111
  s_mul_i32 s35, s35, 3072
  s_add_u32 s35, s35, 54181888
  buffer_store_dwordx4 v[52:55], v3, s[12:15], s35 offen offset:0 sc1
  buffer_store_dwordx4 v[52:55], v3, s[12:15], s35 offen offset:1024 sc1
  buffer_store_dwordx4 v[52:55], v3, s[12:15], s35 offen offset:2048 sc1
  s_and_b32 s35, s34, 15
  s_lshl_b32 s35, s35, 10
  s_add_u32 s35, s35, 55025664
  s_cmp_lt_u32 s34, 112
  s_cselect_b32 s35, 0x40000000, s35
  buffer_store_dwordx4 v[52:55], v3, s[12:15], s35 offen sc1
  s_min_u32 s34, s34, 119
  s_cmp_lt_u32 s34, 96
  s_mov_b32 s35, 70656000
  s_cselect_b32 s35, 70156288, s35
  s_lshl_b32 s34, s34, 10
  s_add_u32 s34, s34, s35
  buffer_store_dwordx4 v[52:55], v3, s[12:15], s34 offen sc1
al_232:
  s_mov_b32 s28, s64
  s_mov_b32 s29, s65
  s_mov_b32 s30, 1835008
  s_mov_b32 s31, 0x20000
  s_and_b32 s36, s17, 1
  s_lshr_b32 s37, s17, 1
  s_lshl_b32 s38, s18, 1
  s_add_u32 s38, s38, s36
  s_mul_i32 s35, s36, 28672
  s_mul_i32 s39, s37, 14336
  s_add_u32 m0, s35, s39
  s_mul_i32 s34, s38, 28672
  s_add_u32 s34, s34, s39
  buffer_load_dwordx4 v3, s[28:31], s34 offen offset:0 lds
  buffer_load_dwordx4 v3, s[28:31], s34 offen offset:1024 lds
  buffer_load_dwordx4 v3, s[28:31], s34 offen offset:2048 lds
  buffer_load_dwordx4 v3, s[28:31], s34 offen offset:3072 lds
  s_add_u32 s34, s34, 4096
  s_add_u32 m0, m0, 4096
  s_nop 0
  buffer_load_dwordx4 v3, s[28:31], s34 offen offset:0 lds
  buffer_load_dwordx4 v3, s[28:31], s34 offen offset:1024 lds
  buffer_load_dwordx4 v3, s[28:31], s34 offen offset:2048 lds
  buffer_load_dwordx4 v3, s[28:31], s34 offen offset:3072 lds
  s_add_u32 s34, s34, 4096
  s_add_u32 m0, m0, 4096
  s_nop 0
  buffer_load_dwordx4 v3, s[28:31], s34 offen offset:0 lds
  buffer_load_dwordx4 v3, s[28:31], s34 offen offset:1024 lds
  buffer_load_dwordx4 v3, s[28:31], s34 offen offset:2048 lds
  buffer_load_dwordx4 v3, s[28:31], s34 offen offset:3072 lds
  s_add_u32 s34, s34, 4096
  s_add_u32 m0, m0, 4096
  s_nop 0
  buffer_load_dwordx4 v3, s[28:31], s34 offen offset:0 lds
  buffer_load_dwordx4 v3, s[28:31], s34 offen offset:1024 lds
  v_bfe_u32 v1, v0, 3, 1
  v_lshlrev_b32 v25, 4, v1
  v_bfe_u32 v1, v0, 0, 2
  v_lshl_add_u32 v25, v1, 2, v25
  v_bfe_u32 v1, v0, 2, 1
  v_lshl_add_u32 v25, v1, 1, v25
  v_add_u32 v25, s37, v25
  v_mul_u32_u24 v25, 896, v25
  v_bfe_u32 v1, v0, 4, 1
  v_lshlrev_b32 v2, 6, v1
  v_bfe_u32 v1, v0, 5, 1
  v_lshl_add_u32 v2, v1, 4, v2
  v_add_u32 v25, v25, v2
  v_add_u32 v25, s35, v25
  v_bfe_u32 v1, v0, 4, 1
  v_lshlrev_b32 v2, 6, v1
  v_sub_u32 v26, v25, v2
  s_mul_i32 s34, s38, 32768
  s_lshl_b32 s39, s37, 14
  s_add_u32 s34, s34, s39
  s_add_u32 s34, s34, 13631488
  s_waitcnt vmcnt(0)
  s_barrier
  ds_read_b128 v[56:59], v25 offset:0
  ds_read_b128 v[60:63], v25 offset:224
  ds_read_b128 v[64:67], v25 offset:448
  ds_read_b128 v[68:71], v25 offset:672
  ds_read_b128 v[72:75], v25 offset:32
  ds_read_b128 v[76:79], v25 offset:256
  ds_read_b128 v[80:83], v25 offset:480
  ds_read_b128 v[84:87], v25 offset:704
  s_waitcnt lgkmcnt(7)
  buffer_store_dwordx4 v[56:59], v3, s[12:15], s34 offen offset:0 sc1
  ds_read_b128 v[88:91], v25 offset:128
  s_waitcnt lgkmcnt(7)
  buffer_store_dwordx4 v[60:63], v3, s[12:15], s34 offen offset:1024 sc1
  ds_read_b128 v[92:95], v25 offset:352
  s_waitcnt lgkmcnt(7)
  buffer_store_dwordx4 v[64:67], v3, s[12:15], s34 offen offset:2048 sc1
  ds_read_b128 v[96:99], v25 offset:576
  s_waitcnt lgkmcnt(7)
  buffer_store_dwordx4 v[68:71], v3, s[12:15], s34 offen offset:3072 sc1
  ds_read_b128 v[100:103], v25 offset:800
  s_add_u32 s34, s34, 4096
  s_waitcnt lgkmcnt(7)
  buffer_store_dwordx4 v[72:75], v3, s[12:15], s34 offen offset:0 sc1
  ds_read_b128 v[104:107], v26 offset:160
  s_waitcnt lgkmcnt(7)
  buffer_store_dwordx4 v[76:79], v3, s[12:15], s34 offen offset:1024 sc1
  ds_read_b128 v[108:111], v26 offset:384
  s_waitcnt lgkmcnt(7)
  buffer_store_dwordx4 v[80:83], v3, s[12:15], s34 offen offset:2048 sc1
  ds_read_b128 v[112:115], v26 offset:608
  s_waitcnt lgkmcnt(7)
  buffer_store_dwordx4 v[84:87], v3, s[12:15], s34 offen offset:3072 sc1
  ds_read_b128 v[116:119], v26 offset:832
  s_add_u32 s34, s34, 4096
  s_waitcnt lgkmcnt(7)
  buffer_store_dwordx4 v[88:91], v3, s[12:15], s34 offen offset:0 sc1
  s_waitcnt lgkmcnt(6)
  buffer_store_dwordx4 v[92:95], v3, s[12:15], s34 offen offset:1024 sc1
  s_waitcnt lgkmcnt(5)
  buffer_store_dwordx4 v[96:99], v3, s[12:15], s34 offen offset:2048 sc1
  s_waitcnt lgkmcnt(4)
  buffer_store_dwordx4 v[100:103], v3, s[12:15], s34 offen offset:3072 sc1
  s_add_u32 s34, s34, 4096
  s_waitcnt lgkmcnt(3)
  buffer_store_dwordx4 v[104:107], v3, s[12:15], s34 offen offset:0 sc1
  s_waitcnt lgkmcnt(2)
  buffer_store_dwordx4 v[108:111], v3, s[12:15], s34 offen offset:1024 sc1
  s_waitcnt lgkmcnt(1)
  buffer_store_dwordx4 v[112:115], v3, s[12:15], s34 offen offset:2048 sc1
  s_waitcnt lgkmcnt(0)
  buffer_store_dwordx4 v[116:119], v3, s[12:15], s34 offen offset:3072 sc1
tv_215:
  s_waitcnt vmcnt(0)
  s_barrier
  s_cmp_lg_u32 s17, 0
  s_cbranch_scc1 sg_234
  s_lshl_b32 s62, s16, 7
  s_add_u32 s62, s62, 46858240
  s_waitcnt lgkmcnt(0)
  s_mov_b32 s2, 2
  s_atomic_or s2, s[58:59], s62 glc
sg_234:
  s_branch te_214
tg_213:
  s_and_b32 s34, s32, 6
  s_cmp_eq_u32 s34, 6
  s_cselect_b32 s55, 1, 3
  s_bfe_u32 s19, s32, 0x40003
  s_mul_i32 s34, s19, 52
  s_lshr_b32 s34, s34, 8
  s_mul_i32 s34, s34, 5
  s_sub_u32 s34, s19, s34
  s_and_b32 s35, s32, 3
  s_add_u32 s35, s35, s34
  s_add_u32 s35, s35, 3
  s_cmp_ge_u32 s35, 7
  s_cselect_b32 s36, 7, 0
  s_sub_u32 s35, s35, s36
  s_bfe_u32 s36, s32, 0x10002
  s_and_b32 s37, s32, 7
  s_sub_u32 s37, s37, s35
  s_add_u32 s45, s19, 0
  s_mul_i32 s43, s45, 401408
  s_lshl_b32 s45, s45, 4
  s_add_u32 s45, s45, s35
  s_add_u32 s45, s45, s37
  s_lshr_b32 s37, s17, 1
  s_and_b32 s40, s17, 1
  s_mov_b32 s20, s74
  s_mov_b32 s21, s75
  s_mov_b32 s22, 3670016
  s_mov_b32 s23, 0x20000
  s_lshl_b32 s33, s35, 6
  s_lshl_b32 s39, s37, 5
  s_add_u32 s33, s33, s39
  s_lshl_b32 s39, s40, 1
  s_add_u32 s33, s33, s39
  s_lshl_b32 s33, s33, 13
  s_lshl_b32 s41, s19, 9
  s_add_u32 s33, s33, s41
  s_lshl_b32 s47, s17, 13
  v_xor_b32 v1, 0, v4
  s_add_u32 m0, s47, 0
  s_add_u32 s39, s33, 0
  buffer_load_dwordx4 v1, s[20:23], s39 offen lds
  v_xor_b32 v1, 32, v4
  s_add_u32 m0, s47, 1024
  s_add_u32 s39, s33, 65536
  buffer_load_dwordx4 v1, s[20:23], s39 offen lds
  v_xor_b32 v1, 64, v4
  s_add_u32 m0, s47, 2048
  s_add_u32 s39, s33, 32768
  buffer_load_dwordx4 v1, s[20:23], s39 offen lds
  v_xor_b32 v1, 96, v4
  s_add_u32 m0, s47, 3072
  s_add_u32 s39, s33, 98304
  buffer_load_dwordx4 v1, s[20:23], s39 offen lds
  v_xor_b32 v1, 128, v4
  s_add_u32 m0, s47, 4096
  s_add_u32 s39, s33, 131072
  buffer_load_dwordx4 v1, s[20:23], s39 offen lds
  v_xor_b32 v1, 160, v4
  s_add_u32 m0, s47, 5120
  s_add_u32 s39, s33, 196608
  buffer_load_dwordx4 v1, s[20:23], s39 offen lds
  v_xor_b32 v1, 192, v4
  s_add_u32 m0, s47, 6144
  s_add_u32 s39, s33, 163840
  buffer_load_dwordx4 v1, s[20:23], s39 offen lds
  v_xor_b32 v1, 224, v4
  s_add_u32 m0, s47, 7168
  s_add_u32 s39, s33, 229376
  buffer_load_dwordx4 v1, s[20:23], s39 offen lds
  s_mov_b32 s24, s76
  s_mov_b32 s25, s77
  s_mov_b32 s26, 3670016
  s_mov_b32 s27, 0x20000
  s_lshl_b32 s38, s36, 1
  s_add_u32 s38, s38, s37
  s_mul_i32 s39, s38, 100352
  s_add_u32 s43, s43, s39
  s_lshl_b32 s39, s35, 1
  s_add_u32 s39, s39, s40
  s_lshl_b32 s39, s39, 10
  s_add_u32 s43, s43, s39
  s_waitcnt vmcnt(8)
  s_cmp_lg_u32 s17, 0
  s_cbranch_scc1 ok_236
  v_cmp_gt_u32 vcc, 16, v247
  s_cbranch_vccz ok_236
  s_mov_b32 s23, 300000
  v_mov_b32 v1, 0
w0l_237:
  global_load_dword v2, v1, s[56:57] offset:132 sc1
  s_waitcnt vmcnt(0)
  v_cmp_gt_u32 vcc, 16, v2
  s_cbranch_vccz w0d_238
  s_sleep 4
  s_sub_u32 s23, s23, 1
  s_cbranch_scc0 w0l_237
  s_branch L_exit
w0d_238:
ok_236:
  s_waitcnt vmcnt(8)
  s_barrier
  s_cmp_lg_u32 s17, 0
  s_cbranch_scc1 sg_240
  s_lshl_b32 s62, s16, 7
  s_add_u32 s62, s62, 46858240
  s_waitcnt lgkmcnt(0)
  s_mov_b32 s2, s55
  s_atomic_or s2, s[58:59], s62 glc
sg_240:
  s_mul_i32 s42, s38, 112
  s_lshl_b32 s42, s42, 13
  s_add_u32 s42, s42, s41
  s_mul_i32 s47, s37, 57344
  s_add_u32 s47, s47, 32768
  s_lshl_b32 s39, s40, 12
  s_add_u32 s47, s47, s39
  s_lshl_b32 s39, s40, 16
  s_add_u32 s33, s42, s39
  s_add_u32 s42, s33, s39
  s_add_u32 m0, s47, 0
  s_add_u32 s44, s42, 0
  buffer_load_dwordx4 v204, s[24:27], s44 offen lds
  s_add_u32 m0, s47, 1024
  s_add_u32 s44, s42, 32768
  buffer_load_dwordx4 v205, s[24:27], s44 offen lds
  s_add_u32 m0, s47, 2048
  s_add_u32 s44, s42, 65536
  buffer_load_dwordx4 v206, s[24:27], s44 offen lds
  s_add_u32 m0, s47, 3072
  s_add_u32 s44, s42, 98304
  buffer_load_dwordx4 v207, s[24:27], s44 offen lds
  s_add_u32 m0, s47, 8192
  s_add_u32 s44, s42, 16384
  buffer_load_dwordx4 v204, s[24:27], s44 offen lds
  s_add_u32 m0, s47, 9216
  s_add_u32 s44, s42, 49152
  buffer_load_dwordx4 v205, s[24:27], s44 offen lds
  s_add_u32 m0, s47, 10240
  s_add_u32 s44, s42, 81920
  buffer_load_dwordx4 v206, s[24:27], s44 offen lds
  s_add_u32 m0, s47, 11264
  s_add_u32 s44, s42, 114688
  buffer_load_dwordx4 v207, s[24:27], s44 offen lds
  s_add_u32 m0, s47, 16384
  s_add_u32 s44, s42, 262144
  buffer_load_dwordx4 v204, s[24:27], s44 offen lds
  s_add_u32 m0, s47, 17408
  s_add_u32 s44, s42, 294912
  buffer_load_dwordx4 v205, s[24:27], s44 offen lds
  s_add_u32 m0, s47, 18432
  s_add_u32 s44, s42, 327680
  buffer_load_dwordx4 v206, s[24:27], s44 offen lds
  s_add_u32 m0, s47, 19456
  s_add_u32 s44, s42, 360448
  buffer_load_dwordx4 v207, s[24:27], s44 offen lds
  s_add_u32 m0, s47, 24576
  s_add_u32 s44, s42, 278528
  buffer_load_dwordx4 v204, s[24:27], s44 offen lds
  s_add_u32 m0, s47, 25600
  s_add_u32 s44, s42, 311296
  buffer_load_dwordx4 v205, s[24:27], s44 offen lds
  s_add_u32 m0, s47, 26624
  s_add_u32 s44, s42, 344064
  buffer_load_dwordx4 v206, s[24:27], s44 offen lds
  s_add_u32 m0, s47, 27648
  s_add_u32 s44, s42, 376832
  buffer_load_dwordx4 v207, s[24:27], s44 offen lds
  s_waitcnt vmcnt(8)
  s_barrier
  ds_read_b128 v[108:111], v6 offset:0
  ds_read_b128 v[112:115], v6 offset:8192
  ds_read_b128 v[172:175], v200 offset:0
  ds_read_b128 v[116:119], v7 offset:0
  ds_read_b128 v[120:123], v7 offset:8192
  ds_read_b128 v[176:179], v201 offset:0
  ds_read_b128 v[124:127], v8 offset:0
  ds_read_b128 v[128:131], v8 offset:8192
  ds_read_b128 v[180:183], v202 offset:0
  ds_read_b128 v[132:135], v9 offset:0
  ds_read_b128 v[136:139], v9 offset:8192
  ds_read_b128 v[184:187], v203 offset:0
  s_waitcnt lgkmcnt(9)
  v_mfma_f32_16x16x32_bf16 v[52:55], v[108:111], v[172:175], 0
  ds_read_b128 v[140:143], v6 offset:256
  ds_read_b128 v[144:147], v6 offset:8448
  ds_read_b128 v[188:191], v200 offset:256
  v_mfma_f32_16x16x32_bf16 v[56:59], v[112:115], v[172:175], 0
  s_waitcnt lgkmcnt(9)
  v_mfma_f32_16x16x32_bf16 v[52:55], v[116:119], v[176:179], v[52:55]
  ds_read_b128 v[148:151], v7 offset:256
  ds_read_b128 v[152:155], v7 offset:8448
  ds_read_b128 v[192:195], v201 offset:256
  v_mfma_f32_16x16x32_bf16 v[56:59], v[120:123], v[176:179], v[56:59]
  s_add_u32 m0, s47, 32768
  s_add_u32 s44, s42, 524288
  buffer_load_dwordx4 v204, s[24:27], s44 offen lds
  s_waitcnt lgkmcnt(9)
  v_mfma_f32_16x16x32_bf16 v[52:55], v[124:127], v[180:183], v[52:55]
  ds_read_b128 v[156:159], v8 offset:256
  ds_read_b128 v[160:163], v8 offset:8448
  ds_read_b128 v[172:175], v202 offset:256
  v_mfma_f32_16x16x32_bf16 v[56:59], v[128:131], v[180:183], v[56:59]
  s_waitcnt lgkmcnt(9)
  v_mfma_f32_16x16x32_bf16 v[52:55], v[132:135], v[184:187], v[52:55]
  ds_read_b128 v[164:167], v9 offset:256
  ds_read_b128 v[168:171], v9 offset:8448
  ds_read_b128 v[176:179], v203 offset:256
  v_mfma_f32_16x16x32_bf16 v[56:59], v[136:139], v[184:187], v[56:59]
  s_add_u32 m0, s47, 33792
  s_add_u32 s44, s42, 557056
  buffer_load_dwordx4 v205, s[24:27], s44 offen lds
  s_waitcnt lgkmcnt(9)
  v_mfma_f32_16x16x32_bf16 v[52:55], v[140:143], v[188:191], v[52:55]
  ds_read_b128 v[180:183], v200 offset:8192
  v_mfma_f32_16x16x32_bf16 v[56:59], v[144:147], v[188:191], v[56:59]
  s_waitcnt lgkmcnt(7)
  v_mfma_f32_16x16x32_bf16 v[52:55], v[148:151], v[192:195], v[52:55]
  ds_read_b128 v[184:187], v201 offset:8192
  v_mfma_f32_16x16x32_bf16 v[56:59], v[152:155], v[192:195], v[56:59]
  s_add_u32 m0, s47, 34816
  s_add_u32 s44, s42, 589824
  buffer_load_dwordx4 v206, s[24:27], s44 offen lds
  s_waitcnt lgkmcnt(5)
  v_mfma_f32_16x16x32_bf16 v[52:55], v[156:159], v[172:175], v[52:55]
  ds_read_b128 v[188:191], v202 offset:8192
  v_mfma_f32_16x16x32_bf16 v[56:59], v[160:163], v[172:175], v[56:59]
  s_waitcnt lgkmcnt(3)
  v_mfma_f32_16x16x32_bf16 v[52:55], v[164:167], v[176:179], v[52:55]
  ds_read_b128 v[192:195], v203 offset:8192
  v_mfma_f32_16x16x32_bf16 v[56:59], v[168:171], v[176:179], v[56:59]
  s_add_u32 m0, s47, 35840
  s_add_u32 s44, s42, 622592
  buffer_load_dwordx4 v207, s[24:27], s44 offen lds
  s_waitcnt lgkmcnt(3)
  v_mfma_f32_16x16x32_bf16 v[60:63], v[108:111], v[180:183], 0
  ds_read_b128 v[172:175], v200 offset:8448
  v_mfma_f32_16x16x32_bf16 v[64:67], v[112:115], v[180:183], 0
  s_waitcnt lgkmcnt(3)
  v_mfma_f32_16x16x32_bf16 v[60:63], v[116:119], v[184:187], v[60:63]
  ds_read_b128 v[176:179], v201 offset:8448
  v_mfma_f32_16x16x32_bf16 v[64:67], v[120:123], v[184:187], v[64:67]
  s_add_u32 m0, s47, 40960
  s_add_u32 s44, s42, 540672
  buffer_load_dwordx4 v204, s[24:27], s44 offen lds
  s_waitcnt lgkmcnt(3)
  v_mfma_f32_16x16x32_bf16 v[60:63], v[124:127], v[188:191], v[60:63]
  ds_read_b128 v[180:183], v202 offset:8448
  v_mfma_f32_16x16x32_bf16 v[64:67], v[128:131], v[188:191], v[64:67]
  s_waitcnt lgkmcnt(3)
  v_mfma_f32_16x16x32_bf16 v[60:63], v[132:135], v[192:195], v[60:63]
  ds_read_b128 v[184:187], v203 offset:8448
  v_mfma_f32_16x16x32_bf16 v[64:67], v[136:139], v[192:195], v[64:67]
  s_add_u32 m0, s47, 41984
  s_add_u32 s44, s42, 573440
  buffer_load_dwordx4 v205, s[24:27], s44 offen lds
  s_waitcnt lgkmcnt(3)
  v_mfma_f32_16x16x32_bf16 v[60:63], v[140:143], v[172:175], v[60:63]
  v_mfma_f32_16x16x32_bf16 v[64:67], v[144:147], v[172:175], v[64:67]
  s_waitcnt lgkmcnt(2)
  v_mfma_f32_16x16x32_bf16 v[60:63], v[148:151], v[176:179], v[60:63]
  v_mfma_f32_16x16x32_bf16 v[64:67], v[152:155], v[176:179], v[64:67]
  s_add_u32 m0, s47, 43008
  s_add_u32 s44, s42, 606208
  buffer_load_dwordx4 v206, s[24:27], s44 offen lds
  s_waitcnt lgkmcnt(1)
  v_mfma_f32_16x16x32_bf16 v[60:63], v[156:159], v[180:183], v[60:63]
  v_mfma_f32_16x16x32_bf16 v[64:67], v[160:163], v[180:183], v[64:67]
  s_waitcnt lgkmcnt(0)
  v_mfma_f32_16x16x32_bf16 v[60:63], v[164:167], v[184:187], v[60:63]
  v_mfma_f32_16x16x32_bf16 v[64:67], v[168:171], v[184:187], v[64:67]
  s_add_u32 m0, s47, 44032
  s_add_u32 s44, s42, 638976
  buffer_load_dwordx4 v207, s[24:27], s44 offen lds
  s_waitcnt vmcnt(8)
  s_barrier
  ds_read_b128 v[188:191], v200 offset:16384
  ds_read_b128 v[192:195], v201 offset:16384
  ds_read_b128 v[172:175], v202 offset:16384
  ds_read_b128 v[176:179], v203 offset:16384
  s_waitcnt lgkmcnt(3)
  v_mfma_f32_16x16x32_bf16 v[68:71], v[108:111], v[188:191], 0
  ds_read_b128 v[180:183], v200 offset:16640
  v_mfma_f32_16x16x32_bf16 v[72:75], v[112:115], v[188:191], 0
  s_waitcnt lgkmcnt(3)
  v_mfma_f32_16x16x32_bf16 v[68:71], v[116:119], v[192:195], v[68:71]
  ds_read_b128 v[184:187], v201 offset:16640
  v_mfma_f32_16x16x32_bf16 v[72:75], v[120:123], v[192:195], v[72:75]
  s_add_u32 m0, s47, 49152
  s_add_u32 s44, s33, 786432
  buffer_load_dwordx4 v204, s[24:27], s44 offen lds
  s_waitcnt lgkmcnt(3)
  v_mfma_f32_16x16x32_bf16 v[68:71], v[124:127], v[172:175], v[68:71]
  ds_read_b128 v[188:191], v202 offset:16640
  v_mfma_f32_16x16x32_bf16 v[72:75], v[128:131], v[172:175], v[72:75]
  s_waitcnt lgkmcnt(3)
  v_mfma_f32_16x16x32_bf16 v[68:71], v[132:135], v[176:179], v[68:71]
  ds_read_b128 v[192:195], v203 offset:16640
  v_mfma_f32_16x16x32_bf16 v[72:75], v[136:139], v[176:179], v[72:75]
  s_add_u32 m0, s47, 50176
  s_add_u32 s44, s33, 802816
  buffer_load_dwordx4 v205, s[24:27], s44 offen lds
  s_waitcnt lgkmcnt(3)
  v_mfma_f32_16x16x32_bf16 v[68:71], v[140:143], v[180:183], v[68:71]
  ds_read_b128 v[172:175], v200 offset:24576
  v_mfma_f32_16x16x32_bf16 v[72:75], v[144:147], v[180:183], v[72:75]
  s_waitcnt lgkmcnt(3)
  v_mfma_f32_16x16x32_bf16 v[68:71], v[148:151], v[184:187], v[68:71]
  ds_read_b128 v[176:179], v201 offset:24576
  v_mfma_f32_16x16x32_bf16 v[72:75], v[152:155], v[184:187], v[72:75]
  s_add_u32 m0, s47, 51200
  s_add_u32 s44, s33, 819200
  buffer_load_dwordx4 v206, s[24:27], s44 offen lds
  s_waitcnt lgkmcnt(3)
  v_mfma_f32_16x16x32_bf16 v[68:71], v[156:159], v[188:191], v[68:71]
  ds_read_b128 v[180:183], v202 offset:24576
  v_mfma_f32_16x16x32_bf16 v[72:75], v[160:163], v[188:191], v[72:75]
  s_waitcnt lgkmcnt(3)
  v_mfma_f32_16x16x32_bf16 v[68:71], v[164:167], v[192:195], v[68:71]
  ds_read_b128 v[184:187], v203 offset:24576
  v_mfma_f32_16x16x32_bf16 v[72:75], v[168:171], v[192:195], v[72:75]
  s_add_u32 m0, s47, 52224
  s_add_u32 s44, s33, 835584
  buffer_load_dwordx4 v207, s[24:27], s44 offen lds
  s_waitcnt lgkmcnt(3)
  v_mfma_f32_16x16x32_bf16 v[76:79], v[108:111], v[172:175], 0
  ds_read_b128 v[188:191], v200 offset:24832
  v_mfma_f32_16x16x32_bf16 v[80:83], v[112:115], v[172:175], 0
  s_waitcnt lgkmcnt(3)
  v_mfma_f32_16x16x32_bf16 v[76:79], v[116:119], v[176:179], v[76:79]
  ds_read_b128 v[192:195], v201 offset:24832
  v_mfma_f32_16x16x32_bf16 v[80:83], v[120:123], v[176:179], v[80:83]
  s_waitcnt lgkmcnt(3)
  v_mfma_f32_16x16x32_bf16 v[76:79], v[124:127], v[180:183], v[76:79]
  ds_read_b128 v[172:175], v202 offset:24832
  v_mfma_f32_16x16x32_bf16 v[80:83], v[128:131], v[180:183], v[80:83]
  s_waitcnt lgkmcnt(3)
  v_mfma_f32_16x16x32_bf16 v[76:79], v[132:135], v[184:187], v[76:79]
  ds_read_b128 v[176:179], v203 offset:24832
  v_mfma_f32_16x16x32_bf16 v[80:83], v[136:139], v[184:187], v[80:83]
  s_waitcnt lgkmcnt(3)
  v_mfma_f32_16x16x32_bf16 v[76:79], v[140:143], v[188:191], v[76:79]
  v_mfma_f32_16x16x32_bf16 v[80:83], v[144:147], v[188:191], v[80:83]
  s_waitcnt lgkmcnt(2)
  v_mfma_f32_16x16x32_bf16 v[76:79], v[148:151], v[192:195], v[76:79]
  v_mfma_f32_16x16x32_bf16 v[80:83], v[152:155], v[192:195], v[80:83]
  s_waitcnt lgkmcnt(1)
  v_mfma_f32_16x16x32_bf16 v[76:79], v[156:159], v[172:175], v[76:79]
  v_mfma_f32_16x16x32_bf16 v[80:83], v[160:163], v[172:175], v[80:83]
  s_waitcnt lgkmcnt(0)
  v_mfma_f32_16x16x32_bf16 v[76:79], v[164:167], v[176:179], v[76:79]
  v_mfma_f32_16x16x32_bf16 v[80:83], v[168:171], v[176:179], v[80:83]
  s_waitcnt vmcnt(4)
  s_barrier
  ds_read_b128 v[180:183], v200 offset:32768
  ds_read_b128 v[184:187], v201 offset:32768
  ds_read_b128 v[188:191], v202 offset:32768
  ds_read_b128 v[192:195], v203 offset:32768
  s_waitcnt lgkmcnt(3)
  v_mfma_f32_16x16x32_bf16 v[84:87], v[108:111], v[180:183], 0
  ds_read_b128 v[172:175], v200 offset:33024
  v_mfma_f32_16x16x32_bf16 v[88:91], v[112:115], v[180:183], 0
  s_waitcnt lgkmcnt(3)
  v_mfma_f32_16x16x32_bf16 v[84:87], v[116:119], v[184:187], v[84:87]
  ds_read_b128 v[176:179], v201 offset:33024
  v_mfma_f32_16x16x32_bf16 v[88:91], v[120:123], v[184:187], v[88:91]
  s_waitcnt lgkmcnt(3)
  v_mfma_f32_16x16x32_bf16 v[84:87], v[124:127], v[188:191], v[84:87]
  ds_read_b128 v[180:183], v202 offset:33024
  v_mfma_f32_16x16x32_bf16 v[88:91], v[128:131], v[188:191], v[88:91]
  s_waitcnt lgkmcnt(3)
  v_mfma_f32_16x16x32_bf16 v[84:87], v[132:135], v[192:195], v[84:87]
  ds_read_b128 v[184:187], v203 offset:33024
  v_mfma_f32_16x16x32_bf16 v[88:91], v[136:139], v[192:195], v[88:91]
  s_waitcnt lgkmcnt(3)
  v_mfma_f32_16x16x32_bf16 v[84:87], v[140:143], v[172:175], v[84:87]
  ds_read_b128 v[188:191], v200 offset:40960
  v_mfma_f32_16x16x32_bf16 v[88:91], v[144:147], v[172:175], v[88:91]
  s_waitcnt lgkmcnt(3)
  v_mfma_f32_16x16x32_bf16 v[84:87], v[148:151], v[176:179], v[84:87]
  ds_read_b128 v[192:195], v201 offset:40960
  v_mfma_f32_16x16x32_bf16 v[88:91], v[152:155], v[176:179], v[88:91]
  s_waitcnt lgkmcnt(3)
  v_mfma_f32_16x16x32_bf16 v[84:87], v[156:159], v[180:183], v[84:87]
  ds_read_b128 v[172:175], v202 offset:40960
  v_mfma_f32_16x16x32_bf16 v[88:91], v[160:163], v[180:183], v[88:91]
  s_waitcnt lgkmcnt(3)
  v_mfma_f32_16x16x32_bf16 v[84:87], v[164:167], v[184:187], v[84:87]
  ds_read_b128 v[176:179], v203 offset:40960
  v_mfma_f32_16x16x32_bf16 v[88:91], v[168:171], v[184:187], v[88:91]
  s_waitcnt lgkmcnt(3)
  v_mfma_f32_16x16x32_bf16 v[92:95], v[108:111], v[188:191], 0
  ds_read_b128 v[180:183], v200 offset:41216
  v_mfma_f32_16x16x32_bf16 v[96:99], v[112:115], v[188:191], 0
  s_waitcnt lgkmcnt(3)
  v_mfma_f32_16x16x32_bf16 v[92:95], v[116:119], v[192:195], v[92:95]
  ds_read_b128 v[184:187], v201 offset:41216
  v_mfma_f32_16x16x32_bf16 v[96:99], v[120:123], v[192:195], v[96:99]
  s_waitcnt lgkmcnt(3)
  v_mfma_f32_16x16x32_bf16 v[92:95], v[124:127], v[172:175], v[92:95]
  ds_read_b128 v[188:191], v202 offset:41216
  v_mfma_f32_16x16x32_bf16 v[96:99], v[128:131], v[172:175], v[96:99]
  s_waitcnt lgkmcnt(3)
  v_mfma_f32_16x16x32_bf16 v[92:95], v[132:135], v[176:179], v[92:95]
  ds_read_b128 v[192:195], v203 offset:41216
  v_mfma_f32_16x16x32_bf16 v[96:99], v[136:139], v[176:179], v[96:99]
  s_waitcnt lgkmcnt(3)
  v_mfma_f32_16x16x32_bf16 v[92:95], v[140:143], v[180:183], v[92:95]
  v_mfma_f32_16x16x32_bf16 v[96:99], v[144:147], v[180:183], v[96:99]
  s_waitcnt lgkmcnt(2)
  v_mfma_f32_16x16x32_bf16 v[92:95], v[148:151], v[184:187], v[92:95]
  v_mfma_f32_16x16x32_bf16 v[96:99], v[152:155], v[184:187], v[96:99]
  s_waitcnt lgkmcnt(1)
  v_mfma_f32_16x16x32_bf16 v[92:95], v[156:159], v[188:191], v[92:95]
  v_mfma_f32_16x16x32_bf16 v[96:99], v[160:163], v[188:191], v[96:99]
  s_waitcnt lgkmcnt(0)
  v_mfma_f32_16x16x32_bf16 v[92:95], v[164:167], v[192:195], v[92:95]
  v_mfma_f32_16x16x32_bf16 v[96:99], v[168:171], v[192:195], v[96:99]
  s_waitcnt vmcnt(0)
  s_barrier
  ds_read_b128 v[172:175], v200 offset:49152
  ds_read_b128 v[176:179], v201 offset:49152
  ds_read_b128 v[180:183], v202 offset:49152
  ds_read_b128 v[184:187], v203 offset:49152
  s_waitcnt lgkmcnt(3)
  v_mfma_f32_16x16x32_bf16 v[100:103], v[108:111], v[172:175], 0
  ds_read_b128 v[188:191], v200 offset:49408
  v_mfma_f32_16x16x32_bf16 v[104:107], v[112:115], v[172:175], 0
  s_waitcnt lgkmcnt(3)
  v_mfma_f32_16x16x32_bf16 v[100:103], v[116:119], v[176:179], v[100:103]
  ds_read_b128 v[192:195], v201 offset:49408
  v_mfma_f32_16x16x32_bf16 v[104:107], v[120:123], v[176:179], v[104:107]
  s_waitcnt lgkmcnt(3)
  v_mfma_f32_16x16x32_bf16 v[100:103], v[124:127], v[180:183], v[100:103]
  ds_read_b128 v[172:175], v202 offset:49408
  v_mfma_f32_16x16x32_bf16 v[104:107], v[128:131], v[180:183], v[104:107]
  s_waitcnt lgkmcnt(3)
  v_mfma_f32_16x16x32_bf16 v[100:103], v[132:135], v[184:187], v[100:103]
  ds_read_b128 v[176:179], v203 offset:49408
  v_mfma_f32_16x16x32_bf16 v[104:107], v[136:139], v[184:187], v[104:107]
  s_waitcnt lgkmcnt(3)
  v_mfma_f32_16x16x32_bf16 v[100:103], v[140:143], v[188:191], v[100:103]
  v_mfma_f32_16x16x32_bf16 v[104:107], v[144:147], v[188:191], v[104:107]
  s_waitcnt lgkmcnt(2)
  v_mfma_f32_16x16x32_bf16 v[100:103], v[148:151], v[192:195], v[100:103]
  v_mfma_f32_16x16x32_bf16 v[104:107], v[152:155], v[192:195], v[104:107]
  s_waitcnt lgkmcnt(1)
  v_mfma_f32_16x16x32_bf16 v[100:103], v[156:159], v[172:175], v[100:103]
  v_mfma_f32_16x16x32_bf16 v[104:107], v[160:163], v[172:175], v[104:107]
  s_waitcnt lgkmcnt(0)
  v_mfma_f32_16x16x32_bf16 v[100:103], v[164:167], v[176:179], v[100:103]
  v_mfma_f32_16x16x32_bf16 v[104:107], v[168:171], v[176:179], v[104:107]
  s_mov_b32 s44, 0x3db8aa3b
  v_mul_f32 v52, s44, v52
  v_mul_f32 v53, s44, v53
  v_mul_f32 v54, s44, v54
  v_mul_f32 v55, s44, v55
  v_mul_f32 v56, s44, v56
  v_mul_f32 v57, s44, v57
  v_mul_f32 v58, s44, v58
  v_mul_f32 v59, s44, v59
  v_cvt_pk_bf16_f32 v52, v52, v53
  v_cvt_pk_bf16_f32 v53, v54, v55
  v_cvt_pk_bf16_f32 v54, v56, v57
  v_cvt_pk_bf16_f32 v55, v58, v59
  buffer_store_dwordx4 v[52:55], v3, s[12:15], s43 offen sc1
  s_add_u32 s43, s43, 14336
  v_mul_f32 v60, s44, v60
  v_mul_f32 v61, s44, v61
  v_mul_f32 v62, s44, v62
  v_mul_f32 v63, s44, v63
  v_mul_f32 v64, s44, v64
  v_mul_f32 v65, s44, v65
  v_mul_f32 v66, s44, v66
  v_mul_f32 v67, s44, v67
  v_cvt_pk_bf16_f32 v60, v60, v61
  v_cvt_pk_bf16_f32 v61, v62, v63
  v_cvt_pk_bf16_f32 v62, v64, v65
  v_cvt_pk_bf16_f32 v63, v66, v67
  buffer_store_dwordx4 v[60:63], v3, s[12:15], s43 offen sc1
  s_add_u32 s43, s43, 14336
  v_mul_f32 v68, s44, v68
  v_mul_f32 v69, s44, v69
  v_mul_f32 v70, s44, v70
  v_mul_f32 v71, s44, v71
  v_mul_f32 v72, s44, v72
  v_mul_f32 v73, s44, v73
  v_mul_f32 v74, s44, v74
  v_mul_f32 v75, s44, v75
  v_cvt_pk_bf16_f32 v68, v68, v69
  v_cvt_pk_bf16_f32 v69, v70, v71
  v_cvt_pk_bf16_f32 v70, v72, v73
  v_cvt_pk_bf16_f32 v71, v74, v75
  buffer_store_dwordx4 v[68:71], v3, s[12:15], s43 offen sc1
  s_add_u32 s43, s43, 14336
  v_mul_f32 v76, s44, v76
  v_mul_f32 v77, s44, v77
  v_mul_f32 v78, s44, v78
  v_mul_f32 v79, s44, v79
  v_mul_f32 v80, s44, v80
  v_mul_f32 v81, s44, v81
  v_mul_f32 v82, s44, v82
  v_mul_f32 v83, s44, v83
  v_cvt_pk_bf16_f32 v76, v76, v77
  v_cvt_pk_bf16_f32 v77, v78, v79
  v_cvt_pk_bf16_f32 v78, v80, v81
  v_cvt_pk_bf16_f32 v79, v82, v83
  buffer_store_dwordx4 v[76:79], v3, s[12:15], s43 offen sc1
  s_add_u32 s43, s43, 14336
  v_mul_f32 v84, s44, v84
  v_mul_f32 v85, s44, v85
  v_mul_f32 v86, s44, v86
  v_mul_f32 v87, s44, v87
  v_mul_f32 v88, s44, v88
  v_mul_f32 v89, s44, v89
  v_mul_f32 v90, s44, v90
  v_mul_f32 v91, s44, v91
  v_cvt_pk_bf16_f32 v84, v84, v85
  v_cvt_pk_bf16_f32 v85, v86, v87
  v_cvt_pk_bf16_f32 v86, v88, v89
  v_cvt_pk_bf16_f32 v87, v90, v91
  buffer_store_dwordx4 v[84:87], v3, s[12:15], s43 offen sc1
  s_add_u32 s43, s43, 14336
  v_mul_f32 v92, s44, v92
  v_mul_f32 v93, s44, v93
  v_mul_f32 v94, s44, v94
  v_mul_f32 v95, s44, v95
  v_mul_f32 v96, s44, v96
  v_mul_f32 v97, s44, v97
  v_mul_f32 v98, s44, v98
  v_mul_f32 v99, s44, v99
  v_cvt_pk_bf16_f32 v92, v92, v93
  v_cvt_pk_bf16_f32 v93, v94, v95
  v_cvt_pk_bf16_f32 v94, v96, v97
  v_cvt_pk_bf16_f32 v95, v98, v99
  buffer_store_dwordx4 v[92:95], v3, s[12:15], s43 offen sc1
  s_add_u32 s43, s43, 14336
  v_mul_f32 v100, s44, v100
  v_mul_f32 v101, s44, v101
  v_mul_f32 v102, s44, v102
  v_mul_f32 v103, s44, v103
  v_mul_f32 v104, s44, v104
  v_mul_f32 v105, s44, v105
  v_mul_f32 v106, s44, v106
  v_mul_f32 v107, s44, v107
  v_cvt_pk_bf16_f32 v100, v100, v101
  v_cvt_pk_bf16_f32 v101, v102, v103
  v_cvt_pk_bf16_f32 v102, v104, v105
  v_cvt_pk_bf16_f32 v103, v106, v107
  buffer_store_dwordx4 v[100:103], v3, s[12:15], s43 offen sc1
  s_waitcnt vmcnt(0)
  s_barrier
  s_cmp_lg_u32 s17, 0
  s_cbranch_scc1 sg_242
  s_lshl_b32 s62, s45, 7
  s_add_u32 s62, s62, 46858240
  s_waitcnt lgkmcnt(0)
  s_mov_b32 s2, 1
  s_atomic_or s2, s[58:59], s62 glc
sg_242:
  s_cmp_eq_u32 s55, 1
  s_cbranch_scc1 tg_235
  s_lshr_b32 s19, s32, 3
  s_and_b32 s37, s32, 7
  s_mul_i32 s34, s19, 52
  s_lshr_b32 s34, s34, 8
  s_mul_i32 s34, s34, 5
  s_sub_u32 s34, s19, s34
  s_cmp_ge_u32 s37, 3
  s_cselect_b32 s36, 1, 0
  s_cselect_b32 s35, 3, 0
  s_sub_u32 s35, s37, s35
  s_add_u32 s35, s35, s34
  s_add_u32 s37, s37, 8
  s_sub_u32 s37, s37, s35
  s_add_u32 s45, s19, 0
  s_mul_i32 s43, s45, 401408
  s_lshl_b32 s45, s45, 4
  s_add_u32 s45, s45, s35
  s_add_u32 s45, s45, s37
  s_lshr_b32 s37, s17, 1
  s_and_b32 s40, s17, 1
  s_mov_b32 s20, s74
  s_mov_b32 s21, s75
  s_mov_b32 s22, 3670016
  s_mov_b32 s23, 0x20000
  s_lshl_b32 s33, s35, 6
  s_lshl_b32 s39, s37, 5
  s_add_u32 s33, s33, s39
  s_lshl_b32 s39, s40, 1
  s_add_u32 s33, s33, s39
  s_lshl_b32 s33, s33, 13
  s_lshl_b32 s41, s19, 9
  s_add_u32 s33, s33, s41
  s_lshl_b32 s47, s17, 13
  v_xor_b32 v1, 0, v4
  s_add_u32 m0, s47, 0
  s_add_u32 s39, s33, 0
  buffer_load_dwordx4 v1, s[20:23], s39 offen lds
  v_xor_b32 v1, 32, v4
  s_add_u32 m0, s47, 1024
  s_add_u32 s39, s33, 65536
  buffer_load_dwordx4 v1, s[20:23], s39 offen lds
  v_xor_b32 v1, 64, v4
  s_add_u32 m0, s47, 2048
  s_add_u32 s39, s33, 32768
  buffer_load_dwordx4 v1, s[20:23], s39 offen lds
  v_xor_b32 v1, 96, v4
  s_add_u32 m0, s47, 3072
  s_add_u32 s39, s33, 98304
  buffer_load_dwordx4 v1, s[20:23], s39 offen lds
  v_xor_b32 v1, 128, v4
  s_add_u32 m0, s47, 4096
  s_add_u32 s39, s33, 131072
  buffer_load_dwordx4 v1, s[20:23], s39 offen lds
  v_xor_b32 v1, 160, v4
  s_add_u32 m0, s47, 5120
  s_add_u32 s39, s33, 196608
  buffer_load_dwordx4 v1, s[20:23], s39 offen lds
  v_xor_b32 v1, 192, v4
  s_add_u32 m0, s47, 6144
  s_add_u32 s39, s33, 163840
  buffer_load_dwordx4 v1, s[20:23], s39 offen lds
  v_xor_b32 v1, 224, v4
  s_add_u32 m0, s47, 7168
  s_add_u32 s39, s33, 229376
  buffer_load_dwordx4 v1, s[20:23], s39 offen lds
  s_mov_b32 s24, s76
  s_mov_b32 s25, s77
  s_mov_b32 s26, 3670016
  s_mov_b32 s27, 0x20000
  s_lshl_b32 s38, s36, 1
  s_add_u32 s38, s38, s37
  s_mul_i32 s39, s38, 100352
  s_add_u32 s43, s43, s39
  s_lshl_b32 s39, s35, 1
  s_add_u32 s39, s39, s40
  s_lshl_b32 s39, s39, 10
  s_add_u32 s43, s43, s39
  s_mul_i32 s42, s38, 112
  s_lshl_b32 s42, s42, 13
  s_add_u32 s42, s42, s41
  s_mul_i32 s47, s37, 57344
  s_add_u32 s47, s47, 32768
  s_lshl_b32 s39, s40, 12
  s_add_u32 s47, s47, s39
  s_lshl_b32 s39, s40, 16
  s_add_u32 s33, s42, s39
  s_add_u32 s42, s33, s39
  s_add_u32 m0, s47, 0
  s_add_u32 s44, s42, 0
  buffer_load_dwordx4 v204, s[24:27], s44 offen lds
  s_add_u32 m0, s47, 1024
  s_add_u32 s44, s42, 32768
  buffer_load_dwordx4 v205, s[24:27], s44 offen lds
  s_add_u32 m0, s47, 2048
  s_add_u32 s44, s42, 65536
  buffer_load_dwordx4 v206, s[24:27], s44 offen lds
  s_add_u32 m0, s47, 3072
  s_add_u32 s44, s42, 98304
  buffer_load_dwordx4 v207, s[24:27], s44 offen lds
  s_add_u32 m0, s47, 8192
  s_add_u32 s44, s42, 16384
  buffer_load_dwordx4 v204, s[24:27], s44 offen lds
  s_add_u32 m0, s47, 9216
  s_add_u32 s44, s42, 49152
  buffer_load_dwordx4 v205, s[24:27], s44 offen lds
  s_add_u32 m0, s47, 10240
  s_add_u32 s44, s42, 81920
  buffer_load_dwordx4 v206, s[24:27], s44 offen lds
  s_add_u32 m0, s47, 11264
  s_add_u32 s44, s42, 114688
  buffer_load_dwordx4 v207, s[24:27], s44 offen lds
  s_add_u32 m0, s47, 16384
  s_add_u32 s44, s42, 262144
  buffer_load_dwordx4 v204, s[24:27], s44 offen lds
  s_add_u32 m0, s47, 17408
  s_add_u32 s44, s42, 294912
  buffer_load_dwordx4 v205, s[24:27], s44 offen lds
  s_add_u32 m0, s47, 18432
  s_add_u32 s44, s42, 327680
  buffer_load_dwordx4 v206, s[24:27], s44 offen lds
  s_add_u32 m0, s47, 19456
  s_add_u32 s44, s42, 360448
  buffer_load_dwordx4 v207, s[24:27], s44 offen lds
  s_add_u32 m0, s47, 24576
  s_add_u32 s44, s42, 278528
  buffer_load_dwordx4 v204, s[24:27], s44 offen lds
  s_add_u32 m0, s47, 25600
  s_add_u32 s44, s42, 311296
  buffer_load_dwordx4 v205, s[24:27], s44 offen lds
  s_add_u32 m0, s47, 26624
  s_add_u32 s44, s42, 344064
  buffer_load_dwordx4 v206, s[24:27], s44 offen lds
  s_add_u32 m0, s47, 27648
  s_add_u32 s44, s42, 376832
  buffer_load_dwordx4 v207, s[24:27], s44 offen lds
  s_waitcnt vmcnt(8)
  s_barrier
  ds_read_b128 v[108:111], v6 offset:0
  ds_read_b128 v[112:115], v6 offset:8192
  ds_read_b128 v[172:175], v200 offset:0
  ds_read_b128 v[116:119], v7 offset:0
  ds_read_b128 v[120:123], v7 offset:8192
  ds_read_b128 v[176:179], v201 offset:0
  ds_read_b128 v[124:127], v8 offset:0
  ds_read_b128 v[128:131], v8 offset:8192
  ds_read_b128 v[180:183], v202 offset:0
  ds_read_b128 v[132:135], v9 offset:0
  ds_read_b128 v[136:139], v9 offset:8192
  ds_read_b128 v[184:187], v203 offset:0
  s_waitcnt lgkmcnt(9)
  v_mfma_f32_16x16x32_bf16 v[52:55], v[108:111], v[172:175], 0
  ds_read_b128 v[140:143], v6 offset:256
  ds_read_b128 v[144:147], v6 offset:8448
  ds_read_b128 v[188:191], v200 offset:256
  v_mfma_f32_16x16x32_bf16 v[56:59], v[112:115], v[172:175], 0
  s_waitcnt lgkmcnt(9)
  v_mfma_f32_16x16x32_bf16 v[52:55], v[116:119], v[176:179], v[52:55]
  ds_read_b128 v[148:151], v7 offset:256
  ds_read_b128 v[152:155], v7 offset:8448
  ds_read_b128 v[192:195], v201 offset:256
  v_mfma_f32_16x16x32_bf16 v[56:59], v[120:123], v[176:179], v[56:59]
  s_add_u32 m0, s47, 32768
  s_add_u32 s44, s42, 524288
  buffer_load_dwordx4 v204, s[24:27], s44 offen lds
  s_waitcnt lgkmcnt(9)
  v_mfma_f32_16x16x32_bf16 v[52:55], v[124:127], v[180:183], v[52:55]
  ds_read_b128 v[156:159], v8 offset:256
  ds_read_b128 v[160:163], v8 offset:8448
  ds_read_b128 v[172:175], v202 offset:256
  v_mfma_f32_16x16x32_bf16 v[56:59], v[128:131], v[180:183], v[56:59]
  s_waitcnt lgkmcnt(9)
  v_mfma_f32_16x16x32_bf16 v[52:55], v[132:135], v[184:187], v[52:55]
  ds_read_b128 v[164:167], v9 offset:256
  ds_read_b128 v[168:171], v9 offset:8448
  ds_read_b128 v[176:179], v203 offset:256
  v_mfma_f32_16x16x32_bf16 v[56:59], v[136:139], v[184:187], v[56:59]
  s_add_u32 m0, s47, 33792
  s_add_u32 s44, s42, 557056
  buffer_load_dwordx4 v205, s[24:27], s44 offen lds
  s_waitcnt lgkmcnt(9)
  v_mfma_f32_16x16x32_bf16 v[52:55], v[140:143], v[188:191], v[52:55]
  ds_read_b128 v[180:183], v200 offset:8192
  v_mfma_f32_16x16x32_bf16 v[56:59], v[144:147], v[188:191], v[56:59]
  s_waitcnt lgkmcnt(7)
  v_mfma_f32_16x16x32_bf16 v[52:55], v[148:151], v[192:195], v[52:55]
  ds_read_b128 v[184:187], v201 offset:8192
  v_mfma_f32_16x16x32_bf16 v[56:59], v[152:155], v[192:195], v[56:59]
  s_add_u32 m0, s47, 34816
  s_add_u32 s44, s42, 589824
  buffer_load_dwordx4 v206, s[24:27], s44 offen lds
  s_waitcnt lgkmcnt(5)
  v_mfma_f32_16x16x32_bf16 v[52:55], v[156:159], v[172:175], v[52:55]
  ds_read_b128 v[188:191], v202 offset:8192
  v_mfma_f32_16x16x32_bf16 v[56:59], v[160:163], v[172:175], v[56:59]
  s_waitcnt lgkmcnt(3)
  v_mfma_f32_16x16x32_bf16 v[52:55], v[164:167], v[176:179], v[52:55]
  ds_read_b128 v[192:195], v203 offset:8192
  v_mfma_f32_16x16x32_bf16 v[56:59], v[168:171], v[176:179], v[56:59]
  s_add_u32 m0, s47, 35840
  s_add_u32 s44, s42, 622592
  buffer_load_dwordx4 v207, s[24:27], s44 offen lds
  s_waitcnt lgkmcnt(3)
  v_mfma_f32_16x16x32_bf16 v[60:63], v[108:111], v[180:183], 0
  ds_read_b128 v[172:175], v200 offset:8448
  v_mfma_f32_16x16x32_bf16 v[64:67], v[112:115], v[180:183], 0
  s_waitcnt lgkmcnt(3)
  v_mfma_f32_16x16x32_bf16 v[60:63], v[116:119], v[184:187], v[60:63]
  ds_read_b128 v[176:179], v201 offset:8448
  v_mfma_f32_16x16x32_bf16 v[64:67], v[120:123], v[184:187], v[64:67]
  s_add_u32 m0, s47, 40960
  s_add_u32 s44, s42, 540672
  buffer_load_dwordx4 v204, s[24:27], s44 offen lds
  s_waitcnt lgkmcnt(3)
  v_mfma_f32_16x16x32_bf16 v[60:63], v[124:127], v[188:191], v[60:63]
  ds_read_b128 v[180:183], v202 offset:8448
  v_mfma_f32_16x16x32_bf16 v[64:67], v[128:131], v[188:191], v[64:67]
  s_waitcnt lgkmcnt(3)
  v_mfma_f32_16x16x32_bf16 v[60:63], v[132:135], v[192:195], v[60:63]
  ds_read_b128 v[184:187], v203 offset:8448
  v_mfma_f32_16x16x32_bf16 v[64:67], v[136:139], v[192:195], v[64:67]
  s_add_u32 m0, s47, 41984
  s_add_u32 s44, s42, 573440
  buffer_load_dwordx4 v205, s[24:27], s44 offen lds
  s_waitcnt lgkmcnt(3)
  v_mfma_f32_16x16x32_bf16 v[60:63], v[140:143], v[172:175], v[60:63]
  v_mfma_f32_16x16x32_bf16 v[64:67], v[144:147], v[172:175], v[64:67]
  s_waitcnt lgkmcnt(2)
  v_mfma_f32_16x16x32_bf16 v[60:63], v[148:151], v[176:179], v[60:63]
  v_mfma_f32_16x16x32_bf16 v[64:67], v[152:155], v[176:179], v[64:67]
  s_add_u32 m0, s47, 43008
  s_add_u32 s44, s42, 606208
  buffer_load_dwordx4 v206, s[24:27], s44 offen lds
  s_waitcnt lgkmcnt(1)
  v_mfma_f32_16x16x32_bf16 v[60:63], v[156:159], v[180:183], v[60:63]
  v_mfma_f32_16x16x32_bf16 v[64:67], v[160:163], v[180:183], v[64:67]
  s_waitcnt lgkmcnt(0)
  v_mfma_f32_16x16x32_bf16 v[60:63], v[164:167], v[184:187], v[60:63]
  v_mfma_f32_16x16x32_bf16 v[64:67], v[168:171], v[184:187], v[64:67]
  s_add_u32 m0, s47, 44032
  s_add_u32 s44, s42, 638976
  buffer_load_dwordx4 v207, s[24:27], s44 offen lds
  s_waitcnt vmcnt(8)
  s_barrier
  ds_read_b128 v[188:191], v200 offset:16384
  ds_read_b128 v[192:195], v201 offset:16384
  ds_read_b128 v[172:175], v202 offset:16384
  ds_read_b128 v[176:179], v203 offset:16384
  s_waitcnt lgkmcnt(3)
  v_mfma_f32_16x16x32_bf16 v[68:71], v[108:111], v[188:191], 0
  ds_read_b128 v[180:183], v200 offset:16640
  v_mfma_f32_16x16x32_bf16 v[72:75], v[112:115], v[188:191], 0
  s_waitcnt lgkmcnt(3)
  v_mfma_f32_16x16x32_bf16 v[68:71], v[116:119], v[192:195], v[68:71]
  ds_read_b128 v[184:187], v201 offset:16640
  v_mfma_f32_16x16x32_bf16 v[72:75], v[120:123], v[192:195], v[72:75]
  s_add_u32 m0, s47, 49152
  s_add_u32 s44, s33, 786432
  buffer_load_dwordx4 v204, s[24:27], s44 offen lds
  s_waitcnt lgkmcnt(3)
  v_mfma_f32_16x16x32_bf16 v[68:71], v[124:127], v[172:175], v[68:71]
  ds_read_b128 v[188:191], v202 offset:16640
  v_mfma_f32_16x16x32_bf16 v[72:75], v[128:131], v[172:175], v[72:75]
  s_waitcnt lgkmcnt(3)
  v_mfma_f32_16x16x32_bf16 v[68:71], v[132:135], v[176:179], v[68:71]
  ds_read_b128 v[192:195], v203 offset:16640
  v_mfma_f32_16x16x32_bf16 v[72:75], v[136:139], v[176:179], v[72:75]
  s_add_u32 m0, s47, 50176
  s_add_u32 s44, s33, 802816
  buffer_load_dwordx4 v205, s[24:27], s44 offen lds
  s_waitcnt lgkmcnt(3)
  v_mfma_f32_16x16x32_bf16 v[68:71], v[140:143], v[180:183], v[68:71]
  ds_read_b128 v[172:175], v200 offset:24576
  v_mfma_f32_16x16x32_bf16 v[72:75], v[144:147], v[180:183], v[72:75]
  s_waitcnt lgkmcnt(3)
  v_mfma_f32_16x16x32_bf16 v[68:71], v[148:151], v[184:187], v[68:71]
  ds_read_b128 v[176:179], v201 offset:24576
  v_mfma_f32_16x16x32_bf16 v[72:75], v[152:155], v[184:187], v[72:75]
  s_add_u32 m0, s47, 51200
  s_add_u32 s44, s33, 819200
  buffer_load_dwordx4 v206, s[24:27], s44 offen lds
  s_waitcnt lgkmcnt(3)
  v_mfma_f32_16x16x32_bf16 v[68:71], v[156:159], v[188:191], v[68:71]
  ds_read_b128 v[180:183], v202 offset:24576
  v_mfma_f32_16x16x32_bf16 v[72:75], v[160:163], v[188:191], v[72:75]
  s_waitcnt lgkmcnt(3)
  v_mfma_f32_16x16x32_bf16 v[68:71], v[164:167], v[192:195], v[68:71]
  ds_read_b128 v[184:187], v203 offset:24576
  v_mfma_f32_16x16x32_bf16 v[72:75], v[168:171], v[192:195], v[72:75]
  s_add_u32 m0, s47, 52224
  s_add_u32 s44, s33, 835584
  buffer_load_dwordx4 v207, s[24:27], s44 offen lds
  s_waitcnt lgkmcnt(3)
  v_mfma_f32_16x16x32_bf16 v[76:79], v[108:111], v[172:175], 0
  ds_read_b128 v[188:191], v200 offset:24832
  v_mfma_f32_16x16x32_bf16 v[80:83], v[112:115], v[172:175], 0
  s_waitcnt lgkmcnt(3)
  v_mfma_f32_16x16x32_bf16 v[76:79], v[116:119], v[176:179], v[76:79]
  ds_read_b128 v[192:195], v201 offset:24832
  v_mfma_f32_16x16x32_bf16 v[80:83], v[120:123], v[176:179], v[80:83]
  s_waitcnt lgkmcnt(3)
  v_mfma_f32_16x16x32_bf16 v[76:79], v[124:127], v[180:183], v[76:79]
  ds_read_b128 v[172:175], v202 offset:24832
  v_mfma_f32_16x16x32_bf16 v[80:83], v[128:131], v[180:183], v[80:83]
  s_waitcnt lgkmcnt(3)
  v_mfma_f32_16x16x32_bf16 v[76:79], v[132:135], v[184:187], v[76:79]
  ds_read_b128 v[176:179], v203 offset:24832
  v_mfma_f32_16x16x32_bf16 v[80:83], v[136:139], v[184:187], v[80:83]
  s_waitcnt lgkmcnt(3)
  v_mfma_f32_16x16x32_bf16 v[76:79], v[140:143], v[188:191], v[76:79]
  v_mfma_f32_16x16x32_bf16 v[80:83], v[144:147], v[188:191], v[80:83]
  s_waitcnt lgkmcnt(2)
  v_mfma_f32_16x16x32_bf16 v[76:79], v[148:151], v[192:195], v[76:79]
  v_mfma_f32_16x16x32_bf16 v[80:83], v[152:155], v[192:195], v[80:83]
  s_waitcnt lgkmcnt(1)
  v_mfma_f32_16x16x32_bf16 v[76:79], v[156:159], v[172:175], v[76:79]
  v_mfma_f32_16x16x32_bf16 v[80:83], v[160:163], v[172:175], v[80:83]
  s_waitcnt lgkmcnt(0)
  v_mfma_f32_16x16x32_bf16 v[76:79], v[164:167], v[176:179], v[76:79]
  v_mfma_f32_16x16x32_bf16 v[80:83], v[168:171], v[176:179], v[80:83]
  s_waitcnt vmcnt(4)
  s_barrier
  ds_read_b128 v[180:183], v200 offset:32768
  ds_read_b128 v[184:187], v201 offset:32768
  ds_read_b128 v[188:191], v202 offset:32768
  ds_read_b128 v[192:195], v203 offset:32768
  s_waitcnt lgkmcnt(3)
  v_mfma_f32_16x16x32_bf16 v[84:87], v[108:111], v[180:183], 0
  ds_read_b128 v[172:175], v200 offset:33024
  v_mfma_f32_16x16x32_bf16 v[88:91], v[112:115], v[180:183], 0
  s_waitcnt lgkmcnt(3)
  v_mfma_f32_16x16x32_bf16 v[84:87], v[116:119], v[184:187], v[84:87]
  ds_read_b128 v[176:179], v201 offset:33024
  v_mfma_f32_16x16x32_bf16 v[88:91], v[120:123], v[184:187], v[88:91]
  s_waitcnt lgkmcnt(3)
  v_mfma_f32_16x16x32_bf16 v[84:87], v[124:127], v[188:191], v[84:87]
  ds_read_b128 v[180:183], v202 offset:33024
  v_mfma_f32_16x16x32_bf16 v[88:91], v[128:131], v[188:191], v[88:91]
  s_waitcnt lgkmcnt(3)
  v_mfma_f32_16x16x32_bf16 v[84:87], v[132:135], v[192:195], v[84:87]
  ds_read_b128 v[184:187], v203 offset:33024
  v_mfma_f32_16x16x32_bf16 v[88:91], v[136:139], v[192:195], v[88:91]
  s_waitcnt lgkmcnt(3)
  v_mfma_f32_16x16x32_bf16 v[84:87], v[140:143], v[172:175], v[84:87]
  ds_read_b128 v[188:191], v200 offset:40960
  v_mfma_f32_16x16x32_bf16 v[88:91], v[144:147], v[172:175], v[88:91]
  s_waitcnt lgkmcnt(3)
  v_mfma_f32_16x16x32_bf16 v[84:87], v[148:151], v[176:179], v[84:87]
  ds_read_b128 v[192:195], v201 offset:40960
  v_mfma_f32_16x16x32_bf16 v[88:91], v[152:155], v[176:179], v[88:91]
  s_waitcnt lgkmcnt(3)
  v_mfma_f32_16x16x32_bf16 v[84:87], v[156:159], v[180:183], v[84:87]
  ds_read_b128 v[172:175], v202 offset:40960
  v_mfma_f32_16x16x32_bf16 v[88:91], v[160:163], v[180:183], v[88:91]
  s_waitcnt lgkmcnt(3)
  v_mfma_f32_16x16x32_bf16 v[84:87], v[164:167], v[184:187], v[84:87]
  ds_read_b128 v[176:179], v203 offset:40960
  v_mfma_f32_16x16x32_bf16 v[88:91], v[168:171], v[184:187], v[88:91]
  s_waitcnt lgkmcnt(3)
  v_mfma_f32_16x16x32_bf16 v[92:95], v[108:111], v[188:191], 0
  ds_read_b128 v[180:183], v200 offset:41216
  v_mfma_f32_16x16x32_bf16 v[96:99], v[112:115], v[188:191], 0
  s_waitcnt lgkmcnt(3)
  v_mfma_f32_16x16x32_bf16 v[92:95], v[116:119], v[192:195], v[92:95]
  ds_read_b128 v[184:187], v201 offset:41216
  v_mfma_f32_16x16x32_bf16 v[96:99], v[120:123], v[192:195], v[96:99]
  s_waitcnt lgkmcnt(3)
  v_mfma_f32_16x16x32_bf16 v[92:95], v[124:127], v[172:175], v[92:95]
  ds_read_b128 v[188:191], v202 offset:41216
  v_mfma_f32_16x16x32_bf16 v[96:99], v[128:131], v[172:175], v[96:99]
  s_waitcnt lgkmcnt(3)
  v_mfma_f32_16x16x32_bf16 v[92:95], v[132:135], v[176:179], v[92:95]
  ds_read_b128 v[192:195], v203 offset:41216
  v_mfma_f32_16x16x32_bf16 v[96:99], v[136:139], v[176:179], v[96:99]
  s_waitcnt lgkmcnt(3)
  v_mfma_f32_16x16x32_bf16 v[92:95], v[140:143], v[180:183], v[92:95]
  v_mfma_f32_16x16x32_bf16 v[96:99], v[144:147], v[180:183], v[96:99]
  s_waitcnt lgkmcnt(2)
  v_mfma_f32_16x16x32_bf16 v[92:95], v[148:151], v[184:187], v[92:95]
  v_mfma_f32_16x16x32_bf16 v[96:99], v[152:155], v[184:187], v[96:99]
  s_waitcnt lgkmcnt(1)
  v_mfma_f32_16x16x32_bf16 v[92:95], v[156:159], v[188:191], v[92:95]
  v_mfma_f32_16x16x32_bf16 v[96:99], v[160:163], v[188:191], v[96:99]
  s_waitcnt lgkmcnt(0)
  v_mfma_f32_16x16x32_bf16 v[92:95], v[164:167], v[192:195], v[92:95]
  v_mfma_f32_16x16x32_bf16 v[96:99], v[168:171], v[192:195], v[96:99]
  s_waitcnt vmcnt(0)
  s_barrier
  ds_read_b128 v[172:175], v200 offset:49152
  ds_read_b128 v[176:179], v201 offset:49152
  ds_read_b128 v[180:183], v202 offset:49152
  ds_read_b128 v[184:187], v203 offset:49152
  s_waitcnt lgkmcnt(3)
  v_mfma_f32_16x16x32_bf16 v[100:103], v[108:111], v[172:175], 0
  ds_read_b128 v[188:191], v200 offset:49408
  v_mfma_f32_16x16x32_bf16 v[104:107], v[112:115], v[172:175], 0
  s_waitcnt lgkmcnt(3)
  v_mfma_f32_16x16x32_bf16 v[100:103], v[116:119], v[176:179], v[100:103]
  ds_read_b128 v[192:195], v201 offset:49408
  v_mfma_f32_16x16x32_bf16 v[104:107], v[120:123], v[176:179], v[104:107]
  s_waitcnt lgkmcnt(3)
  v_mfma_f32_16x16x32_bf16 v[100:103], v[124:127], v[180:183], v[100:103]
  ds_read_b128 v[172:175], v202 offset:49408
  v_mfma_f32_16x16x32_bf16 v[104:107], v[128:131], v[180:183], v[104:107]
  s_waitcnt lgkmcnt(3)
  v_mfma_f32_16x16x32_bf16 v[100:103], v[132:135], v[184:187], v[100:103]
  ds_read_b128 v[176:179], v203 offset:49408
  v_mfma_f32_16x16x32_bf16 v[104:107], v[136:139], v[184:187], v[104:107]
  s_waitcnt lgkmcnt(3)
  v_mfma_f32_16x16x32_bf16 v[100:103], v[140:143], v[188:191], v[100:103]
  v_mfma_f32_16x16x32_bf16 v[104:107], v[144:147], v[188:191], v[104:107]
  s_waitcnt lgkmcnt(2)
  v_mfma_f32_16x16x32_bf16 v[100:103], v[148:151], v[192:195], v[100:103]
  v_mfma_f32_16x16x32_bf16 v[104:107], v[152:155], v[192:195], v[104:107]
  s_waitcnt lgkmcnt(1)
  v_mfma_f32_16x16x32_bf16 v[100:103], v[156:159], v[172:175], v[100:103]
  v_mfma_f32_16x16x32_bf16 v[104:107], v[160:163], v[172:175], v[104:107]
  s_waitcnt lgkmcnt(0)
  v_mfma_f32_16x16x32_bf16 v[100:103], v[164:167], v[176:179], v[100:103]
  v_mfma_f32_16x16x32_bf16 v[104:107], v[168:171], v[176:179], v[104:107]
  s_mov_b32 s44, 0x3db8aa3b
  v_mul_f32 v52, s44, v52
  v_mul_f32 v53, s44, v53
  v_mul_f32 v54, s44, v54
  v_mul_f32 v55, s44, v55
  v_mul_f32 v56, s44, v56
  v_mul_f32 v57, s44, v57
  v_mul_f32 v58, s44, v58
  v_mul_f32 v59, s44, v59
  v_cvt_pk_bf16_f32 v52, v52, v53
  v_cvt_pk_bf16_f32 v53, v54, v55
  v_cvt_pk_bf16_f32 v54, v56, v57
  v_cvt_pk_bf16_f32 v55, v58, v59
  buffer_store_dwordx4 v[52:55], v3, s[12:15], s43 offen sc1
  s_add_u32 s43, s43, 14336
  v_mul_f32 v60, s44, v60
  v_mul_f32 v61, s44, v61
  v_mul_f32 v62, s44, v62
  v_mul_f32 v63, s44, v63
  v_mul_f32 v64, s44, v64
  v_mul_f32 v65, s44, v65
  v_mul_f32 v66, s44, v66
  v_mul_f32 v67, s44, v67
  v_cvt_pk_bf16_f32 v60, v60, v61
  v_cvt_pk_bf16_f32 v61, v62, v63
  v_cvt_pk_bf16_f32 v62, v64, v65
  v_cvt_pk_bf16_f32 v63, v66, v67
  buffer_store_dwordx4 v[60:63], v3, s[12:15], s43 offen sc1
  s_add_u32 s43, s43, 14336
  v_mul_f32 v68, s44, v68
  v_mul_f32 v69, s44, v69
  v_mul_f32 v70, s44, v70
  v_mul_f32 v71, s44, v71
  v_mul_f32 v72, s44, v72
  v_mul_f32 v73, s44, v73
  v_mul_f32 v74, s44, v74
  v_mul_f32 v75, s44, v75
  v_cvt_pk_bf16_f32 v68, v68, v69
  v_cvt_pk_bf16_f32 v69, v70, v71
  v_cvt_pk_bf16_f32 v70, v72, v73
  v_cvt_pk_bf16_f32 v71, v74, v75
  buffer_store_dwordx4 v[68:71], v3, s[12:15], s43 offen sc1
  s_add_u32 s43, s43, 14336
  v_mul_f32 v76, s44, v76
  v_mul_f32 v77, s44, v77
  v_mul_f32 v78, s44, v78
  v_mul_f32 v79, s44, v79
  v_mul_f32 v80, s44, v80
  v_mul_f32 v81, s44, v81
  v_mul_f32 v82, s44, v82
  v_mul_f32 v83, s44, v83
  v_cvt_pk_bf16_f32 v76, v76, v77
  v_cvt_pk_bf16_f32 v77, v78, v79
  v_cvt_pk_bf16_f32 v78, v80, v81
  v_cvt_pk_bf16_f32 v79, v82, v83
  buffer_store_dwordx4 v[76:79], v3, s[12:15], s43 offen sc1
  s_add_u32 s43, s43, 14336
  v_mul_f32 v84, s44, v84
  v_mul_f32 v85, s44, v85
  v_mul_f32 v86, s44, v86
  v_mul_f32 v87, s44, v87
  v_mul_f32 v88, s44, v88
  v_mul_f32 v89, s44, v89
  v_mul_f32 v90, s44, v90
  v_mul_f32 v91, s44, v91
  v_cvt_pk_bf16_f32 v84, v84, v85
  v_cvt_pk_bf16_f32 v85, v86, v87
  v_cvt_pk_bf16_f32 v86, v88, v89
  v_cvt_pk_bf16_f32 v87, v90, v91
  buffer_store_dwordx4 v[84:87], v3, s[12:15], s43 offen sc1
  s_add_u32 s43, s43, 14336
  v_mul_f32 v92, s44, v92
  v_mul_f32 v93, s44, v93
  v_mul_f32 v94, s44, v94
  v_mul_f32 v95, s44, v95
  v_mul_f32 v96, s44, v96
  v_mul_f32 v97, s44, v97
  v_mul_f32 v98, s44, v98
  v_mul_f32 v99, s44, v99
  v_cvt_pk_bf16_f32 v92, v92, v93
  v_cvt_pk_bf16_f32 v93, v94, v95
  v_cvt_pk_bf16_f32 v94, v96, v97
  v_cvt_pk_bf16_f32 v95, v98, v99
  buffer_store_dwordx4 v[92:95], v3, s[12:15], s43 offen sc1
  s_add_u32 s43, s43, 14336
  v_mul_f32 v100, s44, v100
  v_mul_f32 v101, s44, v101
  v_mul_f32 v102, s44, v102
  v_mul_f32 v103, s44, v103
  v_mul_f32 v104, s44, v104
  v_mul_f32 v105, s44, v105
  v_mul_f32 v106, s44, v106
  v_mul_f32 v107, s44, v107
  v_cvt_pk_bf16_f32 v100, v100, v101
  v_cvt_pk_bf16_f32 v101, v102, v103
  v_cvt_pk_bf16_f32 v102, v104, v105
  v_cvt_pk_bf16_f32 v103, v106, v107
  buffer_store_dwordx4 v[100:103], v3, s[12:15], s43 offen sc1
  s_waitcnt vmcnt(0)
  s_barrier
  s_cmp_lg_u32 s17, 0
  s_cbranch_scc1 sg_244
  s_lshl_b32 s62, s45, 7
  s_add_u32 s62, s62, 46858240
  s_waitcnt lgkmcnt(0)
  s_mov_b32 s2, 1
  s_atomic_or s2, s[58:59], s62 glc
sg_244:
  s_branch te_214
tg_235:
  s_lshr_b32 s34, s32, 3
  s_lshl_b32 s34, s34, 1
  s_and_b32 s35, s32, 1
  s_add_u32 s34, s34, s35
  s_add_u32 s34, s34, 64
  s_lshl_b32 s60, s34, 3
  s_lshl_b32 s34, s17, 1
  s_add_u32 s60, s60, s34
  s_add_u32 s33, s60, 256
  s_add_u32 s42, s33, 256
  s_mov_b32 s28, s64
  s_mov_b32 s29, s65
  s_mov_b32 s30, 1835008
  s_mov_b32 s31, 0x20000
  v_bfe_u32 v1, v0, 2, 2
  v_lshlrev_b32 v2, 3, v1
  v_bfe_u32 v1, v0, 0, 2
  v_lshl_add_u32 v2, v1, 0, v2
  v_mul_u32_u24 v2, 896, v2
  v_bfe_u32 v1, v0, 5, 1
  v_lshlrev_b32 v21, 5, v1
  v_bfe_u32 v1, v0, 4, 1
  v_lshl_add_u32 v21, v1, 3, v21
  v_add_u32 v21, v21, v2
  s_mul_i32 s34, s60, 2341
  s_lshr_b32 s34, s34, 16
  s_mul_i32 s35, s34, 28
  s_sub_u32 s35, s60, s35
  s_mul_i32 s36, s34, 28672
  s_cmp_ge_u32 s35, 14
  s_cselect_b32 s37, 2688, 0
  s_add_u32 s36, s36, s37
  s_lshl_b32 s37, s35, 6
  s_add_u32 s36, s36, s37
  buffer_load_dwordx2 v[28:29], v21, s[28:31], s36 offen offset:0
  buffer_load_dwordx2 v[30:31], v21, s[28:31], s36 offen offset:16
  buffer_load_dwordx2 v[32:33], v21, s[28:31], s36 offen offset:64
  buffer_load_dwordx2 v[34:35], v21, s[28:31], s36 offen offset:80
  s_cmp_ge_u32 s60, 1344
  s_cbranch_scc1 wof_245
  s_mov_b32 s28, s66
  s_mov_b32 s29, s67
  s_mov_b32 s30, 1204224
  s_mov_b32 s31, 0x20000
  s_mul_i32 s36, s34, 21846
  s_lshr_b32 s36, s36, 16
  s_mul_i32 s37, s36, 3
  s_sub_u32 s37, s34, s37
  s_mul_i32 s37, s37, 896
  s_mul_i32 s36, s36, 56
  s_add_u32 s37, s37, s36
  s_mul_i32 s36, s35, 43008
  s_add_u32 s37, s37, s36
  s_add_u32 s48, s37, 0
  s_add_u32 s49, s37, 2688
  s_add_u32 s50, s37, 21504
  s_add_u32 s51, s37, 24192
  s_add_u32 s52, s37, 5376
  s_add_u32 s53, s37, 8064
  s_add_u32 s54, s37, 26880
  s_add_u32 s55, s37, 29568
  v_bfe_u32 v1, v0, 5, 1
  v_lshlrev_b32 v2, 0, v1
  v_mul_u32_u24 v2, 10752, v2
  v_bfe_u32 v1, v0, 0, 5
  v_lshlrev_b32 v22, 1, v1
  v_cmp_lt_u32 vcc, 27, v1
  v_add_u32 v22, v22, v2
  v_mov_b32 v1, 0x40000000
  v_cndmask_b32 v22, v22, v1, vcc
  v_mov_b32 v23, v22
  s_mov_b32 s61, 43008
  s_branch j_246
wof_245:
  s_mov_b32 s28, s68
  s_mov_b32 s29, s69
  s_mov_b32 s30, 401408
  s_mov_b32 s31, 0x20000
  s_sub_u32 s34, s60, 1344
  s_and_b32 s36, s34, 15
  s_lshr_b32 s34, s34, 4
  s_lshl_b32 s34, s34, 5
  s_mul_i32 s36, s36, 25088
  s_add_u32 s37, s34, s36
  s_add_u32 s48, s37, 0
  s_add_u32 s49, s37, 896
  s_add_u32 s50, s37, 1792
  s_add_u32 s51, s37, 2688
  s_add_u32 s52, s37, 7168
  s_add_u32 s53, s37, 8064
  s_add_u32 s54, s37, 8960
  s_add_u32 s55, s37, 9856
  v_bfe_u32 v1, v0, 5, 1
  v_lshlrev_b32 v2, 4, v1
  v_bfe_u32 v1, v0, 4, 1
  v_lshl_add_u32 v2, v1, 2, v2
  v_mul_u32_u24 v2, 896, v2
  v_bfe_u32 v1, v0, 0, 4
  v_lshlrev_b32 v22, 1, v1
  v_add_u32 v22, v22, v2
  v_cmp_lt_u32 vcc, 47, v0
  v_mov_b32 v1, 0x40000000
  s_nop 0
  v_cndmask_b32 v23, v22, v1, vcc
  s_mov_b32 s61, 25088
j_246:
  buffer_load_ushort v36, v22, s[28:31], s48 offen
  s_add_u32 s48, s48, s61
  buffer_load_ushort v37, v22, s[28:31], s49 offen
  s_add_u32 s49, s49, s61
  buffer_load_ushort v38, v22, s[28:31], s50 offen
  s_add_u32 s50, s50, s61
  buffer_load_ushort v39, v22, s[28:31], s51 offen
  s_add_u32 s51, s51, s61
  buffer_load_ushort v40, v23, s[28:31], s52 offen
  s_add_u32 s52, s52, s61
  buffer_load_ushort v41, v23, s[28:31], s53 offen
  s_add_u32 s53, s53, s61
  buffer_load_ushort v42, v23, s[28:31], s54 offen
  s_add_u32 s54, s54, s61
  buffer_load_ushort v43, v23, s[28:31], s55 offen
  s_add_u32 s55, s55, s61
  buffer_load_ushort v44, v22, s[28:31], s48 offen
  buffer_load_ushort v45, v22, s[28:31], s49 offen
  buffer_load_ushort v46, v22, s[28:31], s50 offen
  buffer_load_ushort v47, v22, s[28:31], s51 offen
  buffer_load_ushort v48, v23, s[28:31], s52 offen
  buffer_load_ushort v49, v23, s[28:31], s53 offen
  buffer_load_ushort v50, v23, s[28:31], s54 offen
  buffer_load_ushort v51, v23, s[28:31], s55 offen
  s_mov_b32 s28, s64
  s_mov_b32 s29, s65
  s_mov_b32 s30, 1835008
  s_mov_b32 s31, 0x20000
  v_bfe_u32 v1, v0, 2, 2
  v_lshlrev_b32 v2, 3, v1
  v_bfe_u32 v1, v0, 0, 2
  v_lshl_add_u32 v2, v1, 0, v2
  v_mul_u32_u24 v2, 896, v2
  v_bfe_u32 v1, v0, 5, 1
  v_lshlrev_b32 v21, 5, v1
  v_bfe_u32 v1, v0, 4, 1
  v_lshl_add_u32 v21, v1, 3, v21
  v_add_u32 v21, v21, v2
  s_mul_i32 s34, s33, 2341
  s_lshr_b32 s34, s34, 16
  s_mul_i32 s35, s34, 28
  s_sub_u32 s35, s33, s35
  s_mul_i32 s36, s34, 28672
  s_cmp_ge_u32 s35, 14
  s_cselect_b32 s37, 2688, 0
  s_add_u32 s36, s36, s37
  s_lshl_b32 s37, s35, 6
  s_add_u32 s36, s36, s37
  buffer_load_dwordx2 v[108:109], v21, s[28:31], s36 offen offset:0
  buffer_load_dwordx2 v[110:111], v21, s[28:31], s36 offen offset:16
  buffer_load_dwordx2 v[112:113], v21, s[28:31], s36 offen offset:64
  buffer_load_dwordx2 v[114:115], v21, s[28:31], s36 offen offset:80
  s_cmp_ge_u32 s33, 1344
  s_cbranch_scc1 wof_247
  s_mov_b32 s28, s66
  s_mov_b32 s29, s67
  s_mov_b32 s30, 1204224
  s_mov_b32 s31, 0x20000
  s_mul_i32 s36, s34, 21846
  s_lshr_b32 s36, s36, 16
  s_mul_i32 s37, s36, 3
  s_sub_u32 s37, s34, s37
  s_mul_i32 s37, s37, 896
  s_mul_i32 s36, s36, 56
  s_add_u32 s37, s37, s36
  s_mul_i32 s36, s35, 43008
  s_add_u32 s37, s37, s36
  s_add_u32 s48, s37, 0
  s_add_u32 s49, s37, 2688
  s_add_u32 s50, s37, 21504
  s_add_u32 s51, s37, 24192
  s_add_u32 s52, s37, 5376
  s_add_u32 s53, s37, 8064
  s_add_u32 s54, s37, 26880
  s_add_u32 s55, s37, 29568
  v_bfe_u32 v1, v0, 5, 1
  v_lshlrev_b32 v2, 0, v1
  v_mul_u32_u24 v2, 10752, v2
  v_bfe_u32 v1, v0, 0, 5
  v_lshlrev_b32 v22, 1, v1
  v_cmp_lt_u32 vcc, 27, v1
  v_add_u32 v22, v22, v2
  v_mov_b32 v1, 0x40000000
  v_cndmask_b32 v22, v22, v1, vcc
  v_mov_b32 v23, v22
  s_mov_b32 s61, 43008
  s_branch j_248
wof_247:
  s_mov_b32 s28, s68
  s_mov_b32 s29, s69
  s_mov_b32 s30, 401408
  s_mov_b32 s31, 0x20000
  s_sub_u32 s34, s33, 1344
  s_and_b32 s36, s34, 15
  s_lshr_b32 s34, s34, 4
  s_lshl_b32 s34, s34, 5
  s_mul_i32 s36, s36, 25088
  s_add_u32 s37, s34, s36
  s_add_u32 s48, s37, 0
  s_add_u32 s49, s37, 896
  s_add_u32 s50, s37, 1792
  s_add_u32 s51, s37, 2688
  s_add_u32 s52, s37, 7168
  s_add_u32 s53, s37, 8064
  s_add_u32 s54, s37, 8960
  s_add_u32 s55, s37, 9856
  v_bfe_u32 v1, v0, 5, 1
  v_lshlrev_b32 v2, 4, v1
  v_bfe_u32 v1, v0, 4, 1
  v_lshl_add_u32 v2, v1, 2, v2
  v_mul_u32_u24 v2, 896, v2
  v_bfe_u32 v1, v0, 0, 4
  v_lshlrev_b32 v22, 1, v1
  v_add_u32 v22, v22, v2
  v_cmp_lt_u32 vcc, 47, v0
  v_mov_b32 v1, 0x40000000
  s_nop 0
  v_cndmask_b32 v23, v22, v1, vcc
  s_mov_b32 s61, 25088
j_248:
  buffer_load_ushort v116, v22, s[28:31], s48 offen
  s_add_u32 s48, s48, s61
  buffer_load_ushort v117, v22, s[28:31], s49 offen
  s_add_u32 s49, s49, s61
  buffer_load_ushort v118, v22, s[28:31], s50 offen
  s_add_u32 s50, s50, s61
  buffer_load_ushort v119, v22, s[28:31], s51 offen
  s_add_u32 s51, s51, s61
  buffer_load_ushort v120, v23, s[28:31], s52 offen
  s_add_u32 s52, s52, s61
  buffer_load_ushort v121, v23, s[28:31], s53 offen
  s_add_u32 s53, s53, s61
  buffer_load_ushort v122, v23, s[28:31], s54 offen
  s_add_u32 s54, s54, s61
  buffer_load_ushort v123, v23, s[28:31], s55 offen
  s_add_u32 s55, s55, s61
  buffer_load_ushort v124, v22, s[28:31], s48 offen
  buffer_load_ushort v125, v22, s[28:31], s49 offen
  buffer_load_ushort v126, v22, s[28:31], s50 offen
  buffer_load_ushort v127, v22, s[28:31], s51 offen
  buffer_load_ushort v128, v23, s[28:31], s52 offen
  buffer_load_ushort v129, v23, s[28:31], s53 offen
  buffer_load_ushort v130, v23, s[28:31], s54 offen
  buffer_load_ushort v131, v23, s[28:31], s55 offen
  s_cmp_ge_u32 s60, 28
  s_cbranch_scc1 ng_249
  s_mov_b32 s28, s84
  s_mov_b32 s29, s85
  s_mov_b32 s30, 896
  s_mov_b32 s31, 0x20000
  s_lshl_b32 s34, s60, 5
  v_bfe_u32 v1, v0, 5, 1
  v_lshlrev_b32 v24, 3, v1
  s_mov_b32 exec_lo, 0x10000000
  s_mov_b32 exec_hi, 0x10000000
  buffer_load_ushort v36, v24, s[28:31], s34 offen offset:0
  buffer_load_ushort v37, v24, s[28:31], s34 offen offset:2
  buffer_load_ushort v38, v24, s[28:31], s34 offen offset:16
  buffer_load_ushort v39, v24, s[28:31], s34 offen offset:18
  buffer_load_ushort v40, v24, s[28:31], s34 offen offset:4
  buffer_load_ushort v41, v24, s[28:31], s34 offen offset:6
  buffer_load_ushort v42, v24, s[28:31], s34 offen offset:20
  buffer_load_ushort v43, v24, s[28:31], s34 offen offset:22
  buffer_load_ushort v44, v24, s[28:31], s34 offen offset:32
  buffer_load_ushort v45, v24, s[28:31], s34 offen offset:34
  buffer_load_ushort v46, v24, s[28:31], s34 offen offset:48
  buffer_load_ushort v47, v24, s[28:31], s34 offen offset:50
  buffer_load_ushort v48, v24, s[28:31], s34 offen offset:36
  buffer_load_ushort v49, v24, s[28:31], s34 offen offset:38
  buffer_load_ushort v50, v24, s[28:31], s34 offen offset:52
  buffer_load_ushort v51, v24, s[28:31], s34 offen offset:54
  s_mov_b64 exec, -1
  s_waitcnt vmcnt(0)
ng_249:
  s_waitcnt vmcnt(20)
  s_lshl_b32 s34, s60, 10
  s_add_u32 s35, s34, 56623104
  s_add_u32 s34, s34, 58720256
  v_swap_b32 v29, v30
  buffer_store_dwordx4 v[28:31], v3, s[12:15], s35 offen offset:0 sc1
  v_lshl_or_b32 v36, v37, 16, v36
  v_lshl_or_b32 v37, v39, 16, v38
  v_lshl_or_b32 v38, v41, 16, v40
  v_lshl_or_b32 v39, v43, 16, v42
  buffer_store_dwordx4 v[36:39], v3, s[12:15], s34 offen offset:0 sc1
  v_swap_b32 v33, v34
  buffer_store_dwordx4 v[32:35], v3, s[12:15], s35 offen offset:1024 sc1
  v_lshl_or_b32 v44, v45, 16, v44
  v_lshl_or_b32 v45, v47, 16, v46
  v_lshl_or_b32 v46, v49, 16, v48
  v_lshl_or_b32 v47, v51, 16, v50
  buffer_store_dwordx4 v[44:47], v3, s[12:15], s34 offen offset:1024 sc1
  s_cmp_ge_u32 s33, 28
  s_cbranch_scc1 ng_250
  s_mov_b32 s28, s84
  s_mov_b32 s29, s85
  s_mov_b32 s30, 896
  s_mov_b32 s31, 0x20000
  s_lshl_b32 s34, s33, 5
  v_bfe_u32 v1, v0, 5, 1
  v_lshlrev_b32 v24, 3, v1
  s_mov_b32 exec_lo, 0x10000000
  s_mov_b32 exec_hi, 0x10000000
  buffer_load_ushort v116, v24, s[28:31], s34 offen offset:0
  buffer_load_ushort v117, v24, s[28:31], s34 offen offset:2
  buffer_load_ushort v118, v24, s[28:31], s34 offen offset:16
  buffer_load_ushort v119, v24, s[28:31], s34 offen offset:18
  buffer_load_ushort v120, v24, s[28:31], s34 offen offset:4
  buffer_load_ushort v121, v24, s[28:31], s34 offen offset:6
  buffer_load_ushort v122, v24, s[28:31], s34 offen offset:20
  buffer_load_ushort v123, v24, s[28:31], s34 offen offset:22
  buffer_load_ushort v124, v24, s[28:31], s34 offen offset:32
  buffer_load_ushort v125, v24, s[28:31], s34 offen offset:34
  buffer_load_ushort v126, v24, s[28:31], s34 offen offset:48
  buffer_load_ushort v127, v24, s[28:31], s34 offen offset:50
  buffer_load_ushort v128, v24, s[28:31], s34 offen offset:36
  buffer_load_ushort v129, v24, s[28:31], s34 offen offset:38
  buffer_load_ushort v130, v24, s[28:31], s34 offen offset:52
  buffer_load_ushort v131, v24, s[28:31], s34 offen offset:54
  s_mov_b64 exec, -1
  s_waitcnt vmcnt(0)
ng_250:
  s_waitcnt vmcnt(4)
  s_lshl_b32 s34, s33, 10
  s_add_u32 s35, s34, 56623104
  s_add_u32 s34, s34, 58720256
  v_swap_b32 v109, v110
  buffer_store_dwordx4 v[108:111], v3, s[12:15], s35 offen offset:0 sc1
  v_lshl_or_b32 v116, v117, 16, v116
  v_lshl_or_b32 v117, v119, 16, v118
  v_lshl_or_b32 v118, v121, 16, v120
  v_lshl_or_b32 v119, v123, 16, v122
  buffer_store_dwordx4 v[116:119], v3, s[12:15], s34 offen offset:0 sc1
  v_swap_b32 v113, v114
  buffer_store_dwordx4 v[112:115], v3, s[12:15], s35 offen offset:1024 sc1
  v_lshl_or_b32 v124, v125, 16, v124
  v_lshl_or_b32 v125, v127, 16, v126
  v_lshl_or_b32 v126, v129, 16, v128
  v_lshl_or_b32 v127, v131, 16, v130
  buffer_store_dwordx4 v[124:127], v3, s[12:15], s34 offen offset:1024 sc1
  s_waitcnt vmcnt(0)
  s_barrier
  s_cmp_lg_u32 s17, 0
  s_cbranch_scc1 sg_252
  s_lshl_b32 s62, s16, 7
  s_add_u32 s62, s62, 46858240
  s_waitcnt lgkmcnt(0)
  s_mov_b32 s2, 2
  s_atomic_or s2, s[58:59], s62 glc
sg_252:
te_214:
  s_mov_b32 s42, 0
  s_mov_b32 s43, 0
  s_cmp_lt_u32 s46, 64
  s_cbranch_scc1 L_fin
  s_and_b32 s26, s32, 127
  s_cmp_lt_u32 s32, 128
  s_cbranch_scc1 L_roleG
  s_lshr_b32 s16, s26, 2
  s_and_b32 s19, s26, 3
  v_mov_b32 v16, v0
  v_lshlrev_b32 v0, 4, v16
  v_bfe_u32 v17, v16, 1, 1
  v_mov_b32 v1, 0xaaaa
  v_mul_u32_u24 v1, v1, v17
  v_add_u32 v1, 0x4444, v1
  v_mov_b32 v2, 1
  v_min_u32 v3, 1, v16
  v_lshlrev_b32 v3, 30, v3
  v_lshlrev_b32 v5, 2, v16
  v_min_u32 v6, 55, v16
  v_lshlrev_b32 v6, 7, v6
  s_and_b32 s27, s16, 3
  s_lshl_b32 s27, s27, 2
  s_lshr_b32 s34, s16, 2
  s_add_u32 s27, s27, s34
  s_mov_b32 s20, 0
  s_mov_b32 s18, s19
  s_add_u32 s22, s16, 16
  s_cmp_lg_u32 s17, 0
  s_cbranch_scc1 wm_253
  v_and_b32 v17, 15, v16
  v_min_u32 v17, 13, v17
  v_lshlrev_b32 v17, 7, v17
  s_lshl_b32 s34, s22, 11
  v_add_u32 v17, s34, v17
  v_and_b32 v18, 15, v16
  v_lshlrev_b32 v18, 7, v18
  v_add_u32 v18, 67584, v18
  v_cmp_gt_u32 vcc, 32, v16
  s_nop 1
  v_cndmask_b32 v17, v18, v17, vcc
  s_mov_b32 s34, 0
  s_add_u32 s34, s34, 46858240
  s_mov_b32 s23, 300000
fp_254:
  buffer_load_dword v18, v17, s[12:15], s34 offen sc1
  s_waitcnt vmcnt(0)
  v_cmp_gt_u32 vcc, 1, v18
  s_cbranch_vccz fpd_255
  s_sleep 1
  s_sub_u32 s23, s23, 1
  s_cbranch_scc0 fp_254
  s_branch L_exit
fpd_255:
wm_253:
  s_barrier
  s_mul_i32 s34, s16, 401408
  s_mul_i32 s35, s17, 100352
  s_add_u32 s34, s34, s35
  s_add_u32 s60, s34, 6422528
  s_add_u32 s61, s34, 6436864
  s_add_u32 s62, s34, 6451200
  s_add_u32 s63, s34, 6465536
  s_add_u32 s64, s34, 6479872
  s_add_u32 s65, s34, 6494208
  s_add_u32 s66, s34, 6508544
  s_mul_i32 s34, s18, 28672
  s_mul_i32 s35, s17, 7168
  s_add_u32 s34, s34, s35
  s_add_u32 s34, s34, 56623104
  s_add_u32 m0, s35, s20
  s_nop 0
  buffer_load_dwordx4 v0, s[12:15], s34 offen offset:0 sc1 lds
  buffer_load_dwordx4 v0, s[12:15], s34 offen offset:1024 sc1 lds
  buffer_load_dwordx4 v0, s[12:15], s34 offen offset:2048 sc1 lds
  buffer_load_dwordx4 v0, s[12:15], s34 offen offset:3072 sc1 lds
  s_add_u32 s34, s34, 4096
  s_add_u32 m0, m0, 4096
  s_nop 0
  buffer_load_dwordx4 v0, s[12:15], s34 offen offset:0 sc1 lds
  buffer_load_dwordx4 v0, s[12:15], s34 offen offset:1024 sc1 lds
  buffer_load_dwordx4 v0, s[12:15], s34 offen offset:2048 sc1 lds
  buffer_load_dwordx4 a[0:3], v0, s[12:15], s60 offen offset:0 sc1
  buffer_load_dwordx4 a[56:59], v0, s[12:15], s61 offen offset:0 sc1
  buffer_load_dwordx4 a[112:115], v0, s[12:15], s62 offen offset:0 sc1
  buffer_load_dwordx4 a[168:171], v0, s[12:15], s63 offen offset:0 sc1
  buffer_load_dwordx4 a[224:227], v0, s[12:15], s64 offen offset:0 sc1
  buffer_load_dwordx4 v[144:147], v0, s[12:15], s65 offen offset:0 sc1
  buffer_load_dwordx4 v[200:203], v0, s[12:15], s66 offen offset:0 sc1
  buffer_load_dwordx4 a[4:7], v0, s[12:15], s60 offen offset:1024 sc1
  buffer_load_dwordx4 a[60:63], v0, s[12:15], s61 offen offset:1024 sc1
  buffer_load_dwordx4 a[116:119], v0, s[12:15], s62 offen offset:1024 sc1
  buffer_load_dwordx4 a[172:175], v0, s[12:15], s63 offen offset:1024 sc1
  buffer_load_dwordx4 a[228:231], v0, s[12:15], s64 offen offset:1024 sc1
  buffer_load_dwordx4 v[148:151], v0, s[12:15], s65 offen offset:1024 sc1
  buffer_load_dwordx4 v[204:207], v0, s[12:15], s66 offen offset:1024 sc1
  buffer_load_dwordx4 a[8:11], v0, s[12:15], s60 offen offset:2048 sc1
  buffer_load_dwordx4 a[64:67], v0, s[12:15], s61 offen offset:2048 sc1
  buffer_load_dwordx4 a[120:123], v0, s[12:15], s62 offen offset:2048 sc1
  buffer_load_dwordx4 a[176:179], v0, s[12:15], s63 offen offset:2048 sc1
  buffer_load_dwordx4 a[232:235], v0, s[12:15], s64 offen offset:2048 sc1
  buffer_load_dwordx4 v[152:155], v0, s[12:15], s65 offen offset:2048 sc1
  buffer_load_dwordx4 v[208:211], v0, s[12:15], s66 offen offset:2048 sc1
  buffer_load_dwordx4 a[12:15], v0, s[12:15], s60 offen offset:3072 sc1
  buffer_load_dwordx4 a[68:71], v0, s[12:15], s61 offen offset:3072 sc1
  buffer_load_dwordx4 a[124:127], v0, s[12:15], s62 offen offset:3072 sc1
  buffer_load_dwordx4 a[180:183], v0, s[12:15], s63 offen offset:3072 sc1
  buffer_load_dwordx4 a[236:239], v0, s[12:15], s64 offen offset:3072 sc1
  buffer_load_dwordx4 v[156:159], v0, s[12:15], s65 offen offset:3072 sc1
  buffer_load_dwordx4 v[212:215], v0, s[12:15], s66 offen offset:3072 sc1
  s_waitcnt vmcnt(28)
  s_barrier
  v_add_u32 v4, s20, v0
  s_xor_b32 s20, s20, 32768
  s_add_u32 s25, s18, 4
  ds_read_b128 v[72:75], v4 offset:0
  ds_read_b128 v[76:79], v4 offset:14336
  ds_read_b128 v[80:83], v4 offset:1024
  ds_read_b128 v[84:87], v4 offset:15360
  s_waitcnt lgkmcnt(2)
  s_waitcnt vmcnt(21)
  s_add_u32 s60, s60, 4096
  buffer_load_dwordx4 a[16:19], v0, s[12:15], s60 offen offset:0 sc1
  v_mfma_f32_16x16x32_bf16 v[16:19], v[72:75], a[0:3], 0
  v_mfma_f32_16x16x32_bf16 v[20:23], v[76:79], a[0:3], 0
  s_add_u32 s61, s61, 4096
  buffer_load_dwordx4 a[72:75], v0, s[12:15], s61 offen offset:0 sc1
  v_mfma_f32_16x16x32_bf16 v[24:27], v[72:75], a[56:59], 0
  v_mfma_f32_16x16x32_bf16 v[28:31], v[76:79], a[56:59], 0
  s_add_u32 s62, s62, 4096
  buffer_load_dwordx4 a[128:131], v0, s[12:15], s62 offen offset:0 sc1
  v_mfma_f32_16x16x32_bf16 v[32:35], v[72:75], a[112:115], 0
  v_mfma_f32_16x16x32_bf16 v[36:39], v[76:79], a[112:115], 0
  s_add_u32 s63, s63, 4096
  buffer_load_dwordx4 a[184:187], v0, s[12:15], s63 offen offset:0 sc1
  v_mfma_f32_16x16x32_bf16 v[40:43], v[72:75], a[168:171], 0
  v_mfma_f32_16x16x32_bf16 v[44:47], v[76:79], a[168:171], 0
  s_add_u32 s64, s64, 4096
  buffer_load_dwordx4 a[240:243], v0, s[12:15], s64 offen offset:0 sc1
  v_mfma_f32_16x16x32_bf16 v[48:51], v[72:75], a[224:227], 0
  v_mfma_f32_16x16x32_bf16 v[52:55], v[76:79], a[224:227], 0
  s_add_u32 s65, s65, 4096
  buffer_load_dwordx4 v[160:163], v0, s[12:15], s65 offen offset:0 sc1
  v_mfma_f32_16x16x32_bf16 v[56:59], v[72:75], v[144:147], 0
  v_mfma_f32_16x16x32_bf16 v[60:63], v[76:79], v[144:147], 0
  s_add_u32 s66, s66, 4096
  buffer_load_dwordx4 v[216:219], v0, s[12:15], s66 offen offset:0 sc1
  v_mfma_f32_16x16x32_bf16 v[64:67], v[72:75], v[200:203], 0
  v_mfma_f32_16x16x32_bf16 v[68:71], v[76:79], v[200:203], 0
  s_waitcnt lgkmcnt(0)
  s_waitcnt vmcnt(21)
  buffer_load_dwordx4 a[20:23], v0, s[12:15], s60 offen offset:1024 sc1
  v_mfma_f32_16x16x32_bf16 v[16:19], v[80:83], a[4:7], v[16:19]
  v_mfma_f32_16x16x32_bf16 v[20:23], v[84:87], a[4:7], v[20:23]
  ds_read_b128 v[72:75], v4 offset:2048
  ds_read_b128 v[76:79], v4 offset:16384
  buffer_load_dwordx4 a[76:79], v0, s[12:15], s61 offen offset:1024 sc1
  v_mfma_f32_16x16x32_bf16 v[24:27], v[80:83], a[60:63], v[24:27]
  v_mfma_f32_16x16x32_bf16 v[28:31], v[84:87], a[60:63], v[28:31]
  buffer_load_dwordx4 a[132:135], v0, s[12:15], s62 offen offset:1024 sc1
  v_mfma_f32_16x16x32_bf16 v[32:35], v[80:83], a[116:119], v[32:35]
  v_mfma_f32_16x16x32_bf16 v[36:39], v[84:87], a[116:119], v[36:39]
  buffer_load_dwordx4 a[188:191], v0, s[12:15], s63 offen offset:1024 sc1
  v_mfma_f32_16x16x32_bf16 v[40:43], v[80:83], a[172:175], v[40:43]
  v_mfma_f32_16x16x32_bf16 v[44:47], v[84:87], a[172:175], v[44:47]
  buffer_load_dwordx4 a[244:247], v0, s[12:15], s64 offen offset:1024 sc1
  v_mfma_f32_16x16x32_bf16 v[48:51], v[80:83], a[228:231], v[48:51]
  v_mfma_f32_16x16x32_bf16 v[52:55], v[84:87], a[228:231], v[52:55]
  buffer_load_dwordx4 v[164:167], v0, s[12:15], s65 offen offset:1024 sc1
  v_mfma_f32_16x16x32_bf16 v[56:59], v[80:83], v[148:151], v[56:59]
  v_mfma_f32_16x16x32_bf16 v[60:63], v[84:87], v[148:151], v[60:63]
  buffer_load_dwordx4 v[220:223], v0, s[12:15], s66 offen offset:1024 sc1
  v_mfma_f32_16x16x32_bf16 v[64:67], v[80:83], v[204:207], v[64:67]
  v_mfma_f32_16x16x32_bf16 v[68:71], v[84:87], v[204:207], v[68:71]
  s_waitcnt lgkmcnt(0)
  s_waitcnt vmcnt(21)
  buffer_load_dwordx4 a[24:27], v0, s[12:15], s60 offen offset:2048 sc1
  v_mfma_f32_16x16x32_bf16 v[16:19], v[72:75], a[8:11], v[16:19]
  v_mfma_f32_16x16x32_bf16 v[20:23], v[76:79], a[8:11], v[20:23]
  ds_read_b128 v[80:83], v4 offset:3072
  ds_read_b128 v[84:87], v4 offset:17408
  buffer_load_dwordx4 a[80:83], v0, s[12:15], s61 offen offset:2048 sc1
  v_mfma_f32_16x16x32_bf16 v[24:27], v[72:75], a[64:67], v[24:27]
  v_mfma_f32_16x16x32_bf16 v[28:31], v[76:79], a[64:67], v[28:31]
  buffer_load_dwordx4 a[136:139], v0, s[12:15], s62 offen offset:2048 sc1
  v_mfma_f32_16x16x32_bf16 v[32:35], v[72:75], a[120:123], v[32:35]
  v_mfma_f32_16x16x32_bf16 v[36:39], v[76:79], a[120:123], v[36:39]
  buffer_load_dwordx4 a[192:195], v0, s[12:15], s63 offen offset:2048 sc1
  v_mfma_f32_16x16x32_bf16 v[40:43], v[72:75], a[176:179], v[40:43]
  v_mfma_f32_16x16x32_bf16 v[44:47], v[76:79], a[176:179], v[44:47]
  buffer_load_dwordx4 a[248:251], v0, s[12:15], s64 offen offset:2048 sc1
  v_mfma_f32_16x16x32_bf16 v[48:51], v[72:75], a[232:235], v[48:51]
  v_mfma_f32_16x16x32_bf16 v[52:55], v[76:79], a[232:235], v[52:55]
  buffer_load_dwordx4 v[168:171], v0, s[12:15], s65 offen offset:2048 sc1
  v_mfma_f32_16x16x32_bf16 v[56:59], v[72:75], v[152:155], v[56:59]
  v_mfma_f32_16x16x32_bf16 v[60:63], v[76:79], v[152:155], v[60:63]
  buffer_load_dwordx4 v[224:227], v0, s[12:15], s66 offen offset:2048 sc1
  v_mfma_f32_16x16x32_bf16 v[64:67], v[72:75], v[208:211], v[64:67]
  v_mfma_f32_16x16x32_bf16 v[68:71], v[76:79], v[208:211], v[68:71]
  s_waitcnt lgkmcnt(0)
  s_waitcnt vmcnt(21)
  buffer_load_dwordx4 a[28:31], v0, s[12:15], s60 offen offset:3072 sc1
  v_mfma_f32_16x16x32_bf16 v[16:19], v[80:83], a[12:15], v[16:19]
  v_mfma_f32_16x16x32_bf16 v[20:23], v[84:87], a[12:15], v[20:23]
  ds_read_b128 v[72:75], v4 offset:4096
  ds_read_b128 v[76:79], v4 offset:18432
  buffer_load_dwordx4 a[84:87], v0, s[12:15], s61 offen offset:3072 sc1
  v_mfma_f32_16x16x32_bf16 v[24:27], v[80:83], a[68:71], v[24:27]
  v_mfma_f32_16x16x32_bf16 v[28:31], v[84:87], a[68:71], v[28:31]
  buffer_load_dwordx4 a[140:143], v0, s[12:15], s62 offen offset:3072 sc1
  v_mfma_f32_16x16x32_bf16 v[32:35], v[80:83], a[124:127], v[32:35]
  v_mfma_f32_16x16x32_bf16 v[36:39], v[84:87], a[124:127], v[36:39]
  buffer_load_dwordx4 a[196:199], v0, s[12:15], s63 offen offset:3072 sc1
  v_mfma_f32_16x16x32_bf16 v[40:43], v[80:83], a[180:183], v[40:43]
  v_mfma_f32_16x16x32_bf16 v[44:47], v[84:87], a[180:183], v[44:47]
  buffer_load_dwordx4 a[252:255], v0, s[12:15], s64 offen offset:3072 sc1
  v_mfma_f32_16x16x32_bf16 v[48:51], v[80:83], a[236:239], v[48:51]
  v_mfma_f32_16x16x32_bf16 v[52:55], v[84:87], a[236:239], v[52:55]
  buffer_load_dwordx4 v[172:175], v0, s[12:15], s65 offen offset:3072 sc1
  v_mfma_f32_16x16x32_bf16 v[56:59], v[80:83], v[156:159], v[56:59]
  v_mfma_f32_16x16x32_bf16 v[60:63], v[84:87], v[156:159], v[60:63]
  buffer_load_dwordx4 v[228:231], v0, s[12:15], s66 offen offset:3072 sc1
  v_mfma_f32_16x16x32_bf16 v[64:67], v[80:83], v[212:215], v[64:67]
  v_mfma_f32_16x16x32_bf16 v[68:71], v[84:87], v[212:215], v[68:71]
  s_waitcnt lgkmcnt(0)
  s_waitcnt vmcnt(21)
  s_add_u32 s60, s60, 4096
  buffer_load_dwordx4 a[32:35], v0, s[12:15], s60 offen offset:0 sc1
  v_mfma_f32_16x16x32_bf16 v[16:19], v[72:75], a[16:19], v[16:19]
  v_mfma_f32_16x16x32_bf16 v[20:23], v[76:79], a[16:19], v[20:23]
  ds_read_b128 v[80:83], v4 offset:5120
  ds_read_b128 v[84:87], v4 offset:19456
  s_add_u32 s61, s61, 4096
  buffer_load_dwordx4 a[88:91], v0, s[12:15], s61 offen offset:0 sc1
  v_mfma_f32_16x16x32_bf16 v[24:27], v[72:75], a[72:75], v[24:27]
  v_mfma_f32_16x16x32_bf16 v[28:31], v[76:79], a[72:75], v[28:31]
  s_add_u32 s62, s62, 4096
  buffer_load_dwordx4 a[144:147], v0, s[12:15], s62 offen offset:0 sc1
  v_mfma_f32_16x16x32_bf16 v[32:35], v[72:75], a[128:131], v[32:35]
  v_mfma_f32_16x16x32_bf16 v[36:39], v[76:79], a[128:131], v[36:39]
  s_add_u32 s63, s63, 4096
  buffer_load_dwordx4 a[200:203], v0, s[12:15], s63 offen offset:0 sc1
  v_mfma_f32_16x16x32_bf16 v[40:43], v[72:75], a[184:187], v[40:43]
  v_mfma_f32_16x16x32_bf16 v[44:47], v[76:79], a[184:187], v[44:47]
  s_add_u32 s64, s64, 4096
  buffer_load_dwordx4 v[120:123], v0, s[12:15], s64 offen offset:0 sc1
  v_mfma_f32_16x16x32_bf16 v[48:51], v[72:75], a[240:243], v[48:51]
  v_mfma_f32_16x16x32_bf16 v[52:55], v[76:79], a[240:243], v[52:55]
  s_add_u32 s65, s65, 4096
  buffer_load_dwordx4 v[176:179], v0, s[12:15], s65 offen offset:0 sc1
  v_mfma_f32_16x16x32_bf16 v[56:59], v[72:75], v[160:163], v[56:59]
  v_mfma_f32_16x16x32_bf16 v[60:63], v[76:79], v[160:163], v[60:63]
  s_add_u32 s66, s66, 4096
  buffer_load_dwordx4 v[232:235], v0, s[12:15], s66 offen offset:0 sc1
  v_mfma_f32_16x16x32_bf16 v[64:67], v[72:75], v[216:219], v[64:67]
  v_mfma_f32_16x16x32_bf16 v[68:71], v[76:79], v[216:219], v[68:71]
  s_waitcnt lgkmcnt(0)
  s_waitcnt vmcnt(21)
  buffer_load_dwordx4 a[36:39], v0, s[12:15], s60 offen offset:1024 sc1
  v_mfma_f32_16x16x32_bf16 v[16:19], v[80:83], a[20:23], v[16:19]
  v_mfma_f32_16x16x32_bf16 v[20:23], v[84:87], a[20:23], v[20:23]
  ds_read_b128 v[72:75], v4 offset:6144
  ds_read_b128 v[76:79], v4 offset:20480
  buffer_load_dwordx4 a[92:95], v0, s[12:15], s61 offen offset:1024 sc1
  v_mfma_f32_16x16x32_bf16 v[24:27], v[80:83], a[76:79], v[24:27]
  v_mfma_f32_16x16x32_bf16 v[28:31], v[84:87], a[76:79], v[28:31]
  buffer_load_dwordx4 a[148:151], v0, s[12:15], s62 offen offset:1024 sc1
  v_mfma_f32_16x16x32_bf16 v[32:35], v[80:83], a[132:135], v[32:35]
  v_mfma_f32_16x16x32_bf16 v[36:39], v[84:87], a[132:135], v[36:39]
  buffer_load_dwordx4 a[204:207], v0, s[12:15], s63 offen offset:1024 sc1
  v_mfma_f32_16x16x32_bf16 v[40:43], v[80:83], a[188:191], v[40:43]
  v_mfma_f32_16x16x32_bf16 v[44:47], v[84:87], a[188:191], v[44:47]
  buffer_load_dwordx4 v[124:127], v0, s[12:15], s64 offen offset:1024 sc1
  v_mfma_f32_16x16x32_bf16 v[48:51], v[80:83], a[244:247], v[48:51]
  v_mfma_f32_16x16x32_bf16 v[52:55], v[84:87], a[244:247], v[52:55]
  buffer_load_dwordx4 v[180:183], v0, s[12:15], s65 offen offset:1024 sc1
  v_mfma_f32_16x16x32_bf16 v[56:59], v[80:83], v[164:167], v[56:59]
  v_mfma_f32_16x16x32_bf16 v[60:63], v[84:87], v[164:167], v[60:63]
  buffer_load_dwordx4 v[236:239], v0, s[12:15], s66 offen offset:1024 sc1
  v_mfma_f32_16x16x32_bf16 v[64:67], v[80:83], v[220:223], v[64:67]
  v_mfma_f32_16x16x32_bf16 v[68:71], v[84:87], v[220:223], v[68:71]
  s_waitcnt lgkmcnt(0)
  s_waitcnt vmcnt(21)
  buffer_load_dwordx4 a[40:43], v0, s[12:15], s60 offen offset:2048 sc1
  v_mfma_f32_16x16x32_bf16 v[16:19], v[72:75], a[24:27], v[16:19]
  v_mfma_f32_16x16x32_bf16 v[20:23], v[76:79], a[24:27], v[20:23]
  ds_read_b128 v[80:83], v4 offset:7168
  ds_read_b128 v[84:87], v4 offset:21504
  buffer_load_dwordx4 a[96:99], v0, s[12:15], s61 offen offset:2048 sc1
  v_mfma_f32_16x16x32_bf16 v[24:27], v[72:75], a[80:83], v[24:27]
  v_mfma_f32_16x16x32_bf16 v[28:31], v[76:79], a[80:83], v[28:31]
  buffer_load_dwordx4 a[152:155], v0, s[12:15], s62 offen offset:2048 sc1
  v_mfma_f32_16x16x32_bf16 v[32:35], v[72:75], a[136:139], v[32:35]
  v_mfma_f32_16x16x32_bf16 v[36:39], v[76:79], a[136:139], v[36:39]
  buffer_load_dwordx4 a[208:211], v0, s[12:15], s63 offen offset:2048 sc1
  v_mfma_f32_16x16x32_bf16 v[40:43], v[72:75], a[192:195], v[40:43]
  v_mfma_f32_16x16x32_bf16 v[44:47], v[76:79], a[192:195], v[44:47]
  buffer_load_dwordx4 v[128:131], v0, s[12:15], s64 offen offset:2048 sc1
  v_mfma_f32_16x16x32_bf16 v[48:51], v[72:75], a[248:251], v[48:51]
  v_mfma_f32_16x16x32_bf16 v[52:55], v[76:79], a[248:251], v[52:55]
  buffer_load_dwordx4 v[184:187], v0, s[12:15], s65 offen offset:2048 sc1
  v_mfma_f32_16x16x32_bf16 v[56:59], v[72:75], v[168:171], v[56:59]
  v_mfma_f32_16x16x32_bf16 v[60:63], v[76:79], v[168:171], v[60:63]
  buffer_load_dwordx4 v[240:243], v0, s[12:15], s66 offen offset:2048 sc1
  v_mfma_f32_16x16x32_bf16 v[64:67], v[72:75], v[224:227], v[64:67]
  v_mfma_f32_16x16x32_bf16 v[68:71], v[76:79], v[224:227], v[68:71]
  s_waitcnt lgkmcnt(0)
  s_waitcnt vmcnt(21)
  buffer_load_dwordx4 a[44:47], v0, s[12:15], s60 offen offset:3072 sc1
  v_mfma_f32_16x16x32_bf16 v[16:19], v[80:83], a[28:31], v[16:19]
  v_mfma_f32_16x16x32_bf16 v[20:23], v[84:87], a[28:31], v[20:23]
  ds_read_b128 v[72:75], v4 offset:8192
  ds_read_b128 v[76:79], v4 offset:22528
  buffer_load_dwordx4 a[100:103], v0, s[12:15], s61 offen offset:3072 sc1
  v_mfma_f32_16x16x32_bf16 v[24:27], v[80:83], a[84:87], v[24:27]
  v_mfma_f32_16x16x32_bf16 v[28:31], v[84:87], a[84:87], v[28:31]
  buffer_load_dwordx4 a[156:159], v0, s[12:15], s62 offen offset:3072 sc1
  v_mfma_f32_16x16x32_bf16 v[32:35], v[80:83], a[140:143], v[32:35]
  v_mfma_f32_16x16x32_bf16 v[36:39], v[84:87], a[140:143], v[36:39]
  buffer_load_dwordx4 a[212:215], v0, s[12:15], s63 offen offset:3072 sc1
  v_mfma_f32_16x16x32_bf16 v[40:43], v[80:83], a[196:199], v[40:43]
  v_mfma_f32_16x16x32_bf16 v[44:47], v[84:87], a[196:199], v[44:47]
  buffer_load_dwordx4 v[132:135], v0, s[12:15], s64 offen offset:3072 sc1
  v_mfma_f32_16x16x32_bf16 v[48:51], v[80:83], a[252:255], v[48:51]
  v_mfma_f32_16x16x32_bf16 v[52:55], v[84:87], a[252:255], v[52:55]
  buffer_load_dwordx4 v[188:191], v0, s[12:15], s65 offen offset:3072 sc1
  v_mfma_f32_16x16x32_bf16 v[56:59], v[80:83], v[172:175], v[56:59]
  v_mfma_f32_16x16x32_bf16 v[60:63], v[84:87], v[172:175], v[60:63]
  buffer_load_dwordx4 v[244:247], v0, s[12:15], s66 offen offset:3072 sc1
  v_mfma_f32_16x16x32_bf16 v[64:67], v[80:83], v[228:231], v[64:67]
  v_mfma_f32_16x16x32_bf16 v[68:71], v[84:87], v[228:231], v[68:71]
  s_waitcnt lgkmcnt(0)
  s_waitcnt vmcnt(21)
  s_add_u32 s60, s60, 4096
  buffer_load_dwordx4 a[48:51], v0, s[12:15], s60 offen offset:0 sc1
  v_mfma_f32_16x16x32_bf16 v[16:19], v[72:75], a[32:35], v[16:19]
  v_mfma_f32_16x16x32_bf16 v[20:23], v[76:79], a[32:35], v[20:23]
  ds_read_b128 v[80:83], v4 offset:9216
  ds_read_b128 v[84:87], v4 offset:23552
  s_add_u32 s61, s61, 4096
  buffer_load_dwordx4 a[104:107], v0, s[12:15], s61 offen offset:0 sc1
  v_mfma_f32_16x16x32_bf16 v[24:27], v[72:75], a[88:91], v[24:27]
  v_mfma_f32_16x16x32_bf16 v[28:31], v[76:79], a[88:91], v[28:31]
  s_add_u32 s62, s62, 4096
  buffer_load_dwordx4 a[160:163], v0, s[12:15], s62 offen offset:0 sc1
  v_mfma_f32_16x16x32_bf16 v[32:35], v[72:75], a[144:147], v[32:35]
  v_mfma_f32_16x16x32_bf16 v[36:39], v[76:79], a[144:147], v[36:39]
  s_add_u32 s63, s63, 4096
  buffer_load_dwordx4 a[216:219], v0, s[12:15], s63 offen offset:0 sc1
  v_mfma_f32_16x16x32_bf16 v[40:43], v[72:75], a[200:203], v[40:43]
  v_mfma_f32_16x16x32_bf16 v[44:47], v[76:79], a[200:203], v[44:47]
  s_add_u32 s64, s64, 4096
  buffer_load_dwordx4 v[136:139], v0, s[12:15], s64 offen offset:0 sc1
  v_mfma_f32_16x16x32_bf16 v[48:51], v[72:75], v[120:123], v[48:51]
  v_mfma_f32_16x16x32_bf16 v[52:55], v[76:79], v[120:123], v[52:55]
  s_add_u32 s65, s65, 4096
  buffer_load_dwordx4 v[192:195], v0, s[12:15], s65 offen offset:0 sc1
  v_mfma_f32_16x16x32_bf16 v[56:59], v[72:75], v[176:179], v[56:59]
  v_mfma_f32_16x16x32_bf16 v[60:63], v[76:79], v[176:179], v[60:63]
  s_add_u32 s66, s66, 4096
  buffer_load_dwordx4 v[248:251], v0, s[12:15], s66 offen offset:0 sc1
  v_mfma_f32_16x16x32_bf16 v[64:67], v[72:75], v[232:235], v[64:67]
  v_mfma_f32_16x16x32_bf16 v[68:71], v[76:79], v[232:235], v[68:71]
  s_waitcnt lgkmcnt(0)
  s_waitcnt vmcnt(21)
  buffer_load_dwordx4 a[52:55], v0, s[12:15], s60 offen offset:1024 sc1
  v_mfma_f32_16x16x32_bf16 v[16:19], v[80:83], a[36:39], v[16:19]
  v_mfma_f32_16x16x32_bf16 v[20:23], v[84:87], a[36:39], v[20:23]
  ds_read_b128 v[72:75], v4 offset:10240
  ds_read_b128 v[76:79], v4 offset:24576
  buffer_load_dwordx4 a[108:111], v0, s[12:15], s61 offen offset:1024 sc1
  v_mfma_f32_16x16x32_bf16 v[24:27], v[80:83], a[92:95], v[24:27]
  v_mfma_f32_16x16x32_bf16 v[28:31], v[84:87], a[92:95], v[28:31]
  buffer_load_dwordx4 a[164:167], v0, s[12:15], s62 offen offset:1024 sc1
  v_mfma_f32_16x16x32_bf16 v[32:35], v[80:83], a[148:151], v[32:35]
  v_mfma_f32_16x16x32_bf16 v[36:39], v[84:87], a[148:151], v[36:39]
  buffer_load_dwordx4 a[220:223], v0, s[12:15], s63 offen offset:1024 sc1
  v_mfma_f32_16x16x32_bf16 v[40:43], v[80:83], a[204:207], v[40:43]
  v_mfma_f32_16x16x32_bf16 v[44:47], v[84:87], a[204:207], v[44:47]
  buffer_load_dwordx4 v[140:143], v0, s[12:15], s64 offen offset:1024 sc1
  v_mfma_f32_16x16x32_bf16 v[48:51], v[80:83], v[124:127], v[48:51]
  v_mfma_f32_16x16x32_bf16 v[52:55], v[84:87], v[124:127], v[52:55]
  buffer_load_dwordx4 v[196:199], v0, s[12:15], s65 offen offset:1024 sc1
  v_mfma_f32_16x16x32_bf16 v[56:59], v[80:83], v[180:183], v[56:59]
  v_mfma_f32_16x16x32_bf16 v[60:63], v[84:87], v[180:183], v[60:63]
  buffer_load_dwordx4 v[252:255], v0, s[12:15], s66 offen offset:1024 sc1
  v_mfma_f32_16x16x32_bf16 v[64:67], v[80:83], v[236:239], v[64:67]
  v_mfma_f32_16x16x32_bf16 v[68:71], v[84:87], v[236:239], v[68:71]
  s_waitcnt lgkmcnt(0)
  s_mul_i32 s34, s25, 28672
  s_mul_i32 s35, s17, 7168
  s_add_u32 s34, s34, s35
  s_add_u32 s34, s34, 56623104
  s_add_u32 m0, s35, s20
  s_nop 0
  buffer_load_dwordx4 v0, s[12:15], s34 offen offset:0 sc1 lds
  buffer_load_dwordx4 v0, s[12:15], s34 offen offset:1024 sc1 lds
  buffer_load_dwordx4 v0, s[12:15], s34 offen offset:2048 sc1 lds
  buffer_load_dwordx4 v0, s[12:15], s34 offen offset:3072 sc1 lds
  s_add_u32 s34, s34, 4096
  s_add_u32 m0, m0, 4096
  s_nop 0
  buffer_load_dwordx4 v0, s[12:15], s34 offen offset:0 sc1 lds
  buffer_load_dwordx4 v0, s[12:15], s34 offen offset:1024 sc1 lds
  buffer_load_dwordx4 v0, s[12:15], s34 offen offset:2048 sc1 lds
  s_waitcnt vmcnt(28)
  v_mfma_f32_16x16x32_bf16 v[16:19], v[72:75], a[40:43], v[16:19]
  v_mfma_f32_16x16x32_bf16 v[20:23], v[76:79], a[40:43], v[20:23]
  ds_read_b128 v[80:83], v4 offset:11264
  ds_read_b128 v[84:87], v4 offset:25600
  v_mfma_f32_16x16x32_bf16 v[24:27], v[72:75], a[96:99], v[24:27]
  v_mfma_f32_16x16x32_bf16 v[28:31], v[76:79], a[96:99], v[28:31]
  v_mfma_f32_16x16x32_bf16 v[32:35], v[72:75], a[152:155], v[32:35]
  v_mfma_f32_16x16x32_bf16 v[36:39], v[76:79], a[152:155], v[36:39]
  v_mfma_f32_16x16x32_bf16 v[40:43], v[72:75], a[208:211], v[40:43]
  v_mfma_f32_16x16x32_bf16 v[44:47], v[76:79], a[208:211], v[44:47]
  v_mfma_f32_16x16x32_bf16 v[48:51], v[72:75], v[128:131], v[48:51]
  v_mfma_f32_16x16x32_bf16 v[52:55], v[76:79], v[128:131], v[52:55]
  v_mfma_f32_16x16x32_bf16 v[56:59], v[72:75], v[184:187], v[56:59]
  v_mfma_f32_16x16x32_bf16 v[60:63], v[76:79], v[184:187], v[60:63]
  v_mfma_f32_16x16x32_bf16 v[64:67], v[72:75], v[240:243], v[64:67]
  v_mfma_f32_16x16x32_bf16 v[68:71], v[76:79], v[240:243], v[68:71]
  s_waitcnt lgkmcnt(0)
  s_waitcnt vmcnt(21)
  v_mfma_f32_16x16x32_bf16 v[16:19], v[80:83], a[44:47], v[16:19]
  v_mfma_f32_16x16x32_bf16 v[20:23], v[84:87], a[44:47], v[20:23]
  ds_read_b128 v[72:75], v4 offset:12288
  ds_read_b128 v[76:79], v4 offset:26624
  v_mfma_f32_16x16x32_bf16 v[24:27], v[80:83], a[100:103], v[24:27]
  v_mfma_f32_16x16x32_bf16 v[28:31], v[84:87], a[100:103], v[28:31]
  v_mfma_f32_16x16x32_bf16 v[32:35], v[80:83], a[156:159], v[32:35]
  v_mfma_f32_16x16x32_bf16 v[36:39], v[84:87], a[156:159], v[36:39]
  v_mfma_f32_16x16x32_bf16 v[40:43], v[80:83], a[212:215], v[40:43]
  v_mfma_f32_16x16x32_bf16 v[44:47], v[84:87], a[212:215], v[44:47]
  v_mfma_f32_16x16x32_bf16 v[48:51], v[80:83], v[132:135], v[48:51]
  v_mfma_f32_16x16x32_bf16 v[52:55], v[84:87], v[132:135], v[52:55]
  v_mfma_f32_16x16x32_bf16 v[56:59], v[80:83], v[188:191], v[56:59]
  v_mfma_f32_16x16x32_bf16 v[60:63], v[84:87], v[188:191], v[60:63]
  v_mfma_f32_16x16x32_bf16 v[64:67], v[80:83], v[244:247], v[64:67]
  v_mfma_f32_16x16x32_bf16 v[68:71], v[84:87], v[244:247], v[68:71]
  s_waitcnt lgkmcnt(0)
  s_waitcnt vmcnt(14)
  v_mfma_f32_16x16x32_bf16 v[16:19], v[72:75], a[48:51], v[16:19]
  v_mfma_f32_16x16x32_bf16 v[20:23], v[76:79], a[48:51], v[20:23]
  ds_read_b128 v[80:83], v4 offset:13312
  ds_read_b128 v[84:87], v4 offset:27648
  v_mfma_f32_16x16x32_bf16 v[24:27], v[72:75], a[104:107], v[24:27]
  v_mfma_f32_16x16x32_bf16 v[28:31], v[76:79], a[104:107], v[28:31]
  v_mfma_f32_16x16x32_bf16 v[32:35], v[72:75], a[160:163], v[32:35]
  v_mfma_f32_16x16x32_bf16 v[36:39], v[76:79], a[160:163], v[36:39]
  v_mfma_f32_16x16x32_bf16 v[40:43], v[72:75], a[216:219], v[40:43]
  v_mfma_f32_16x16x32_bf16 v[44:47], v[76:79], a[216:219], v[44:47]
  v_mfma_f32_16x16x32_bf16 v[48:51], v[72:75], v[136:139], v[48:51]
  v_mfma_f32_16x16x32_bf16 v[52:55], v[76:79], v[136:139], v[52:55]
  v_mfma_f32_16x16x32_bf16 v[56:59], v[72:75], v[192:195], v[56:59]
  v_mfma_f32_16x16x32_bf16 v[60:63], v[76:79], v[192:195], v[60:63]
  v_mfma_f32_16x16x32_bf16 v[64:67], v[72:75], v[248:251], v[64:67]
  v_mfma_f32_16x16x32_bf16 v[68:71], v[76:79], v[248:251], v[68:71]
  s_waitcnt lgkmcnt(0)
  s_waitcnt vmcnt(7)
  v_mfma_f32_16x16x32_bf16 v[16:19], v[80:83], a[52:55], v[16:19]
  v_mfma_f32_16x16x32_bf16 v[20:23], v[84:87], a[52:55], v[20:23]
  v_mfma_f32_16x16x32_bf16 v[24:27], v[80:83], a[108:111], v[24:27]
  v_mfma_f32_16x16x32_bf16 v[28:31], v[84:87], a[108:111], v[28:31]
  v_mfma_f32_16x16x32_bf16 v[32:35], v[80:83], a[164:167], v[32:35]
  v_mfma_f32_16x16x32_bf16 v[36:39], v[84:87], a[164:167], v[36:39]
  v_mfma_f32_16x16x32_bf16 v[40:43], v[80:83], a[220:223], v[40:43]
  v_mfma_f32_16x16x32_bf16 v[44:47], v[84:87], a[220:223], v[44:47]
  v_mfma_f32_16x16x32_bf16 v[48:51], v[80:83], v[140:143], v[48:51]
  v_mfma_f32_16x16x32_bf16 v[52:55], v[84:87], v[140:143], v[52:55]
  v_mfma_f32_16x16x32_bf16 v[56:59], v[80:83], v[196:199], v[56:59]
  v_mfma_f32_16x16x32_bf16 v[60:63], v[84:87], v[196:199], v[60:63]
  v_mfma_f32_16x16x32_bf16 v[64:67], v[80:83], v[252:255], v[64:67]
  v_mfma_f32_16x16x32_bf16 v[68:71], v[84:87], v[252:255], v[68:71]
  s_branch Vepi_256
Vtop_257:
  s_cmp_ge_u32 s18, 8
  s_cbranch_scc1 nf_258
  s_waitcnt vmcnt(0)
  s_barrier
  s_cmp_lg_u32 s17, 0
  s_cbranch_scc1 w0_261
  buffer_store_dword v2, v3, s[12:15], s24 offen sc1
w0_261:
  s_cmp_lg_u32 s17, 0
  s_cbranch_scc1 wa_262
  s_lshr_b32 s34, s46, 5
  s_lshl_b32 s34, s34, 7
  s_add_u32 s34, s34, 46927872
  v_mov_b32 v8, 0
  s_mov_b32 s23, 300000
fp_263:
  buffer_load_dword v9, v8, s[12:15], s34 offen sc1
  s_waitcnt vmcnt(0)
  v_cmp_gt_u32 vcc, 1, v9
  s_cbranch_vccz fpd_264
  s_sleep 4
  s_sub_u32 s23, s23, 1
  s_cbranch_scc0 fp_263
  s_branch L_exit
fpd_264:
wa_262:
  s_barrier
nf_258:
  v_add_u32 v4, s20, v0
  s_xor_b32 s20, s20, 32768
  s_add_u32 s25, s18, 4
  ds_read_b128 v[72:75], v4 offset:0
  ds_read_b128 v[76:79], v4 offset:14336
  ds_read_b128 v[80:83], v4 offset:1024
  ds_read_b128 v[84:87], v4 offset:15360
  s_waitcnt lgkmcnt(2)
  v_mfma_f32_16x16x32_bf16 v[16:19], v[72:75], a[0:3], 0
  v_mfma_f32_16x16x32_bf16 v[20:23], v[76:79], a[0:3], 0
  v_mfma_f32_16x16x32_bf16 v[24:27], v[72:75], a[56:59], 0
  v_mfma_f32_16x16x32_bf16 v[28:31], v[76:79], a[56:59], 0
  v_mfma_f32_16x16x32_bf16 v[32:35], v[72:75], a[112:115], 0
  v_mfma_f32_16x16x32_bf16 v[36:39], v[76:79], a[112:115], 0
  v_mfma_f32_16x16x32_bf16 v[40:43], v[72:75], a[168:171], 0
  v_mfma_f32_16x16x32_bf16 v[44:47], v[76:79], a[168:171], 0
  v_mfma_f32_16x16x32_bf16 v[48:51], v[72:75], a[224:227], 0
  v_mfma_f32_16x16x32_bf16 v[52:55], v[76:79], a[224:227], 0
  v_mfma_f32_16x16x32_bf16 v[56:59], v[72:75], v[144:147], 0
  v_mfma_f32_16x16x32_bf16 v[60:63], v[76:79], v[144:147], 0
  v_mfma_f32_16x16x32_bf16 v[64:67], v[72:75], v[200:203], 0
  v_mfma_f32_16x16x32_bf16 v[68:71], v[76:79], v[200:203], 0
  s_waitcnt lgkmcnt(0)
  v_mfma_f32_16x16x32_bf16 v[16:19], v[80:83], a[4:7], v[16:19]
  v_mfma_f32_16x16x32_bf16 v[20:23], v[84:87], a[4:7], v[20:23]
  ds_read_b128 v[72:75], v4 offset:2048
  ds_read_b128 v[76:79], v4 offset:16384
  v_mfma_f32_16x16x32_bf16 v[24:27], v[80:83], a[60:63], v[24:27]
  v_mfma_f32_16x16x32_bf16 v[28:31], v[84:87], a[60:63], v[28:31]
  v_mfma_f32_16x16x32_bf16 v[32:35], v[80:83], a[116:119], v[32:35]
  v_mfma_f32_16x16x32_bf16 v[36:39], v[84:87], a[116:119], v[36:39]
  v_mfma_f32_16x16x32_bf16 v[40:43], v[80:83], a[172:175], v[40:43]
  v_mfma_f32_16x16x32_bf16 v[44:47], v[84:87], a[172:175], v[44:47]
  v_mfma_f32_16x16x32_bf16 v[48:51], v[80:83], a[228:231], v[48:51]
  v_mfma_f32_16x16x32_bf16 v[52:55], v[84:87], a[228:231], v[52:55]
  v_mfma_f32_16x16x32_bf16 v[56:59], v[80:83], v[148:151], v[56:59]
  v_mfma_f32_16x16x32_bf16 v[60:63], v[84:87], v[148:151], v[60:63]
  v_mfma_f32_16x16x32_bf16 v[64:67], v[80:83], v[204:207], v[64:67]
  v_mfma_f32_16x16x32_bf16 v[68:71], v[84:87], v[204:207], v[68:71]
  s_waitcnt lgkmcnt(0)
  v_mfma_f32_16x16x32_bf16 v[16:19], v[72:75], a[8:11], v[16:19]
  v_mfma_f32_16x16x32_bf16 v[20:23], v[76:79], a[8:11], v[20:23]
  ds_read_b128 v[80:83], v4 offset:3072
  ds_read_b128 v[84:87], v4 offset:17408
  v_mfma_f32_16x16x32_bf16 v[24:27], v[72:75], a[64:67], v[24:27]
  v_mfma_f32_16x16x32_bf16 v[28:31], v[76:79], a[64:67], v[28:31]
  v_mfma_f32_16x16x32_bf16 v[32:35], v[72:75], a[120:123], v[32:35]
  v_mfma_f32_16x16x32_bf16 v[36:39], v[76:79], a[120:123], v[36:39]
  v_mfma_f32_16x16x32_bf16 v[40:43], v[72:75], a[176:179], v[40:43]
  v_mfma_f32_16x16x32_bf16 v[44:47], v[76:79], a[176:179], v[44:47]
  v_mfma_f32_16x16x32_bf16 v[48:51], v[72:75], a[232:235], v[48:51]
  v_mfma_f32_16x16x32_bf16 v[52:55], v[76:79], a[232:235], v[52:55]
  v_mfma_f32_16x16x32_bf16 v[56:59], v[72:75], v[152:155], v[56:59]
  v_mfma_f32_16x16x32_bf16 v[60:63], v[76:79], v[152:155], v[60:63]
  v_mfma_f32_16x16x32_bf16 v[64:67], v[72:75], v[208:211], v[64:67]
  v_mfma_f32_16x16x32_bf16 v[68:71], v[76:79], v[208:211], v[68:71]
  s_waitcnt lgkmcnt(0)
  v_mfma_f32_16x16x32_bf16 v[16:19], v[80:83], a[12:15], v[16:19]
  v_mfma_f32_16x16x32_bf16 v[20:23], v[84:87], a[12:15], v[20:23]
  ds_read_b128 v[72:75], v4 offset:4096
  ds_read_b128 v[76:79], v4 offset:18432
  v_mfma_f32_16x16x32_bf16 v[24:27], v[80:83], a[68:71], v[24:27]
  v_mfma_f32_16x16x32_bf16 v[28:31], v[84:87], a[68:71], v[28:31]
  v_mfma_f32_16x16x32_bf16 v[32:35], v[80:83], a[124:127], v[32:35]
  v_mfma_f32_16x16x32_bf16 v[36:39], v[84:87], a[124:127], v[36:39]
  v_mfma_f32_16x16x32_bf16 v[40:43], v[80:83], a[180:183], v[40:43]
  v_mfma_f32_16x16x32_bf16 v[44:47], v[84:87], a[180:183], v[44:47]
  v_mfma_f32_16x16x32_bf16 v[48:51], v[80:83], a[236:239], v[48:51]
  v_mfma_f32_16x16x32_bf16 v[52:55], v[84:87], a[236:239], v[52:55]
  v_mfma_f32_16x16x32_bf16 v[56:59], v[80:83], v[156:159], v[56:59]
  v_mfma_f32_16x16x32_bf16 v[60:63], v[84:87], v[156:159], v[60:63]
  v_mfma_f32_16x16x32_bf16 v[64:67], v[80:83], v[212:215], v[64:67]
  v_mfma_f32_16x16x32_bf16 v[68:71], v[84:87], v[212:215], v[68:71]
  s_waitcnt lgkmcnt(0)
  v_mfma_f32_16x16x32_bf16 v[16:19], v[72:75], a[16:19], v[16:19]
  v_mfma_f32_16x16x32_bf16 v[20:23], v[76:79], a[16:19], v[20:23]
  ds_read_b128 v[80:83], v4 offset:5120
  ds_read_b128 v[84:87], v4 offset:19456
  v_mfma_f32_16x16x32_bf16 v[24:27], v[72:75], a[72:75], v[24:27]
  v_mfma_f32_16x16x32_bf16 v[28:31], v[76:79], a[72:75], v[28:31]
  v_mfma_f32_16x16x32_bf16 v[32:35], v[72:75], a[128:131], v[32:35]
  v_mfma_f32_16x16x32_bf16 v[36:39], v[76:79], a[128:131], v[36:39]
  v_mfma_f32_16x16x32_bf16 v[40:43], v[72:75], a[184:187], v[40:43]
  v_mfma_f32_16x16x32_bf16 v[44:47], v[76:79], a[184:187], v[44:47]
  v_mfma_f32_16x16x32_bf16 v[48:51], v[72:75], a[240:243], v[48:51]
  v_mfma_f32_16x16x32_bf16 v[52:55], v[76:79], a[240:243], v[52:55]
  v_mfma_f32_16x16x32_bf16 v[56:59], v[72:75], v[160:163], v[56:59]
  v_mfma_f32_16x16x32_bf16 v[60:63], v[76:79], v[160:163], v[60:63]
  v_mfma_f32_16x16x32_bf16 v[64:67], v[72:75], v[216:219], v[64:67]
  v_mfma_f32_16x16x32_bf16 v[68:71], v[76:79], v[216:219], v[68:71]
  s_waitcnt lgkmcnt(0)
  v_mfma_f32_16x16x32_bf16 v[16:19], v[80:83], a[20:23], v[16:19]
  v_mfma_f32_16x16x32_bf16 v[20:23], v[84:87], a[20:23], v[20:23]
  ds_read_b128 v[72:75], v4 offset:6144
  ds_read_b128 v[76:79], v4 offset:20480
  v_mfma_f32_16x16x32_bf16 v[24:27], v[80:83], a[76:79], v[24:27]
  v_mfma_f32_16x16x32_bf16 v[28:31], v[84:87], a[76:79], v[28:31]
  v_mfma_f32_16x16x32_bf16 v[32:35], v[80:83], a[132:135], v[32:35]
  v_mfma_f32_16x16x32_bf16 v[36:39], v[84:87], a[132:135], v[36:39]
  s_waitcnt vmcnt(0)
  s_barrier
  s_cmp_lg_u32 s17, 0
  s_cbranch_scc1 w0_265
  buffer_store_dword v2, v3, s[12:15], s24 offen sc1
w0_265:
  s_cmp_ge_u32 s25, 64
  s_cbranch_scc1 nd_259
  s_mul_i32 s34, s25, 28672
  s_mul_i32 s35, s17, 7168
  s_add_u32 s34, s34, s35
  s_add_u32 s34, s34, 56623104
  s_add_u32 m0, s35, s20
  s_nop 0
  buffer_load_dwordx4 v0, s[12:15], s34 offen offset:0 sc1 lds
  buffer_load_dwordx4 v0, s[12:15], s34 offen offset:1024 sc1 lds
  buffer_load_dwordx4 v0, s[12:15], s34 offen offset:2048 sc1 lds
  buffer_load_dwordx4 v0, s[12:15], s34 offen offset:3072 sc1 lds
  s_add_u32 s34, s34, 4096
  s_add_u32 m0, m0, 4096
  s_nop 0
  buffer_load_dwordx4 v0, s[12:15], s34 offen offset:0 sc1 lds
  buffer_load_dwordx4 v0, s[12:15], s34 offen offset:1024 sc1 lds
  buffer_load_dwordx4 v0, s[12:15], s34 offen offset:2048 sc1 lds
nd_259:
  v_mfma_f32_16x16x32_bf16 v[40:43], v[80:83], a[188:191], v[40:43]
  v_mfma_f32_16x16x32_bf16 v[44:47], v[84:87], a[188:191], v[44:47]
  v_mfma_f32_16x16x32_bf16 v[48:51], v[80:83], a[244:247], v[48:51]
  v_mfma_f32_16x16x32_bf16 v[52:55], v[84:87], a[244:247], v[52:55]
  v_mfma_f32_16x16x32_bf16 v[56:59], v[80:83], v[164:167], v[56:59]
  v_mfma_f32_16x16x32_bf16 v[60:63], v[84:87], v[164:167], v[60:63]
  v_mfma_f32_16x16x32_bf16 v[64:67], v[80:83], v[220:223], v[64:67]
  v_mfma_f32_16x16x32_bf16 v[68:71], v[84:87], v[220:223], v[68:71]
  s_waitcnt lgkmcnt(0)
  v_mfma_f32_16x16x32_bf16 v[16:19], v[72:75], a[24:27], v[16:19]
  v_mfma_f32_16x16x32_bf16 v[20:23], v[76:79], a[24:27], v[20:23]
  ds_read_b128 v[80:83], v4 offset:7168
  ds_read_b128 v[84:87], v4 offset:21504
  v_mfma_f32_16x16x32_bf16 v[24:27], v[72:75], a[80:83], v[24:27]
  v_mfma_f32_16x16x32_bf16 v[28:31], v[76:79], a[80:83], v[28:31]
  v_mfma_f32_16x16x32_bf16 v[32:35], v[72:75], a[136:139], v[32:35]
  v_mfma_f32_16x16x32_bf16 v[36:39], v[76:79], a[136:139], v[36:39]
  v_mfma_f32_16x16x32_bf16 v[40:43], v[72:75], a[192:195], v[40:43]
  v_mfma_f32_16x16x32_bf16 v[44:47], v[76:79], a[192:195], v[44:47]
  v_mfma_f32_16x16x32_bf16 v[48:51], v[72:75], a[248:251], v[48:51]
  v_mfma_f32_16x16x32_bf16 v[52:55], v[76:79], a[248:251], v[52:55]
  v_mfma_f32_16x16x32_bf16 v[56:59], v[72:75], v[168:171], v[56:59]
  v_mfma_f32_16x16x32_bf16 v[60:63], v[76:79], v[168:171], v[60:63]
  v_mfma_f32_16x16x32_bf16 v[64:67], v[72:75], v[224:227], v[64:67]
  v_mfma_f32_16x16x32_bf16 v[68:71], v[76:79], v[224:227], v[68:71]
  s_waitcnt lgkmcnt(0)
  v_mfma_f32_16x16x32_bf16 v[16:19], v[80:83], a[28:31], v[16:19]
  v_mfma_f32_16x16x32_bf16 v[20:23], v[84:87], a[28:31], v[20:23]
  ds_read_b128 v[72:75], v4 offset:8192
  ds_read_b128 v[76:79], v4 offset:22528
  v_mfma_f32_16x16x32_bf16 v[24:27], v[80:83], a[84:87], v[24:27]
  v_mfma_f32_16x16x32_bf16 v[28:31], v[84:87], a[84:87], v[28:31]
  v_mfma_f32_16x16x32_bf16 v[32:35], v[80:83], a[140:143], v[32:35]
  v_mfma_f32_16x16x32_bf16 v[36:39], v[84:87], a[140:143], v[36:39]
  v_mfma_f32_16x16x32_bf16 v[40:43], v[80:83], a[196:199], v[40:43]
  v_mfma_f32_16x16x32_bf16 v[44:47], v[84:87], a[196:199], v[44:47]
  v_mfma_f32_16x16x32_bf16 v[48:51], v[80:83], a[252:255], v[48:51]
  v_mfma_f32_16x16x32_bf16 v[52:55], v[84:87], a[252:255], v[52:55]
  v_mfma_f32_16x16x32_bf16 v[56:59], v[80:83], v[172:175], v[56:59]
  v_mfma_f32_16x16x32_bf16 v[60:63], v[84:87], v[172:175], v[60:63]
  v_mfma_f32_16x16x32_bf16 v[64:67], v[80:83], v[228:231], v[64:67]
  v_mfma_f32_16x16x32_bf16 v[68:71], v[84:87], v[228:231], v[68:71]
  s_waitcnt lgkmcnt(0)
  v_mfma_f32_16x16x32_bf16 v[16:19], v[72:75], a[32:35], v[16:19]
  v_mfma_f32_16x16x32_bf16 v[20:23], v[76:79], a[32:35], v[20:23]
  ds_read_b128 v[80:83], v4 offset:9216
  ds_read_b128 v[84:87], v4 offset:23552
  v_mfma_f32_16x16x32_bf16 v[24:27], v[72:75], a[88:91], v[24:27]
  v_mfma_f32_16x16x32_bf16 v[28:31], v[76:79], a[88:91], v[28:31]
  v_mfma_f32_16x16x32_bf16 v[32:35], v[72:75], a[144:147], v[32:35]
  v_mfma_f32_16x16x32_bf16 v[36:39], v[76:79], a[144:147], v[36:39]
  v_mfma_f32_16x16x32_bf16 v[40:43], v[72:75], a[200:203], v[40:43]
  v_mfma_f32_16x16x32_bf16 v[44:47], v[76:79], a[200:203], v[44:47]
  v_mfma_f32_16x16x32_bf16 v[48:51], v[72:75], v[120:123], v[48:51]
  v_mfma_f32_16x16x32_bf16 v[52:55], v[76:79], v[120:123], v[52:55]
  v_mfma_f32_16x16x32_bf16 v[56:59], v[72:75], v[176:179], v[56:59]
  v_mfma_f32_16x16x32_bf16 v[60:63], v[76:79], v[176:179], v[60:63]
  v_mfma_f32_16x16x32_bf16 v[64:67], v[72:75], v[232:235], v[64:67]
  v_mfma_f32_16x16x32_bf16 v[68:71], v[76:79], v[232:235], v[68:71]
  s_waitcnt lgkmcnt(0)
  v_mfma_f32_16x16x32_bf16 v[16:19], v[80:83], a[36:39], v[16:19]
  v_mfma_f32_16x16x32_bf16 v[20:23], v[84:87], a[36:39], v[20:23]
  ds_read_b128 v[72:75], v4 offset:10240
  ds_read_b128 v[76:79], v4 offset:24576
  v_mfma_f32_16x16x32_bf16 v[24:27], v[80:83], a[92:95], v[24:27]
  v_mfma_f32_16x16x32_bf16 v[28:31], v[84:87], a[92:95], v[28:31]
  v_mfma_f32_16x16x32_bf16 v[32:35], v[80:83], a[148:151], v[32:35]
  v_mfma_f32_16x16x32_bf16 v[36:39], v[84:87], a[148:151], v[36:39]
  v_mfma_f32_16x16x32_bf16 v[40:43], v[80:83], a[204:207], v[40:43]
  v_mfma_f32_16x16x32_bf16 v[44:47], v[84:87], a[204:207], v[44:47]
  v_mfma_f32_16x16x32_bf16 v[48:51], v[80:83], v[124:127], v[48:51]
  v_mfma_f32_16x16x32_bf16 v[52:55], v[84:87], v[124:127], v[52:55]
  v_mfma_f32_16x16x32_bf16 v[56:59], v[80:83], v[180:183], v[56:59]
  v_mfma_f32_16x16x32_bf16 v[60:63], v[84:87], v[180:183], v[60:63]
  v_mfma_f32_16x16x32_bf16 v[64:67], v[80:83], v[236:239], v[64:67]
  v_mfma_f32_16x16x32_bf16 v[68:71], v[84:87], v[236:239], v[68:71]
  s_waitcnt lgkmcnt(0)
  v_mfma_f32_16x16x32_bf16 v[16:19], v[72:75], a[40:43], v[16:19]
  v_mfma_f32_16x16x32_bf16 v[20:23], v[76:79], a[40:43], v[20:23]
  ds_read_b128 v[80:83], v4 offset:11264
  ds_read_b128 v[84:87], v4 offset:25600
  v_mfma_f32_16x16x32_bf16 v[24:27], v[72:75], a[96:99], v[24:27]
  v_mfma_f32_16x16x32_bf16 v[28:31], v[76:79], a[96:99], v[28:31]
  v_mfma_f32_16x16x32_bf16 v[32:35], v[72:75], a[152:155], v[32:35]
  v_mfma_f32_16x16x32_bf16 v[36:39], v[76:79], a[152:155], v[36:39]
  v_mfma_f32_16x16x32_bf16 v[40:43], v[72:75], a[208:211], v[40:43]
  v_mfma_f32_16x16x32_bf16 v[44:47], v[76:79], a[208:211], v[44:47]
  v_mfma_f32_16x16x32_bf16 v[48:51], v[72:75], v[128:131], v[48:51]
  v_mfma_f32_16x16x32_bf16 v[52:55], v[76:79], v[128:131], v[52:55]
  v_mfma_f32_16x16x32_bf16 v[56:59], v[72:75], v[184:187], v[56:59]
  v_mfma_f32_16x16x32_bf16 v[60:63], v[76:79], v[184:187], v[60:63]
  v_mfma_f32_16x16x32_bf16 v[64:67], v[72:75], v[240:243], v[64:67]
  v_mfma_f32_16x16x32_bf16 v[68:71], v[76:79], v[240:243], v[68:71]
  s_waitcnt lgkmcnt(0)
  v_mfma_f32_16x16x32_bf16 v[16:19], v[80:83], a[44:47], v[16:19]
  v_mfma_f32_16x16x32_bf16 v[20:23], v[84:87], a[44:47], v[20:23]
  ds_read_b128 v[72:75], v4 offset:12288
  ds_read_b128 v[76:79], v4 offset:26624
  v_mfma_f32_16x16x32_bf16 v[24:27], v[80:83], a[100:103], v[24:27]
  v_mfma_f32_16x16x32_bf16 v[28:31], v[84:87], a[100:103], v[28:31]
  v_mfma_f32_16x16x32_bf16 v[32:35], v[80:83], a[156:159], v[32:35]
  v_mfma_f32_16x16x32_bf16 v[36:39], v[84:87], a[156:159], v[36:39]
  v_mfma_f32_16x16x32_bf16 v[40:43], v[80:83], a[212:215], v[40:43]
  v_mfma_f32_16x16x32_bf16 v[44:47], v[84:87], a[212:215], v[44:47]
  v_mfma_f32_16x16x32_bf16 v[48:51], v[80:83], v[132:135], v[48:51]
  v_mfma_f32_16x16x32_bf16 v[52:55], v[84:87], v[132:135], v[52:55]
  v_mfma_f32_16x16x32_bf16 v[56:59], v[80:83], v[188:191], v[56:59]
  v_mfma_f32_16x16x32_bf16 v[60:63], v[84:87], v[188:191], v[60:63]
  v_mfma_f32_16x16x32_bf16 v[64:67], v[80:83], v[244:247], v[64:67]
  v_mfma_f32_16x16x32_bf16 v[68:71], v[84:87], v[244:247], v[68:71]
  s_waitcnt lgkmcnt(0)
  v_mfma_f32_16x16x32_bf16 v[16:19], v[72:75], a[48:51], v[16:19]
  v_mfma_f32_16x16x32_bf16 v[20:23], v[76:79], a[48:51], v[20:23]
  ds_read_b128 v[80:83], v4 offset:13312
  ds_read_b128 v[84:87], v4 offset:27648
  v_mfma_f32_16x16x32_bf16 v[24:27], v[72:75], a[104:107], v[24:27]
  v_mfma_f32_16x16x32_bf16 v[28:31], v[76:79], a[104:107], v[28:31]
  v_mfma_f32_16x16x32_bf16 v[32:35], v[72:75], a[160:163], v[32:35]
  v_mfma_f32_16x16x32_bf16 v[36:39], v[76:79], a[160:163], v[36:39]
  v_mfma_f32_16x16x32_bf16 v[40:43], v[72:75], a[216:219], v[40:43]
  v_mfma_f32_16x16x32_bf16 v[44:47], v[76:79], a[216:219], v[44:47]
  v_mfma_f32_16x16x32_bf16 v[48:51], v[72:75], v[136:139], v[48:51]
  v_mfma_f32_16x16x32_bf16 v[52:55], v[76:79], v[136:139], v[52:55]
  v_mfma_f32_16x16x32_bf16 v[56:59], v[72:75], v[192:195], v[56:59]
  v_mfma_f32_16x16x32_bf16 v[60:63], v[76:79], v[192:195], v[60:63]
  v_mfma_f32_16x16x32_bf16 v[64:67], v[72:75], v[248:251], v[64:67]
  v_mfma_f32_16x16x32_bf16 v[68:71], v[76:79], v[248:251], v[68:71]
  s_waitcnt lgkmcnt(0)
  v_mfma_f32_16x16x32_bf16 v[16:19], v[80:83], a[52:55], v[16:19]
  v_mfma_f32_16x16x32_bf16 v[20:23], v[84:87], a[52:55], v[20:23]
  v_mfma_f32_16x16x32_bf16 v[24:27], v[80:83], a[108:111], v[24:27]
  v_mfma_f32_16x16x32_bf16 v[28:31], v[84:87], a[108:111], v[28:31]
  v_mfma_f32_16x16x32_bf16 v[32:35], v[80:83], a[164:167], v[32:35]
  v_mfma_f32_16x16x32_bf16 v[36:39], v[84:87], a[164:167], v[36:39]
  v_mfma_f32_16x16x32_bf16 v[40:43], v[80:83], a[220:223], v[40:43]
  v_mfma_f32_16x16x32_bf16 v[44:47], v[84:87], a[220:223], v[44:47]
  v_mfma_f32_16x16x32_bf16 v[48:51], v[80:83], v[140:143], v[48:51]
  v_mfma_f32_16x16x32_bf16 v[52:55], v[84:87], v[140:143], v[52:55]
  v_mfma_f32_16x16x32_bf16 v[56:59], v[80:83], v[196:199], v[56:59]
  v_mfma_f32_16x16x32_bf16 v[60:63], v[84:87], v[196:199], v[60:63]
  v_mfma_f32_16x16x32_bf16 v[64:67], v[80:83], v[252:255], v[64:67]
  v_mfma_f32_16x16x32_bf16 v[68:71], v[84:87], v[252:255], v[68:71]
  s_waitcnt vmcnt(0)
  s_barrier
Vepi_256:
  s_nop 7
  s_mul_i32 s22, s18, 458752
  s_mul_i32 s34, s17, 114688
  s_add_u32 s22, s22, s34
  s_lshl_b32 s34, s27, 10
  s_add_u32 s22, s22, s34
  s_add_u32 s22, s22, 16777216
  v_cvt_pk_bf16_f32 v16, v16, v17
  v_cvt_pk_bf16_f32 v17, v18, v19
  v_cvt_pk_bf16_f32 v18, v20, v21
  v_cvt_pk_bf16_f32 v19, v22, v23
  buffer_store_dwordx4 v[16:19], v0, s[12:15], s22 offen sc1
  s_add_u32 s22, s22, 16384
  v_cvt_pk_bf16_f32 v24, v24, v25
  v_cvt_pk_bf16_f32 v25, v26, v27
  v_cvt_pk_bf16_f32 v26, v28, v29
  v_cvt_pk_bf16_f32 v27, v30, v31
  buffer_store_dwordx4 v[24:27], v0, s[12:15], s22 offen sc1
  s_add_u32 s22, s22, 16384
  v_cvt_pk_bf16_f32 v32, v32, v33
  v_cvt_pk_bf16_f32 v33, v34, v35
  v_cvt_pk_bf16_f32 v34, v36, v37
  v_cvt_pk_bf16_f32 v35, v38, v39
  buffer_store_dwordx4 v[32:35], v0, s[12:15], s22 offen sc1
  s_add_u32 s22, s22, 16384
  v_cvt_pk_bf16_f32 v40, v40, v41
  v_cvt_pk_bf16_f32 v41, v42, v43
  v_cvt_pk_bf16_f32 v42, v44, v45
  v_cvt_pk_bf16_f32 v43, v46, v47
  buffer_store_dwordx4 v[40:43], v0, s[12:15], s22 offen sc1
  s_add_u32 s22, s22, 16384
  v_cvt_pk_bf16_f32 v48, v48, v49
  v_cvt_pk_bf16_f32 v49, v50, v51
  v_cvt_pk_bf16_f32 v50, v52, v53
  v_cvt_pk_bf16_f32 v51, v54, v55
  buffer_store_dwordx4 v[48:51], v0, s[12:15], s22 offen sc1
  s_add_u32 s22, s22, 16384
  v_cvt_pk_bf16_f32 v56, v56, v57
  v_cvt_pk_bf16_f32 v57, v58, v59
  v_cvt_pk_bf16_f32 v58, v60, v61
  v_cvt_pk_bf16_f32 v59, v62, v63
  buffer_store_dwordx4 v[56:59], v0, s[12:15], s22 offen sc1
  s_add_u32 s22, s22, 16384
  v_cvt_pk_bf16_f32 v64, v64, v65
  v_cvt_pk_bf16_f32 v65, v66, v67
  v_cvt_pk_bf16_f32 v66, v68, v69
  v_cvt_pk_bf16_f32 v67, v70, v71
  buffer_store_dwordx4 v[64:67], v0, s[12:15], s22 offen sc1
  s_lshl_b32 s24, s18, 8
  s_lshl_b32 s34, s16, 2
  s_add_u32 s24, s24, s34
  s_add_u32 s24, s24, 46989312
  s_mov_b32 s18, s25
  s_cmp_lt_u32 s18, 64
  s_cbranch_scc1 Vtop_257
  s_waitcnt vmcnt(0)
  s_barrier
  s_cmp_lg_u32 s17, 0
  s_cbranch_scc1 w0_266
  buffer_store_dword v2, v3, s[12:15], s24 offen sc1
w0_266:
Vdone_260:
  s_mov_b32 s18, s19
Vm_267:
  s_lshl_b32 s22, s18, 13
  s_add_u32 s22, s22, 54525952
  s_add_u32 s25, s22, 4096
  s_mov_b32 s23, 300000
  v_mov_b64 v[16:17], 0
  v_mov_b64 v[18:19], 0
  v_mov_b64 v[20:21], 0
  v_mov_b64 v[22:23], 0
  v_mov_b64 v[24:25], 0
  v_mov_b64 v[26:27], 0
  v_mov_b64 v[28:29], 0
  v_mov_b64 v[30:31], 0
  v_mov_b64 v[32:33], 0
  v_mov_b64 v[34:35], 0
  v_mov_b64 v[36:37], 0
  v_mov_b64 v[38:39], 0
  v_mov_b64 v[40:41], 0
  v_mov_b64 v[42:43], 0
  s_lshl_b32 s34, s18, 8
  s_add_u32 s34, s34, 46989504
  v_bfe_u32 v73, v0, 4, 1
  v_lshlrev_b32 v73, 2, v73
  s_mov_b32 s23, 300000
wp_272:
  buffer_load_dword v72, v73, s[12:15], s34 offen sc1
  s_waitcnt vmcnt(0)
  v_cmp_gt_u32 vcc, 1, v72
  s_cbranch_vccz wpd_273
  s_sleep 1
  s_sub_u32 s23, s23, 1
  s_cbranch_scc0 wp_272
  s_branch L_exit
wpd_273:
mw_271:
  s_mov_b32 s23, 300000
Vmp_268:
  buffer_load_dwordx4 v[72:75], v0, s[12:15], s22 offen offset:0 sc1
  buffer_load_dwordx4 v[76:79], v0, s[12:15], s22 offen offset:1024 sc1
  buffer_load_dwordx4 v[80:83], v0, s[12:15], s22 offen offset:2048 sc1
  buffer_load_dwordx4 v[84:87], v0, s[12:15], s22 offen offset:3072 sc1
  buffer_load_dwordx4 v[88:91], v0, s[12:15], s25 offen offset:0 sc1
  buffer_load_dwordx4 v[92:95], v0, s[12:15], s25 offen offset:1024 sc1
  buffer_load_dwordx4 v[96:99], v0, s[12:15], s25 offen offset:2048 sc1
  s_waitcnt vmcnt(0)
  v_max_u32 v7, v72, v73
  v_max3_u32 v7, v7, v74, v75
  v_max3_u32 v7, v7, v76, v77
  v_max3_u32 v7, v7, v78, v79
  v_max3_u32 v7, v7, v80, v81
  v_max3_u32 v7, v7, v82, v83
  v_max3_u32 v7, v7, v84, v85
  v_max3_u32 v7, v7, v86, v87
  v_max3_u32 v7, v7, v88, v89
  v_max3_u32 v7, v7, v90, v91
  v_max3_u32 v7, v7, v92, v93
  v_max3_u32 v7, v7, v94, v95
  v_max3_u32 v7, v7, v96, v97
  v_max3_u32 v7, v7, v98, v99
  v_cmp_eq_u32 vcc, -1, v7
  s_cbranch_vccz Vmo_270
Vmb_269:
  s_add_u32 s43, s43, 1
  s_sleep 1
  s_sub_u32 s23, s23, 1
  s_cbranch_scc0 Vmp_268
  s_branch L_exit
Vmo_270:
  s_mul_i32 s22, s18, 114688
  s_mul_i32 s34, s17, 28672
  s_add_u32 s22, s22, s34
  s_lshl_b32 s34, s27, 8
  s_add_u32 s22, s22, s34
  s_add_u32 s22, s22, 47185920
  v_smfmac_f32_16x16x64_bf16 v[16:19], v[72:75], a[0:7], v1
  v_smfmac_f32_16x16x64_bf16 v[16:19], v[76:79], a[8:15], v1
  v_smfmac_f32_16x16x64_bf16 v[16:19], v[80:83], a[16:23], v1
  v_smfmac_f32_16x16x64_bf16 v[16:19], v[84:87], a[24:31], v1
  v_smfmac_f32_16x16x64_bf16 v[16:19], v[88:91], a[32:39], v1
  v_smfmac_f32_16x16x64_bf16 v[16:19], v[92:95], a[40:47], v1
  v_smfmac_f32_16x16x64_bf16 v[16:19], v[96:99], a[48:55], v1
  v_smfmac_f32_16x16x64_bf16 v[20:23], v[72:75], a[56:63], v1
  v_smfmac_f32_16x16x64_bf16 v[20:23], v[76:79], a[64:71], v1
  v_smfmac_f32_16x16x64_bf16 v[20:23], v[80:83], a[72:79], v1
  v_add_f32 v16, v16, v18
  v_smfmac_f32_16x16x64_bf16 v[20:23], v[84:87], a[80:87], v1
  v_add_f32 v17, v17, v19
  v_smfmac_f32_16x16x64_bf16 v[20:23], v[88:91], a[88:95], v1
  v_cvt_pk_bf16_f32 v16, v16, v17
  v_smfmac_f32_16x16x64_bf16 v[20:23], v[92:95], a[96:103], v1
  v_min_u32 v16, -2, v16
  v_smfmac_f32_16x16x64_bf16 v[20:23], v[96:99], a[104:111], v1
  buffer_store_dword v16, v5, s[12:15], s22 offen sc1
  s_add_u32 s22, s22, 4096
  s_cmp_lt_u32 s18, 61
  s_cbranch_scc1 ef_274
  s_cmp_lg_u32 s17, 0
  s_cbranch_scc1 ef_274
  s_lshl_b32 s40, s18, 12
  s_lshl_b32 s41, s16, 7
  s_add_u32 s40, s40, s41
  s_add_u32 s40, s40, 46766080
  buffer_store_dword v2, v3, s[12:15], s40 offen sc1
ef_274:
  v_smfmac_f32_16x16x64_bf16 v[24:27], v[72:75], a[112:119], v1
  v_smfmac_f32_16x16x64_bf16 v[24:27], v[76:79], a[120:127], v1
  v_smfmac_f32_16x16x64_bf16 v[24:27], v[80:83], a[128:135], v1
  v_add_f32 v20, v20, v22
  v_smfmac_f32_16x16x64_bf16 v[24:27], v[84:87], a[136:143], v1
  v_add_f32 v21, v21, v23
  v_smfmac_f32_16x16x64_bf16 v[24:27], v[88:91], a[144:151], v1
  v_cvt_pk_bf16_f32 v20, v20, v21
  v_smfmac_f32_16x16x64_bf16 v[24:27], v[92:95], a[152:159], v1
  v_min_u32 v20, -2, v20
  v_smfmac_f32_16x16x64_bf16 v[24:27], v[96:99], a[160:167], v1
  buffer_store_dword v20, v5, s[12:15], s22 offen sc1
  s_add_u32 s22, s22, 4096
  v_smfmac_f32_16x16x64_bf16 v[28:31], v[72:75], a[168:175], v1
  v_smfmac_f32_16x16x64_bf16 v[28:31], v[76:79], a[176:183], v1
  v_smfmac_f32_16x16x64_bf16 v[28:31], v[80:83], a[184:191], v1
  v_add_f32 v24, v24, v26
  v_smfmac_f32_16x16x64_bf16 v[28:31], v[84:87], a[192:199], v1
  v_add_f32 v25, v25, v27
  v_smfmac_f32_16x16x64_bf16 v[28:31], v[88:91], a[200:207], v1
  v_cvt_pk_bf16_f32 v24, v24, v25
  v_smfmac_f32_16x16x64_bf16 v[28:31], v[92:95], a[208:215], v1
  v_min_u32 v24, -2, v24
  v_smfmac_f32_16x16x64_bf16 v[28:31], v[96:99], a[216:223], v1
  buffer_store_dword v24, v5, s[12:15], s22 offen sc1
  s_add_u32 s22, s22, 4096
  v_smfmac_f32_16x16x64_bf16 v[32:35], v[72:75], a[224:231], v1
  v_smfmac_f32_16x16x64_bf16 v[32:35], v[76:79], a[232:239], v1
  v_smfmac_f32_16x16x64_bf16 v[32:35], v[80:83], a[240:247], v1
  v_add_f32 v28, v28, v30
  v_smfmac_f32_16x16x64_bf16 v[32:35], v[84:87], a[248:255], v1
  v_add_f32 v29, v29, v31
  v_smfmac_f32_16x16x64_bf16 v[32:35], v[88:91], v[120:127], v1
  v_cvt_pk_bf16_f32 v28, v28, v29
  v_smfmac_f32_16x16x64_bf16 v[32:35], v[92:95], v[128:135], v1
  v_min_u32 v28, -2, v28
  v_smfmac_f32_16x16x64_bf16 v[32:35], v[96:99], v[136:143], v1
  buffer_store_dword v28, v5, s[12:15], s22 offen sc1
  s_add_u32 s22, s22, 4096
  v_smfmac_f32_16x16x64_bf16 v[36:39], v[72:75], v[144:151], v1
  v_smfmac_f32_16x16x64_bf16 v[36:39], v[76:79], v[152:159], v1
  v_smfmac_f32_16x16x64_bf16 v[36:39], v[80:83], v[160:167], v1
  v_add_f32 v32, v32, v34
  v_smfmac_f32_16x16x64_bf16 v[36:39], v[84:87], v[168:175], v1
  v_add_f32 v33, v33, v35
  v_smfmac_f32_16x16x64_bf16 v[36:39], v[88:91], v[176:183], v1
  v_cvt_pk_bf16_f32 v32, v32, v33
  v_smfmac_f32_16x16x64_bf16 v[36:39], v[92:95], v[184:191], v1
  v_min_u32 v32, -2, v32
  v_smfmac_f32_16x16x64_bf16 v[36:39], v[96:99], v[192:199], v1
  buffer_store_dword v32, v5, s[12:15], s22 offen sc1
  s_add_u32 s22, s22, 4096
  v_smfmac_f32_16x16x64_bf16 v[40:43], v[72:75], v[200:207], v1
  v_smfmac_f32_16x16x64_bf16 v[40:43], v[76:79], v[208:215], v1
  v_smfmac_f32_16x16x64_bf16 v[40:43], v[80:83], v[216:223], v1
  v_add_f32 v36, v36, v38
  v_smfmac_f32_16x16x64_bf16 v[40:43], v[84:87], v[224:231], v1
  v_add_f32 v37, v37, v39
  v_smfmac_f32_16x16x64_bf16 v[40:43], v[88:91], v[232:239], v1
  v_cvt_pk_bf16_f32 v36, v36, v37
  v_smfmac_f32_16x16x64_bf16 v[40:43], v[92:95], v[240:247], v1
  v_min_u32 v36, -2, v36
  v_smfmac_f32_16x16x64_bf16 v[40:43], v[96:99], v[248:255], v1
  buffer_store_dword v36, v5, s[12:15], s22 offen sc1
  s_add_u32 s22, s22, 4096
  s_nop 5
  v_add_f32 v40, v40, v42
  v_add_f32 v41, v41, v43
  v_cvt_pk_bf16_f32 v40, v40, v41
  v_min_u32 v40, -2, v40
  buffer_store_dword v40, v5, s[12:15], s22 offen sc1
  s_add_u32 s22, s22, 4096
  s_lshl_b32 s24, s18, 8
  s_lshl_b32 s34, s16, 2
  s_add_u32 s24, s24, s34
  s_add_u32 s24, s24, 46989440
  s_waitcnt vmcnt(0)
  s_barrier
  s_cmp_lg_u32 s17, 0
  s_cbranch_scc1 w0_275
  buffer_store_dword v2, v3, s[12:15], s24 offen sc1
w0_275:
  s_add_u32 s18, s18, 4
  s_cmp_lt_u32 s18, 64
  s_cbranch_scc1 Vm_267
  s_branch L_fin
L_roleS:
  s_cmp_lg_u32 s17, 0
  s_cbranch_scc1 wm_276
  v_and_b32 v16, 15, v0
  v_min_u32 v16, 13, v16
  v_lshlrev_b32 v16, 7, v16
  s_lshl_b32 s34, s16, 11
  s_add_u32 s34, s34, 46858240
  s_mov_b32 s23, 300000
fp_277:
  buffer_load_dword v17, v16, s[12:15], s34 offen sc1
  s_waitcnt vmcnt(0)
  v_cmp_gt_u32 vcc, 1, v17
  s_cbranch_vccz fpd_278
  s_sleep 1
  s_sub_u32 s23, s23, 1
  s_cbranch_scc0 fp_277
  s_branch L_exit
fpd_278:
wm_276:
  s_barrier
  v_mov_b32 v16, v0
  v_lshlrev_b32 v0, 4, v16
  v_mov_b32 v1, 1
  v_min_u32 v2, 1, v16
  v_lshlrev_b32 v2, 30, v2
  v_bfe_u32 v17, v16, 5, 1
  v_lshlrev_b32 v4, 12, v17
  v_bfe_u32 v17, v16, 4, 1
  v_lshl_add_u32 v4, v17, 9, v4
  v_bfe_u32 v17, v16, 0, 4
  v_lshl_add_u32 v4, v17, 4, v4
  v_bfe_u32 v17, v16, 5, 1
  v_lshlrev_b32 v5, 9, v17
  v_bfe_u32 v17, v16, 4, 1
  v_lshl_add_u32 v5, v17, 3, v5
  v_bfe_u32 v17, v16, 0, 4
  v_lshl_add_u32 v5, v17, 4, v5
  v_add_u32 v5, 256, v5
  s_mul_i32 s34, s17, 1792
  v_bfe_u32 v17, v16, 5, 1
  v_lshlrev_b32 v6, 8, v17
  v_bfe_u32 v17, v16, 4, 1
  v_lshl_add_u32 v6, v17, 5, v6
  v_bfe_u32 v17, v16, 1, 2
  v_lshl_add_u32 v6, v17, 6, v6
  v_bfe_u32 v17, v16, 0, 1
  v_lshl_add_u32 v6, v17, 4, v6
  v_add_u32 v6, s34, v6
  v_bfe_u32 v17, v16, 5, 1
  v_lshlrev_b32 v7, 5, v17
  v_bfe_u32 v17, v16, 4, 1
  v_lshl_add_u32 v7, v17, 3, v7
  v_bfe_u32 v17, v16, 1, 2
  v_lshl_add_u32 v7, v17, 6, v7
  v_bfe_u32 v17, v16, 0, 1
  v_lshl_add_u32 v7, v17, 4, v7
  v_add_u32 v7, s34, v7
  v_add_u32 v7, 1536, v7
  s_mul_i32 s34, s17, 5632
  s_add_u32 s34, s34, 65536
  v_bfe_u32 v17, v16, 0, 4
  v_lshlrev_b32 v18, 0, v17
  v_mul_u32_u24 v18, 176, v18
  v_add_u32 v18, s34, v18
  v_bfe_u32 v17, v16, 5, 1
  v_lshlrev_b32 v8, 6, v17
  v_bfe_u32 v17, v16, 4, 1
  v_lshl_add_u32 v8, v17, 3, v8
  v_add_u32 v8, v8, v18
  v_bfe_u32 v17, v16, 4, 1
  v_lshlrev_b32 v9, 4, v17
  v_add_u32 v9, 128, v9
  v_add_u32 v9, v9, v18
  s_mul_i32 s34, s17, 1408
  s_add_u32 s34, s34, 65536
  v_bfe_u32 v17, v16, 3, 3
  v_lshlrev_b32 v18, 0, v17
  v_mul_u32_u24 v18, 176, v18
  v_add_u32 v18, s34, v18
  v_bfe_u32 v17, v16, 0, 3
  v_lshlrev_b32 v10, 4, v17
  v_add_u32 v10, v10, v18
  v_bfe_u32 v17, v16, 0, 3
  v_lshlrev_b32 v11, 2, v17
  v_add_u32 v11, 128, v11
  v_add_u32 v11, v11, v18
  s_lshr_b32 s34, s17, 1
  s_and_b32 s35, s17, 1
  s_lshl_b32 s36, s34, 4
  s_add_u32 s36, s36, s16
  s_lshl_b32 s37, s36, 10
  s_lshl_b32 s38, s35, 7
  s_add_u32 s37, s37, s38
  v_bfe_u32 v17, v16, 1, 2
  v_lshlrev_b32 v12, 8, v17
  v_bfe_u32 v17, v16, 3, 3
  v_lshl_add_u32 v12, v17, 4, v12
  v_bfe_u32 v17, v16, 0, 1
  v_lshl_add_u32 v12, v17, 3, v12
  v_add_u32 v12, s37, v12
  v_add_u32 v12, 68157440, v12
  s_lshl_b32 s37, s36, 8
  s_lshl_b32 s38, s35, 5
  s_add_u32 s37, s37, s38
  v_bfe_u32 v17, v16, 1, 2
  v_lshlrev_b32 v13, 6, v17
  v_bfe_u32 v17, v16, 3, 3
  v_lshl_add_u32 v13, v17, 2, v13
  v_bfe_u32 v17, v16, 0, 1
  v_lshl_add_u32 v13, v17, 30, v13
  v_add_u32 v13, s37, v13
  v_add_u32 v13, 70254592, v13
  s_lshl_b32 s37, s35, 4
  s_lshl_b32 s38, s34, 2
  s_add_u32 s37, s37, s38
  v_bfe_u32 v17, v16, 5, 1
  v_lshlrev_b32 v18, 3, v17
  v_bfe_u32 v17, v16, 3, 2
  v_lshl_add_u32 v18, v17, 0, v18
  v_add_u32 v18, s37, v18
  v_bfe_u32 v17, v16, 0, 3
  v_lshlrev_b32 v15, 2, v17
  v_cmp_le_u32 s[48:49], v15, v18
  v_add_u32 v15, 1, v15
  v_cmp_le_u32 s[50:51], v15, v18
  v_add_u32 v15, 1, v15
  v_cmp_le_u32 s[52:53], v15, v18
  v_add_u32 v15, 1, v15
  v_cmp_le_u32 s[54:55], v15, v18
  v_add_u32 v15, 1, v15
  v_mov_b32 v14, 0xceabfb8f
  s_mov_b32 s20, 0
  s_mov_b32 s18, s19
  s_mul_i32 s34, s18, 28672
  s_mul_i32 s35, s17, 7168
  s_add_u32 s34, s34, s35
  s_add_u32 s34, s34, 56623104
  s_add_u32 m0, s35, s20
  s_nop 0
  buffer_load_dwordx4 v0, s[12:15], s34 offen offset:0 sc1 lds
  buffer_load_dwordx4 v0, s[12:15], s34 offen offset:1024 sc1 lds
  buffer_load_dwordx4 v0, s[12:15], s34 offen offset:2048 sc1 lds
  buffer_load_dwordx4 v0, s[12:15], s34 offen offset:3072 sc1 lds
  s_add_u32 s34, s34, 4096
  s_add_u32 m0, m0, 4096
  s_nop 0
  buffer_load_dwordx4 v0, s[12:15], s34 offen offset:0 sc1 lds
  buffer_load_dwordx4 v0, s[12:15], s34 offen offset:1024 sc1 lds
  buffer_load_dwordx4 v0, s[12:15], s34 offen offset:2048 sc1 lds
  s_mul_i32 s34, s16, 401408
  s_mul_i32 s35, s17, 100352
  s_add_u32 s34, s34, s35
  buffer_load_dwordx4 a[0:3], v0, s[12:15], s34 offen offset:0 sc1
  buffer_load_dwordx4 a[4:7], v0, s[12:15], s34 offen offset:1024 sc1
  buffer_load_dwordx4 a[8:11], v0, s[12:15], s34 offen offset:2048 sc1
  buffer_load_dwordx4 a[12:15], v0, s[12:15], s34 offen offset:3072 sc1
  s_add_u32 s34, s34, 4096
  buffer_load_dwordx4 a[16:19], v0, s[12:15], s34 offen offset:0 sc1
  buffer_load_dwordx4 a[20:23], v0, s[12:15], s34 offen offset:1024 sc1
  buffer_load_dwordx4 a[24:27], v0, s[12:15], s34 offen offset:2048 sc1
  buffer_load_dwordx4 a[28:31], v0, s[12:15], s34 offen offset:3072 sc1
  s_add_u32 s34, s34, 4096
  buffer_load_dwordx4 a[32:35], v0, s[12:15], s34 offen offset:0 sc1
  buffer_load_dwordx4 a[36:39], v0, s[12:15], s34 offen offset:1024 sc1
  buffer_load_dwordx4 a[40:43], v0, s[12:15], s34 offen offset:2048 sc1
  buffer_load_dwordx4 a[44:47], v0, s[12:15], s34 offen offset:3072 sc1
  s_add_u32 s34, s34, 4096
  buffer_load_dwordx4 a[48:51], v0, s[12:15], s34 offen offset:0 sc1
  buffer_load_dwordx4 a[52:55], v0, s[12:15], s34 offen offset:1024 sc1
  buffer_load_dwordx4 a[56:59], v0, s[12:15], s34 offen offset:2048 sc1
  buffer_load_dwordx4 a[60:63], v0, s[12:15], s34 offen offset:3072 sc1
  s_add_u32 s34, s34, 4096
  buffer_load_dwordx4 a[64:67], v0, s[12:15], s34 offen offset:0 sc1
  buffer_load_dwordx4 a[68:71], v0, s[12:15], s34 offen offset:1024 sc1
  buffer_load_dwordx4 a[72:75], v0, s[12:15], s34 offen offset:2048 sc1
  buffer_load_dwordx4 a[76:79], v0, s[12:15], s34 offen offset:3072 sc1
  s_add_u32 s34, s34, 4096
  buffer_load_dwordx4 a[80:83], v0, s[12:15], s34 offen offset:0 sc1
  buffer_load_dwordx4 a[84:87], v0, s[12:15], s34 offen offset:1024 sc1
  buffer_load_dwordx4 a[88:91], v0, s[12:15], s34 offen offset:2048 sc1
  buffer_load_dwordx4 a[92:95], v0, s[12:15], s34 offen offset:3072 sc1
  s_add_u32 s34, s34, 4096
  buffer_load_dwordx4 a[96:99], v0, s[12:15], s34 offen offset:0 sc1
  buffer_load_dwordx4 a[100:103], v0, s[12:15], s34 offen offset:1024 sc1
  buffer_load_dwordx4 a[104:107], v0, s[12:15], s34 offen offset:2048 sc1
  buffer_load_dwordx4 a[108:111], v0, s[12:15], s34 offen offset:3072 sc1
  s_add_u32 s34, s34, 4096
  buffer_load_dwordx4 a[112:115], v0, s[12:15], s34 offen offset:0 sc1
  buffer_load_dwordx4 a[116:119], v0, s[12:15], s34 offen offset:1024 sc1
  buffer_load_dwordx4 a[120:123], v0, s[12:15], s34 offen offset:2048 sc1
  buffer_load_dwordx4 a[124:127], v0, s[12:15], s34 offen offset:3072 sc1
  s_add_u32 s34, s34, 4096
  buffer_load_dwordx4 a[128:131], v0, s[12:15], s34 offen offset:0 sc1
  buffer_load_dwordx4 a[132:135], v0, s[12:15], s34 offen offset:1024 sc1
  buffer_load_dwordx4 a[136:139], v0, s[12:15], s34 offen offset:2048 sc1
  buffer_load_dwordx4 a[140:143], v0, s[12:15], s34 offen offset:3072 sc1
  s_add_u32 s34, s34, 4096
  buffer_load_dwordx4 a[144:147], v0, s[12:15], s34 offen offset:0 sc1
  buffer_load_dwordx4 a[148:151], v0, s[12:15], s34 offen offset:1024 sc1
  buffer_load_dwordx4 a[152:155], v0, s[12:15], s34 offen offset:2048 sc1
  buffer_load_dwordx4 a[156:159], v0, s[12:15], s34 offen offset:3072 sc1
  s_add_u32 s34, s34, 4096
  buffer_load_dwordx4 a[160:163], v0, s[12:15], s34 offen offset:0 sc1
  buffer_load_dwordx4 a[164:167], v0, s[12:15], s34 offen offset:1024 sc1
  buffer_load_dwordx4 a[168:171], v0, s[12:15], s34 offen offset:2048 sc1
  buffer_load_dwordx4 a[172:175], v0, s[12:15], s34 offen offset:3072 sc1
  s_add_u32 s34, s34, 4096
  buffer_load_dwordx4 a[176:179], v0, s[12:15], s34 offen offset:0 sc1
  buffer_load_dwordx4 a[180:183], v0, s[12:15], s34 offen offset:1024 sc1
  buffer_load_dwordx4 a[184:187], v0, s[12:15], s34 offen offset:2048 sc1
  buffer_load_dwordx4 a[188:191], v0, s[12:15], s34 offen offset:3072 sc1
  s_add_u32 s34, s34, 4096
  buffer_load_dwordx4 a[192:195], v0, s[12:15], s34 offen offset:0 sc1
  buffer_load_dwordx4 a[196:199], v0, s[12:15], s34 offen offset:1024 sc1
  buffer_load_dwordx4 a[200:203], v0, s[12:15], s34 offen offset:2048 sc1
  buffer_load_dwordx4 a[204:207], v0, s[12:15], s34 offen offset:3072 sc1
  s_add_u32 s34, s34, 4096
  buffer_load_dwordx4 a[208:211], v0, s[12:15], s34 offen offset:0 sc1
  buffer_load_dwordx4 a[212:215], v0, s[12:15], s34 offen offset:1024 sc1
  buffer_load_dwordx4 a[216:219], v0, s[12:15], s34 offen offset:2048 sc1
  buffer_load_dwordx4 a[220:223], v0, s[12:15], s34 offen offset:3072 sc1
  s_add_u32 s34, s34, 4096
  buffer_load_dwordx4 a[224:227], v0, s[12:15], s34 offen offset:0 sc1
  buffer_load_dwordx4 a[228:231], v0, s[12:15], s34 offen offset:1024 sc1
  buffer_load_dwordx4 a[232:235], v0, s[12:15], s34 offen offset:2048 sc1
  buffer_load_dwordx4 a[236:239], v0, s[12:15], s34 offen offset:3072 sc1
  s_add_u32 s34, s34, 4096
  buffer_load_dwordx4 a[240:243], v0, s[12:15], s34 offen offset:0 sc1
  buffer_load_dwordx4 a[244:247], v0, s[12:15], s34 offen offset:1024 sc1
  buffer_load_dwordx4 a[248:251], v0, s[12:15], s34 offen offset:2048 sc1
  buffer_load_dwordx4 a[252:255], v0, s[12:15], s34 offen offset:3072 sc1
  s_add_u32 s34, s34, 4096
  buffer_load_dwordx4 v[120:123], v0, s[12:15], s34 offen offset:0 sc1
  buffer_load_dwordx4 v[124:127], v0, s[12:15], s34 offen offset:1024 sc1
  buffer_load_dwordx4 v[128:131], v0, s[12:15], s34 offen offset:2048 sc1
  buffer_load_dwordx4 v[132:135], v0, s[12:15], s34 offen offset:3072 sc1
  s_add_u32 s34, s34, 4096
  buffer_load_dwordx4 v[136:139], v0, s[12:15], s34 offen offset:0 sc1
  buffer_load_dwordx4 v[140:143], v0, s[12:15], s34 offen offset:1024 sc1
  buffer_load_dwordx4 v[144:147], v0, s[12:15], s34 offen offset:2048 sc1
  buffer_load_dwordx4 v[148:151], v0, s[12:15], s34 offen offset:3072 sc1
  s_add_u32 s34, s34, 4096
  buffer_load_dwordx4 v[152:155], v0, s[12:15], s34 offen offset:0 sc1
  buffer_load_dwordx4 v[156:159], v0, s[12:15], s34 offen offset:1024 sc1
  buffer_load_dwordx4 v[160:163], v0, s[12:15], s34 offen offset:2048 sc1
  buffer_load_dwordx4 v[164:167], v0, s[12:15], s34 offen offset:3072 sc1
  s_add_u32 s34, s34, 4096
  buffer_load_dwordx4 v[168:171], v0, s[12:15], s34 offen offset:0 sc1
  buffer_load_dwordx4 v[172:175], v0, s[12:15], s34 offen offset:1024 sc1
  buffer_load_dwordx4 v[176:179], v0, s[12:15], s34 offen offset:2048 sc1
  buffer_load_dwordx4 v[180:183], v0, s[12:15], s34 offen offset:3072 sc1
  s_add_u32 s34, s34, 4096
  buffer_load_dwordx4 v[184:187], v0, s[12:15], s34 offen offset:0 sc1
  buffer_load_dwordx4 v[188:191], v0, s[12:15], s34 offen offset:1024 sc1
  buffer_load_dwordx4 v[192:195], v0, s[12:15], s34 offen offset:2048 sc1
  buffer_load_dwordx4 v[196:199], v0, s[12:15], s34 offen offset:3072 sc1
  s_add_u32 s34, s34, 4096
  buffer_load_dwordx4 v[200:203], v0, s[12:15], s34 offen offset:0 sc1
  buffer_load_dwordx4 v[204:207], v0, s[12:15], s34 offen offset:1024 sc1
  buffer_load_dwordx4 v[208:211], v0, s[12:15], s34 offen offset:2048 sc1
  buffer_load_dwordx4 v[212:215], v0, s[12:15], s34 offen offset:3072 sc1
  s_add_u32 s34, s34, 4096
  buffer_load_dwordx4 v[216:219], v0, s[12:15], s34 offen offset:0 sc1
  buffer_load_dwordx4 v[220:223], v0, s[12:15], s34 offen offset:1024 sc1
  buffer_load_dwordx4 v[224:227], v0, s[12:15], s34 offen offset:2048 sc1
  buffer_load_dwordx4 v[228:231], v0, s[12:15], s34 offen offset:3072 sc1
  s_add_u32 s34, s34, 4096
  buffer_load_dwordx4 v[232:235], v0, s[12:15], s34 offen offset:0 sc1
  buffer_load_dwordx4 v[236:239], v0, s[12:15], s34 offen offset:1024 sc1
  buffer_load_dwordx4 v[240:243], v0, s[12:15], s34 offen offset:2048 sc1
  buffer_load_dwordx4 v[244:247], v0, s[12:15], s34 offen offset:3072 sc1
  s_add_u32 s34, s34, 4096
  buffer_load_dwordx4 v[248:251], v0, s[12:15], s34 offen offset:0 sc1
  buffer_load_dwordx4 v[252:255], v0, s[12:15], s34 offen offset:1024 sc1
  s_mov_b32 s24, 0x40000000
  s_waitcnt vmcnt(0)
  s_barrier
Stop_279:
  v_add_u32 v3, s20, v0
  s_xor_b32 s20, s20, 32768
  s_add_u32 s25, s18, 5
  s_mul_i32 s26, s18, 32768
  s_lshl_b32 s34, s17, 10
  s_add_u32 s26, s26, s34
  s_add_u32 s26, s26, 13631488
  s_add_u32 s60, s26, 0
  s_add_u32 s61, s26, 8192
  s_add_u32 s62, s26, 16384
  s_add_u32 s63, s26, 24576
  s_lshl_b32 s28, s18, 8
  s_add_u32 s28, s28, 46989504
  v_bfe_u32 v117, v0, 4, 1
  v_lshlrev_b32 v117, 2, v117
  ds_read_b128 v[72:75], v3 offset:0
  ds_read_b128 v[76:79], v3 offset:14336
  ds_read_b128 v[80:83], v3 offset:1024
  ds_read_b128 v[84:87], v3 offset:15360
  s_waitcnt lgkmcnt(2)
  v_mfma_f32_16x16x32_bf16 v[16:19], a[0:3], v[72:75], 0
  v_mfma_f32_16x16x32_bf16 v[44:47], a[0:3], v[76:79], 0
  v_mfma_f32_16x16x32_bf16 v[20:23], a[56:59], v[72:75], 0
  v_mfma_f32_16x16x32_bf16 v[48:51], a[56:59], v[76:79], 0
  v_mfma_f32_16x16x32_bf16 v[24:27], a[112:115], v[72:75], 0
  v_mfma_f32_16x16x32_bf16 v[52:55], a[112:115], v[76:79], 0
  v_mfma_f32_16x16x32_bf16 v[28:31], a[168:171], v[72:75], 0
  v_mfma_f32_16x16x32_bf16 v[56:59], a[168:171], v[76:79], 0
  v_mfma_f32_16x16x32_bf16 v[32:35], a[224:227], v[72:75], 0
  v_mfma_f32_16x16x32_bf16 v[60:63], a[224:227], v[76:79], 0
  v_mfma_f32_16x16x32_bf16 v[36:39], v[144:147], v[72:75], 0
  v_mfma_f32_16x16x32_bf16 v[64:67], v[144:147], v[76:79], 0
  v_mfma_f32_16x16x32_bf16 v[40:43], v[200:203], v[72:75], 0
  v_mfma_f32_16x16x32_bf16 v[68:71], v[200:203], v[76:79], 0
  s_waitcnt lgkmcnt(0)
  v_mfma_f32_16x16x32_bf16 v[16:19], a[4:7], v[80:83], v[16:19]
  v_mfma_f32_16x16x32_bf16 v[44:47], a[4:7], v[84:87], v[44:47]
  ds_read_b128 v[72:75], v3 offset:2048
  ds_read_b128 v[76:79], v3 offset:16384
  v_mfma_f32_16x16x32_bf16 v[20:23], a[60:63], v[80:83], v[20:23]
  v_mfma_f32_16x16x32_bf16 v[48:51], a[60:63], v[84:87], v[48:51]
  v_mfma_f32_16x16x32_bf16 v[24:27], a[116:119], v[80:83], v[24:27]
  v_mfma_f32_16x16x32_bf16 v[52:55], a[116:119], v[84:87], v[52:55]
  v_mfma_f32_16x16x32_bf16 v[28:31], a[172:175], v[80:83], v[28:31]
  v_mfma_f32_16x16x32_bf16 v[56:59], a[172:175], v[84:87], v[56:59]
  v_mfma_f32_16x16x32_bf16 v[32:35], a[228:231], v[80:83], v[32:35]
  v_mfma_f32_16x16x32_bf16 v[60:63], a[228:231], v[84:87], v[60:63]
  v_mfma_f32_16x16x32_bf16 v[36:39], v[148:151], v[80:83], v[36:39]
  v_mfma_f32_16x16x32_bf16 v[64:67], v[148:151], v[84:87], v[64:67]
  v_mfma_f32_16x16x32_bf16 v[40:43], v[204:207], v[80:83], v[40:43]
  v_mfma_f32_16x16x32_bf16 v[68:71], v[204:207], v[84:87], v[68:71]
  s_waitcnt lgkmcnt(0)
  v_mfma_f32_16x16x32_bf16 v[16:19], a[8:11], v[72:75], v[16:19]
  v_mfma_f32_16x16x32_bf16 v[44:47], a[8:11], v[76:79], v[44:47]
  ds_read_b128 v[80:83], v3 offset:3072
  ds_read_b128 v[84:87], v3 offset:17408
  v_mfma_f32_16x16x32_bf16 v[20:23], a[64:67], v[72:75], v[20:23]
  v_mfma_f32_16x16x32_bf16 v[48:51], a[64:67], v[76:79], v[48:51]
  v_mfma_f32_16x16x32_bf16 v[24:27], a[120:123], v[72:75], v[24:27]
  v_mfma_f32_16x16x32_bf16 v[52:55], a[120:123], v[76:79], v[52:55]
  v_mfma_f32_16x16x32_bf16 v[28:31], a[176:179], v[72:75], v[28:31]
  v_mfma_f32_16x16x32_bf16 v[56:59], a[176:179], v[76:79], v[56:59]
  v_mfma_f32_16x16x32_bf16 v[32:35], a[232:235], v[72:75], v[32:35]
  v_mfma_f32_16x16x32_bf16 v[60:63], a[232:235], v[76:79], v[60:63]
  v_mfma_f32_16x16x32_bf16 v[36:39], v[152:155], v[72:75], v[36:39]
  v_mfma_f32_16x16x32_bf16 v[64:67], v[152:155], v[76:79], v[64:67]
  v_mfma_f32_16x16x32_bf16 v[40:43], v[208:211], v[72:75], v[40:43]
  v_mfma_f32_16x16x32_bf16 v[68:71], v[208:211], v[76:79], v[68:71]
  s_waitcnt lgkmcnt(0)
  v_mfma_f32_16x16x32_bf16 v[16:19], a[12:15], v[80:83], v[16:19]
  v_mfma_f32_16x16x32_bf16 v[44:47], a[12:15], v[84:87], v[44:47]
  ds_read_b128 v[72:75], v3 offset:4096
  ds_read_b128 v[76:79], v3 offset:18432
  v_mfma_f32_16x16x32_bf16 v[20:23], a[68:71], v[80:83], v[20:23]
  v_mfma_f32_16x16x32_bf16 v[48:51], a[68:71], v[84:87], v[48:51]
  v_mfma_f32_16x16x32_bf16 v[24:27], a[124:127], v[80:83], v[24:27]
  v_mfma_f32_16x16x32_bf16 v[52:55], a[124:127], v[84:87], v[52:55]
  s_waitcnt vmcnt(0)
  s_barrier
  s_cmp_lg_u32 s17, 0
  s_cbranch_scc1 w0_283
  buffer_store_dword v1, v2, s[12:15], s24 offen sc1
w0_283:
  s_cmp_ge_u32 s25, 64
  s_cbranch_scc1 nd_280
  s_mul_i32 s34, s25, 28672
  s_mul_i32 s35, s17, 7168
  s_add_u32 s34, s34, s35
  s_add_u32 s34, s34, 56623104
  s_add_u32 m0, s35, s20
  s_nop 0
  buffer_load_dwordx4 v0, s[12:15], s34 offen offset:0 sc1 lds
  buffer_load_dwordx4 v0, s[12:15], s34 offen offset:1024 sc1 lds
  buffer_load_dwordx4 v0, s[12:15], s34 offen offset:2048 sc1 lds
  buffer_load_dwordx4 v0, s[12:15], s34 offen offset:3072 sc1 lds
  s_add_u32 s34, s34, 4096
  s_add_u32 m0, m0, 4096
  s_nop 0
  buffer_load_dwordx4 v0, s[12:15], s34 offen offset:0 sc1 lds
  buffer_load_dwordx4 v0, s[12:15], s34 offen offset:1024 sc1 lds
  buffer_load_dwordx4 v0, s[12:15], s34 offen offset:2048 sc1 lds
nd_280:
  v_mfma_f32_16x16x32_bf16 v[28:31], a[180:183], v[80:83], v[28:31]
  v_mfma_f32_16x16x32_bf16 v[56:59], a[180:183], v[84:87], v[56:59]
  v_mfma_f32_16x16x32_bf16 v[32:35], a[236:239], v[80:83], v[32:35]
  v_mfma_f32_16x16x32_bf16 v[60:63], a[236:239], v[84:87], v[60:63]
  v_mfma_f32_16x16x32_bf16 v[36:39], v[156:159], v[80:83], v[36:39]
  v_mfma_f32_16x16x32_bf16 v[64:67], v[156:159], v[84:87], v[64:67]
  v_mfma_f32_16x16x32_bf16 v[40:43], v[212:215], v[80:83], v[40:43]
  v_mfma_f32_16x16x32_bf16 v[68:71], v[212:215], v[84:87], v[68:71]
  s_waitcnt lgkmcnt(0)
  v_mfma_f32_16x16x32_bf16 v[16:19], a[16:19], v[72:75], v[16:19]
  v_mfma_f32_16x16x32_bf16 v[44:47], a[16:19], v[76:79], v[44:47]
  ds_read_b128 v[80:83], v3 offset:5120
  ds_read_b128 v[84:87], v3 offset:19456
  v_mfma_f32_16x16x32_bf16 v[20:23], a[72:75], v[72:75], v[20:23]
  v_mfma_f32_16x16x32_bf16 v[48:51], a[72:75], v[76:79], v[48:51]
  v_mfma_f32_16x16x32_bf16 v[24:27], a[128:131], v[72:75], v[24:27]
  v_mfma_f32_16x16x32_bf16 v[52:55], a[128:131], v[76:79], v[52:55]
  buffer_load_dwordx4 v[88:91], v4, s[12:15], s60 offen offset:0 sc1
  v_mfma_f32_16x16x32_bf16 v[28:31], a[184:187], v[72:75], v[28:31]
  v_mfma_f32_16x16x32_bf16 v[56:59], a[184:187], v[76:79], v[56:59]
  v_mfma_f32_16x16x32_bf16 v[32:35], a[240:243], v[72:75], v[32:35]
  v_mfma_f32_16x16x32_bf16 v[60:63], a[240:243], v[76:79], v[60:63]
  v_mfma_f32_16x16x32_bf16 v[36:39], v[160:163], v[72:75], v[36:39]
  v_mfma_f32_16x16x32_bf16 v[64:67], v[160:163], v[76:79], v[64:67]
  buffer_load_dwordx4 v[92:95], v4, s[12:15], s60 offen offset:256 sc1
  v_mfma_f32_16x16x32_bf16 v[40:43], v[216:219], v[72:75], v[40:43]
  v_mfma_f32_16x16x32_bf16 v[68:71], v[216:219], v[76:79], v[68:71]
  s_waitcnt lgkmcnt(0)
  v_mfma_f32_16x16x32_bf16 v[16:19], a[20:23], v[80:83], v[16:19]
  v_mfma_f32_16x16x32_bf16 v[44:47], a[20:23], v[84:87], v[44:47]
  ds_read_b128 v[72:75], v3 offset:6144
  ds_read_b128 v[76:79], v3 offset:20480
  v_mfma_f32_16x16x32_bf16 v[20:23], a[76:79], v[80:83], v[20:23]
  v_mfma_f32_16x16x32_bf16 v[48:51], a[76:79], v[84:87], v[48:51]
  v_mfma_f32_16x16x32_bf16 v[24:27], a[132:135], v[80:83], v[24:27]
  v_mfma_f32_16x16x32_bf16 v[52:55], a[132:135], v[84:87], v[52:55]
  buffer_load_dwordx4 v[96:99], v4, s[12:15], s61 offen offset:0 sc1
  v_mfma_f32_16x16x32_bf16 v[28:31], a[188:191], v[80:83], v[28:31]
  v_mfma_f32_16x16x32_bf16 v[56:59], a[188:191], v[84:87], v[56:59]
  v_mfma_f32_16x16x32_bf16 v[32:35], a[244:247], v[80:83], v[32:35]
  v_mfma_f32_16x16x32_bf16 v[60:63], a[244:247], v[84:87], v[60:63]
  v_mfma_f32_16x16x32_bf16 v[36:39], v[164:167], v[80:83], v[36:39]
  v_mfma_f32_16x16x32_bf16 v[64:67], v[164:167], v[84:87], v[64:67]
  buffer_load_dwordx2 v[100:101], v5, s[12:15], s61 offen sc1
  v_mfma_f32_16x16x32_bf16 v[40:43], v[220:223], v[80:83], v[40:43]
  v_mfma_f32_16x16x32_bf16 v[68:71], v[220:223], v[84:87], v[68:71]
  s_waitcnt lgkmcnt(0)
  v_mfma_f32_16x16x32_bf16 v[16:19], a[24:27], v[72:75], v[16:19]
  v_mfma_f32_16x16x32_bf16 v[44:47], a[24:27], v[76:79], v[44:47]
  ds_read_b128 v[80:83], v3 offset:7168
  ds_read_b128 v[84:87], v3 offset:21504
  v_mfma_f32_16x16x32_bf16 v[20:23], a[80:83], v[72:75], v[20:23]
  v_mfma_f32_16x16x32_bf16 v[48:51], a[80:83], v[76:79], v[48:51]
  v_mfma_f32_16x16x32_bf16 v[24:27], a[136:139], v[72:75], v[24:27]
  v_mfma_f32_16x16x32_bf16 v[52:55], a[136:139], v[76:79], v[52:55]
  buffer_load_dwordx4 v[102:105], v4, s[12:15], s62 offen offset:0 sc1
  v_mfma_f32_16x16x32_bf16 v[28:31], a[192:195], v[72:75], v[28:31]
  v_mfma_f32_16x16x32_bf16 v[56:59], a[192:195], v[76:79], v[56:59]
  v_mfma_f32_16x16x32_bf16 v[32:35], a[248:251], v[72:75], v[32:35]
  v_mfma_f32_16x16x32_bf16 v[60:63], a[248:251], v[76:79], v[60:63]
  v_mfma_f32_16x16x32_bf16 v[36:39], v[168:171], v[72:75], v[36:39]
  v_mfma_f32_16x16x32_bf16 v[64:67], v[168:171], v[76:79], v[64:67]
  buffer_load_dwordx4 v[106:109], v4, s[12:15], s62 offen offset:256 sc1
  v_mfma_f32_16x16x32_bf16 v[40:43], v[224:227], v[72:75], v[40:43]
  v_mfma_f32_16x16x32_bf16 v[68:71], v[224:227], v[76:79], v[68:71]
  s_waitcnt lgkmcnt(0)
  v_mfma_f32_16x16x32_bf16 v[16:19], a[28:31], v[80:83], v[16:19]
  v_mfma_f32_16x16x32_bf16 v[44:47], a[28:31], v[84:87], v[44:47]
  ds_read_b128 v[72:75], v3 offset:8192
  ds_read_b128 v[76:79], v3 offset:22528
  v_mfma_f32_16x16x32_bf16 v[20:23], a[84:87], v[80:83], v[20:23]
  v_mfma_f32_16x16x32_bf16 v[48:51], a[84:87], v[84:87], v[48:51]
  v_mfma_f32_16x16x32_bf16 v[24:27], a[140:143], v[80:83], v[24:27]
  v_mfma_f32_16x16x32_bf16 v[52:55], a[140:143], v[84:87], v[52:55]
  buffer_load_dwordx4 v[110:113], v4, s[12:15], s63 offen offset:0 sc1
  v_mfma_f32_16x16x32_bf16 v[28:31], a[196:199], v[80:83], v[28:31]
  v_mfma_f32_16x16x32_bf16 v[56:59], a[196:199], v[84:87], v[56:59]
  v_mfma_f32_16x16x32_bf16 v[32:35], a[252:255], v[80:83], v[32:35]
  v_mfma_f32_16x16x32_bf16 v[60:63], a[252:255], v[84:87], v[60:63]
  v_mfma_f32_16x16x32_bf16 v[36:39], v[172:175], v[80:83], v[36:39]
  v_mfma_f32_16x16x32_bf16 v[64:67], v[172:175], v[84:87], v[64:67]
  buffer_load_dwordx2 v[114:115], v5, s[12:15], s63 offen sc1
  v_mfma_f32_16x16x32_bf16 v[40:43], v[228:231], v[80:83], v[40:43]
  v_mfma_f32_16x16x32_bf16 v[68:71], v[228:231], v[84:87], v[68:71]
  s_waitcnt lgkmcnt(0)
  v_mfma_f32_16x16x32_bf16 v[16:19], a[32:35], v[72:75], v[16:19]
  v_mfma_f32_16x16x32_bf16 v[44:47], a[32:35], v[76:79], v[44:47]
  ds_read_b128 v[80:83], v3 offset:9216
  ds_read_b128 v[84:87], v3 offset:23552
  v_mfma_f32_16x16x32_bf16 v[20:23], a[88:91], v[72:75], v[20:23]
  v_mfma_f32_16x16x32_bf16 v[48:51], a[88:91], v[76:79], v[48:51]
  v_mfma_f32_16x16x32_bf16 v[24:27], a[144:147], v[72:75], v[24:27]
  v_mfma_f32_16x16x32_bf16 v[52:55], a[144:147], v[76:79], v[52:55]
  buffer_load_dword v116, v117, s[12:15], s28 offen sc1
  v_mfma_f32_16x16x32_bf16 v[28:31], a[200:203], v[72:75], v[28:31]
  v_mfma_f32_16x16x32_bf16 v[56:59], a[200:203], v[76:79], v[56:59]
  v_mfma_f32_16x16x32_bf16 v[32:35], v[120:123], v[72:75], v[32:35]
  v_mfma_f32_16x16x32_bf16 v[60:63], v[120:123], v[76:79], v[60:63]
  v_mfma_f32_16x16x32_bf16 v[36:39], v[176:179], v[72:75], v[36:39]
  v_mfma_f32_16x16x32_bf16 v[64:67], v[176:179], v[76:79], v[64:67]
  v_mfma_f32_16x16x32_bf16 v[40:43], v[232:235], v[72:75], v[40:43]
  v_mfma_f32_16x16x32_bf16 v[68:71], v[232:235], v[76:79], v[68:71]
  s_waitcnt lgkmcnt(0)
  v_mfma_f32_16x16x32_bf16 v[16:19], a[36:39], v[80:83], v[16:19]
  v_mfma_f32_16x16x32_bf16 v[44:47], a[36:39], v[84:87], v[44:47]
  ds_read_b128 v[72:75], v3 offset:10240
  ds_read_b128 v[76:79], v3 offset:24576
  v_mfma_f32_16x16x32_bf16 v[20:23], a[92:95], v[80:83], v[20:23]
  v_mfma_f32_16x16x32_bf16 v[48:51], a[92:95], v[84:87], v[48:51]
  v_mfma_f32_16x16x32_bf16 v[24:27], a[148:151], v[80:83], v[24:27]
  v_mfma_f32_16x16x32_bf16 v[52:55], a[148:151], v[84:87], v[52:55]
  v_mfma_f32_16x16x32_bf16 v[28:31], a[204:207], v[80:83], v[28:31]
  v_mfma_f32_16x16x32_bf16 v[56:59], a[204:207], v[84:87], v[56:59]
  v_mfma_f32_16x16x32_bf16 v[32:35], v[124:127], v[80:83], v[32:35]
  v_mfma_f32_16x16x32_bf16 v[60:63], v[124:127], v[84:87], v[60:63]
  v_mfma_f32_16x16x32_bf16 v[36:39], v[180:183], v[80:83], v[36:39]
  v_mfma_f32_16x16x32_bf16 v[64:67], v[180:183], v[84:87], v[64:67]
  v_mfma_f32_16x16x32_bf16 v[40:43], v[236:239], v[80:83], v[40:43]
  v_mfma_f32_16x16x32_bf16 v[68:71], v[236:239], v[84:87], v[68:71]
  s_waitcnt lgkmcnt(0)
  v_mfma_f32_16x16x32_bf16 v[16:19], a[40:43], v[72:75], v[16:19]
  v_mfma_f32_16x16x32_bf16 v[44:47], a[40:43], v[76:79], v[44:47]
  ds_read_b128 v[80:83], v3 offset:11264
  ds_read_b128 v[84:87], v3 offset:25600
  v_mfma_f32_16x16x32_bf16 v[20:23], a[96:99], v[72:75], v[20:23]
  v_mfma_f32_16x16x32_bf16 v[48:51], a[96:99], v[76:79], v[48:51]
  v_mfma_f32_16x16x32_bf16 v[24:27], a[152:155], v[72:75], v[24:27]
  v_mfma_f32_16x16x32_bf16 v[52:55], a[152:155], v[76:79], v[52:55]
  v_mfma_f32_16x16x32_bf16 v[28:31], a[208:211], v[72:75], v[28:31]
  v_mfma_f32_16x16x32_bf16 v[56:59], a[208:211], v[76:79], v[56:59]
  v_mfma_f32_16x16x32_bf16 v[32:35], v[128:131], v[72:75], v[32:35]
  v_mfma_f32_16x16x32_bf16 v[60:63], v[128:131], v[76:79], v[60:63]
  v_mfma_f32_16x16x32_bf16 v[36:39], v[184:187], v[72:75], v[36:39]
  v_mfma_f32_16x16x32_bf16 v[64:67], v[184:187], v[76:79], v[64:67]
  v_mfma_f32_16x16x32_bf16 v[40:43], v[240:243], v[72:75], v[40:43]
  v_mfma_f32_16x16x32_bf16 v[68:71], v[240:243], v[76:79], v[68:71]
  s_waitcnt lgkmcnt(0)
  v_mfma_f32_16x16x32_bf16 v[16:19], a[44:47], v[80:83], v[16:19]
  v_mfma_f32_16x16x32_bf16 v[44:47], a[44:47], v[84:87], v[44:47]
  ds_read_b128 v[72:75], v3 offset:12288
  ds_read_b128 v[76:79], v3 offset:26624
  v_mfma_f32_16x16x32_bf16 v[20:23], a[100:103], v[80:83], v[20:23]
  v_mfma_f32_16x16x32_bf16 v[48:51], a[100:103], v[84:87], v[48:51]
  v_mfma_f32_16x16x32_bf16 v[24:27], a[156:159], v[80:83], v[24:27]
  v_mfma_f32_16x16x32_bf16 v[52:55], a[156:159], v[84:87], v[52:55]
  v_mfma_f32_16x16x32_bf16 v[28:31], a[212:215], v[80:83], v[28:31]
  v_mfma_f32_16x16x32_bf16 v[56:59], a[212:215], v[84:87], v[56:59]
  v_mfma_f32_16x16x32_bf16 v[32:35], v[132:135], v[80:83], v[32:35]
  v_mfma_f32_16x16x32_bf16 v[60:63], v[132:135], v[84:87], v[60:63]
  v_mfma_f32_16x16x32_bf16 v[36:39], v[188:191], v[80:83], v[36:39]
  v_mfma_f32_16x16x32_bf16 v[64:67], v[188:191], v[84:87], v[64:67]
  v_mfma_f32_16x16x32_bf16 v[40:43], v[244:247], v[80:83], v[40:43]
  v_mfma_f32_16x16x32_bf16 v[68:71], v[244:247], v[84:87], v[68:71]
  s_waitcnt lgkmcnt(0)
  v_mfma_f32_16x16x32_bf16 v[16:19], a[48:51], v[72:75], v[16:19]
  v_mfma_f32_16x16x32_bf16 v[44:47], a[48:51], v[76:79], v[44:47]
  ds_read_b128 v[80:83], v3 offset:13312
  ds_read_b128 v[84:87], v3 offset:27648
  v_mfma_f32_16x16x32_bf16 v[20:23], a[104:107], v[72:75], v[20:23]
  v_mfma_f32_16x16x32_bf16 v[48:51], a[104:107], v[76:79], v[48:51]
  v_mfma_f32_16x16x32_bf16 v[24:27], a[160:163], v[72:75], v[24:27]
  v_mfma_f32_16x16x32_bf16 v[52:55], a[160:163], v[76:79], v[52:55]
  v_mfma_f32_16x16x32_bf16 v[28:31], a[216:219], v[72:75], v[28:31]
  v_mfma_f32_16x16x32_bf16 v[56:59], a[216:219], v[76:79], v[56:59]
  v_mfma_f32_16x16x32_bf16 v[32:35], v[136:139], v[72:75], v[32:35]
  v_mfma_f32_16x16x32_bf16 v[60:63], v[136:139], v[76:79], v[60:63]
  v_mfma_f32_16x16x32_bf16 v[36:39], v[192:195], v[72:75], v[36:39]
  v_mfma_f32_16x16x32_bf16 v[64:67], v[192:195], v[76:79], v[64:67]
  v_mfma_f32_16x16x32_bf16 v[40:43], v[248:251], v[72:75], v[40:43]
  v_mfma_f32_16x16x32_bf16 v[68:71], v[248:251], v[76:79], v[68:71]
  s_waitcnt lgkmcnt(0)
  v_mfma_f32_16x16x32_bf16 v[16:19], a[52:55], v[80:83], v[16:19]
  v_mfma_f32_16x16x32_bf16 v[44:47], a[52:55], v[84:87], v[44:47]
  v_mfma_f32_16x16x32_bf16 v[20:23], a[108:111], v[80:83], v[20:23]
  v_mfma_f32_16x16x32_bf16 v[48:51], a[108:111], v[84:87], v[48:51]
  v_mfma_f32_16x16x32_bf16 v[24:27], a[164:167], v[80:83], v[24:27]
  v_mfma_f32_16x16x32_bf16 v[52:55], a[164:167], v[84:87], v[52:55]
  v_mfma_f32_16x16x32_bf16 v[28:31], a[220:223], v[80:83], v[28:31]
  v_mfma_f32_16x16x32_bf16 v[56:59], a[220:223], v[84:87], v[56:59]
  v_mfma_f32_16x16x32_bf16 v[32:35], v[140:143], v[80:83], v[32:35]
  v_mfma_f32_16x16x32_bf16 v[60:63], v[140:143], v[84:87], v[60:63]
  v_mfma_f32_16x16x32_bf16 v[36:39], v[196:199], v[80:83], v[36:39]
  v_mfma_f32_16x16x32_bf16 v[64:67], v[196:199], v[84:87], v[64:67]
  v_mfma_f32_16x16x32_bf16 v[40:43], v[252:255], v[80:83], v[40:43]
  v_mfma_f32_16x16x32_bf16 v[68:71], v[252:255], v[84:87], v[68:71]
  s_lshl_b32 s22, s18, 13
  s_add_u32 s22, s22, 54525952
  s_waitcnt vmcnt(0)
  v_cmp_gt_u32 s[30:31], 1, v116
  s_cmp_lg_u64 s[30:31], 0
  s_cbranch_scc1 e_284
  buffer_load_dwordx4 v[72:75], v6, s[12:15], s22 offen offset:0 sc1
  buffer_load_dwordx4 v[76:79], v6, s[12:15], s22 offen offset:512 sc1
  buffer_load_dwordx4 v[80:83], v6, s[12:15], s22 offen offset:1024 sc1
  buffer_load_dwordx2 v[84:85], v7, s[12:15], s22 offen sc1
e_284:
  v_cvt_pk_bf16_f32 v16, v16, v17
  v_cvt_pk_bf16_f32 v17, v20, v21
  v_cvt_pk_bf16_f32 v18, v18, v19
  v_cvt_pk_bf16_f32 v19, v22, v23
  v_cvt_pk_bf16_f32 v44, v44, v45
  v_cvt_pk_bf16_f32 v45, v48, v49
  v_cvt_pk_bf16_f32 v46, v46, v47
  v_cvt_pk_bf16_f32 v47, v50, v51
  v_cvt_pk_bf16_f32 v24, v24, v25
  v_cvt_pk_bf16_f32 v25, v28, v29
  v_cvt_pk_bf16_f32 v26, v26, v27
  v_cvt_pk_bf16_f32 v27, v30, v31
  v_cvt_pk_bf16_f32 v52, v52, v53
  v_cvt_pk_bf16_f32 v53, v56, v57
  v_cvt_pk_bf16_f32 v54, v54, v55
  v_cvt_pk_bf16_f32 v55, v58, v59
  v_cvt_pk_bf16_f32 v32, v32, v33
  v_cvt_pk_bf16_f32 v33, v36, v37
  v_cvt_pk_bf16_f32 v34, v34, v35
  v_cvt_pk_bf16_f32 v35, v38, v39
  v_cvt_pk_bf16_f32 v60, v60, v61
  v_cvt_pk_bf16_f32 v61, v64, v65
  v_cvt_pk_bf16_f32 v62, v62, v63
  v_cvt_pk_bf16_f32 v63, v66, v67
  v_cvt_pk_bf16_f32 v40, v40, v41
  v_cvt_pk_bf16_f32 v41, v42, v43
  v_cvt_pk_bf16_f32 v68, v68, v69
  v_cvt_pk_bf16_f32 v69, v70, v71
  v_mfma_f32_16x16x32_bf16 v[20:23], v[88:91], v[16:19], 0
  v_mfma_f32_16x16x32_bf16 v[48:51], v[88:91], v[44:47], 0
  v_mfma_f32_16x16x32_bf16 v[28:31], v[102:105], v[16:19], 0
  v_mfma_f32_16x16x32_bf16 v[56:59], v[102:105], v[44:47], 0
  v_mfma_f32_16x16x32_bf16 v[20:23], v[92:95], v[24:27], v[20:23]
  v_mfma_f32_16x16x32_bf16 v[48:51], v[92:95], v[52:55], v[48:51]
  v_mfma_f32_16x16x32_bf16 v[28:31], v[106:109], v[24:27], v[28:31]
  v_mfma_f32_16x16x32_bf16 v[56:59], v[106:109], v[52:55], v[56:59]
  v_mfma_f32_16x16x32_bf16 v[20:23], v[96:99], v[32:35], v[20:23]
  v_mfma_f32_16x16x32_bf16 v[48:51], v[96:99], v[60:63], v[48:51]
  v_mfma_f32_16x16x32_bf16 v[28:31], v[110:113], v[32:35], v[28:31]
  v_mfma_f32_16x16x32_bf16 v[56:59], v[110:113], v[60:63], v[56:59]
  v_mfma_f32_16x16x16_bf16 v[20:23], v[100:101], v[40:41], v[20:23]
  v_mfma_f32_16x16x16_bf16 v[48:51], v[100:101], v[68:69], v[48:51]
  v_mfma_f32_16x16x16_bf16 v[28:31], v[114:115], v[40:41], v[28:31]
  v_mfma_f32_16x16x16_bf16 v[56:59], v[114:115], v[68:69], v[56:59]
  s_nop 3
  ds_write2_b32 v8, v20, v28 offset0:0 offset1:1
  ds_write2_b32 v8, v21, v29 offset0:4 offset1:5
  ds_write2_b32 v8, v22, v30 offset0:8 offset1:9
  ds_write2_b32 v8, v23, v31 offset0:12 offset1:13
  v_add_u32 v15, 2816, v8
  ds_write2_b32 v15, v48, v56 offset0:0 offset1:1
  ds_write2_b32 v15, v49, v57 offset0:4 offset1:5
  ds_write2_b32 v15, v50, v58 offset0:8 offset1:9
  ds_write2_b32 v15, v51, v59 offset0:12 offset1:13
  s_cmp_eq_u64 s[30:31], 0
  s_cbranch_scc1 e_285
  s_lshl_b32 s34, s18, 8
  s_add_u32 s34, s34, 46989504
  v_bfe_u32 v73, v0, 4, 1
  v_lshlrev_b32 v73, 2, v73
  s_mov_b32 s23, 300000
wp_287:
  buffer_load_dword v72, v73, s[12:15], s34 offen sc1
  s_waitcnt vmcnt(0)
  v_cmp_gt_u32 vcc, 1, v72
  s_cbranch_vccz wpd_288
  s_sleep 1
  s_sub_u32 s23, s23, 1
  s_cbranch_scc0 wp_287
  s_branch L_exit
wpd_288:
mw_286:
  buffer_load_dwordx4 v[72:75], v6, s[12:15], s22 offen offset:0 sc1
  buffer_load_dwordx4 v[76:79], v6, s[12:15], s22 offen offset:512 sc1
  buffer_load_dwordx4 v[80:83], v6, s[12:15], s22 offen offset:1024 sc1
  buffer_load_dwordx2 v[84:85], v7, s[12:15], s22 offen sc1
e_285:
  s_mov_b32 s23, 300000
Smp_281:
  s_waitcnt vmcnt(0)
  v_max_u32 v15, v72, v73
  v_max3_u32 v15, v15, v74, v75
  v_max3_u32 v15, v15, v76, v77
  v_max3_u32 v15, v15, v78, v79
  v_max3_u32 v15, v15, v80, v81
  v_max3_u32 v15, v15, v82, v83
  v_max3_u32 v15, v15, v84, v85
  v_cmp_eq_u32 vcc, -1, v15
  s_cbranch_vccz Smo_282
  buffer_load_dwordx4 v[72:75], v6, s[12:15], s22 offen offset:0 sc1
  buffer_load_dwordx4 v[76:79], v6, s[12:15], s22 offen offset:512 sc1
  buffer_load_dwordx4 v[80:83], v6, s[12:15], s22 offen offset:1024 sc1
  buffer_load_dwordx2 v[84:85], v7, s[12:15], s22 offen sc1
  s_sub_u32 s23, s23, 1
  s_cbranch_scc0 Smp_281
  s_branch L_exit
Smo_282:
  v_mfma_f32_16x16x32_bf16 v[36:39], v[72:75], v[16:19], 0
  v_mfma_f32_16x16x32_bf16 v[64:67], v[72:75], v[44:47], 0
  v_mfma_f32_16x16x32_bf16 v[36:39], v[76:79], v[24:27], v[36:39]
  v_mfma_f32_16x16x32_bf16 v[64:67], v[76:79], v[52:55], v[64:67]
  v_mfma_f32_16x16x32_bf16 v[36:39], v[80:83], v[32:35], v[36:39]
  v_mfma_f32_16x16x32_bf16 v[64:67], v[80:83], v[60:63], v[64:67]
  v_mfma_f32_16x16x16_bf16 v[36:39], v[84:85], v[40:41], v[36:39]
  v_mfma_f32_16x16x16_bf16 v[64:67], v[84:85], v[68:69], v[64:67]
  s_nop 3
  ds_write_b128 v9, v[36:39] offset:0
  s_nop 2
  ds_write_b128 v9, v[64:67] offset:2816
  s_waitcnt lgkmcnt(0)
  s_barrier
  ds_read_b128 v[16:19], v10 offset:0
  ds_read_b128 v[20:23], v10 offset:5632
  ds_read_b128 v[24:27], v10 offset:11264
  ds_read_b128 v[28:31], v10 offset:16896
  ds_read_b32 v32, v11 offset:0
  ds_read_b32 v33, v11 offset:5632
  ds_read_b32 v34, v11 offset:11264
  ds_read_b32 v35, v11 offset:16896
  s_cmp_lt_u32 s18, 61
  s_cbranch_scc1 ef_289
  s_cmp_lg_u32 s17, 0
  s_cbranch_scc1 ef_289
  s_lshl_b32 s40, s18, 12
  s_lshl_b32 s41, s16, 7
  s_add_u32 s40, s40, s41
  s_add_u32 s40, s40, 46764032
  buffer_store_dword v1, v2, s[12:15], s40 offen sc1
ef_289:
  s_lshl_b32 s22, s18, 15
  s_lshl_b32 s35, s18, 13
  s_lshl_b32 s24, s18, 8
  s_lshl_b32 s34, s16, 2
  s_add_u32 s24, s24, s34
  s_add_u32 s24, s24, 46989376
  s_waitcnt lgkmcnt(0)
  v_pk_add_f32 v[16:17], v[16:17], v[20:21]
  v_pk_add_f32 v[18:19], v[18:19], v[22:23]
  v_pk_add_f32 v[24:25], v[24:25], v[28:29]
  v_pk_add_f32 v[26:27], v[26:27], v[30:31]
  v_pk_add_f32 v[32:33], v[32:33], v[34:35]
  v_pk_add_f32 v[16:17], v[16:17], v[24:25]
  v_pk_add_f32 v[18:19], v[18:19], v[26:27]
  v_add_f32 v20, v32, v33
  v_cndmask_b32 v16, v14, v16, s[48:49]
  v_cndmask_b32 v17, v14, v17, s[50:51]
  v_cndmask_b32 v18, v14, v18, s[52:53]
  v_cndmask_b32 v19, v14, v19, s[54:55]
  v_max3_f32 v44, v16, v17, v18
  v_max3_f32 v44, v44, v19, v20
  s_nop 1
  v_max_f32_dpp v44, v44, v44 quad_perm:[1,0,3,2] row_mask:0xf bank_mask:0xf
  s_nop 1
  v_max_f32_dpp v44, v44, v44 quad_perm:[2,3,0,1] row_mask:0xf bank_mask:0xf
  s_nop 1
  v_max_f32_dpp v44, v44, v44 row_half_mirror row_mask:0xf bank_mask:0xf
  v_sub_f32 v16, v16, v44
  v_sub_f32 v17, v17, v44
  v_sub_f32 v18, v18, v44
  v_sub_f32 v19, v19, v44
  v_sub_f32 v20, v20, v44
  v_exp_f32 v40, v20
  v_exp_f32 v36, v16
  v_exp_f32 v37, v17
  v_exp_f32 v38, v18
  v_exp_f32 v39, v19
  v_mov_b32_dpp v41, v40 quad_perm:[1,0,3,2] row_mask:0xf bank_mask:0xf
  v_pk_add_f32 v[44:45], v[36:37], v[38:39]
  v_add_f32 v44, v44, v40
  v_add_f32 v44, v44, v45
  s_nop 1
  v_add_f32_dpp v44, v44, v44 quad_perm:[1,0,3,2] row_mask:0xf bank_mask:0xf
  s_nop 1
  v_add_f32_dpp v44, v44, v44 quad_perm:[2,3,0,1] row_mask:0xf bank_mask:0xf
  s_nop 1
  v_add_f32_dpp v44, v44, v44 row_half_mirror row_mask:0xf bank_mask:0xf
  v_rcp_f32 v44, v44
  s_nop 0
  v_pk_mul_f32 v[36:37], v[36:37], v[44:45] op_sel_hi:[1,0] clamp
  v_pk_mul_f32 v[38:39], v[38:39], v[44:45] op_sel_hi:[1,0] clamp
  v_pk_mul_f32 v[40:41], v[40:41], v[44:45] op_sel_hi:[1,0] clamp
  v_cvt_pk_bf16_f32 v46, v36, v37
  v_cvt_pk_bf16_f32 v47, v38, v39
  v_cvt_pk_bf16_f32 v48, v40, v41
  buffer_store_dwordx2 v[46:47], v12, s[12:15], s22 offen sc1
  buffer_store_dword v48, v13, s[12:15], s35 offen sc1
  s_mov_b32 s18, s25
  s_cmp_lt_u32 s18, 64
  s_cbranch_scc1 Stop_279
  s_waitcnt vmcnt(0)
  s_barrier
  s_cmp_lg_u32 s17, 0
  s_cbranch_scc1 w0_290
  buffer_store_dword v1, v2, s[12:15], s24 offen sc1
w0_290:
  s_branch L_fin
L_roleG:
  s_lshr_b32 s16, s26, 3
  s_and_b32 s19, s26, 7
  s_cmp_lg_u32 s17, 0
  s_cbranch_scc1 wa_291
  s_lshr_b32 s34, s46, 5
  s_lshl_b32 s34, s34, 7
  s_add_u32 s34, s34, 46927872
  v_mov_b32 v16, 0
  s_mov_b32 s23, 300000
fp_292:
  buffer_load_dword v17, v16, s[12:15], s34 offen sc1
  s_waitcnt vmcnt(0)
  v_cmp_gt_u32 vcc, 1, v17
  s_cbranch_vccz fpd_293
  s_sleep 4
  s_sub_u32 s23, s23, 1
  s_cbranch_scc0 fp_292
  s_branch L_exit
fpd_293:
wa_291:
  s_barrier
  v_mov_b32 v8, v0
  v_lshlrev_b32 v0, 4, v8
  v_mov_b32 v1, 1
  v_min_u32 v2, 1, v8
  v_lshlrev_b32 v2, 30, v2
  v_bfe_u32 v4, v8, 4, 1
  v_lshlrev_b32 v5, 0, v4
  v_mul_u32_u24 v5, 14336, v5
  v_bfe_u32 v4, v8, 5, 1
  v_lshlrev_b32 v3, 8, v4
  v_bfe_u32 v4, v8, 0, 4
  v_lshl_add_u32 v3, v4, 4, v3
  v_add_u32 v3, v3, v5
  v_bfe_u32 v4, v8, 4, 1
  v_lshlrev_b32 v6, 14, v4
  v_bfe_u32 v4, v8, 5, 1
  v_lshl_add_u32 v6, v4, 8, v6
  v_bfe_u32 v4, v8, 0, 4
  v_lshl_add_u32 v6, v4, 4, v6
  s_lshl_b32 s18, s19, 3
  s_lshl_b32 s34, s17, 1
  s_add_u32 s18, s18, s34
  s_mul_i32 s20, s18, 28672
  s_add_u32 s20, s20, 56623104
  s_add_u32 s21, s20, 28672
  s_mul_i32 s27, s16, 86016
  s_mul_i32 s34, s17, 21504
  s_add_u32 s27, s27, s34
  s_add_u32 s27, s27, 58720256
  s_mov_b32 m0, s34
  s_nop 0
  buffer_load_dwordx4 v0, s[12:15], s27 offen offset:0 sc1 lds
  buffer_load_dwordx4 v0, s[12:15], s27 offen offset:1024 sc1 lds
  buffer_load_dwordx4 v0, s[12:15], s27 offen offset:2048 sc1 lds
  buffer_load_dwordx4 v0, s[12:15], s27 offen offset:3072 sc1 lds
  s_add_u32 s27, s27, 4096
  s_add_u32 m0, m0, 4096
  s_nop 0
  buffer_load_dwordx4 v0, s[12:15], s27 offen offset:0 sc1 lds
  buffer_load_dwordx4 v0, s[12:15], s27 offen offset:1024 sc1 lds
  buffer_load_dwordx4 v0, s[12:15], s27 offen offset:2048 sc1 lds
  buffer_load_dwordx4 v0, s[12:15], s27 offen offset:3072 sc1 lds
  s_add_u32 s27, s27, 4096
  s_add_u32 m0, m0, 4096
  s_nop 0
  buffer_load_dwordx4 v0, s[12:15], s27 offen offset:0 sc1 lds
  buffer_load_dwordx4 v0, s[12:15], s27 offen offset:1024 sc1 lds
  buffer_load_dwordx4 v0, s[12:15], s27 offen offset:2048 sc1 lds
  buffer_load_dwordx4 v0, s[12:15], s27 offen offset:3072 sc1 lds
  s_add_u32 s27, s27, 4096
  s_add_u32 m0, m0, 4096
  s_nop 0
  buffer_load_dwordx4 v0, s[12:15], s27 offen offset:0 sc1 lds
  buffer_load_dwordx4 v0, s[12:15], s27 offen offset:1024 sc1 lds
  buffer_load_dwordx4 v0, s[12:15], s27 offen offset:2048 sc1 lds
  buffer_load_dwordx4 v0, s[12:15], s27 offen offset:3072 sc1 lds
  s_add_u32 s27, s27, 4096
  s_add_u32 m0, m0, 4096
  s_nop 0
  buffer_load_dwordx4 v0, s[12:15], s27 offen offset:0 sc1 lds
  buffer_load_dwordx4 v0, s[12:15], s27 offen offset:1024 sc1 lds
  buffer_load_dwordx4 v0, s[12:15], s27 offen offset:2048 sc1 lds
  buffer_load_dwordx4 v0, s[12:15], s27 offen offset:3072 sc1 lds
  s_add_u32 s27, s27, 4096
  s_add_u32 m0, m0, 4096
  s_nop 0
  buffer_load_dwordx4 v0, s[12:15], s27 offen offset:0 sc1 lds
  buffer_load_dwordx4 v[112:115], v3, s[12:15], s20 offen offset:0 sc1
  buffer_load_dwordx4 v[116:119], v3, s[12:15], s21 offen offset:0 sc1
  buffer_load_dwordx4 v[120:123], v3, s[12:15], s20 offen offset:512 sc1
  buffer_load_dwordx4 v[124:127], v3, s[12:15], s21 offen offset:512 sc1
  buffer_load_dwordx4 v[128:131], v3, s[12:15], s20 offen offset:1024 sc1
  buffer_load_dwordx4 v[132:135], v3, s[12:15], s21 offen offset:1024 sc1
  buffer_load_dwordx4 v[136:139], v3, s[12:15], s20 offen offset:1536 sc1
  buffer_load_dwordx4 v[140:143], v3, s[12:15], s21 offen offset:1536 sc1
  buffer_load_dwordx4 v[144:147], v3, s[12:15], s20 offen offset:2048 sc1
  buffer_load_dwordx4 v[148:151], v3, s[12:15], s21 offen offset:2048 sc1
  buffer_load_dwordx4 v[152:155], v3, s[12:15], s20 offen offset:2560 sc1
  buffer_load_dwordx4 v[156:159], v3, s[12:15], s21 offen offset:2560 sc1
  buffer_load_dwordx4 v[160:163], v3, s[12:15], s20 offen offset:3072 sc1
  buffer_load_dwordx4 v[164:167], v3, s[12:15], s21 offen offset:3072 sc1
  v_and_b32 v4, 31, v8
  v_cmp_eq_u32 vcc, 28, v4
  s_nop 1
  v_cndmask_b32 v4, 0, 1.0, vcc
  v_add_u32 v5, 57344, v0
  v_mov_b32 v48, v4
  v_mov_b32 v49, v4
  v_mov_b32 v50, v4
  v_mov_b32 v51, v4
  v_mov_b32 v52, v4
  v_mov_b32 v53, v4
  v_mov_b32 v54, v4
  v_mov_b32 v55, v4
  v_mov_b32 v56, v4
  v_mov_b32 v57, v4
  v_mov_b32 v58, v4
  v_mov_b32 v59, v4
  v_mov_b32 v60, v4
  v_mov_b32 v61, v4
  v_mov_b32 v62, v4
  v_mov_b32 v63, v4
  v_mov_b32 v96, v4
  v_mov_b32 v97, v4
  v_mov_b32 v98, v4
  v_mov_b32 v99, v4
  v_mov_b32 v100, v4
  v_mov_b32 v101, v4
  v_mov_b32 v102, v4
  v_mov_b32 v103, v4
  v_mov_b32 v104, v4
  v_mov_b32 v105, v4
  v_mov_b32 v106, v4
  v_mov_b32 v107, v4
  v_mov_b32 v108, v4
  v_mov_b32 v109, v4
  v_mov_b32 v110, v4
  v_mov_b32 v111, v4
  s_waitcnt vmcnt(14)
  s_barrier
  ds_read_b128 v[176:179], v0 offset:0
  ds_read_b128 v[180:183], v0 offset:28672
  ds_read_b128 v[184:187], v5 offset:0
  s_waitcnt vmcnt(12)
  s_waitcnt lgkmcnt(0)
  v_mfma_f32_32x32x16_bf16 v[16:31], v[176:179], v[112:115], 0
  ds_read_b128 v[188:191], v0 offset:1024
  v_mfma_f32_32x32x16_bf16 v[32:47], v[180:183], v[112:115], 0
  ds_read_b128 v[192:195], v0 offset:29696
  v_mfma_f32_32x32x16_bf16 v[48:63], v[112:115], v[184:187], v[48:63]
  ds_read_b128 v[196:199], v5 offset:1024
  v_mfma_f32_32x32x16_bf16 v[64:79], v[176:179], v[116:119], 0
  buffer_load_dwordx4 v[168:171], v3, s[12:15], s20 offen offset:3584 sc1
  v_mfma_f32_32x32x16_bf16 v[80:95], v[180:183], v[116:119], 0
  buffer_load_dwordx4 v[172:175], v3, s[12:15], s21 offen offset:3584 sc1
  v_mfma_f32_32x32x16_bf16 v[96:111], v[116:119], v[184:187], v[96:111]
  s_waitcnt vmcnt(12)
  s_waitcnt lgkmcnt(0)
  s_add_u32 s20, s20, 4096
  s_add_u32 s21, s21, 4096
  v_mfma_f32_32x32x16_bf16 v[16:31], v[188:191], v[120:123], v[16:31]
  ds_read_b128 v[176:179], v0 offset:2048
  v_mfma_f32_32x32x16_bf16 v[32:47], v[192:195], v[120:123], v[32:47]
  ds_read_b128 v[180:183], v0 offset:30720
  v_mfma_f32_32x32x16_bf16 v[48:63], v[120:123], v[196:199], v[48:63]
  ds_read_b128 v[184:187], v5 offset:2048
  v_mfma_f32_32x32x16_bf16 v[64:79], v[188:191], v[124:127], v[64:79]
  buffer_load_dwordx4 v[112:115], v3, s[12:15], s20 offen offset:0 sc1
  v_mfma_f32_32x32x16_bf16 v[80:95], v[192:195], v[124:127], v[80:95]
  buffer_load_dwordx4 v[116:119], v3, s[12:15], s21 offen offset:0 sc1
  v_mfma_f32_32x32x16_bf16 v[96:111], v[124:127], v[196:199], v[96:111]
  s_waitcnt vmcnt(12)
  s_waitcnt lgkmcnt(0)
  v_mfma_f32_32x32x16_bf16 v[16:31], v[176:179], v[128:131], v[16:31]
  ds_read_b128 v[188:191], v0 offset:3072
  v_mfma_f32_32x32x16_bf16 v[32:47], v[180:183], v[128:131], v[32:47]
  ds_read_b128 v[192:195], v0 offset:31744
  v_mfma_f32_32x32x16_bf16 v[48:63], v[128:131], v[184:187], v[48:63]
  ds_read_b128 v[196:199], v5 offset:3072
  v_mfma_f32_32x32x16_bf16 v[64:79], v[176:179], v[132:135], v[64:79]
  buffer_load_dwordx4 v[120:123], v3, s[12:15], s20 offen offset:512 sc1
  v_mfma_f32_32x32x16_bf16 v[80:95], v[180:183], v[132:135], v[80:95]
  buffer_load_dwordx4 v[124:127], v3, s[12:15], s21 offen offset:512 sc1
  v_mfma_f32_32x32x16_bf16 v[96:111], v[132:135], v[184:187], v[96:111]
  s_waitcnt vmcnt(12)
  s_waitcnt lgkmcnt(0)
  v_mfma_f32_32x32x16_bf16 v[16:31], v[188:191], v[136:139], v[16:31]
  ds_read_b128 v[176:179], v0 offset:4096
  v_mfma_f32_32x32x16_bf16 v[32:47], v[192:195], v[136:139], v[32:47]
  ds_read_b128 v[180:183], v0 offset:32768
  v_mfma_f32_32x32x16_bf16 v[48:63], v[136:139], v[196:199], v[48:63]
  ds_read_b128 v[184:187], v5 offset:4096
  v_mfma_f32_32x32x16_bf16 v[64:79], v[188:191], v[140:143], v[64:79]
  buffer_load_dwordx4 v[128:131], v3, s[12:15], s20 offen offset:1024 sc1
  v_mfma_f32_32x32x16_bf16 v[80:95], v[192:195], v[140:143], v[80:95]
  buffer_load_dwordx4 v[132:135], v3, s[12:15], s21 offen offset:1024 sc1
  v_mfma_f32_32x32x16_bf16 v[96:111], v[140:143], v[196:199], v[96:111]
  s_waitcnt vmcnt(12)
  s_waitcnt lgkmcnt(0)
  v_mfma_f32_32x32x16_bf16 v[16:31], v[176:179], v[144:147], v[16:31]
  ds_read_b128 v[188:191], v0 offset:5120
  v_mfma_f32_32x32x16_bf16 v[32:47], v[180:183], v[144:147], v[32:47]
  ds_read_b128 v[192:195], v0 offset:33792
  v_mfma_f32_32x32x16_bf16 v[48:63], v[144:147], v[184:187], v[48:63]
  ds_read_b128 v[196:199], v5 offset:5120
  v_mfma_f32_32x32x16_bf16 v[64:79], v[176:179], v[148:151], v[64:79]
  buffer_load_dwordx4 v[136:139], v3, s[12:15], s20 offen offset:1536 sc1
  v_mfma_f32_32x32x16_bf16 v[80:95], v[180:183], v[148:151], v[80:95]
  buffer_load_dwordx4 v[140:143], v3, s[12:15], s21 offen offset:1536 sc1
  v_mfma_f32_32x32x16_bf16 v[96:111], v[148:151], v[184:187], v[96:111]
  s_waitcnt vmcnt(12)
  s_waitcnt lgkmcnt(0)
  v_mfma_f32_32x32x16_bf16 v[16:31], v[188:191], v[152:155], v[16:31]
  ds_read_b128 v[176:179], v0 offset:6144
  v_mfma_f32_32x32x16_bf16 v[32:47], v[192:195], v[152:155], v[32:47]
  ds_read_b128 v[180:183], v0 offset:34816
  v_mfma_f32_32x32x16_bf16 v[48:63], v[152:155], v[196:199], v[48:63]
  ds_read_b128 v[184:187], v5 offset:6144
  v_mfma_f32_32x32x16_bf16 v[64:79], v[188:191], v[156:159], v[64:79]
  buffer_load_dwordx4 v[144:147], v3, s[12:15], s20 offen offset:2048 sc1
  v_mfma_f32_32x32x16_bf16 v[80:95], v[192:195], v[156:159], v[80:95]
  buffer_load_dwordx4 v[148:151], v3, s[12:15], s21 offen offset:2048 sc1
  v_mfma_f32_32x32x16_bf16 v[96:111], v[156:159], v[196:199], v[96:111]
  s_waitcnt vmcnt(12)
  s_waitcnt lgkmcnt(0)
  v_mfma_f32_32x32x16_bf16 v[16:31], v[176:179], v[160:163], v[16:31]
  ds_read_b128 v[188:191], v0 offset:7168
  v_mfma_f32_32x32x16_bf16 v[32:47], v[180:183], v[160:163], v[32:47]
  ds_read_b128 v[192:195], v0 offset:35840
  v_mfma_f32_32x32x16_bf16 v[48:63], v[160:163], v[184:187], v[48:63]
  ds_read_b128 v[196:199], v5 offset:7168
  v_mfma_f32_32x32x16_bf16 v[64:79], v[176:179], v[164:167], v[64:79]
  buffer_load_dwordx4 v[152:155], v3, s[12:15], s20 offen offset:2560 sc1
  v_mfma_f32_32x32x16_bf16 v[80:95], v[180:183], v[164:167], v[80:95]
  buffer_load_dwordx4 v[156:159], v3, s[12:15], s21 offen offset:2560 sc1
  v_mfma_f32_32x32x16_bf16 v[96:111], v[164:167], v[184:187], v[96:111]
  s_waitcnt vmcnt(12)
  s_waitcnt lgkmcnt(0)
  v_mfma_f32_32x32x16_bf16 v[16:31], v[188:191], v[168:171], v[16:31]
  ds_read_b128 v[176:179], v0 offset:8192
  v_mfma_f32_32x32x16_bf16 v[32:47], v[192:195], v[168:171], v[32:47]
  ds_read_b128 v[180:183], v0 offset:36864
  v_mfma_f32_32x32x16_bf16 v[48:63], v[168:171], v[196:199], v[48:63]
  ds_read_b128 v[184:187], v5 offset:8192
  v_mfma_f32_32x32x16_bf16 v[64:79], v[188:191], v[172:175], v[64:79]
  buffer_load_dwordx4 v[160:163], v3, s[12:15], s20 offen offset:3072 sc1
  v_mfma_f32_32x32x16_bf16 v[80:95], v[192:195], v[172:175], v[80:95]
  buffer_load_dwordx4 v[164:167], v3, s[12:15], s21 offen offset:3072 sc1
  v_mfma_f32_32x32x16_bf16 v[96:111], v[172:175], v[196:199], v[96:111]
  s_waitcnt vmcnt(12)
  s_waitcnt lgkmcnt(0)
  v_mfma_f32_32x32x16_bf16 v[16:31], v[176:179], v[112:115], v[16:31]
  ds_read_b128 v[188:191], v0 offset:9216
  v_mfma_f32_32x32x16_bf16 v[32:47], v[180:183], v[112:115], v[32:47]
  ds_read_b128 v[192:195], v0 offset:37888
  v_mfma_f32_32x32x16_bf16 v[48:63], v[112:115], v[184:187], v[48:63]
  ds_read_b128 v[196:199], v5 offset:9216
  v_mfma_f32_32x32x16_bf16 v[64:79], v[176:179], v[116:119], v[64:79]
  buffer_load_dwordx4 v[168:171], v3, s[12:15], s20 offen offset:3584 sc1
  v_mfma_f32_32x32x16_bf16 v[80:95], v[180:183], v[116:119], v[80:95]
  buffer_load_dwordx4 v[172:175], v3, s[12:15], s21 offen offset:3584 sc1
  v_mfma_f32_32x32x16_bf16 v[96:111], v[116:119], v[184:187], v[96:111]
  s_waitcnt vmcnt(12)
  s_waitcnt lgkmcnt(0)
  s_add_u32 s20, s20, 4096
  s_add_u32 s21, s21, 4096
  v_mfma_f32_32x32x16_bf16 v[16:31], v[188:191], v[120:123], v[16:31]
  ds_read_b128 v[176:179], v0 offset:10240
  v_mfma_f32_32x32x16_bf16 v[32:47], v[192:195], v[120:123], v[32:47]
  ds_read_b128 v[180:183], v0 offset:38912
  v_mfma_f32_32x32x16_bf16 v[48:63], v[120:123], v[196:199], v[48:63]
  ds_read_b128 v[184:187], v5 offset:10240
  v_mfma_f32_32x32x16_bf16 v[64:79], v[188:191], v[124:127], v[64:79]
  buffer_load_dwordx4 v[112:115], v3, s[12:15], s20 offen offset:0 sc1
  v_mfma_f32_32x32x16_bf16 v[80:95], v[192:195], v[124:127], v[80:95]
  buffer_load_dwordx4 v[116:119], v3, s[12:15], s21 offen offset:0 sc1
  v_mfma_f32_32x32x16_bf16 v[96:111], v[124:127], v[196:199], v[96:111]
  s_waitcnt vmcnt(12)
  s_waitcnt lgkmcnt(0)
  v_mfma_f32_32x32x16_bf16 v[16:31], v[176:179], v[128:131], v[16:31]
  ds_read_b128 v[188:191], v0 offset:11264
  v_mfma_f32_32x32x16_bf16 v[32:47], v[180:183], v[128:131], v[32:47]
  ds_read_b128 v[192:195], v0 offset:39936
  v_mfma_f32_32x32x16_bf16 v[48:63], v[128:131], v[184:187], v[48:63]
  ds_read_b128 v[196:199], v5 offset:11264
  v_mfma_f32_32x32x16_bf16 v[64:79], v[176:179], v[132:135], v[64:79]
  buffer_load_dwordx4 v[120:123], v3, s[12:15], s20 offen offset:512 sc1
  v_mfma_f32_32x32x16_bf16 v[80:95], v[180:183], v[132:135], v[80:95]
  buffer_load_dwordx4 v[124:127], v3, s[12:15], s21 offen offset:512 sc1
  v_mfma_f32_32x32x16_bf16 v[96:111], v[132:135], v[184:187], v[96:111]
  s_waitcnt vmcnt(12)
  s_waitcnt lgkmcnt(0)
  v_mfma_f32_32x32x16_bf16 v[16:31], v[188:191], v[136:139], v[16:31]
  ds_read_b128 v[176:179], v0 offset:12288
  v_mfma_f32_32x32x16_bf16 v[32:47], v[192:195], v[136:139], v[32:47]
  ds_read_b128 v[180:183], v0 offset:40960
  v_mfma_f32_32x32x16_bf16 v[48:63], v[136:139], v[196:199], v[48:63]
  ds_read_b128 v[184:187], v5 offset:12288
  v_mfma_f32_32x32x16_bf16 v[64:79], v[188:191], v[140:143], v[64:79]
  buffer_load_dwordx4 v[128:131], v3, s[12:15], s20 offen offset:1024 sc1
  v_mfma_f32_32x32x16_bf16 v[80:95], v[192:195], v[140:143], v[80:95]
  buffer_load_dwordx4 v[132:135], v3, s[12:15], s21 offen offset:1024 sc1
  v_mfma_f32_32x32x16_bf16 v[96:111], v[140:143], v[196:199], v[96:111]
  s_waitcnt vmcnt(12)
  s_waitcnt lgkmcnt(0)
  v_mfma_f32_32x32x16_bf16 v[16:31], v[176:179], v[144:147], v[16:31]
  ds_read_b128 v[188:191], v0 offset:13312
  v_mfma_f32_32x32x16_bf16 v[32:47], v[180:183], v[144:147], v[32:47]
  ds_read_b128 v[192:195], v0 offset:41984
  v_mfma_f32_32x32x16_bf16 v[48:63], v[144:147], v[184:187], v[48:63]
  ds_read_b128 v[196:199], v5 offset:13312
  v_mfma_f32_32x32x16_bf16 v[64:79], v[176:179], v[148:151], v[64:79]
  buffer_load_dwordx4 v[136:139], v3, s[12:15], s20 offen offset:1536 sc1
  v_mfma_f32_32x32x16_bf16 v[80:95], v[180:183], v[148:151], v[80:95]
  buffer_load_dwordx4 v[140:143], v3, s[12:15], s21 offen offset:1536 sc1
  v_mfma_f32_32x32x16_bf16 v[96:111], v[148:151], v[184:187], v[96:111]
  s_waitcnt vmcnt(12)
  s_waitcnt lgkmcnt(0)
  v_mfma_f32_32x32x16_bf16 v[16:31], v[188:191], v[152:155], v[16:31]
  ds_read_b128 v[176:179], v0 offset:14336
  v_mfma_f32_32x32x16_bf16 v[32:47], v[192:195], v[152:155], v[32:47]
  ds_read_b128 v[180:183], v0 offset:43008
  v_mfma_f32_32x32x16_bf16 v[48:63], v[152:155], v[196:199], v[48:63]
  ds_read_b128 v[184:187], v5 offset:14336
  v_mfma_f32_32x32x16_bf16 v[64:79], v[188:191], v[156:159], v[64:79]
  buffer_load_dwordx4 v[144:147], v3, s[12:15], s20 offen offset:2048 sc1
  v_mfma_f32_32x32x16_bf16 v[80:95], v[192:195], v[156:159], v[80:95]
  buffer_load_dwordx4 v[148:151], v3, s[12:15], s21 offen offset:2048 sc1
  v_mfma_f32_32x32x16_bf16 v[96:111], v[156:159], v[196:199], v[96:111]
  s_waitcnt vmcnt(12)
  s_waitcnt lgkmcnt(0)
  v_mfma_f32_32x32x16_bf16 v[16:31], v[176:179], v[160:163], v[16:31]
  ds_read_b128 v[188:191], v0 offset:15360
  v_mfma_f32_32x32x16_bf16 v[32:47], v[180:183], v[160:163], v[32:47]
  ds_read_b128 v[192:195], v0 offset:44032
  v_mfma_f32_32x32x16_bf16 v[48:63], v[160:163], v[184:187], v[48:63]
  ds_read_b128 v[196:199], v5 offset:15360
  v_mfma_f32_32x32x16_bf16 v[64:79], v[176:179], v[164:167], v[64:79]
  buffer_load_dwordx4 v[152:155], v3, s[12:15], s20 offen offset:2560 sc1
  v_mfma_f32_32x32x16_bf16 v[80:95], v[180:183], v[164:167], v[80:95]
  buffer_load_dwordx4 v[156:159], v3, s[12:15], s21 offen offset:2560 sc1
  v_mfma_f32_32x32x16_bf16 v[96:111], v[164:167], v[184:187], v[96:111]
  s_waitcnt vmcnt(12)
  s_waitcnt lgkmcnt(0)
  v_mfma_f32_32x32x16_bf16 v[16:31], v[188:191], v[168:171], v[16:31]
  ds_read_b128 v[176:179], v0 offset:16384
  v_mfma_f32_32x32x16_bf16 v[32:47], v[192:195], v[168:171], v[32:47]
  ds_read_b128 v[180:183], v0 offset:45056
  v_mfma_f32_32x32x16_bf16 v[48:63], v[168:171], v[196:199], v[48:63]
  ds_read_b128 v[184:187], v5 offset:16384
  v_mfma_f32_32x32x16_bf16 v[64:79], v[188:191], v[172:175], v[64:79]
  buffer_load_dwordx4 v[160:163], v3, s[12:15], s20 offen offset:3072 sc1
  v_mfma_f32_32x32x16_bf16 v[80:95], v[192:195], v[172:175], v[80:95]
  buffer_load_dwordx4 v[164:167], v3, s[12:15], s21 offen offset:3072 sc1
  v_mfma_f32_32x32x16_bf16 v[96:111], v[172:175], v[196:199], v[96:111]
  s_waitcnt vmcnt(12)
  s_waitcnt lgkmcnt(0)
  v_mfma_f32_32x32x16_bf16 v[16:31], v[176:179], v[112:115], v[16:31]
  ds_read_b128 v[188:191], v0 offset:17408
  v_mfma_f32_32x32x16_bf16 v[32:47], v[180:183], v[112:115], v[32:47]
  ds_read_b128 v[192:195], v0 offset:46080
  v_mfma_f32_32x32x16_bf16 v[48:63], v[112:115], v[184:187], v[48:63]
  ds_read_b128 v[196:199], v5 offset:17408
  v_mfma_f32_32x32x16_bf16 v[64:79], v[176:179], v[116:119], v[64:79]
  buffer_load_dwordx4 v[168:171], v3, s[12:15], s20 offen offset:3584 sc1
  v_mfma_f32_32x32x16_bf16 v[80:95], v[180:183], v[116:119], v[80:95]
  buffer_load_dwordx4 v[172:175], v3, s[12:15], s21 offen offset:3584 sc1
  v_mfma_f32_32x32x16_bf16 v[96:111], v[116:119], v[184:187], v[96:111]
  s_waitcnt vmcnt(12)
  s_waitcnt lgkmcnt(0)
  s_add_u32 s20, s20, 4096
  s_add_u32 s21, s21, 4096
  v_mfma_f32_32x32x16_bf16 v[16:31], v[188:191], v[120:123], v[16:31]
  ds_read_b128 v[176:179], v0 offset:18432
  v_mfma_f32_32x32x16_bf16 v[32:47], v[192:195], v[120:123], v[32:47]
  ds_read_b128 v[180:183], v0 offset:47104
  v_mfma_f32_32x32x16_bf16 v[48:63], v[120:123], v[196:199], v[48:63]
  ds_read_b128 v[184:187], v5 offset:18432
  v_mfma_f32_32x32x16_bf16 v[64:79], v[188:191], v[124:127], v[64:79]
  buffer_load_dwordx4 v[112:115], v3, s[12:15], s20 offen offset:0 sc1
  v_mfma_f32_32x32x16_bf16 v[80:95], v[192:195], v[124:127], v[80:95]
  buffer_load_dwordx4 v[116:119], v3, s[12:15], s21 offen offset:0 sc1
  v_mfma_f32_32x32x16_bf16 v[96:111], v[124:127], v[196:199], v[96:111]
  s_waitcnt vmcnt(12)
  s_waitcnt lgkmcnt(0)
  v_mfma_f32_32x32x16_bf16 v[16:31], v[176:179], v[128:131], v[16:31]
  ds_read_b128 v[188:191], v0 offset:19456
  v_mfma_f32_32x32x16_bf16 v[32:47], v[180:183], v[128:131], v[32:47]
  ds_read_b128 v[192:195], v0 offset:48128
  v_mfma_f32_32x32x16_bf16 v[48:63], v[128:131], v[184:187], v[48:63]
  ds_read_b128 v[196:199], v5 offset:19456
  v_mfma_f32_32x32x16_bf16 v[64:79], v[176:179], v[132:135], v[64:79]
  buffer_load_dwordx4 v[120:123], v3, s[12:15], s20 offen offset:512 sc1
  v_mfma_f32_32x32x16_bf16 v[80:95], v[180:183], v[132:135], v[80:95]
  buffer_load_dwordx4 v[124:127], v3, s[12:15], s21 offen offset:512 sc1
  v_mfma_f32_32x32x16_bf16 v[96:111], v[132:135], v[184:187], v[96:111]
  s_waitcnt vmcnt(12)
  s_waitcnt lgkmcnt(0)
  v_mfma_f32_32x32x16_bf16 v[16:31], v[188:191], v[136:139], v[16:31]
  ds_read_b128 v[176:179], v0 offset:20480
  v_mfma_f32_32x32x16_bf16 v[32:47], v[192:195], v[136:139], v[32:47]
  ds_read_b128 v[180:183], v0 offset:49152
  v_mfma_f32_32x32x16_bf16 v[48:63], v[136:139], v[196:199], v[48:63]
  ds_read_b128 v[184:187], v5 offset:20480
  v_mfma_f32_32x32x16_bf16 v[64:79], v[188:191], v[140:143], v[64:79]
  buffer_load_dwordx4 v[128:131], v3, s[12:15], s20 offen offset:1024 sc1
  v_mfma_f32_32x32x16_bf16 v[80:95], v[192:195], v[140:143], v[80:95]
  buffer_load_dwordx4 v[132:135], v3, s[12:15], s21 offen offset:1024 sc1
  v_mfma_f32_32x32x16_bf16 v[96:111], v[140:143], v[196:199], v[96:111]
  s_waitcnt vmcnt(12)
  s_waitcnt lgkmcnt(0)
  v_mfma_f32_32x32x16_bf16 v[16:31], v[176:179], v[144:147], v[16:31]
  ds_read_b128 v[188:191], v0 offset:21504
  v_mfma_f32_32x32x16_bf16 v[32:47], v[180:183], v[144:147], v[32:47]
  ds_read_b128 v[192:195], v0 offset:50176
  v_mfma_f32_32x32x16_bf16 v[48:63], v[144:147], v[184:187], v[48:63]
  ds_read_b128 v[196:199], v5 offset:21504
  v_mfma_f32_32x32x16_bf16 v[64:79], v[176:179], v[148:151], v[64:79]
  buffer_load_dwordx4 v[136:139], v3, s[12:15], s20 offen offset:1536 sc1
  v_mfma_f32_32x32x16_bf16 v[80:95], v[180:183], v[148:151], v[80:95]
  buffer_load_dwordx4 v[140:143], v3, s[12:15], s21 offen offset:1536 sc1
  v_mfma_f32_32x32x16_bf16 v[96:111], v[148:151], v[184:187], v[96:111]
  s_waitcnt vmcnt(12)
  s_waitcnt lgkmcnt(0)
  v_mfma_f32_32x32x16_bf16 v[16:31], v[188:191], v[152:155], v[16:31]
  ds_read_b128 v[176:179], v0 offset:22528
  v_mfma_f32_32x32x16_bf16 v[32:47], v[192:195], v[152:155], v[32:47]
  ds_read_b128 v[180:183], v0 offset:51200
  v_mfma_f32_32x32x16_bf16 v[48:63], v[152:155], v[196:199], v[48:63]
  ds_read_b128 v[184:187], v5 offset:22528
  v_mfma_f32_32x32x16_bf16 v[64:79], v[188:191], v[156:159], v[64:79]
  v_mfma_f32_32x32x16_bf16 v[80:95], v[192:195], v[156:159], v[80:95]
  v_mfma_f32_32x32x16_bf16 v[96:111], v[156:159], v[196:199], v[96:111]
  s_waitcnt vmcnt(10)
  s_waitcnt lgkmcnt(0)
  v_mfma_f32_32x32x16_bf16 v[16:31], v[176:179], v[160:163], v[16:31]
  ds_read_b128 v[188:191], v0 offset:23552
  v_mfma_f32_32x32x16_bf16 v[32:47], v[180:183], v[160:163], v[32:47]
  ds_read_b128 v[192:195], v0 offset:52224
  v_mfma_f32_32x32x16_bf16 v[48:63], v[160:163], v[184:187], v[48:63]
  ds_read_b128 v[196:199], v5 offset:23552
  v_mfma_f32_32x32x16_bf16 v[64:79], v[176:179], v[164:167], v[64:79]
  v_mfma_f32_32x32x16_bf16 v[80:95], v[180:183], v[164:167], v[80:95]
  v_mfma_f32_32x32x16_bf16 v[96:111], v[164:167], v[184:187], v[96:111]
  s_waitcnt vmcnt(8)
  s_waitcnt lgkmcnt(0)
  v_mfma_f32_32x32x16_bf16 v[16:31], v[188:191], v[168:171], v[16:31]
  ds_read_b128 v[176:179], v0 offset:24576
  v_mfma_f32_32x32x16_bf16 v[32:47], v[192:195], v[168:171], v[32:47]
  ds_read_b128 v[180:183], v0 offset:53248
  v_mfma_f32_32x32x16_bf16 v[48:63], v[168:171], v[196:199], v[48:63]
  ds_read_b128 v[184:187], v5 offset:24576
  v_mfma_f32_32x32x16_bf16 v[64:79], v[188:191], v[172:175], v[64:79]
  v_mfma_f32_32x32x16_bf16 v[80:95], v[192:195], v[172:175], v[80:95]
  v_mfma_f32_32x32x16_bf16 v[96:111], v[172:175], v[196:199], v[96:111]
  s_waitcnt vmcnt(6)
  s_waitcnt lgkmcnt(0)
  v_mfma_f32_32x32x16_bf16 v[16:31], v[176:179], v[112:115], v[16:31]
  ds_read_b128 v[188:191], v0 offset:25600
  v_mfma_f32_32x32x16_bf16 v[32:47], v[180:183], v[112:115], v[32:47]
  ds_read_b128 v[192:195], v0 offset:54272
  v_mfma_f32_32x32x16_bf16 v[48:63], v[112:115], v[184:187], v[48:63]
  ds_read_b128 v[196:199], v5 offset:25600
  v_mfma_f32_32x32x16_bf16 v[64:79], v[176:179], v[116:119], v[64:79]
  v_mfma_f32_32x32x16_bf16 v[80:95], v[180:183], v[116:119], v[80:95]
  v_mfma_f32_32x32x16_bf16 v[96:111], v[116:119], v[184:187], v[96:111]
  s_waitcnt vmcnt(4)
  s_waitcnt lgkmcnt(0)
  v_mfma_f32_32x32x16_bf16 v[16:31], v[188:191], v[120:123], v[16:31]
  ds_read_b128 v[176:179], v0 offset:26624
  v_mfma_f32_32x32x16_bf16 v[32:47], v[192:195], v[120:123], v[32:47]
  ds_read_b128 v[180:183], v0 offset:55296
  v_mfma_f32_32x32x16_bf16 v[48:63], v[120:123], v[196:199], v[48:63]
  ds_read_b128 v[184:187], v5 offset:26624
  v_mfma_f32_32x32x16_bf16 v[64:79], v[188:191], v[124:127], v[64:79]
  v_mfma_f32_32x32x16_bf16 v[80:95], v[192:195], v[124:127], v[80:95]
  v_mfma_f32_32x32x16_bf16 v[96:111], v[124:127], v[196:199], v[96:111]
  s_waitcnt vmcnt(2)
  s_waitcnt lgkmcnt(0)
  v_mfma_f32_32x32x16_bf16 v[16:31], v[176:179], v[128:131], v[16:31]
  ds_read_b128 v[188:191], v0 offset:27648
  v_mfma_f32_32x32x16_bf16 v[32:47], v[180:183], v[128:131], v[32:47]
  ds_read_b128 v[192:195], v0 offset:56320
  v_mfma_f32_32x32x16_bf16 v[48:63], v[128:131], v[184:187], v[48:63]
  ds_read_b128 v[196:199], v5 offset:27648
  v_mfma_f32_32x32x16_bf16 v[64:79], v[176:179], v[132:135], v[64:79]
  v_mfma_f32_32x32x16_bf16 v[80:95], v[180:183], v[132:135], v[80:95]
  v_mfma_f32_32x32x16_bf16 v[96:111], v[132:135], v[184:187], v[96:111]
  s_waitcnt vmcnt(0)
  s_waitcnt lgkmcnt(0)
  v_mfma_f32_32x32x16_bf16 v[16:31], v[188:191], v[136:139], v[16:31]
  v_mfma_f32_32x32x16_bf16 v[32:47], v[192:195], v[136:139], v[32:47]
  v_mfma_f32_32x32x16_bf16 v[48:63], v[136:139], v[196:199], v[48:63]
  v_mfma_f32_32x32x16_bf16 v[64:79], v[188:191], v[140:143], v[64:79]
  v_mfma_f32_32x32x16_bf16 v[80:95], v[192:195], v[140:143], v[80:95]
  v_mfma_f32_32x32x16_bf16 v[96:111], v[140:143], v[196:199], v[96:111]
  s_lshl_b32 s22, s16, 6
  s_add_u32 s22, s22, s18
  s_lshl_b32 s22, s22, 12
  s_add_u32 s22, s22, 61865984
  v_cvt_pk_bf16_f32 v32, v32, v33
  v_cvt_pk_bf16_f32 v33, v34, v35
  v_cvt_pk_bf16_f32 v34, v36, v37
  v_cvt_pk_bf16_f32 v35, v38, v39
  v_cvt_pk_bf16_f32 v36, v40, v41
  v_cvt_pk_bf16_f32 v37, v42, v43
  v_cvt_pk_bf16_f32 v38, v44, v45
  v_cvt_pk_bf16_f32 v39, v46, v47
  buffer_store_dwordx4 v[32:35], v0, s[12:15], s22 offen offset:0 sc1
  buffer_store_dwordx4 v[36:39], v0, s[12:15], s22 offen offset:1024 sc1
  v_cvt_pk_bf16_f32 v48, v48, v49
  v_cvt_pk_bf16_f32 v49, v50, v51
  v_cvt_pk_bf16_f32 v50, v52, v53
  v_cvt_pk_bf16_f32 v51, v54, v55
  v_cvt_pk_bf16_f32 v52, v56, v57
  v_cvt_pk_bf16_f32 v53, v58, v59
  v_cvt_pk_bf16_f32 v54, v60, v61
  v_cvt_pk_bf16_f32 v55, v62, v63
  buffer_store_dwordx4 v[48:51], v0, s[12:15], s22 offen offset:2048 sc1
  buffer_store_dwordx4 v[52:55], v0, s[12:15], s22 offen offset:3072 sc1
  s_add_u32 s22, s22, 4096
  v_cvt_pk_bf16_f32 v80, v80, v81
  v_cvt_pk_bf16_f32 v81, v82, v83
  v_cvt_pk_bf16_f32 v82, v84, v85
  v_cvt_pk_bf16_f32 v83, v86, v87
  v_cvt_pk_bf16_f32 v84, v88, v89
  v_cvt_pk_bf16_f32 v85, v90, v91
  v_cvt_pk_bf16_f32 v86, v92, v93
  v_cvt_pk_bf16_f32 v87, v94, v95
  buffer_store_dwordx4 v[80:83], v0, s[12:15], s22 offen offset:0 sc1
  buffer_store_dwordx4 v[84:87], v0, s[12:15], s22 offen offset:1024 sc1
  v_cvt_pk_bf16_f32 v96, v96, v97
  v_cvt_pk_bf16_f32 v97, v98, v99
  v_cvt_pk_bf16_f32 v98, v100, v101
  v_cvt_pk_bf16_f32 v99, v102, v103
  v_cvt_pk_bf16_f32 v100, v104, v105
  v_cvt_pk_bf16_f32 v101, v106, v107
  v_cvt_pk_bf16_f32 v102, v108, v109
  v_cvt_pk_bf16_f32 v103, v110, v111
  buffer_store_dwordx4 v[96:99], v0, s[12:15], s22 offen offset:2048 sc1
  buffer_store_dwordx4 v[100:103], v0, s[12:15], s22 offen offset:3072 sc1
  s_cmp_lg_u32 s16, 0
  s_cbranch_scc1 ng_294
  s_lshl_b32 s34, s18, 7
  s_add_u32 s34, s34, 47054848
  v_bfe_u32 v4, v8, 0, 5
  v_lshlrev_b32 v5, 2, v4
  v_bfe_u32 v4, v8, 5, 1
  v_lshl_add_u32 v5, v4, 30, v5
  v_xor_b32 v5, 0x40000000, v5
  v_mul_f32 v132, 0xbfb8aa3b, v28
  v_exp_f32 v132, v132
  s_nop 0
  v_add_f32 v132, 1.0, v132
  v_rcp_f32 v132, v132
  s_nop 0
  buffer_store_dword v132, v5, s[12:15], s34 offen offset:0 sc1
  v_mul_f32 v133, 0xbfb8aa3b, v76
  v_exp_f32 v133, v133
  s_nop 0
  v_add_f32 v133, 1.0, v133
  v_rcp_f32 v133, v133
  s_nop 0
  buffer_store_dword v133, v5, s[12:15], s34 offen offset:128 sc1
ng_294:
  s_mov_b32 s34, 0x3e8b97f6
  v_mul_f32 v16, s34, v16
  v_mul_f32 v17, s34, v17
  v_mul_f32 v18, s34, v18
  v_mul_f32 v19, s34, v19
  v_mul_f32 v20, s34, v20
  v_mul_f32 v21, s34, v21
  v_mul_f32 v22, s34, v22
  v_mul_f32 v23, s34, v23
  v_mul_f32 v24, s34, v24
  v_mul_f32 v25, s34, v25
  v_mul_f32 v26, s34, v26
  v_mul_f32 v27, s34, v27
  v_mul_f32 v28, s34, v28
  v_mul_f32 v29, s34, v29
  v_mul_f32 v30, s34, v30
  v_mul_f32 v31, s34, v31
  v_cvt_pk_bf16_f32 v112, v16, v17
  v_cvt_pk_bf16_f32 v113, v18, v19
  v_cvt_pk_bf16_f32 v114, v20, v21
  v_cvt_pk_bf16_f32 v115, v22, v23
  v_cvt_pk_bf16_f32 v116, v24, v25
  v_cvt_pk_bf16_f32 v117, v26, v27
  v_cvt_pk_bf16_f32 v118, v28, v29
  v_cvt_pk_bf16_f32 v119, v30, v31
  v_mul_f32 v64, s34, v64
  v_mul_f32 v65, s34, v65
  v_mul_f32 v66, s34, v66
  v_mul_f32 v67, s34, v67
  v_mul_f32 v68, s34, v68
  v_mul_f32 v69, s34, v69
  v_mul_f32 v70, s34, v70
  v_mul_f32 v71, s34, v71
  v_mul_f32 v72, s34, v72
  v_mul_f32 v73, s34, v73
  v_mul_f32 v74, s34, v74
  v_mul_f32 v75, s34, v75
  v_mul_f32 v76, s34, v76
  v_mul_f32 v77, s34, v77
  v_mul_f32 v78, s34, v78
  v_mul_f32 v79, s34, v79
  v_cvt_pk_bf16_f32 v120, v64, v65
  v_cvt_pk_bf16_f32 v121, v66, v67
  v_cvt_pk_bf16_f32 v122, v68, v69
  v_cvt_pk_bf16_f32 v123, v70, v71
  v_cvt_pk_bf16_f32 v124, v72, v73
  v_cvt_pk_bf16_f32 v125, v74, v75
  v_cvt_pk_bf16_f32 v126, v76, v77
  v_cvt_pk_bf16_f32 v127, v78, v79
  s_lshl_b32 s22, s16, 8
  s_add_u32 s22, s22, 47009792
  s_lshl_b32 s24, s19, 2
  s_add_u32 s24, s24, s22
  s_waitcnt vmcnt(0)
  s_barrier
  v_bfe_u32 v4, v8, 0, 3
  v_lshlrev_b32 v7, 2, v4
  s_cmp_lg_u32 s17, 0
  s_cbranch_scc1 w0_295
  buffer_store_dword v1, v2, s[12:15], s24 offen sc1
  s_mov_b32 s23, 300000
wp_296:
  buffer_load_dword v4, v7, s[12:15], s22 offen sc1
  s_waitcnt vmcnt(0)
  v_cmp_gt_u32 vcc, 1, v4
  s_cbranch_vccz wpd_297
  s_sleep 2
  s_sub_u32 s23, s23, 1
  s_cbranch_scc0 wp_296
  s_branch L_exit
wpd_297:
w0_295:
  s_barrier
  s_lshl_b32 s33, s16, 18
  s_add_u32 s33, s33, 61865984
  buffer_load_dwordx4 a[0:3], v0, s[12:15], s33 offen offset:0 sc1
  buffer_load_dwordx4 a[4:7], v0, s[12:15], s33 offen offset:1024 sc1
  buffer_load_dwordx4 a[8:11], v0, s[12:15], s33 offen offset:2048 sc1
  buffer_load_dwordx4 a[12:15], v0, s[12:15], s33 offen offset:3072 sc1
  s_add_u32 s33, s33, 4096
  buffer_load_dwordx4 a[16:19], v0, s[12:15], s33 offen offset:0 sc1
  buffer_load_dwordx4 a[20:23], v0, s[12:15], s33 offen offset:1024 sc1
  buffer_load_dwordx4 a[24:27], v0, s[12:15], s33 offen offset:2048 sc1
  buffer_load_dwordx4 a[28:31], v0, s[12:15], s33 offen offset:3072 sc1
  s_add_u32 s33, s33, 4096
  v_mov_b64 v[48:49], 0
  v_mov_b64 v[50:51], 0
  v_mov_b64 v[52:53], 0
  v_mov_b64 v[54:55], 0
  v_mov_b64 v[56:57], 0
  v_mov_b64 v[58:59], 0
  v_mov_b64 v[60:61], 0
  v_mov_b64 v[62:63], 0
  v_mov_b64 v[64:65], 0
  v_mov_b64 v[66:67], 0
  v_mov_b64 v[68:69], 0
  v_mov_b64 v[70:71], 0
  v_mov_b64 v[72:73], 0
  v_mov_b64 v[74:75], 0
  v_mov_b64 v[76:77], 0
  v_mov_b64 v[78:79], 0
  v_mov_b64 v[80:81], 0
  v_mov_b64 v[82:83], 0
  v_mov_b64 v[84:85], 0
  v_mov_b64 v[86:87], 0
  v_mov_b64 v[88:89], 0
  v_mov_b64 v[90:91], 0
  v_mov_b64 v[92:93], 0
  v_mov_b64 v[94:95], 0
  v_mov_b64 v[96:97], 0
  v_mov_b64 v[98:99], 0
  v_mov_b64 v[100:101], 0
  v_mov_b64 v[102:103], 0
  v_mov_b64 v[104:105], 0
  v_mov_b64 v[106:107], 0
  v_mov_b64 v[108:109], 0
  v_mov_b64 v[110:111], 0
  v_mov_b64 v[136:137], 0
  v_mov_b64 v[138:139], 0
  v_mov_b64 v[140:141], 0
  v_mov_b64 v[142:143], 0
  v_accvgpr_write_b32 a56, 0
  v_accvgpr_write_b32 a57, 0
  v_accvgpr_write_b32 a58, 0
  v_accvgpr_write_b32 a59, 0
  v_accvgpr_write_b32 a60, 0
  v_accvgpr_write_b32 a61, 0
  v_accvgpr_write_b32 a62, 0
  v_accvgpr_write_b32 a63, 0
  s_mov_b32 s30, 0xff800000
  s_mov_b32 s31, 0xff800000
  s_mov_b32 s32, 0
  s_waitcnt vmcnt(4)
  v_mfma_f32_32x32x16_bf16 v[16:31], a[0:3], v[112:115], v[48:63]
  v_mfma_f32_32x32x16_bf16 v[16:31], a[4:7], v[116:119], v[16:31]
  s_nop 15
Atop_298:
  v_mfma_f32_32x32x16_bf16 v[32:47], a[0:3], v[120:123], v[64:79]
  buffer_load_dwordx4 a[32:35], v0, s[12:15], s33 offen offset:0 sc1
  v_max3_f32 v4, v16, v17, v18
  v_exp_f32 v208, v16
  v_max3_f32 v5, v19, v20, v21
  v_exp_f32 v209, v17
  v_max3_f32 v4, v4, v22, v23
  v_exp_f32 v210, v18
  v_max3_f32 v5, v5, v24, v25
  v_exp_f32 v211, v19
  v_mfma_f32_32x32x16_bf16 v[32:47], a[4:7], v[124:127], v[32:47]
  buffer_load_dwordx4 a[36:39], v0, s[12:15], s33 offen offset:1024 sc1
  v_max3_f32 v4, v4, v26, v27
  v_exp_f32 v212, v20
  v_max3_f32 v5, v5, v28, v29
  v_exp_f32 v213, v21
  v_max3_f32 v4, v4, v30, v31
  v_exp_f32 v214, v22
  v_max_f32 v4, v4, v5
  v_exp_f32 v215, v23
  v_mfma_f32_32x32x16_bf16 v[96:111], a[56:59], v[136:139], v[96:111]
  v_cmp_lt_f32 vcc, s30, v4
  v_exp_f32 v216, v24
  v_exp_f32 v217, v25
  v_cvt_pk_bf16_f32 v128, v208, v209
  v_exp_f32 v218, v26
  v_cvt_pk_bf16_f32 v129, v210, v211
  v_exp_f32 v219, v27
  v_cvt_pk_bf16_f32 v130, v212, v213
  v_mfma_f32_32x32x16_bf16 v[96:111], a[60:63], v[140:143], v[96:111]
  s_cbranch_vccnz rsc_299
rsb_300:
  v_exp_f32 v220, v28
  v_cvt_pk_bf16_f32 v131, v214, v215
  v_exp_f32 v221, v29
  v_cvt_pk_bf16_f32 v132, v216, v217
  v_exp_f32 v222, v30
  v_cvt_pk_bf16_f32 v133, v218, v219
  v_exp_f32 v223, v31
  v_cvt_pk_bf16_f32 v134, v220, v221
  v_cvt_pk_bf16_f32 v135, v222, v223
  s_waitcnt vmcnt(4)
  v_mfma_f32_32x32x16_bf16 v[16:31], a[16:19], v[112:115], v[48:63]
  buffer_load_dwordx4 a[40:43], v0, s[12:15], s33 offen offset:2048 sc1
  v_max3_f32 v4, v32, v33, v34
  v_exp_f32 v208, v32
  v_max3_f32 v5, v35, v36, v37
  v_exp_f32 v209, v33
  v_max3_f32 v4, v4, v38, v39
  v_exp_f32 v210, v34
  v_max3_f32 v5, v5, v40, v41
  v_exp_f32 v211, v35
  v_mfma_f32_32x32x16_bf16 v[16:31], a[20:23], v[116:119], v[16:31]
  buffer_load_dwordx4 a[44:47], v0, s[12:15], s33 offen offset:3072 sc1
  s_add_u32 s33, s33, 4096
  v_max3_f32 v4, v4, v42, v43
  v_exp_f32 v212, v36
  v_max3_f32 v5, v5, v44, v45
  v_exp_f32 v213, v37
  v_max3_f32 v4, v4, v46, v47
  v_exp_f32 v214, v38
  v_max_f32 v4, v4, v5
  v_exp_f32 v215, v39
  v_mfma_f32_32x32x16_bf16 v[80:95], a[8:11], v[128:131], v[80:95]
  v_cmp_lt_f32 vcc, s30, v4
  v_exp_f32 v216, v40
  v_exp_f32 v217, v41
  v_cvt_pk_bf16_f32 v136, v208, v209
  v_exp_f32 v218, v42
  v_cvt_pk_bf16_f32 v137, v210, v211
  v_exp_f32 v219, v43
  v_cvt_pk_bf16_f32 v138, v212, v213
  v_mfma_f32_32x32x16_bf16 v[80:95], a[12:15], v[132:135], v[80:95]
  s_cbranch_vccnz rsc_301
rsb_302:
  v_exp_f32 v220, v44
  v_cvt_pk_bf16_f32 v139, v214, v215
  v_exp_f32 v221, v45
  v_cvt_pk_bf16_f32 v140, v216, v217
  v_exp_f32 v222, v46
  v_cvt_pk_bf16_f32 v141, v218, v219
  v_exp_f32 v223, v47
  v_cvt_pk_bf16_f32 v142, v220, v221
  v_cvt_pk_bf16_f32 v143, v222, v223
  s_mov_b32 s30, 1101004800
  s_mov_b32 s31, 0
  v_mfma_f32_32x32x16_bf16 v[32:47], a[16:19], v[120:123], v[64:79]
  buffer_load_dwordx4 a[48:51], v0, s[12:15], s33 offen offset:0 sc1
  v_max3_f32 v4, v16, v17, v18
  v_exp_f32 v208, v16
  v_max3_f32 v5, v19, v20, v21
  v_exp_f32 v209, v17
  v_max3_f32 v4, v4, v22, v23
  v_exp_f32 v210, v18
  v_max3_f32 v5, v5, v24, v25
  v_exp_f32 v211, v19
  v_mfma_f32_32x32x16_bf16 v[32:47], a[20:23], v[124:127], v[32:47]
  buffer_load_dwordx4 a[52:55], v0, s[12:15], s33 offen offset:1024 sc1
  v_max3_f32 v4, v4, v26, v27
  v_exp_f32 v212, v20
  v_max3_f32 v5, v5, v28, v29
  v_exp_f32 v213, v21
  v_max3_f32 v4, v4, v30, v31
  v_exp_f32 v214, v22
  v_max_f32 v4, v4, v5
  v_exp_f32 v215, v23
  v_mfma_f32_32x32x16_bf16 v[96:111], a[8:11], v[136:139], v[96:111]
  v_cmp_lt_f32 vcc, s30, v4
  v_exp_f32 v216, v24
  v_exp_f32 v217, v25
  v_cvt_pk_bf16_f32 v128, v208, v209
  v_exp_f32 v218, v26
  v_cvt_pk_bf16_f32 v129, v210, v211
  v_exp_f32 v219, v27
  v_cvt_pk_bf16_f32 v130, v212, v213
  v_mfma_f32_32x32x16_bf16 v[96:111], a[12:15], v[140:143], v[96:111]
  s_cbranch_vccnz rsc_303
rsb_304:
  v_exp_f32 v220, v28
  v_cvt_pk_bf16_f32 v131, v214, v215
  v_exp_f32 v221, v29
  v_cvt_pk_bf16_f32 v132, v216, v217
  v_exp_f32 v222, v30
  v_cvt_pk_bf16_f32 v133, v218, v219
  v_exp_f32 v223, v31
  v_cvt_pk_bf16_f32 v134, v220, v221
  v_cvt_pk_bf16_f32 v135, v222, v223
  s_waitcnt vmcnt(4)
  v_mfma_f32_32x32x16_bf16 v[16:31], a[32:35], v[112:115], v[48:63]
  buffer_load_dwordx4 a[56:59], v0, s[12:15], s33 offen offset:2048 sc1
  v_max3_f32 v4, v32, v33, v34
  v_exp_f32 v208, v32
  v_max3_f32 v5, v35, v36, v37
  v_exp_f32 v209, v33
  v_max3_f32 v4, v4, v38, v39
  v_exp_f32 v210, v34
  v_max3_f32 v5, v5, v40, v41
  v_exp_f32 v211, v35
  v_mfma_f32_32x32x16_bf16 v[16:31], a[36:39], v[116:119], v[16:31]
  buffer_load_dwordx4 a[60:63], v0, s[12:15], s33 offen offset:3072 sc1
  s_add_u32 s33, s33, 4096
  v_max3_f32 v4, v4, v42, v43
  v_exp_f32 v212, v36
  v_max3_f32 v5, v5, v44, v45
  v_exp_f32 v213, v37
  v_max3_f32 v4, v4, v46, v47
  v_exp_f32 v214, v38
  v_max_f32 v4, v4, v5
  v_exp_f32 v215, v39
  v_mfma_f32_32x32x16_bf16 v[80:95], a[24:27], v[128:131], v[80:95]
  v_cmp_lt_f32 vcc, s30, v4
  v_exp_f32 v216, v40
  v_exp_f32 v217, v41
  v_cvt_pk_bf16_f32 v136, v208, v209
  v_exp_f32 v218, v42
  v_cvt_pk_bf16_f32 v137, v210, v211
  v_exp_f32 v219, v43
  v_cvt_pk_bf16_f32 v138, v212, v213
  v_mfma_f32_32x32x16_bf16 v[80:95], a[28:31], v[132:135], v[80:95]
  s_cbranch_vccnz rsc_305
rsb_306:
  v_exp_f32 v220, v44
  v_cvt_pk_bf16_f32 v139, v214, v215
  v_exp_f32 v221, v45
  v_cvt_pk_bf16_f32 v140, v216, v217
  v_exp_f32 v222, v46
  v_cvt_pk_bf16_f32 v141, v218, v219
  v_exp_f32 v223, v47
  v_cvt_pk_bf16_f32 v142, v220, v221
  v_cvt_pk_bf16_f32 v143, v222, v223
  v_mfma_f32_32x32x16_bf16 v[32:47], a[32:35], v[120:123], v[64:79]
  buffer_load_dwordx4 a[0:3], v0, s[12:15], s33 offen offset:0 sc1
  v_max3_f32 v4, v16, v17, v18
  v_exp_f32 v208, v16
  v_max3_f32 v5, v19, v20, v21
  v_exp_f32 v209, v17
  v_max3_f32 v4, v4, v22, v23
  v_exp_f32 v210, v18
  v_max3_f32 v5, v5, v24, v25
  v_exp_f32 v211, v19
  v_mfma_f32_32x32x16_bf16 v[32:47], a[36:39], v[124:127], v[32:47]
  buffer_load_dwordx4 a[4:7], v0, s[12:15], s33 offen offset:1024 sc1
  v_max3_f32 v4, v4, v26, v27
  v_exp_f32 v212, v20
  v_max3_f32 v5, v5, v28, v29
  v_exp_f32 v213, v21
  v_max3_f32 v4, v4, v30, v31
  v_exp_f32 v214, v22
  v_max_f32 v4, v4, v5
  v_exp_f32 v215, v23
  v_mfma_f32_32x32x16_bf16 v[96:111], a[24:27], v[136:139], v[96:111]
  v_cmp_lt_f32 vcc, s30, v4
  v_exp_f32 v216, v24
  v_exp_f32 v217, v25
  v_cvt_pk_bf16_f32 v128, v208, v209
  v_exp_f32 v218, v26
  v_cvt_pk_bf16_f32 v129, v210, v211
  v_exp_f32 v219, v27
  v_cvt_pk_bf16_f32 v130, v212, v213
  v_mfma_f32_32x32x16_bf16 v[96:111], a[28:31], v[140:143], v[96:111]
  s_cbranch_vccnz rsc_307
rsb_308:
  v_exp_f32 v220, v28
  v_cvt_pk_bf16_f32 v131, v214, v215
  v_exp_f32 v221, v29
  v_cvt_pk_bf16_f32 v132, v216, v217
  v_exp_f32 v222, v30
  v_cvt_pk_bf16_f32 v133, v218, v219
  v_exp_f32 v223, v31
  v_cvt_pk_bf16_f32 v134, v220, v221
  v_cvt_pk_bf16_f32 v135, v222, v223
  s_waitcnt vmcnt(4)
  v_mfma_f32_32x32x16_bf16 v[16:31], a[48:51], v[112:115], v[48:63]
  buffer_load_dwordx4 a[8:11], v0, s[12:15], s33 offen offset:2048 sc1
  v_max3_f32 v4, v32, v33, v34
  v_exp_f32 v208, v32
  v_max3_f32 v5, v35, v36, v37
  v_exp_f32 v209, v33
  v_max3_f32 v4, v4, v38, v39
  v_exp_f32 v210, v34
  v_max3_f32 v5, v5, v40, v41
  v_exp_f32 v211, v35
  v_mfma_f32_32x32x16_bf16 v[16:31], a[52:55], v[116:119], v[16:31]
  buffer_load_dwordx4 a[12:15], v0, s[12:15], s33 offen offset:3072 sc1
  s_add_u32 s33, s33, 4096
  v_max3_f32 v4, v4, v42, v43
  v_exp_f32 v212, v36
  v_max3_f32 v5, v5, v44, v45
  v_exp_f32 v213, v37
  v_max3_f32 v4, v4, v46, v47
  v_exp_f32 v214, v38
  v_max_f32 v4, v4, v5
  v_exp_f32 v215, v39
  v_mfma_f32_32x32x16_bf16 v[80:95], a[40:43], v[128:131], v[80:95]
  v_cmp_lt_f32 vcc, s30, v4
  v_exp_f32 v216, v40
  v_exp_f32 v217, v41
  v_cvt_pk_bf16_f32 v136, v208, v209
  v_exp_f32 v218, v42
  v_cvt_pk_bf16_f32 v137, v210, v211
  v_exp_f32 v219, v43
  v_cvt_pk_bf16_f32 v138, v212, v213
  v_mfma_f32_32x32x16_bf16 v[80:95], a[44:47], v[132:135], v[80:95]
  s_cbranch_vccnz rsc_309
rsb_310:
  v_exp_f32 v220, v44
  v_cvt_pk_bf16_f32 v139, v214, v215
  v_exp_f32 v221, v45
  v_cvt_pk_bf16_f32 v140, v216, v217
  v_exp_f32 v222, v46
  v_cvt_pk_bf16_f32 v141, v218, v219
  v_exp_f32 v223, v47
  v_cvt_pk_bf16_f32 v142, v220, v221
  v_cvt_pk_bf16_f32 v143, v222, v223
  v_mfma_f32_32x32x16_bf16 v[32:47], a[48:51], v[120:123], v[64:79]
  buffer_load_dwordx4 a[16:19], v0, s[12:15], s33 offen offset:0 sc1
  v_max3_f32 v4, v16, v17, v18
  v_exp_f32 v208, v16
  v_max3_f32 v5, v19, v20, v21
  v_exp_f32 v209, v17
  v_max3_f32 v4, v4, v22, v23
  v_exp_f32 v210, v18
  v_max3_f32 v5, v5, v24, v25
  v_exp_f32 v211, v19
  v_mfma_f32_32x32x16_bf16 v[32:47], a[52:55], v[124:127], v[32:47]
  buffer_load_dwordx4 a[20:23], v0, s[12:15], s33 offen offset:1024 sc1
  v_max3_f32 v4, v4, v26, v27
  v_exp_f32 v212, v20
  v_max3_f32 v5, v5, v28, v29
  v_exp_f32 v213, v21
  v_max3_f32 v4, v4, v30, v31
  v_exp_f32 v214, v22
  v_max_f32 v4, v4, v5
  v_exp_f32 v215, v23
  v_mfma_f32_32x32x16_bf16 v[96:111], a[40:43], v[136:139], v[96:111]
  v_cmp_lt_f32 vcc, s30, v4
  v_exp_f32 v216, v24
  v_exp_f32 v217, v25
  v_cvt_pk_bf16_f32 v128, v208, v209
  v_exp_f32 v218, v26
  v_cvt_pk_bf16_f32 v129, v210, v211
  v_exp_f32 v219, v27
  v_cvt_pk_bf16_f32 v130, v212, v213
  v_mfma_f32_32x32x16_bf16 v[96:111], a[44:47], v[140:143], v[96:111]
  s_cbranch_vccnz rsc_311
rsb_312:
  v_exp_f32 v220, v28
  v_cvt_pk_bf16_f32 v131, v214, v215
  v_exp_f32 v221, v29
  v_cvt_pk_bf16_f32 v132, v216, v217
  v_exp_f32 v222, v30
  v_cvt_pk_bf16_f32 v133, v218, v219
  v_exp_f32 v223, v31
  v_cvt_pk_bf16_f32 v134, v220, v221
  v_cvt_pk_bf16_f32 v135, v222, v223
  s_waitcnt vmcnt(4)
  v_mfma_f32_32x32x16_bf16 v[16:31], a[0:3], v[112:115], v[48:63]
  buffer_load_dwordx4 a[24:27], v0, s[12:15], s33 offen offset:2048 sc1
  v_max3_f32 v4, v32, v33, v34
  v_exp_f32 v208, v32
  v_max3_f32 v5, v35, v36, v37
  v_exp_f32 v209, v33
  v_max3_f32 v4, v4, v38, v39
  v_exp_f32 v210, v34
  v_max3_f32 v5, v5, v40, v41
  v_exp_f32 v211, v35
  v_mfma_f32_32x32x16_bf16 v[16:31], a[4:7], v[116:119], v[16:31]
  buffer_load_dwordx4 a[28:31], v0, s[12:15], s33 offen offset:3072 sc1
  s_add_u32 s33, s33, 4096
  v_max3_f32 v4, v4, v42, v43
  v_exp_f32 v212, v36
  v_max3_f32 v5, v5, v44, v45
  v_exp_f32 v213, v37
  v_max3_f32 v4, v4, v46, v47
  v_exp_f32 v214, v38
  v_max_f32 v4, v4, v5
  v_exp_f32 v215, v39
  v_mfma_f32_32x32x16_bf16 v[80:95], a[56:59], v[128:131], v[80:95]
  v_cmp_lt_f32 vcc, s30, v4
  v_exp_f32 v216, v40
  v_exp_f32 v217, v41
  v_cvt_pk_bf16_f32 v136, v208, v209
  v_exp_f32 v218, v42
  v_cvt_pk_bf16_f32 v137, v210, v211
  v_exp_f32 v219, v43
  v_cvt_pk_bf16_f32 v138, v212, v213
  v_mfma_f32_32x32x16_bf16 v[80:95], a[60:63], v[132:135], v[80:95]
  s_cbranch_vccnz rsc_313
rsb_314:
  v_exp_f32 v220, v44
  v_cvt_pk_bf16_f32 v139, v214, v215
  v_exp_f32 v221, v45
  v_cvt_pk_bf16_f32 v140, v216, v217
  v_exp_f32 v222, v46
  v_cvt_pk_bf16_f32 v141, v218, v219
  v_exp_f32 v223, v47
  v_cvt_pk_bf16_f32 v142, v220, v221
  v_cvt_pk_bf16_f32 v143, v222, v223
  s_add_u32 s32, s32, 4
  s_cmp_lt_u32 s32, 64
  s_cbranch_scc1 Atop_298
  v_mfma_f32_32x32x16_bf16 v[96:111], a[56:59], v[136:139], v[96:111]
  v_mfma_f32_32x32x16_bf16 v[96:111], a[60:63], v[140:143], v[96:111]
  s_lshl_b32 s22, s18, 15
  s_lshl_b32 s34, s16, 10
  s_add_u32 s22, s22, s34
  s_add_u32 s22, s22, 66060288
  v_mov_b32 v4, v92
  v_mov_b32 v5, v92
  s_nop 1
  v_permlane32_swap_b32 v4, v5
  v_rcp_f32 v5, v5
  s_nop 0
  v_mul_f32 v80, v80, v5
  v_mul_f32 v81, v81, v5
  v_mul_f32 v82, v82, v5
  v_mul_f32 v83, v83, v5
  v_mul_f32 v84, v84, v5
  v_mul_f32 v85, v85, v5
  v_mul_f32 v86, v86, v5
  v_mul_f32 v87, v87, v5
  v_mul_f32 v88, v88, v5
  v_mul_f32 v89, v89, v5
  v_mul_f32 v90, v90, v5
  v_mul_f32 v91, v91, v5
  v_mul_f32 v92, v92, v5
  v_mul_f32 v93, v93, v5
  v_mul_f32 v94, v94, v5
  v_mul_f32 v95, v95, v5
  v_cvt_pk_bf16_f32 v80, v80, v81
  v_cvt_pk_bf16_f32 v81, v82, v83
  v_cvt_pk_bf16_f32 v82, v84, v85
  v_cvt_pk_bf16_f32 v83, v86, v87
  v_cvt_pk_bf16_f32 v84, v88, v89
  v_cvt_pk_bf16_f32 v85, v90, v91
  v_cvt_pk_bf16_f32 v86, v92, v93
  v_cvt_pk_bf16_f32 v87, v94, v95
  buffer_store_dwordx4 v[80:83], v6, s[12:15], s22 offen offset:0 sc1
  buffer_store_dwordx4 v[84:87], v6, s[12:15], s22 offen offset:512 sc1
  s_add_u32 s22, s22, 32768
  v_mov_b32 v4, v108
  v_mov_b32 v5, v108
  s_nop 1
  v_permlane32_swap_b32 v4, v5
  v_rcp_f32 v5, v5
  s_nop 0
  v_mul_f32 v96, v96, v5
  v_mul_f32 v97, v97, v5
  v_mul_f32 v98, v98, v5
  v_mul_f32 v99, v99, v5
  v_mul_f32 v100, v100, v5
  v_mul_f32 v101, v101, v5
  v_mul_f32 v102, v102, v5
  v_mul_f32 v103, v103, v5
  v_mul_f32 v104, v104, v5
  v_mul_f32 v105, v105, v5
  v_mul_f32 v106, v106, v5
  v_mul_f32 v107, v107, v5
  v_mul_f32 v108, v108, v5
  v_mul_f32 v109, v109, v5
  v_mul_f32 v110, v110, v5
  v_mul_f32 v111, v111, v5
  v_cvt_pk_bf16_f32 v96, v96, v97
  v_cvt_pk_bf16_f32 v97, v98, v99
  v_cvt_pk_bf16_f32 v98, v100, v101
  v_cvt_pk_bf16_f32 v99, v102, v103
  v_cvt_pk_bf16_f32 v100, v104, v105
  v_cvt_pk_bf16_f32 v101, v106, v107
  v_cvt_pk_bf16_f32 v102, v108, v109
  v_cvt_pk_bf16_f32 v103, v110, v111
  buffer_store_dwordx4 v[96:99], v6, s[12:15], s22 offen offset:0 sc1
  buffer_store_dwordx4 v[100:103], v6, s[12:15], s22 offen offset:512 sc1
  s_lshl_b32 s24, s19, 8
  s_lshl_b32 s34, s16, 2
  s_add_u32 s24, s24, s34
  s_add_u32 s24, s24, 47005696
  s_waitcnt vmcnt(0)
  s_barrier
  s_cmp_lg_u32 s17, 0
  s_cbranch_scc1 w0_315
  buffer_store_dword v1, v2, s[12:15], s24 offen sc1
w0_315:
  s_branch Otask_316
rsc_299:
  v_mov_b32 v5, v4
  s_nop 1
  v_permlane32_swap_b32 v4, v5
  v_max3_f32 v4, v4, v5, s31
  v_max_f32 v5, 0, v4
  v_exp_f32 v5, -v5
  v_sub_f32 v16, v16, v4
  v_sub_f32 v17, v17, v4
  v_sub_f32 v18, v18, v4
  v_sub_f32 v19, v19, v4
  v_sub_f32 v20, v20, v4
  v_sub_f32 v21, v21, v4
  v_sub_f32 v22, v22, v4
  v_sub_f32 v23, v23, v4
  v_sub_f32 v24, v24, v4
  v_sub_f32 v25, v25, v4
  v_sub_f32 v26, v26, v4
  v_sub_f32 v27, v27, v4
  v_sub_f32 v28, v28, v4
  v_sub_f32 v29, v29, v4
  v_sub_f32 v30, v30, v4
  v_sub_f32 v31, v31, v4
  v_sub_f32 v48, v48, v4
  v_sub_f32 v49, v49, v4
  v_sub_f32 v50, v50, v4
  v_sub_f32 v51, v51, v4
  v_sub_f32 v52, v52, v4
  v_sub_f32 v53, v53, v4
  v_sub_f32 v54, v54, v4
  v_sub_f32 v55, v55, v4
  v_sub_f32 v56, v56, v4
  v_sub_f32 v57, v57, v4
  v_sub_f32 v58, v58, v4
  v_sub_f32 v59, v59, v4
  v_sub_f32 v60, v60, v4
  v_sub_f32 v61, v61, v4
  v_sub_f32 v62, v62, v4
  v_sub_f32 v63, v63, v4
  v_mul_f32 v80, v80, v5
  v_mul_f32 v81, v81, v5
  v_mul_f32 v82, v82, v5
  v_mul_f32 v83, v83, v5
  v_mul_f32 v84, v84, v5
  v_mul_f32 v85, v85, v5
  v_mul_f32 v86, v86, v5
  v_mul_f32 v87, v87, v5
  v_mul_f32 v88, v88, v5
  v_mul_f32 v89, v89, v5
  v_mul_f32 v90, v90, v5
  v_mul_f32 v91, v91, v5
  v_mul_f32 v92, v92, v5
  v_mul_f32 v93, v93, v5
  v_mul_f32 v94, v94, v5
  v_mul_f32 v95, v95, v5
  v_exp_f32 v208, v16
  v_exp_f32 v209, v17
  v_exp_f32 v210, v18
  v_exp_f32 v211, v19
  v_exp_f32 v212, v20
  v_exp_f32 v213, v21
  v_exp_f32 v214, v22
  v_exp_f32 v215, v23
  v_exp_f32 v216, v24
  v_exp_f32 v217, v25
  v_exp_f32 v218, v26
  v_exp_f32 v219, v27
  v_cvt_pk_bf16_f32 v128, v208, v209
  v_cvt_pk_bf16_f32 v129, v210, v211
  v_cvt_pk_bf16_f32 v130, v212, v213
  s_branch rsb_300
rsc_301:
  v_mov_b32 v5, v4
  s_nop 1
  v_permlane32_swap_b32 v4, v5
  v_max3_f32 v4, v4, v5, s31
  v_max_f32 v5, 0, v4
  v_exp_f32 v5, -v5
  v_sub_f32 v32, v32, v4
  v_sub_f32 v33, v33, v4
  v_sub_f32 v34, v34, v4
  v_sub_f32 v35, v35, v4
  v_sub_f32 v36, v36, v4
  v_sub_f32 v37, v37, v4
  v_sub_f32 v38, v38, v4
  v_sub_f32 v39, v39, v4
  v_sub_f32 v40, v40, v4
  v_sub_f32 v41, v41, v4
  v_sub_f32 v42, v42, v4
  v_sub_f32 v43, v43, v4
  v_sub_f32 v44, v44, v4
  v_sub_f32 v45, v45, v4
  v_sub_f32 v46, v46, v4
  v_sub_f32 v47, v47, v4
  v_sub_f32 v64, v64, v4
  v_sub_f32 v65, v65, v4
  v_sub_f32 v66, v66, v4
  v_sub_f32 v67, v67, v4
  v_sub_f32 v68, v68, v4
  v_sub_f32 v69, v69, v4
  v_sub_f32 v70, v70, v4
  v_sub_f32 v71, v71, v4
  v_sub_f32 v72, v72, v4
  v_sub_f32 v73, v73, v4
  v_sub_f32 v74, v74, v4
  v_sub_f32 v75, v75, v4
  v_sub_f32 v76, v76, v4
  v_sub_f32 v77, v77, v4
  v_sub_f32 v78, v78, v4
  v_sub_f32 v79, v79, v4
  v_mul_f32 v96, v96, v5
  v_mul_f32 v97, v97, v5
  v_mul_f32 v98, v98, v5
  v_mul_f32 v99, v99, v5
  v_mul_f32 v100, v100, v5
  v_mul_f32 v101, v101, v5
  v_mul_f32 v102, v102, v5
  v_mul_f32 v103, v103, v5
  v_mul_f32 v104, v104, v5
  v_mul_f32 v105, v105, v5
  v_mul_f32 v106, v106, v5
  v_mul_f32 v107, v107, v5
  v_mul_f32 v108, v108, v5
  v_mul_f32 v109, v109, v5
  v_mul_f32 v110, v110, v5
  v_mul_f32 v111, v111, v5
  v_exp_f32 v208, v32
  v_exp_f32 v209, v33
  v_exp_f32 v210, v34
  v_exp_f32 v211, v35
  v_exp_f32 v212, v36
  v_exp_f32 v213, v37
  v_exp_f32 v214, v38
  v_exp_f32 v215, v39
  v_exp_f32 v216, v40
  v_exp_f32 v217, v41
  v_exp_f32 v218, v42
  v_exp_f32 v219, v43
  v_cvt_pk_bf16_f32 v136, v208, v209
  v_cvt_pk_bf16_f32 v137, v210, v211
  v_cvt_pk_bf16_f32 v138, v212, v213
  s_branch rsb_302
rsc_303:
  v_mov_b32 v5, v4
  s_nop 1
  v_permlane32_swap_b32 v4, v5
  v_max3_f32 v4, v4, v5, s31
  v_max_f32 v5, 0, v4
  v_exp_f32 v5, -v5
  v_sub_f32 v16, v16, v4
  v_sub_f32 v17, v17, v4
  v_sub_f32 v18, v18, v4
  v_sub_f32 v19, v19, v4
  v_sub_f32 v20, v20, v4
  v_sub_f32 v21, v21, v4
  v_sub_f32 v22, v22, v4
  v_sub_f32 v23, v23, v4
  v_sub_f32 v24, v24, v4
  v_sub_f32 v25, v25, v4
  v_sub_f32 v26, v26, v4
  v_sub_f32 v27, v27, v4
  v_sub_f32 v28, v28, v4
  v_sub_f32 v29, v29, v4
  v_sub_f32 v30, v30, v4
  v_sub_f32 v31, v31, v4
  v_sub_f32 v48, v48, v4
  v_sub_f32 v49, v49, v4
  v_sub_f32 v50, v50, v4
  v_sub_f32 v51, v51, v4
  v_sub_f32 v52, v52, v4
  v_sub_f32 v53, v53, v4
  v_sub_f32 v54, v54, v4
  v_sub_f32 v55, v55, v4
  v_sub_f32 v56, v56, v4
  v_sub_f32 v57, v57, v4
  v_sub_f32 v58, v58, v4
  v_sub_f32 v59, v59, v4
  v_sub_f32 v60, v60, v4
  v_sub_f32 v61, v61, v4
  v_sub_f32 v62, v62, v4
  v_sub_f32 v63, v63, v4
  v_mul_f32 v80, v80, v5
  v_mul_f32 v81, v81, v5
  v_mul_f32 v82, v82, v5
  v_mul_f32 v83, v83, v5
  v_mul_f32 v84, v84, v5
  v_mul_f32 v85, v85, v5
  v_mul_f32 v86, v86, v5
  v_mul_f32 v87, v87, v5
  v_mul_f32 v88, v88, v5
  v_mul_f32 v89, v89, v5
  v_mul_f32 v90, v90, v5
  v_mul_f32 v91, v91, v5
  v_mul_f32 v92, v92, v5
  v_mul_f32 v93, v93, v5
  v_mul_f32 v94, v94, v5
  v_mul_f32 v95, v95, v5
  v_exp_f32 v208, v16
  v_exp_f32 v209, v17
  v_exp_f32 v210, v18
  v_exp_f32 v211, v19
  v_exp_f32 v212, v20
  v_exp_f32 v213, v21
  v_exp_f32 v214, v22
  v_exp_f32 v215, v23
  v_exp_f32 v216, v24
  v_exp_f32 v217, v25
  v_exp_f32 v218, v26
  v_exp_f32 v219, v27
  v_cvt_pk_bf16_f32 v128, v208, v209
  v_cvt_pk_bf16_f32 v129, v210, v211
  v_cvt_pk_bf16_f32 v130, v212, v213
  s_branch rsb_304
rsc_305:
  v_mov_b32 v5, v4
  s_nop 1
  v_permlane32_swap_b32 v4, v5
  v_max3_f32 v4, v4, v5, s31
  v_max_f32 v5, 0, v4
  v_exp_f32 v5, -v5
  v_sub_f32 v32, v32, v4
  v_sub_f32 v33, v33, v4
  v_sub_f32 v34, v34, v4
  v_sub_f32 v35, v35, v4
  v_sub_f32 v36, v36, v4
  v_sub_f32 v37, v37, v4
  v_sub_f32 v38, v38, v4
  v_sub_f32 v39, v39, v4
  v_sub_f32 v40, v40, v4
  v_sub_f32 v41, v41, v4
  v_sub_f32 v42, v42, v4
  v_sub_f32 v43, v43, v4
  v_sub_f32 v44, v44, v4
  v_sub_f32 v45, v45, v4
  v_sub_f32 v46, v46, v4
  v_sub_f32 v47, v47, v4
  v_sub_f32 v64, v64, v4
  v_sub_f32 v65, v65, v4
  v_sub_f32 v66, v66, v4
  v_sub_f32 v67, v67, v4
  v_sub_f32 v68, v68, v4
  v_sub_f32 v69, v69, v4
  v_sub_f32 v70, v70, v4
  v_sub_f32 v71, v71, v4
  v_sub_f32 v72, v72, v4
  v_sub_f32 v73, v73, v4
  v_sub_f32 v74, v74, v4
  v_sub_f32 v75, v75, v4
  v_sub_f32 v76, v76, v4
  v_sub_f32 v77, v77, v4
  v_sub_f32 v78, v78, v4
  v_sub_f32 v79, v79, v4
  v_mul_f32 v96, v96, v5
  v_mul_f32 v97, v97, v5
  v_mul_f32 v98, v98, v5
  v_mul_f32 v99, v99, v5
  v_mul_f32 v100, v100, v5
  v_mul_f32 v101, v101, v5
  v_mul_f32 v102, v102, v5
  v_mul_f32 v103, v103, v5
  v_mul_f32 v104, v104, v5
  v_mul_f32 v105, v105, v5
  v_mul_f32 v106, v106, v5
  v_mul_f32 v107, v107, v5
  v_mul_f32 v108, v108, v5
  v_mul_f32 v109, v109, v5
  v_mul_f32 v110, v110, v5
  v_mul_f32 v111, v111, v5
  v_exp_f32 v208, v32
  v_exp_f32 v209, v33
  v_exp_f32 v210, v34
  v_exp_f32 v211, v35
  v_exp_f32 v212, v36
  v_exp_f32 v213, v37
  v_exp_f32 v214, v38
  v_exp_f32 v215, v39
  v_exp_f32 v216, v40
  v_exp_f32 v217, v41
  v_exp_f32 v218, v42
  v_exp_f32 v219, v43
  v_cvt_pk_bf16_f32 v136, v208, v209
  v_cvt_pk_bf16_f32 v137, v210, v211
  v_cvt_pk_bf16_f32 v138, v212, v213
  s_branch rsb_306
rsc_307:
  v_mov_b32 v5, v4
  s_nop 1
  v_permlane32_swap_b32 v4, v5
  v_max3_f32 v4, v4, v5, s31
  v_max_f32 v5, 0, v4
  v_exp_f32 v5, -v5
  v_sub_f32 v16, v16, v4
  v_sub_f32 v17, v17, v4
  v_sub_f32 v18, v18, v4
  v_sub_f32 v19, v19, v4
  v_sub_f32 v20, v20, v4
  v_sub_f32 v21, v21, v4
  v_sub_f32 v22, v22, v4
  v_sub_f32 v23, v23, v4
  v_sub_f32 v24, v24, v4
  v_sub_f32 v25, v25, v4
  v_sub_f32 v26, v26, v4
  v_sub_f32 v27, v27, v4
  v_sub_f32 v28, v28, v4
  v_sub_f32 v29, v29, v4
  v_sub_f32 v30, v30, v4
  v_sub_f32 v31, v31, v4
  v_sub_f32 v48, v48, v4
  v_sub_f32 v49, v49, v4
  v_sub_f32 v50, v50, v4
  v_sub_f32 v51, v51, v4
  v_sub_f32 v52, v52, v4
  v_sub_f32 v53, v53, v4
  v_sub_f32 v54, v54, v4
  v_sub_f32 v55, v55, v4
  v_sub_f32 v56, v56, v4
  v_sub_f32 v57, v57, v4
  v_sub_f32 v58, v58, v4
  v_sub_f32 v59, v59, v4
  v_sub_f32 v60, v60, v4
  v_sub_f32 v61, v61, v4
  v_sub_f32 v62, v62, v4
  v_sub_f32 v63, v63, v4
  v_mul_f32 v80, v80, v5
  v_mul_f32 v81, v81, v5
  v_mul_f32 v82, v82, v5
  v_mul_f32 v83, v83, v5
  v_mul_f32 v84, v84, v5
  v_mul_f32 v85, v85, v5
  v_mul_f32 v86, v86, v5
  v_mul_f32 v87, v87, v5
  v_mul_f32 v88, v88, v5
  v_mul_f32 v89, v89, v5
  v_mul_f32 v90, v90, v5
  v_mul_f32 v91, v91, v5
  v_mul_f32 v92, v92, v5
  v_mul_f32 v93, v93, v5
  v_mul_f32 v94, v94, v5
  v_mul_f32 v95, v95, v5
  v_exp_f32 v208, v16
  v_exp_f32 v209, v17
  v_exp_f32 v210, v18
  v_exp_f32 v211, v19
  v_exp_f32 v212, v20
  v_exp_f32 v213, v21
  v_exp_f32 v214, v22
  v_exp_f32 v215, v23
  v_exp_f32 v216, v24
  v_exp_f32 v217, v25
  v_exp_f32 v218, v26
  v_exp_f32 v219, v27
  v_cvt_pk_bf16_f32 v128, v208, v209
  v_cvt_pk_bf16_f32 v129, v210, v211
  v_cvt_pk_bf16_f32 v130, v212, v213
  s_branch rsb_308
rsc_309:
  v_mov_b32 v5, v4
  s_nop 1
  v_permlane32_swap_b32 v4, v5
  v_max3_f32 v4, v4, v5, s31
  v_max_f32 v5, 0, v4
  v_exp_f32 v5, -v5
  v_sub_f32 v32, v32, v4
  v_sub_f32 v33, v33, v4
  v_sub_f32 v34, v34, v4
  v_sub_f32 v35, v35, v4
  v_sub_f32 v36, v36, v4
  v_sub_f32 v37, v37, v4
  v_sub_f32 v38, v38, v4
  v_sub_f32 v39, v39, v4
  v_sub_f32 v40, v40, v4
  v_sub_f32 v41, v41, v4
  v_sub_f32 v42, v42, v4
  v_sub_f32 v43, v43, v4
  v_sub_f32 v44, v44, v4
  v_sub_f32 v45, v45, v4
  v_sub_f32 v46, v46, v4
  v_sub_f32 v47, v47, v4
  v_sub_f32 v64, v64, v4
  v_sub_f32 v65, v65, v4
  v_sub_f32 v66, v66, v4
  v_sub_f32 v67, v67, v4
  v_sub_f32 v68, v68, v4
  v_sub_f32 v69, v69, v4
  v_sub_f32 v70, v70, v4
  v_sub_f32 v71, v71, v4
  v_sub_f32 v72, v72, v4
  v_sub_f32 v73, v73, v4
  v_sub_f32 v74, v74, v4
  v_sub_f32 v75, v75, v4
  v_sub_f32 v76, v76, v4
  v_sub_f32 v77, v77, v4
  v_sub_f32 v78, v78, v4
  v_sub_f32 v79, v79, v4
  v_mul_f32 v96, v96, v5
  v_mul_f32 v97, v97, v5
  v_mul_f32 v98, v98, v5
  v_mul_f32 v99, v99, v5
  v_mul_f32 v100, v100, v5
  v_mul_f32 v101, v101, v5
  v_mul_f32 v102, v102, v5
  v_mul_f32 v103, v103, v5
  v_mul_f32 v104, v104, v5
  v_mul_f32 v105, v105, v5
  v_mul_f32 v106, v106, v5
  v_mul_f32 v107, v107, v5
  v_mul_f32 v108, v108, v5
  v_mul_f32 v109, v109, v5
  v_mul_f32 v110, v110, v5
  v_mul_f32 v111, v111, v5
  v_exp_f32 v208, v32
  v_exp_f32 v209, v33
  v_exp_f32 v210, v34
  v_exp_f32 v211, v35
  v_exp_f32 v212, v36
  v_exp_f32 v213, v37
  v_exp_f32 v214, v38
  v_exp_f32 v215, v39
  v_exp_f32 v216, v40
  v_exp_f32 v217, v41
  v_exp_f32 v218, v42
  v_exp_f32 v219, v43
  v_cvt_pk_bf16_f32 v136, v208, v209
  v_cvt_pk_bf16_f32 v137, v210, v211
  v_cvt_pk_bf16_f32 v138, v212, v213
  s_branch rsb_310
rsc_311:
  v_mov_b32 v5, v4
  s_nop 1
  v_permlane32_swap_b32 v4, v5
  v_max3_f32 v4, v4, v5, s31
  v_max_f32 v5, 0, v4
  v_exp_f32 v5, -v5
  v_sub_f32 v16, v16, v4
  v_sub_f32 v17, v17, v4
  v_sub_f32 v18, v18, v4
  v_sub_f32 v19, v19, v4
  v_sub_f32 v20, v20, v4
  v_sub_f32 v21, v21, v4
  v_sub_f32 v22, v22, v4
  v_sub_f32 v23, v23, v4
  v_sub_f32 v24, v24, v4
  v_sub_f32 v25, v25, v4
  v_sub_f32 v26, v26, v4
  v_sub_f32 v27, v27, v4
  v_sub_f32 v28, v28, v4
  v_sub_f32 v29, v29, v4
  v_sub_f32 v30, v30, v4
  v_sub_f32 v31, v31, v4
  v_sub_f32 v48, v48, v4
  v_sub_f32 v49, v49, v4
  v_sub_f32 v50, v50, v4
  v_sub_f32 v51, v51, v4
  v_sub_f32 v52, v52, v4
  v_sub_f32 v53, v53, v4
  v_sub_f32 v54, v54, v4
  v_sub_f32 v55, v55, v4
  v_sub_f32 v56, v56, v4
  v_sub_f32 v57, v57, v4
  v_sub_f32 v58, v58, v4
  v_sub_f32 v59, v59, v4
  v_sub_f32 v60, v60, v4
  v_sub_f32 v61, v61, v4
  v_sub_f32 v62, v62, v4
  v_sub_f32 v63, v63, v4
  v_mul_f32 v80, v80, v5
  v_mul_f32 v81, v81, v5
  v_mul_f32 v82, v82, v5
  v_mul_f32 v83, v83, v5
  v_mul_f32 v84, v84, v5
  v_mul_f32 v85, v85, v5
  v_mul_f32 v86, v86, v5
  v_mul_f32 v87, v87, v5
  v_mul_f32 v88, v88, v5
  v_mul_f32 v89, v89, v5
  v_mul_f32 v90, v90, v5
  v_mul_f32 v91, v91, v5
  v_mul_f32 v92, v92, v5
  v_mul_f32 v93, v93, v5
  v_mul_f32 v94, v94, v5
  v_mul_f32 v95, v95, v5
  v_exp_f32 v208, v16
  v_exp_f32 v209, v17
  v_exp_f32 v210, v18
  v_exp_f32 v211, v19
  v_exp_f32 v212, v20
  v_exp_f32 v213, v21
  v_exp_f32 v214, v22
  v_exp_f32 v215, v23
  v_exp_f32 v216, v24
  v_exp_f32 v217, v25
  v_exp_f32 v218, v26
  v_exp_f32 v219, v27
  v_cvt_pk_bf16_f32 v128, v208, v209
  v_cvt_pk_bf16_f32 v129, v210, v211
  v_cvt_pk_bf16_f32 v130, v212, v213
  s_branch rsb_312
rsc_313:
  v_mov_b32 v5, v4
  s_nop 1
  v_permlane32_swap_b32 v4, v5
  v_max3_f32 v4, v4, v5, s31
  v_max_f32 v5, 0, v4
  v_exp_f32 v5, -v5
  v_sub_f32 v32, v32, v4
  v_sub_f32 v33, v33, v4
  v_sub_f32 v34, v34, v4
  v_sub_f32 v35, v35, v4
  v_sub_f32 v36, v36, v4
  v_sub_f32 v37, v37, v4
  v_sub_f32 v38, v38, v4
  v_sub_f32 v39, v39, v4
  v_sub_f32 v40, v40, v4
  v_sub_f32 v41, v41, v4
  v_sub_f32 v42, v42, v4
  v_sub_f32 v43, v43, v4
  v_sub_f32 v44, v44, v4
  v_sub_f32 v45, v45, v4
  v_sub_f32 v46, v46, v4
  v_sub_f32 v47, v47, v4
  v_sub_f32 v64, v64, v4
  v_sub_f32 v65, v65, v4
  v_sub_f32 v66, v66, v4
  v_sub_f32 v67, v67, v4
  v_sub_f32 v68, v68, v4
  v_sub_f32 v69, v69, v4
  v_sub_f32 v70, v70, v4
  v_sub_f32 v71, v71, v4
  v_sub_f32 v72, v72, v4
  v_sub_f32 v73, v73, v4
  v_sub_f32 v74, v74, v4
  v_sub_f32 v75, v75, v4
  v_sub_f32 v76, v76, v4
  v_sub_f32 v77, v77, v4
  v_sub_f32 v78, v78, v4
  v_sub_f32 v79, v79, v4
  v_mul_f32 v96, v96, v5
  v_mul_f32 v97, v97, v5
  v_mul_f32 v98, v98, v5
  v_mul_f32 v99, v99, v5
  v_mul_f32 v100, v100, v5
  v_mul_f32 v101, v101, v5
  v_mul_f32 v102, v102, v5
  v_mul_f32 v103, v103, v5
  v_mul_f32 v104, v104, v5
  v_mul_f32 v105, v105, v5
  v_mul_f32 v106, v106, v5
  v_mul_f32 v107, v107, v5
  v_mul_f32 v108, v108, v5
  v_mul_f32 v109, v109, v5
  v_mul_f32 v110, v110, v5
  v_mul_f32 v111, v111, v5
  v_exp_f32 v208, v32
  v_exp_f32 v209, v33
  v_exp_f32 v210, v34
  v_exp_f32 v211, v35
  v_exp_f32 v212, v36
  v_exp_f32 v213, v37
  v_exp_f32 v214, v38
  v_exp_f32 v215, v39
  v_exp_f32 v216, v40
  v_exp_f32 v217, v41
  v_exp_f32 v218, v42
  v_exp_f32 v219, v43
  v_cvt_pk_bf16_f32 v136, v208, v209
  v_cvt_pk_bf16_f32 v137, v210, v211
  v_cvt_pk_bf16_f32 v138, v212, v213
  s_branch rsb_314
Otask_316:
  s_cmp_ge_u32 s19, 5
  s_cbranch_scc1 no_317
  v_mov_b32 v0, v8
  s_branch L_roleS
no_317:
  s_mul_i32 s26, s16, 3
  s_add_u32 s26, s26, s19
  s_sub_u32 s26, s26, 5
  s_cmp_ge_u32 s26, 42
  s_cbranch_scc1 L_fin
  s_mul_i32 s18, s26, 147
  s_lshr_b32 s18, s18, 10
  s_mul_i32 s34, s18, 7
  s_sub_u32 s20, s26, s34
  s_lshl_b32 s34, s20, 16
  s_lshl_b32 s35, s17, 12
  s_add_u32 s34, s34, s35
  s_add_u32 s34, s34, 60096512
  buffer_load_dwordx4 a[0:3], v0, s[12:15], s34 offen offset:0 sc1
  buffer_load_dwordx4 a[4:7], v0, s[12:15], s34 offen offset:1024 sc1
  buffer_load_dwordx4 a[8:11], v0, s[12:15], s34 offen offset:2048 sc1
  buffer_load_dwordx4 a[12:15], v0, s[12:15], s34 offen offset:3072 sc1
  s_add_u32 s34, s34, 16384
  buffer_load_dwordx4 a[16:19], v0, s[12:15], s34 offen offset:0 sc1
  buffer_load_dwordx4 a[20:23], v0, s[12:15], s34 offen offset:1024 sc1
  buffer_load_dwordx4 a[24:27], v0, s[12:15], s34 offen offset:2048 sc1
  buffer_load_dwordx4 a[28:31], v0, s[12:15], s34 offen offset:3072 sc1
  s_add_u32 s34, s34, 16384
  buffer_load_dwordx4 a[32:35], v0, s[12:15], s34 offen offset:0 sc1
  buffer_load_dwordx4 a[36:39], v0, s[12:15], s34 offen offset:1024 sc1
  buffer_load_dwordx4 a[40:43], v0, s[12:15], s34 offen offset:2048 sc1
  buffer_load_dwordx4 a[44:47], v0, s[12:15], s34 offen offset:3072 sc1
  s_add_u32 s34, s34, 16384
  buffer_load_dwordx4 a[48:51], v0, s[12:15], s34 offen offset:0 sc1
  buffer_load_dwordx4 a[52:55], v0, s[12:15], s34 offen offset:1024 sc1
  buffer_load_dwordx4 a[56:59], v0, s[12:15], s34 offen offset:2048 sc1
  buffer_load_dwordx4 a[60:63], v0, s[12:15], s34 offen offset:3072 sc1
  s_add_u32 s34, s34, 16384
  v_lshlrev_b32 v9, 2, v8
  v_bfe_u32 v4, v8, 0, 4
  v_lshlrev_b32 v3, 2, v4
  v_bfe_u32 v4, v8, 0, 5
  v_lshlrev_b32 v15, 2, v4
  v_add_u32 v15, 64, v15
  s_lshl_b32 s34, s17, 13
  v_add_u32 v12, s34, v0
  s_lshl_b32 s34, s17, 11
  v_add_u32 v13, s34, v0
  v_bfe_u32 v4, v8, 2, 2
  v_lshlrev_b32 v5, 3, v4
  v_bfe_u32 v4, v8, 0, 2
  v_lshl_add_u32 v5, v4, 0, v5
  v_mul_u32_u24 v5, 896, v5
  s_lshl_b32 s34, s20, 7
  s_lshl_b32 s35, s17, 5
  s_add_u32 s34, s34, s35
  v_bfe_u32 v4, v8, 4, 2
  v_lshlrev_b32 v14, 3, v4
  v_add_u32 v14, s34, v14
  v_add_u32 v14, v14, v5
Otop_318:
  s_lshl_b32 s24, s18, 8
  s_add_u32 s24, s24, 46989312
  s_lshr_b32 s22, s18, 3
  s_lshl_b32 s22, s22, 8
  s_add_u32 s22, s22, 47005696
  s_cmp_lg_u32 s17, 0
  s_cbranch_scc1 w0_319
  v_mov_b32 v5, s22
  v_mov_b32 v4, s24
  v_cmp_gt_u32 vcc, 32, v8
  s_nop 1
  v_cndmask_b32 v5, v5, v4, vcc
  v_add_u32 v5, v5, v3
  s_mov_b32 s23, 300000
wp_320:
  buffer_load_dword v4, v5, s[12:15], 0 offen sc1
  s_waitcnt vmcnt(0)
  v_cmp_gt_u32 vcc, 1, v4
  s_cbranch_vccz wpd_321
  s_sleep 4
  s_sub_u32 s23, s23, 1
  s_cbranch_scc0 wp_320
  s_branch L_exit
wpd_321:
w0_319:
  s_barrier
  s_lshl_b32 s21, s18, 15
  s_lshl_b32 s35, s17, 12
  s_add_u32 s21, s21, s35
  s_lshl_b32 s34, s18, 7
  s_add_u32 s34, s34, 47054848
  buffer_load_dword v10, v3, s[12:15], s34 offen offset:0 sc1
  buffer_load_dword v11, v3, s[12:15], s34 offen offset:64 sc1
  s_add_u32 s34, s21, 66060288
  buffer_load_dwordx4 v[80:83], v0, s[12:15], s34 offen offset:0 sc1
  buffer_load_dwordx4 v[84:87], v0, s[12:15], s34 offen offset:1024 sc1
  buffer_load_dwordx4 v[88:91], v0, s[12:15], s34 offen offset:2048 sc1
  buffer_load_dwordx4 v[92:95], v0, s[12:15], s34 offen offset:3072 sc1
  s_add_u32 s34, s34, 16384
  buffer_load_dwordx4 v[96:99], v0, s[12:15], s34 offen offset:0 sc1
  buffer_load_dwordx4 v[100:103], v0, s[12:15], s34 offen offset:1024 sc1
  buffer_load_dwordx4 v[104:107], v0, s[12:15], s34 offen offset:2048 sc1
  buffer_load_dwordx4 v[108:111], v0, s[12:15], s34 offen offset:3072 sc1
  s_mul_i32 s34, s18, 458752
  s_lshl_b32 s36, s20, 16
  s_add_u32 s27, s34, s36
  s_lshl_b32 s36, s17, 10
  s_add_u32 s27, s27, s36
  s_add_u32 s34, s27, 16777216
  buffer_load_dwordx4 v[16:19], v0, s[12:15], s34 offen sc1
  s_add_u32 s34, s34, 4096
  buffer_load_dwordx4 v[20:23], v0, s[12:15], s34 offen sc1
  s_add_u32 s34, s34, 4096
  buffer_load_dwordx4 v[24:27], v0, s[12:15], s34 offen sc1
  s_add_u32 s34, s34, 4096
  buffer_load_dwordx4 v[28:31], v0, s[12:15], s34 offen sc1
  s_add_u32 s34, s34, 4096
  buffer_load_dwordx4 v[32:35], v0, s[12:15], s34 offen sc1
  s_add_u32 s34, s34, 4096
  buffer_load_dwordx4 v[36:39], v0, s[12:15], s34 offen sc1
  s_add_u32 s34, s34, 4096
  buffer_load_dwordx4 v[40:43], v0, s[12:15], s34 offen sc1
  s_add_u32 s34, s34, 4096
  buffer_load_dwordx4 v[44:47], v0, s[12:15], s34 offen sc1
  s_add_u32 s34, s34, 4096
  buffer_load_dwordx4 v[48:51], v0, s[12:15], s34 offen sc1
  s_add_u32 s34, s34, 4096
  buffer_load_dwordx4 v[52:55], v0, s[12:15], s34 offen sc1
  s_add_u32 s34, s34, 4096
  buffer_load_dwordx4 v[56:59], v0, s[12:15], s34 offen sc1
  s_add_u32 s34, s34, 4096
  buffer_load_dwordx4 v[60:63], v0, s[12:15], s34 offen sc1
  s_add_u32 s34, s34, 4096
  buffer_load_dwordx4 v[64:67], v0, s[12:15], s34 offen sc1
  s_add_u32 s34, s34, 4096
  buffer_load_dwordx4 v[68:71], v0, s[12:15], s34 offen sc1
  s_add_u32 s34, s34, 4096
  buffer_load_dwordx4 v[72:75], v0, s[12:15], s34 offen sc1
  s_add_u32 s34, s34, 4096
  buffer_load_dwordx4 v[76:79], v0, s[12:15], s34 offen sc1
  s_add_u32 s34, s34, 4096
  s_waitcnt vmcnt(16)
  v_mfma_f32_16x16x32_bf16 v[136:139], a[0:3], v[80:83], 0
  v_mfma_f32_16x16x32_bf16 v[140:143], a[0:3], v[96:99], 0
  v_mfma_f32_16x16x32_bf16 v[144:147], a[16:19], v[80:83], 0
  v_mfma_f32_16x16x32_bf16 v[148:151], a[16:19], v[96:99], 0
  v_mfma_f32_16x16x32_bf16 v[152:155], a[32:35], v[80:83], 0
  v_mfma_f32_16x16x32_bf16 v[156:159], a[32:35], v[96:99], 0
  v_mfma_f32_16x16x32_bf16 v[160:163], a[48:51], v[80:83], 0
  v_mfma_f32_16x16x32_bf16 v[164:167], a[48:51], v[96:99], 0
  v_mfma_f32_16x16x32_bf16 v[136:139], a[4:7], v[84:87], v[136:139]
  v_mfma_f32_16x16x32_bf16 v[140:143], a[4:7], v[100:103], v[140:143]
  v_mfma_f32_16x16x32_bf16 v[144:147], a[20:23], v[84:87], v[144:147]
  v_mfma_f32_16x16x32_bf16 v[148:151], a[20:23], v[100:103], v[148:151]
  v_mfma_f32_16x16x32_bf16 v[152:155], a[36:39], v[84:87], v[152:155]
  v_mfma_f32_16x16x32_bf16 v[156:159], a[36:39], v[100:103], v[156:159]
  v_mfma_f32_16x16x32_bf16 v[160:163], a[52:55], v[84:87], v[160:163]
  v_mfma_f32_16x16x32_bf16 v[164:167], a[52:55], v[100:103], v[164:167]
  v_mfma_f32_16x16x32_bf16 v[136:139], a[8:11], v[88:91], v[136:139]
  v_mfma_f32_16x16x32_bf16 v[140:143], a[8:11], v[104:107], v[140:143]
  v_mfma_f32_16x16x32_bf16 v[144:147], a[24:27], v[88:91], v[144:147]
  v_mfma_f32_16x16x32_bf16 v[148:151], a[24:27], v[104:107], v[148:151]
  v_mfma_f32_16x16x32_bf16 v[152:155], a[40:43], v[88:91], v[152:155]
  v_mfma_f32_16x16x32_bf16 v[156:159], a[40:43], v[104:107], v[156:159]
  v_mfma_f32_16x16x32_bf16 v[160:163], a[56:59], v[88:91], v[160:163]
  v_mfma_f32_16x16x32_bf16 v[164:167], a[56:59], v[104:107], v[164:167]
  v_mfma_f32_16x16x32_bf16 v[136:139], a[12:15], v[92:95], v[136:139]
  v_mfma_f32_16x16x32_bf16 v[140:143], a[12:15], v[108:111], v[140:143]
  v_mfma_f32_16x16x32_bf16 v[144:147], a[28:31], v[92:95], v[144:147]
  v_mfma_f32_16x16x32_bf16 v[148:151], a[28:31], v[108:111], v[148:151]
  v_mfma_f32_16x16x32_bf16 v[152:155], a[44:47], v[92:95], v[152:155]
  v_mfma_f32_16x16x32_bf16 v[156:159], a[44:47], v[108:111], v[156:159]
  v_mfma_f32_16x16x32_bf16 v[160:163], a[60:63], v[92:95], v[160:163]
  v_mfma_f32_16x16x32_bf16 v[164:167], a[60:63], v[108:111], v[164:167]
  v_sub_f32 v200, 1.0, v10
  v_sub_f32 v201, 1.0, v11
  v_mul_f32 v136, v136, v10
  v_mul_f32 v137, v137, v10
  v_mul_f32 v138, v138, v10
  v_mul_f32 v139, v139, v10
  v_mul_f32 v140, v140, v11
  v_mul_f32 v141, v141, v11
  v_mul_f32 v142, v142, v11
  v_mul_f32 v143, v143, v11
  v_mul_f32 v144, v144, v10
  v_mul_f32 v145, v145, v10
  v_mul_f32 v146, v146, v10
  v_mul_f32 v147, v147, v10
  v_mul_f32 v148, v148, v11
  v_mul_f32 v149, v149, v11
  v_mul_f32 v150, v150, v11
  v_mul_f32 v151, v151, v11
  v_mul_f32 v152, v152, v10
  v_mul_f32 v153, v153, v10
  v_mul_f32 v154, v154, v10
  v_mul_f32 v155, v155, v10
  v_mul_f32 v156, v156, v11
  v_mul_f32 v157, v157, v11
  v_mul_f32 v158, v158, v11
  v_mul_f32 v159, v159, v11
  v_mul_f32 v160, v160, v10
  v_mul_f32 v161, v161, v10
  v_mul_f32 v162, v162, v10
  v_mul_f32 v163, v163, v10
  v_mul_f32 v164, v164, v11
  v_mul_f32 v165, v165, v11
  v_mul_f32 v166, v166, v11
  v_mul_f32 v167, v167, v11
  s_cmp_lg_u32 s17, 0
  s_cbranch_scc1 w0_322
  s_cmp_lt_u32 s18, 61
  s_cbranch_scc1 pb_323
  s_lshl_b32 s24, s18, 12
  s_add_u32 s24, s24, 46764032
  v_bfe_u32 v4, v8, 0, 5
  v_lshlrev_b32 v15, 7, v4
pb_323:
  s_mov_b32 s23, 300000
wp_324:
  buffer_load_dword v4, v15, s[12:15], s24 offen sc1
  s_waitcnt vmcnt(0)
  v_cmp_gt_u32 vcc, 1, v4
  s_cbranch_vccz wpd_325
  s_sub_u32 s23, s23, 1
  s_cbranch_scc0 wp_324
  s_branch L_exit
wpd_325:
w0_322:
  s_barrier
  s_mov_b32 s23, 300000
Oredo_326:
  s_add_u32 s34, s21, 68157440
  buffer_load_dwordx4 v[80:83], v0, s[12:15], s34 offen offset:0 sc1
  buffer_load_dwordx4 v[84:87], v0, s[12:15], s34 offen offset:1024 sc1
  buffer_load_dwordx4 v[88:91], v0, s[12:15], s34 offen offset:2048 sc1
  buffer_load_dwordx4 v[92:95], v0, s[12:15], s34 offen offset:3072 sc1
  s_add_u32 s34, s34, 16384
  buffer_load_dwordx4 v[96:99], v0, s[12:15], s34 offen offset:0 sc1
  buffer_load_dwordx4 v[100:103], v0, s[12:15], s34 offen offset:1024 sc1
  buffer_load_dwordx4 v[104:107], v0, s[12:15], s34 offen offset:2048 sc1
  buffer_load_dwordx4 v[108:111], v0, s[12:15], s34 offen offset:3072 sc1
  s_lshr_b32 s34, s21, 2
  s_add_u32 s34, s34, 70254592
  buffer_load_dword v128, v9, s[12:15], s34 offen offset:0 sc1
  buffer_load_dword v129, v9, s[12:15], s34 offen offset:256 sc1
  buffer_load_dword v130, v9, s[12:15], s34 offen offset:512 sc1
  buffer_load_dword v131, v9, s[12:15], s34 offen offset:768 sc1
  s_add_u32 s34, s34, 4096
  buffer_load_dword v132, v9, s[12:15], s34 offen offset:0 sc1
  buffer_load_dword v133, v9, s[12:15], s34 offen offset:256 sc1
  buffer_load_dword v134, v9, s[12:15], s34 offen offset:512 sc1
  buffer_load_dword v135, v9, s[12:15], s34 offen offset:768 sc1
  s_lshr_b32 s34, s27, 2
  s_add_u32 s34, s34, 47185920
  buffer_load_dword v112, v9, s[12:15], s34 offen offset:0 sc1
  buffer_load_dword v113, v9, s[12:15], s34 offen offset:1024 sc1
  buffer_load_dword v114, v9, s[12:15], s34 offen offset:2048 sc1
  buffer_load_dword v115, v9, s[12:15], s34 offen offset:3072 sc1
  s_add_u32 s34, s34, 4096
  buffer_load_dword v116, v9, s[12:15], s34 offen offset:0 sc1
  buffer_load_dword v117, v9, s[12:15], s34 offen offset:1024 sc1
  buffer_load_dword v118, v9, s[12:15], s34 offen offset:2048 sc1
  buffer_load_dword v119, v9, s[12:15], s34 offen offset:3072 sc1
  s_add_u32 s34, s34, 4096
  buffer_load_dword v120, v9, s[12:15], s34 offen offset:0 sc1
  buffer_load_dword v121, v9, s[12:15], s34 offen offset:1024 sc1
  buffer_load_dword v122, v9, s[12:15], s34 offen offset:2048 sc1
  buffer_load_dword v123, v9, s[12:15], s34 offen offset:3072 sc1
  s_add_u32 s34, s34, 4096
  buffer_load_dword v124, v9, s[12:15], s34 offen offset:0 sc1
  buffer_load_dword v125, v9, s[12:15], s34 offen offset:1024 sc1
  buffer_load_dword v126, v9, s[12:15], s34 offen offset:2048 sc1
  buffer_load_dword v127, v9, s[12:15], s34 offen offset:3072 sc1
  s_waitcnt vmcnt(31)
  v_mfma_f32_16x16x32_bf16 v[168:171], v[16:19], v[80:83], 0
  v_mfma_f32_16x16x32_bf16 v[176:179], v[32:35], v[80:83], 0
  v_mfma_f32_16x16x32_bf16 v[184:187], v[48:51], v[80:83], 0
  v_mfma_f32_16x16x32_bf16 v[192:195], v[64:67], v[80:83], 0
  s_waitcnt vmcnt(30)
  v_mfma_f32_16x16x32_bf16 v[168:171], v[20:23], v[84:87], v[168:171]
  v_mfma_f32_16x16x32_bf16 v[176:179], v[36:39], v[84:87], v[176:179]
  v_mfma_f32_16x16x32_bf16 v[184:187], v[52:55], v[84:87], v[184:187]
  v_mfma_f32_16x16x32_bf16 v[192:195], v[68:71], v[84:87], v[192:195]
  s_waitcnt vmcnt(29)
  v_mfma_f32_16x16x32_bf16 v[168:171], v[24:27], v[88:91], v[168:171]
  v_mfma_f32_16x16x32_bf16 v[176:179], v[40:43], v[88:91], v[176:179]
  v_mfma_f32_16x16x32_bf16 v[184:187], v[56:59], v[88:91], v[184:187]
  v_mfma_f32_16x16x32_bf16 v[192:195], v[72:75], v[88:91], v[192:195]
  s_waitcnt vmcnt(28)
  v_mfma_f32_16x16x32_bf16 v[168:171], v[28:31], v[92:95], v[168:171]
  v_mfma_f32_16x16x32_bf16 v[176:179], v[44:47], v[92:95], v[176:179]
  v_mfma_f32_16x16x32_bf16 v[184:187], v[60:63], v[92:95], v[184:187]
  v_mfma_f32_16x16x32_bf16 v[192:195], v[76:79], v[92:95], v[192:195]
  s_waitcnt vmcnt(27)
  v_mfma_f32_16x16x32_bf16 v[172:175], v[16:19], v[96:99], 0
  v_mfma_f32_16x16x32_bf16 v[180:183], v[32:35], v[96:99], 0
  v_mfma_f32_16x16x32_bf16 v[188:191], v[48:51], v[96:99], 0
  v_mfma_f32_16x16x32_bf16 v[196:199], v[64:67], v[96:99], 0
  s_waitcnt vmcnt(26)
  v_mfma_f32_16x16x32_bf16 v[172:175], v[20:23], v[100:103], v[172:175]
  v_mfma_f32_16x16x32_bf16 v[180:183], v[36:39], v[100:103], v[180:183]
  v_mfma_f32_16x16x32_bf16 v[188:191], v[52:55], v[100:103], v[188:191]
  v_mfma_f32_16x16x32_bf16 v[196:199], v[68:71], v[100:103], v[196:199]
  s_waitcnt vmcnt(25)
  v_mfma_f32_16x16x32_bf16 v[172:175], v[24:27], v[104:107], v[172:175]
  v_mfma_f32_16x16x32_bf16 v[180:183], v[40:43], v[104:107], v[180:183]
  v_mfma_f32_16x16x32_bf16 v[188:191], v[56:59], v[104:107], v[188:191]
  v_mfma_f32_16x16x32_bf16 v[196:199], v[72:75], v[104:107], v[196:199]
  s_waitcnt vmcnt(24)
  v_mfma_f32_16x16x32_bf16 v[172:175], v[28:31], v[108:111], v[172:175]
  v_mfma_f32_16x16x32_bf16 v[180:183], v[44:47], v[108:111], v[180:183]
  v_mfma_f32_16x16x32_bf16 v[188:191], v[60:63], v[108:111], v[188:191]
  v_mfma_f32_16x16x32_bf16 v[196:199], v[76:79], v[108:111], v[196:199]
  s_waitcnt vmcnt(12)
  v_mfma_f32_16x16x32_bf16 v[168:171], v[112:115], v[128:131], v[168:171]
  v_mfma_f32_16x16x32_bf16 v[172:175], v[112:115], v[132:135], v[172:175]
  s_waitcnt vmcnt(8)
  v_mfma_f32_16x16x32_bf16 v[176:179], v[116:119], v[128:131], v[176:179]
  v_mfma_f32_16x16x32_bf16 v[180:183], v[116:119], v[132:135], v[180:183]
  s_waitcnt vmcnt(4)
  v_mfma_f32_16x16x32_bf16 v[184:187], v[120:123], v[128:131], v[184:187]
  v_mfma_f32_16x16x32_bf16 v[188:191], v[120:123], v[132:135], v[188:191]
  s_waitcnt vmcnt(0)
  v_mfma_f32_16x16x32_bf16 v[192:195], v[124:127], v[128:131], v[192:195]
  v_mfma_f32_16x16x32_bf16 v[196:199], v[124:127], v[132:135], v[196:199]
  v_maximum3_f32 v4, v172, v168, v169
  v_maximum3_f32 v4, v4, v170, v171
  v_maximum3_f32 v4, v4, v176, v177
  v_maximum3_f32 v4, v4, v178, v179
  v_maximum3_f32 v4, v4, v184, v185
  v_maximum3_f32 v4, v4, v186, v187
  v_maximum3_f32 v4, v4, v192, v193
  v_maximum3_f32 v4, v4, v194, v195
  v_cmp_u_f32 vcc, v4, v4
  s_cbranch_vccnz Onan_327
Onb_328:
  v_fmac_f32 v136, v168, v200
  v_fmac_f32 v137, v169, v200
  v_fmac_f32 v138, v170, v200
  v_fmac_f32 v139, v171, v200
  ds_write_b128 v12, v[136:139] offset:0
  v_fmac_f32 v140, v172, v201
  v_fmac_f32 v141, v173, v201
  v_fmac_f32 v142, v174, v201
  v_fmac_f32 v143, v175, v201
  ds_write_b128 v12, v[140:143] offset:1024
  v_fmac_f32 v144, v176, v200
  v_fmac_f32 v145, v177, v200
  v_fmac_f32 v146, v178, v200
  v_fmac_f32 v147, v179, v200
  ds_write_b128 v12, v[144:147] offset:2048
  v_fmac_f32 v148, v180, v201
  v_fmac_f32 v149, v181, v201
  v_fmac_f32 v150, v182, v201
  v_fmac_f32 v151, v183, v201
  ds_write_b128 v12, v[148:151] offset:3072
  v_fmac_f32 v152, v184, v200
  v_fmac_f32 v153, v185, v200
  v_fmac_f32 v154, v186, v200
  v_fmac_f32 v155, v187, v200
  ds_write_b128 v12, v[152:155] offset:4096
  v_fmac_f32 v156, v188, v201
  v_fmac_f32 v157, v189, v201
  v_fmac_f32 v158, v190, v201
  v_fmac_f32 v159, v191, v201
  ds_write_b128 v12, v[156:159] offset:5120
  v_fmac_f32 v160, v192, v200
  v_fmac_f32 v161, v193, v200
  v_fmac_f32 v162, v194, v200
  v_fmac_f32 v163, v195, v200
  ds_write_b128 v12, v[160:163] offset:6144
  v_fmac_f32 v164, v196, v201
  v_fmac_f32 v165, v197, v201
  v_fmac_f32 v166, v198, v201
  v_fmac_f32 v167, v199, v201
  ds_write_b128 v12, v[164:167] offset:7168
  s_mul_i32 s22, s18, 28672
  s_waitcnt lgkmcnt(0)
  s_barrier
  ds_read_b128 v[168:171], v13 offset:0
  ds_read_b128 v[172:175], v13 offset:8192
  ds_read_b128 v[176:179], v13 offset:16384
  ds_read_b128 v[180:183], v13 offset:24576
  ds_read_b128 v[184:187], v13 offset:1024
  ds_read_b128 v[188:191], v13 offset:9216
  ds_read_b128 v[192:195], v13 offset:17408
  ds_read_b128 v[196:199], v13 offset:25600
  s_waitcnt lgkmcnt(4)
  v_pk_add_f32 v[168:169], v[168:169], v[172:173]
  v_pk_add_f32 v[170:171], v[170:171], v[174:175]
  v_pk_add_f32 v[176:177], v[176:177], v[180:181]
  v_pk_add_f32 v[178:179], v[178:179], v[182:183]
  v_pk_add_f32 v[168:169], v[168:169], v[176:177]
  v_pk_add_f32 v[170:171], v[170:171], v[178:179]
  v_cvt_pk_bf16_f32 v168, v168, v169
  v_cvt_pk_bf16_f32 v169, v170, v171
  buffer_store_dwordx2 v[168:169], v14, s[8:11], s22 offen offset:0
  s_waitcnt lgkmcnt(0)
  v_pk_add_f32 v[184:185], v[184:185], v[188:189]
  v_pk_add_f32 v[186:187], v[186:187], v[190:191]
  v_pk_add_f32 v[192:193], v[192:193], v[196:197]
  v_pk_add_f32 v[194:195], v[194:195], v[198:199]
  v_pk_add_f32 v[184:185], v[184:185], v[192:193]
  v_pk_add_f32 v[186:187], v[186:187], v[194:195]
  v_cvt_pk_bf16_f32 v184, v184, v185
  v_cvt_pk_bf16_f32 v185, v186, v187
  buffer_store_dwordx2 v[184:185], v14, s[8:11], s22 offen offset:3584
  s_add_u32 s18, s18, 6
  s_cmp_lt_u32 s18, 64
  s_cbranch_scc1 Otop_318
  s_branch L_fin
Onan_327:
  v_max_u32 v4, v80, v81
  v_max3_u32 v4, v4, v82, v83
  v_max3_u32 v4, v4, v84, v85
  v_max3_u32 v4, v4, v86, v87
  v_max3_u32 v4, v4, v88, v89
  v_max3_u32 v4, v4, v90, v91
  v_max3_u32 v4, v4, v92, v93
  v_max3_u32 v4, v4, v94, v95
  v_max3_u32 v4, v4, v96, v97
  v_max3_u32 v4, v4, v98, v99
  v_max3_u32 v4, v4, v100, v101
  v_max3_u32 v4, v4, v102, v103
  v_max3_u32 v4, v4, v104, v105
  v_max3_u32 v4, v4, v106, v107
  v_max3_u32 v4, v4, v108, v109
  v_max3_u32 v4, v4, v110, v111
  v_max3_u32 v4, v4, v112, v113
  v_max3_u32 v4, v4, v114, v115
  v_max3_u32 v4, v4, v116, v117
  v_max3_u32 v4, v4, v118, v119
  v_max3_u32 v4, v4, v120, v121
  v_max3_u32 v4, v4, v122, v123
  v_max3_u32 v4, v4, v124, v125
  v_max3_u32 v4, v4, v126, v127
  v_max3_u32 v4, v4, v128, v129
  v_max3_u32 v4, v4, v130, v131
  v_max3_u32 v4, v4, v132, v133
  v_max3_u32 v4, v4, v134, v135
  v_cmp_eq_u32 vcc, -1, v4
  s_cbranch_vccz Onb_328
  s_add_u32 s42, s42, 1
  s_sub_u32 s23, s23, 1
  s_cbranch_scc0 Oredo_326
  s_branch L_exit
L_fin:
L_exit:
  s_endpgm
.section .rodata,"a"
.p2align 6
.amdhsa_kernel gated_mix__softmax_full_mha__memory_aug_recurrent_mem_tr__prompt_kernel
  .amdhsa_next_free_vgpr 512
  .amdhsa_next_free_sgpr 102
  .amdhsa_accum_offset 256
  .amdhsa_group_segment_fixed_size 0
  .amdhsa_kernarg_size 112
  .amdhsa_user_sgpr_count 2
  .amdhsa_user_sgpr_kernarg_segment_ptr 1
  .amdhsa_system_sgpr_workgroup_id_x 1
.end_amdhsa_kernel
```
